```python
import torch

def _softmax(x, axis=-1):
    return torch.softmax(x, dim=axis)
def _gelu(x):
    return torch.nn.functional.gelu(x, approximate="tanh")
def _silu(x):
    return torch.nn.functional.silu(x)
def _sigmoid(x):
    return torch.sigmoid(x)
def _layernorm(x, axis=-1, eps=1e-5):
    m = x.mean(dim=axis, keepdim=True)
    v = x.var(dim=axis, keepdim=True, unbiased=False)
    return (x - m) / torch.sqrt(v + eps)
def _scatter_add(tgt, idx, src, axis=0):
    return tgt.clone().index_add_(axis, idx, src)
def _segment_sum(src, seg, n):
    out = torch.zeros((n,) + src.shape[1:], dtype=src.dtype)
    return out.index_add_(0, seg, src)
def _pad(x, pw):
    flat = tuple(v for pair in reversed(pw) for v in pair)
    return torch.nn.functional.pad(x, flat)

kernel_name = 'gated_mix__ssm_conv_h3__glu_gated_glu__prompt'

def setup_inputs():

    _w = (lambda a: (lambda t: t.to(torch.bfloat16) if t.is_floating_point() else t)(torch.as_tensor(a)))
    def _A_setup():
        B, S, D = 1, 2048, 576
        ks = 4
        return {
            "q": _w((lambda *s: torch.randn(*s, dtype=torch.bfloat16) * 0.05)(B, S, D)),
            "k": _w((lambda *s: torch.randn(*s, dtype=torch.bfloat16) * 0.8)(B, S, D)),
            "v": _w((lambda *s: torch.randn(*s, dtype=torch.bfloat16) * 0.8)(B, S, D)),
            "shift_k": _w((lambda *s: torch.randn(*s, dtype=torch.bfloat16) * 0.8)(D, ks) * 0.5),
            "ssm_k": _w((lambda *s: torch.randn(*s, dtype=torch.bfloat16) * 0.8)(D, S) * (1.0 / S ** 0.5)),
            "ssm_D": _w((lambda *s: torch.randn(*s, dtype=torch.bfloat16) * 0.8)(D)),
        }
    _A_in = _A_setup()

    def _B_setup():
        B, S, D, F = 1, 2048, 576, 4608
        return {
            "x": _w((lambda *s: torch.randn(*s, dtype=torch.bfloat16) * 0.05)(B, S, D)),
            "w_gate": _w((lambda *s: torch.randn(*s, dtype=torch.bfloat16) * 0.4)(D, F)),
            "w_up": _w((lambda *s: torch.randn(*s, dtype=torch.bfloat16) * 0.05)(D, F)),
            "w_down": _w((lambda *s: torch.randn(*s, dtype=torch.bfloat16) * 0.05)(F, D)),
        }
    _B_in = _B_setup()

    return {
        "A_q": _A_in["q"],
        "A_k": _A_in["k"],
        "A_v": _A_in["v"],
        "A_shift_k": _A_in["shift_k"],
        "A_ssm_k": _A_in["ssm_k"],
        "A_ssm_D": _A_in["ssm_D"],
        "B_x": _B_in["x"],
        "B_w_gate": _B_in["w_gate"],
        "B_w_up": _B_in["w_up"],
        "B_w_down": _B_in["w_down"],
        "gate_w": _w((lambda *s: torch.randn(*s, dtype=torch.bfloat16) * 0.05)(576) * 16.0),
    }

def reference(A_q, A_k, A_v, A_shift_k, A_ssm_k, A_ssm_D, B_x, B_w_gate, B_w_up, B_w_down, gate_w):
    def _A_ref(q, k, v, shift_k, ssm_k, ssm_D):
        B, S, D = q.shape
        ks = shift_k.shape[-1]
        k_pad = _pad(k, ((0, 0), (ks - 1, 0), (0, 0)))
        k_shift = torch.zeros_like(k)
        for t in range(ks):
            k_shift = k_shift + k_pad[:, t:t + S, :] * shift_k[:, ks - 1 - t][None, None, :]
        kv = k_shift * v
        L = 2 * S
        kv_pad = _pad(kv, ((0, 0), (0, S), (0, 0)))
        kf_pad = _pad(ssm_k, ((0, 0), (0, S)))
        kv_f = (lambda x, axes=(-2,-1): torch.fft.rfft2(x.float(), dim=axes))(kv_pad[:, None, :, :], axes=(1, 2))
        kf_f = (lambda x, axes=(-2,-1): torch.fft.rfft2(x.float(), dim=axes))(kf_pad[:, None, :], axes=(1, 2))
        kf_f = (lambda x, *d: x.permute(*d))(kf_f, 1, 2, 0)
        y_f = kv_f * kf_f[None, :, :, :]
        y = (lambda x, s, axes=(-2,-1): torch.fft.irfft2(x, s=s, dim=axes).to(torch.bfloat16))(y_f, (1, L), axes=(1, 2))[:, 0, :S, :]
        y = y + kv * ssm_D[None, None, :]
        return q * y

    def _B_ref(x, w_gate, w_up, w_down):
        g = torch.einsum("bsd,df->bsf", x, w_gate)
        u = torch.einsum("bsd,df->bsf", x, w_up)
        h = _sigmoid(g) * u
        return torch.einsum("bsf,fd->bsd", h, w_down)

    x = A_q
    g = _sigmoid((x * gate_w).sum(-1, keepdims=True))
    a = _A_ref(x, A_k, A_v, A_shift_k, A_ssm_k, A_ssm_D)
    b = _B_ref(x, B_w_gate, B_w_up, B_w_down)
    return g * a + (1 - g) * b
```

```asm
; @launch grid=(256,1,1) block=(256,1,1) lds=163840
.amdgcn_target "amdgcn-amd-amdhsa--gfx950"
.text
.globl gated_mix__ssm_conv_h3__glu_gated_glu__prompt_kernel
.p2align 8
.type gated_mix__ssm_conv_h3__glu_gated_glu__prompt_kernel,@function
gated_mix__ssm_conv_h3__glu_gated_glu__prompt_kernel:
    s_cmp_ge_u32 s2, 256
    s_cbranch_scc1 L_end
    s_load_dwordx16 s[68:83], s[0:1], 0
    s_load_dwordx8 s[88:95], s[0:1], 64
    s_load_dwordx4 s[96:99], s[0:1], 96
    s_getpc_b64 s[100:101]
    s_lshr_b32 s36, s2, 3
    s_mul_i32 s36, s36, 2560
    v_lshrrev_b32 v46, 4, v0
    v_min_u32 v47, 4, v0
    v_cmp_gt_u32 vcc, 8, v0
    v_add_u32 v47, 15, v47
    s_nop 0
    v_cndmask_b32 v46, v46, v47, vcc
    v_lshl_add_u32 v46, v46, 7, s36
    v_min_u32 v46, (L_code_end - gated_mix__ssm_conv_h3__glu_gated_glu__prompt_kernel - 1024), v46
    global_load_dword v16, v46, s[100:101]
    v_lshrrev_b32 v8, 6, v0
    v_and_b32 v1, 63, v0
    v_readfirstlane_b32 s32, v8
    s_and_b32 s41, s2, 3
    s_lshr_b32 s36, s2, 3
    s_and_b32 s42, s36, 3
    s_lshr_b32 s43, s36, 2
    s_and_b32 s40, s2, 4
    s_lshl_b32 s40, s40, 1
    s_add_u32 s40, s40, s43
    s_mul_i32 s45, s42, 2
    s_add_u32 s45, s45, s43
    s_cmp_ge_u32 s45, 9
    s_cselect_b32 s37, 9, 0
    s_sub_u32 s45, s45, s37
    s_mul_i32 s34, s41, 2304
    s_lshl_b32 s36, s42, 7
    s_movk_i32 s3, 384
    s_cmp_eq_u32 s42, 3
    s_cselect_b32 s36, 1920, s36
    s_cselect_b32 s3, 128, s3
    s_add_u32 s34, s34, s36
    s_mul_i32 s33, s32, 4128
    s_lshl_b32 s44, s32, 12
    v_lshrrev_b32 v9, 3, v1
    v_and_b32 v10, 7, v1
    v_lshl_add_u32 v11, v9, 3, v8
    v_mul_u32_u24 v11, 9216, v11
    v_lshl_add_u32 v11, v10, 4, v11
    v_add_u32 v2, 4096, v11
    v_add_u32 v3, 39936, v11
    s_lshl_b32 s36, s40, 7
    s_lshl_b32 s37, s32, 5
    s_add_u32 s36, s36, s37
    v_add_u32 v11, s36, v9
    v_mul_u32_u24 v11, 1152, v11
    v_lshrrev_b32 v12, 1, v9
    v_xor_b32 v12, v12, v10
    v_lshl_add_u32 v13, v12, 4, v11
    v_xor_b32 v12, 4, v12
    v_lshl_add_u32 v14, v12, 4, v11
    v_add_u32 v160, 4096, v13
    v_add_u32 v161, 12288, v14
    v_add_u32 v162, 20480, v13
    v_add_u32 v163, 28672, v14
    s_lshl_b32 s48, s45, 7
    s_mul_i32 s57, s48, 4608
    s_add_u32 s36, s48, 128
    s_cmp_ge_u32 s36, 1152
    s_cselect_b32 s49, 0, s36
    s_mul_i32 s58, s49, 4608
    s_add_u32 s36, s49, 128
    s_cmp_ge_u32 s36, 1152
    s_cselect_b32 s50, 0, s36
    s_mul_i32 s59, s50, 4608
    s_waitcnt lgkmcnt(0)
    s_sub_u32 s12, s68, 4096
    s_subb_u32 s13, s69, 0
    s_and_b32 s13, s13, 0xffff
    s_mov_b32 s14, 2363392
    s_mov_b32 s15, 0x20000
    s_sub_u32 s4, s82, 4096
    s_subb_u32 s5, s83, 0
    s_and_b32 s5, s5, 0xffff
    s_mov_b32 s6, 5312512
    s_mov_b32 s7, 0x20000
    s_sub_u32 s8, s88, 6144
    s_subb_u32 s9, s89, 0
    s_and_b32 s9, s9, 0xffff
    s_mov_b32 s10, 5314560
    s_mov_b32 s11, 0x20000
    s_add_u32 m0, s44, 0
    s_nop 0
    buffer_load_dwordx4 v160, s[12:15], s48 offen offset:0 lds
    buffer_load_dwordx4 v161, s[12:15], s48 offen offset:1024 lds
    buffer_load_dwordx4 v162, s[12:15], s48 offen offset:2048 lds
    buffer_load_dwordx4 v163, s[12:15], s48 offen offset:3072 lds
    s_add_u32 m0, s33, 16384
    s_add_u32 s47, s34, s57
    buffer_load_dwordx4 v2, s[4:7], s47 offen offset:0 lds
    buffer_load_dwordx4 v3, s[4:7], s47 offen offset:1024 lds
    buffer_load_dwordx4 v2, s[8:11], s47 offen offset:2048 lds
    buffer_load_dwordx4 v3, s[8:11], s47 offen offset:3072 lds
    s_add_u32 m0, s44, 32896
    s_nop 0
    buffer_load_dwordx4 v160, s[12:15], s49 offen offset:0 lds
    buffer_load_dwordx4 v161, s[12:15], s49 offen offset:1024 lds
    buffer_load_dwordx4 v162, s[12:15], s49 offen offset:2048 lds
    buffer_load_dwordx4 v163, s[12:15], s49 offen offset:3072 lds
    s_add_u32 m0, s33, 49280
    s_add_u32 s47, s34, s58
    buffer_load_dwordx4 v2, s[4:7], s47 offen offset:0 lds
    buffer_load_dwordx4 v3, s[4:7], s47 offen offset:1024 lds
    buffer_load_dwordx4 v2, s[8:11], s47 offen offset:2048 lds
    buffer_load_dwordx4 v3, s[8:11], s47 offen offset:3072 lds
    s_add_u32 s36, s50, 128
    s_cmp_ge_u32 s36, 1152
    s_cselect_b32 s51, 0, s36
    s_mul_i32 s60, s51, 4608
    s_add_u32 s36, s51, 128
    s_cmp_ge_u32 s36, 1152
    s_cselect_b32 s52, 0, s36
    s_mul_i32 s61, s52, 4608
    s_add_u32 s36, s52, 128
    s_cmp_ge_u32 s36, 1152
    s_cselect_b32 s53, 0, s36
    s_mul_i32 s62, s53, 4608
    s_add_u32 s36, s53, 128
    s_cmp_ge_u32 s36, 1152
    s_cselect_b32 s54, 0, s36
    s_mul_i32 s63, s54, 4608
    s_add_u32 s36, s54, 128
    s_cmp_ge_u32 s36, 1152
    s_cselect_b32 s55, 0, s36
    s_mul_i32 s64, s55, 4608
    s_add_u32 s36, s55, 128
    s_cmp_ge_u32 s36, 1152
    s_cselect_b32 s56, 0, s36
    s_mul_i32 s65, s56, 4608
    v_bfe_u32 v36, v1, 2, 2
    v_mul_u32_u24 v4, 4128, v36
    v_lshrrev_b32 v37, 4, v1
    v_lshl_add_u32 v4, v37, 7, v4
    v_lshrrev_b32 v38, 1, v8
    v_lshl_add_u32 v4, v38, 6, v4
    v_and_b32 v39, 3, v1
    v_lshl_add_u32 v4, v39, 3, v4
    v_add_u32 v5, 0x10000, v4
    v_add_u32 v6, 0x20000, v4
    v_and_b32 v40, 15, v1
    v_and_b32 v41, 1, v8
    v_lshl_add_u32 v42, v41, 6, v40
    v_lshlrev_b32 v42, 7, v42
    v_lshrrev_b32 v43, 1, v40
    v_xor_b32 v43, v43, v37
    v_lshl_add_u32 v164, v43, 4, v42
    v_xor_b32 v165, 64, v164
    v_add_u32 v166, 0x10000, v164
    v_add_u32 v167, 0x10000, v165
    v_add_u32 v168, 0x20000, v164
    v_add_u32 v169, 0x20000, v165
    v_lshl_add_u32 v42, v8, 5, v40
    v_lshlrev_b32 v42, 7, v42
    v_lshrrev_b32 v43, 1, v40
    v_lshrrev_b32 v45, 1, v37
    s_lshl_b32 s36, s41, 1
    v_add_u32 v45, s36, v45
    v_xor_b32 v43, v43, v45
    v_lshl_add_u32 v42, v43, 4, v42
    v_and_b32 v43, 1, v37
    v_lshl_add_u32 v170, v43, 3, v42
    v_add_u32 v171, 0x10000, v170
    v_add_u32 v172, 0x20000, v170
    s_mul_i32 s46, s42, 384
    s_mul_i32 s38, s34, 576
    v_mov_b32 v44, 2147483632
    v_cmp_eq_u32 vcc, 0, v0
    s_nop 1
    v_cndmask_b32 v63, v44, 0, vcc
    s_mov_b32 s16, s98
    s_and_b32 s17, s99, 0xffff
    s_mov_b32 s18, 268435456
    s_mov_b32 s19, 0x20000
    s_mov_b32 s80, s96
    s_and_b32 s81, s97, 0xffff
    s_mov_b32 s82, 256
    s_mov_b32 s83, 0x20000
    s_cmp_eq_u32 s2, 0
    s_cbranch_scc1 L_tag
L_tag_ret:
    s_mul_i32 s96, s3, 576
    s_mov_b32 s97, s38
    s_lshl_b32 s36, s40, 2
    s_add_u32 s36, s36, s41
    s_lshl_b32 s36, s36, 12
    s_add_u32 s36, s36, 786432
    v_lshl_add_u32 v15, v39, 10, s36
    s_lshl_b32 s37, s43, 14
    v_subrev_u32 v60, s37, v15
    v_bfe_u32 v45, v1, 2, 3
    v_lshl_add_u32 v60, v45, 14, v60
    s_lshl_b32 s37, s42, 10
    s_add_u32 s36, s36, s37
    s_cmp_eq_u32 s32, 0
    s_cselect_b32 s36, s36, 0x40000000
    v_and_b32 v45, 31, v1
    v_lshl_add_u32 v62, v45, 2, s36
    v_mov_b32 v61, 0
    s_mov_b32 s39, 0xbfb8aa3b
    s_lshr_b32 s36, s40, 2
    s_mul_i32 s36, s36, 5308416
    s_and_b32 s37, s40, 3
    s_lshl_b32 s37, s37, 13
    s_add_u32 s36, s36, s37
    s_add_u32 s36, s36, 25165824
    v_lshl_add_u32 v43, v1, 4, s36
    v_mul_u32_u24 v42, 36864, v38
    v_lshl_add_u32 v42, v41, 12, v42
    v_add_u32 v7, v42, v43
    s_mul_i32 s37, s41, 1327104
    v_lshl_add_u32 v14, v8, 11, v43
    v_add_u32 v14, s37, v14
    s_sub_u32 s20, s90, 4096
    s_subb_u32 s21, s91, 0
    s_and_b32 s21, s21, 0xffff
    s_mov_b32 s22, 5312512
    s_mov_b32 s23, 0x20000
    v_lshl_add_u32 v12, v9, 2, v8
    v_mul_u32_u24 v12, 1152, v12
    s_lshl_b32 s36, s41, 1
    v_xor_b32 v13, s36, v10
    v_lshl_add_u32 v12, v13, 4, v12
    s_mul_i32 s36, s42, 384
    s_add_u32 s36, s36, s37
    s_add_u32 s36, s36, 4096
    v_add_u32 v11, s36, v12
    v_subrev_u32 v12, 896, v11
    v_subrev_u32 v13, 1792, v11
    v_lshlrev_b32 v18, 6, v38
    v_lshl_add_u32 v18, v36, 10, v18
    s_waitcnt vmcnt(8)
    s_barrier
    ds_read_b64_tr_b16 v[20:21], v4 offset:16384
    ds_read_b128 a[0:3], v164 offset:0
    ds_read_b64_tr_b16 v[22:23], v4 offset:17408
    ds_read_b128 a[4:7], v164 offset:2048
    ds_read_b128 a[8:11], v164 offset:4096
    ds_read_b128 a[12:15], v164 offset:6144
    ds_read_b64_tr_b16 v[24:25], v4 offset:16416
    ds_read_b64_tr_b16 v[26:27], v4 offset:17440
    ds_read_b64_tr_b16 v[28:29], v4 offset:18432
    ds_read_b64_tr_b16 v[30:31], v4 offset:19456
    s_sub_u32 s101, s48, s46
    s_cmp_lt_u32 s101, 384
    s_cbranch_scc1 L_q0
L_qr0:
    s_waitcnt lgkmcnt(7)
    v_mfma_f32_16x16x32_bf16 v[96:99], v[20:23], a[0:3], 0
    ds_read_b64_tr_b16 v[32:33], v4 offset:18464
    s_add_u32 m0, s44, 65792
    s_waitcnt lgkmcnt(7)
    v_mfma_f32_16x16x32_bf16 v[112:115], v[20:23], a[4:7], 0
    ds_read_b64_tr_b16 v[34:35], v4 offset:19488
    s_waitcnt lgkmcnt(7)
    v_mfma_f32_16x16x32_bf16 v[128:131], v[20:23], a[8:11], 0
    buffer_load_dwordx4 v160, s[12:15], s50 offen offset:0 lds
    s_waitcnt lgkmcnt(6)
    v_mfma_f32_16x16x32_bf16 v[144:147], v[20:23], a[12:15], 0
    buffer_load_dwordx4 v161, s[12:15], s50 offen offset:1024 lds
    s_waitcnt lgkmcnt(4)
    v_mfma_f32_16x16x32_bf16 v[148:151], v[24:27], a[12:15], 0
    ds_read_b64_tr_b16 v[20:21], v4 offset:16896
    v_mfma_f32_16x16x32_bf16 v[132:135], v[24:27], a[8:11], 0
    ds_read_b64_tr_b16 v[22:23], v4 offset:17920
    v_mfma_f32_16x16x32_bf16 v[116:119], v[24:27], a[4:7], 0
    ds_read_b128 a[16:19], v165 offset:0
    ds_read_b128 a[20:23], v165 offset:2048
    v_mfma_f32_16x16x32_bf16 v[100:103], v[24:27], a[0:3], 0
    buffer_load_dwordx4 v162, s[12:15], s50 offen offset:2048 lds
    s_waitcnt lgkmcnt(6)
    v_mfma_f32_16x16x32_bf16 v[104:107], v[28:31], a[0:3], 0
    ds_read_b64_tr_b16 v[24:25], v4 offset:16928
    v_mfma_f32_16x16x32_bf16 v[120:123], v[28:31], a[4:7], 0
    ds_read_b64_tr_b16 v[26:27], v4 offset:17952
    v_mfma_f32_16x16x32_bf16 v[136:139], v[28:31], a[8:11], 0
    ds_read_b128 a[24:27], v165 offset:4096
    ds_read_b128 a[28:31], v165 offset:6144
    v_mfma_f32_16x16x32_bf16 v[152:155], v[28:31], a[12:15], 0
    buffer_load_dwordx4 v163, s[12:15], s50 offen offset:3072 lds
    s_waitcnt lgkmcnt(8)
    v_mfma_f32_16x16x32_bf16 v[156:159], v[32:35], a[12:15], 0
    ds_read_b64_tr_b16 v[28:29], v4 offset:18944
    s_add_u32 m0, s33, 82176
    v_mfma_f32_16x16x32_bf16 v[140:143], v[32:35], a[8:11], 0
    ds_read_b64_tr_b16 v[30:31], v4 offset:19968
    s_add_u32 s47, s34, s59
    v_mfma_f32_16x16x32_bf16 v[124:127], v[32:35], a[4:7], 0
    buffer_load_dwordx4 v2, s[4:7], s47 offen offset:0 lds
    v_mfma_f32_16x16x32_bf16 v[108:111], v[32:35], a[0:3], 0
    buffer_load_dwordx4 v3, s[4:7], s47 offen offset:1024 lds
    s_waitcnt lgkmcnt(7)
    v_mfma_f32_16x16x32_bf16 v[96:99], v[20:23], a[16:19], v[96:99]
    ds_read_b64_tr_b16 v[32:33], v4 offset:18976
    s_waitcnt lgkmcnt(7)
    v_mfma_f32_16x16x32_bf16 v[112:115], v[20:23], a[20:23], v[112:115]
    ds_read_b64_tr_b16 v[34:35], v4 offset:20000
    s_waitcnt lgkmcnt(5)
    v_mfma_f32_16x16x32_bf16 v[128:131], v[20:23], a[24:27], v[128:131]
    buffer_load_dwordx4 v2, s[8:11], s47 offen offset:2048 lds
    s_waitcnt lgkmcnt(4)
    v_mfma_f32_16x16x32_bf16 v[144:147], v[20:23], a[28:31], v[144:147]
    buffer_load_dwordx4 v3, s[8:11], s47 offen offset:3072 lds
    v_mfma_f32_16x16x32_bf16 v[148:151], v[24:27], a[28:31], v[148:151]
    s_waitcnt vmcnt(8)
    s_barrier
    ds_read_b64_tr_b16 v[20:21], v4 offset:49280
    s_add_u32 m0, s44, 98688
    v_mfma_f32_16x16x32_bf16 v[132:135], v[24:27], a[24:27], v[132:135]
    ds_read_b64_tr_b16 v[22:23], v4 offset:50304
    v_mfma_f32_16x16x32_bf16 v[116:119], v[24:27], a[20:23], v[116:119]
    ds_read_b128 a[32:35], v164 offset:32896
    ds_read_b128 a[36:39], v164 offset:34944
    v_mfma_f32_16x16x32_bf16 v[100:103], v[24:27], a[16:19], v[100:103]
    buffer_load_dwordx4 v160, s[12:15], s51 offen offset:0 lds
    s_waitcnt lgkmcnt(6)
    v_mfma_f32_16x16x32_bf16 v[104:107], v[28:31], a[16:19], v[104:107]
    ds_read_b64_tr_b16 v[24:25], v4 offset:49312
    v_mfma_f32_16x16x32_bf16 v[120:123], v[28:31], a[20:23], v[120:123]
    ds_read_b64_tr_b16 v[26:27], v4 offset:50336
    v_mfma_f32_16x16x32_bf16 v[136:139], v[28:31], a[24:27], v[136:139]
    ds_read_b128 a[40:43], v164 offset:36992
    ds_read_b128 a[44:47], v164 offset:39040
    v_mfma_f32_16x16x32_bf16 v[152:155], v[28:31], a[28:31], v[152:155]
    buffer_load_dwordx4 v161, s[12:15], s51 offen offset:1024 lds
    s_waitcnt lgkmcnt(8)
    v_mfma_f32_16x16x32_bf16 v[156:159], v[32:35], a[28:31], v[156:159]
    ds_read_b64_tr_b16 v[28:29], v4 offset:51328
    v_mfma_f32_16x16x32_bf16 v[140:143], v[32:35], a[24:27], v[140:143]
    ds_read_b64_tr_b16 v[30:31], v4 offset:52352
    v_mfma_f32_16x16x32_bf16 v[124:127], v[32:35], a[20:23], v[124:127]
    buffer_load_dwordx4 v162, s[12:15], s51 offen offset:2048 lds
    v_mfma_f32_16x16x32_bf16 v[108:111], v[32:35], a[16:19], v[108:111]
    buffer_load_dwordx4 v163, s[12:15], s51 offen offset:3072 lds
    s_sub_u32 s101, s49, s46
    s_cmp_lt_u32 s101, 384
    s_cbranch_scc1 L_q1
L_qr1:
    s_waitcnt lgkmcnt(7)
    v_mfma_f32_16x16x32_bf16 v[96:99], v[20:23], a[32:35], v[96:99]
    ds_read_b64_tr_b16 v[32:33], v4 offset:51360
    s_add_u32 m0, s33, 115072
    s_waitcnt lgkmcnt(7)
    v_mfma_f32_16x16x32_bf16 v[112:115], v[20:23], a[36:39], v[112:115]
    ds_read_b64_tr_b16 v[34:35], v4 offset:52384
    s_add_u32 s47, s34, s60
    s_waitcnt lgkmcnt(5)
    v_mfma_f32_16x16x32_bf16 v[128:131], v[20:23], a[40:43], v[128:131]
    buffer_load_dwordx4 v2, s[4:7], s47 offen offset:0 lds
    s_waitcnt lgkmcnt(4)
    v_mfma_f32_16x16x32_bf16 v[144:147], v[20:23], a[44:47], v[144:147]
    buffer_load_dwordx4 v3, s[4:7], s47 offen offset:1024 lds
    v_mfma_f32_16x16x32_bf16 v[148:151], v[24:27], a[44:47], v[148:151]
    ds_read_b64_tr_b16 v[20:21], v4 offset:49792
    v_mfma_f32_16x16x32_bf16 v[132:135], v[24:27], a[40:43], v[132:135]
    ds_read_b64_tr_b16 v[22:23], v4 offset:50816
    v_mfma_f32_16x16x32_bf16 v[116:119], v[24:27], a[36:39], v[116:119]
    ds_read_b128 a[48:51], v165 offset:32896
    ds_read_b128 a[52:55], v165 offset:34944
    v_mfma_f32_16x16x32_bf16 v[100:103], v[24:27], a[32:35], v[100:103]
    buffer_load_dwordx4 v2, s[8:11], s47 offen offset:2048 lds
    s_waitcnt lgkmcnt(6)
    v_mfma_f32_16x16x32_bf16 v[104:107], v[28:31], a[32:35], v[104:107]
    ds_read_b64_tr_b16 v[24:25], v4 offset:49824
    v_mfma_f32_16x16x32_bf16 v[120:123], v[28:31], a[36:39], v[120:123]
    ds_read_b64_tr_b16 v[26:27], v4 offset:50848
    v_mfma_f32_16x16x32_bf16 v[136:139], v[28:31], a[40:43], v[136:139]
    ds_read_b128 a[56:59], v165 offset:36992
    ds_read_b128 a[60:63], v165 offset:39040
    v_mfma_f32_16x16x32_bf16 v[152:155], v[28:31], a[44:47], v[152:155]
    buffer_load_dwordx4 v3, s[8:11], s47 offen offset:3072 lds
    s_waitcnt lgkmcnt(8)
    v_mfma_f32_16x16x32_bf16 v[156:159], v[32:35], a[44:47], v[156:159]
    ds_read_b64_tr_b16 v[28:29], v4 offset:51840
    s_add_u32 m0, s44, 131584
    v_mfma_f32_16x16x32_bf16 v[140:143], v[32:35], a[40:43], v[140:143]
    ds_read_b64_tr_b16 v[30:31], v4 offset:52864
    v_mfma_f32_16x16x32_bf16 v[124:127], v[32:35], a[36:39], v[124:127]
    buffer_load_dwordx4 v160, s[12:15], s52 offen offset:0 lds
    v_mfma_f32_16x16x32_bf16 v[108:111], v[32:35], a[32:35], v[108:111]
    buffer_load_dwordx4 v161, s[12:15], s52 offen offset:1024 lds
    s_waitcnt lgkmcnt(7)
    v_mfma_f32_16x16x32_bf16 v[96:99], v[20:23], a[48:51], v[96:99]
    ds_read_b64_tr_b16 v[32:33], v4 offset:51872
    s_waitcnt lgkmcnt(7)
    v_mfma_f32_16x16x32_bf16 v[112:115], v[20:23], a[52:55], v[112:115]
    ds_read_b64_tr_b16 v[34:35], v4 offset:52896
    s_waitcnt lgkmcnt(5)
    v_mfma_f32_16x16x32_bf16 v[128:131], v[20:23], a[56:59], v[128:131]
    buffer_load_dwordx4 v162, s[12:15], s52 offen offset:2048 lds
    s_waitcnt lgkmcnt(4)
    v_mfma_f32_16x16x32_bf16 v[144:147], v[20:23], a[60:63], v[144:147]
    buffer_load_dwordx4 v163, s[12:15], s52 offen offset:3072 lds
    v_mfma_f32_16x16x32_bf16 v[148:151], v[24:27], a[60:63], v[148:151]
    s_waitcnt vmcnt(12)
    s_barrier
    ds_read_b64_tr_b16 v[20:21], v5 offset:16640
    s_add_u32 m0, s33, 0
    v_mfma_f32_16x16x32_bf16 v[132:135], v[24:27], a[56:59], v[132:135]
    ds_read_b64_tr_b16 v[22:23], v5 offset:17664
    s_add_u32 s47, s34, s61
    v_mfma_f32_16x16x32_bf16 v[116:119], v[24:27], a[52:55], v[116:119]
    ds_read_b128 a[64:67], v166 offset:256
    ds_read_b128 a[68:71], v166 offset:2304
    v_mfma_f32_16x16x32_bf16 v[100:103], v[24:27], a[48:51], v[100:103]
    buffer_load_dwordx4 v2, s[4:7], s47 offen offset:0 lds
    s_waitcnt lgkmcnt(6)
    v_mfma_f32_16x16x32_bf16 v[104:107], v[28:31], a[48:51], v[104:107]
    ds_read_b64_tr_b16 v[24:25], v5 offset:16672
    v_mfma_f32_16x16x32_bf16 v[120:123], v[28:31], a[52:55], v[120:123]
    ds_read_b64_tr_b16 v[26:27], v5 offset:17696
    v_mfma_f32_16x16x32_bf16 v[136:139], v[28:31], a[56:59], v[136:139]
    ds_read_b128 a[72:75], v166 offset:4352
    ds_read_b128 a[76:79], v166 offset:6400
    v_mfma_f32_16x16x32_bf16 v[152:155], v[28:31], a[60:63], v[152:155]
    buffer_load_dwordx4 v3, s[4:7], s47 offen offset:1024 lds
    s_waitcnt lgkmcnt(8)
    v_mfma_f32_16x16x32_bf16 v[156:159], v[32:35], a[60:63], v[156:159]
    ds_read_b64_tr_b16 v[28:29], v5 offset:18688
    v_mfma_f32_16x16x32_bf16 v[140:143], v[32:35], a[56:59], v[140:143]
    ds_read_b64_tr_b16 v[30:31], v5 offset:19712
    v_mfma_f32_16x16x32_bf16 v[124:127], v[32:35], a[52:55], v[124:127]
    buffer_load_dwordx4 v2, s[8:11], s47 offen offset:2048 lds
    v_mfma_f32_16x16x32_bf16 v[108:111], v[32:35], a[48:51], v[108:111]
    buffer_load_dwordx4 v3, s[8:11], s47 offen offset:3072 lds
    s_sub_u32 s101, s50, s46
    s_cmp_lt_u32 s101, 384
    s_cbranch_scc1 L_q2
L_qr2:
    s_waitcnt lgkmcnt(7)
    v_mfma_f32_16x16x32_bf16 v[96:99], v[20:23], a[64:67], v[96:99]
    ds_read_b64_tr_b16 v[32:33], v5 offset:18720
    s_add_u32 m0, s44, 16512
    s_waitcnt lgkmcnt(7)
    v_mfma_f32_16x16x32_bf16 v[112:115], v[20:23], a[68:71], v[112:115]
    ds_read_b64_tr_b16 v[34:35], v5 offset:19744
    s_waitcnt lgkmcnt(5)
    v_mfma_f32_16x16x32_bf16 v[128:131], v[20:23], a[72:75], v[128:131]
    buffer_load_dwordx4 v160, s[12:15], s53 offen offset:0 lds
    s_waitcnt lgkmcnt(4)
    v_mfma_f32_16x16x32_bf16 v[144:147], v[20:23], a[76:79], v[144:147]
    buffer_load_dwordx4 v161, s[12:15], s53 offen offset:1024 lds
    v_mfma_f32_16x16x32_bf16 v[148:151], v[24:27], a[76:79], v[148:151]
    ds_read_b64_tr_b16 v[20:21], v5 offset:17152
    v_mfma_f32_16x16x32_bf16 v[132:135], v[24:27], a[72:75], v[132:135]
    ds_read_b64_tr_b16 v[22:23], v5 offset:18176
    v_mfma_f32_16x16x32_bf16 v[116:119], v[24:27], a[68:71], v[116:119]
    ds_read_b128 a[80:83], v167 offset:256
    ds_read_b128 a[84:87], v167 offset:2304
    v_mfma_f32_16x16x32_bf16 v[100:103], v[24:27], a[64:67], v[100:103]
    buffer_load_dwordx4 v162, s[12:15], s53 offen offset:2048 lds
    s_waitcnt lgkmcnt(6)
    v_mfma_f32_16x16x32_bf16 v[104:107], v[28:31], a[64:67], v[104:107]
    ds_read_b64_tr_b16 v[24:25], v5 offset:17184
    v_mfma_f32_16x16x32_bf16 v[120:123], v[28:31], a[68:71], v[120:123]
    ds_read_b64_tr_b16 v[26:27], v5 offset:18208
    v_mfma_f32_16x16x32_bf16 v[136:139], v[28:31], a[72:75], v[136:139]
    ds_read_b128 a[88:91], v167 offset:4352
    ds_read_b128 a[92:95], v167 offset:6400
    v_mfma_f32_16x16x32_bf16 v[152:155], v[28:31], a[76:79], v[152:155]
    buffer_load_dwordx4 v163, s[12:15], s53 offen offset:3072 lds
    s_waitcnt lgkmcnt(8)
    v_mfma_f32_16x16x32_bf16 v[156:159], v[32:35], a[76:79], v[156:159]
    ds_read_b64_tr_b16 v[28:29], v5 offset:19200
    v_mfma_f32_16x16x32_bf16 v[140:143], v[32:35], a[72:75], v[140:143]
    ds_read_b64_tr_b16 v[30:31], v5 offset:20224
    v_mfma_f32_16x16x32_bf16 v[124:127], v[32:35], a[68:71], v[124:127]
    s_sub_u32 s24, s70, 4096
    s_subb_u32 s25, s71, 0
    v_mfma_f32_16x16x32_bf16 v[108:111], v[32:35], a[64:67], v[108:111]
    s_and_b32 s25, s25, 0xffff
    s_waitcnt lgkmcnt(7)
    v_mfma_f32_16x16x32_bf16 v[96:99], v[20:23], a[80:83], v[96:99]
    ds_read_b64_tr_b16 v[32:33], v5 offset:19232
    s_mov_b32 s26, 2363392
    s_waitcnt lgkmcnt(7)
    v_mfma_f32_16x16x32_bf16 v[112:115], v[20:23], a[84:87], v[112:115]
    ds_read_b64_tr_b16 v[34:35], v5 offset:20256
    s_mov_b32 s27, 0x20000
    s_waitcnt lgkmcnt(5)
    v_mfma_f32_16x16x32_bf16 v[128:131], v[20:23], a[88:91], v[128:131]
    s_sub_u32 s28, s72, 4096
    s_subb_u32 s29, s73, 0
    s_waitcnt lgkmcnt(4)
    v_mfma_f32_16x16x32_bf16 v[144:147], v[20:23], a[92:95], v[144:147]
    s_and_b32 s29, s29, 0xffff
    v_mfma_f32_16x16x32_bf16 v[148:151], v[24:27], a[92:95], v[148:151]
    s_waitcnt vmcnt(12)
    s_barrier
    ds_read_b64_tr_b16 v[20:21], v5 offset:49536
    s_add_u32 m0, s33, 32896
    v_mfma_f32_16x16x32_bf16 v[132:135], v[24:27], a[88:91], v[132:135]
    ds_read_b64_tr_b16 v[22:23], v5 offset:50560
    s_add_u32 s47, s34, s62
    v_mfma_f32_16x16x32_bf16 v[116:119], v[24:27], a[84:87], v[116:119]
    ds_read_b128 a[96:99], v166 offset:33152
    ds_read_b128 a[100:103], v166 offset:35200
    v_mfma_f32_16x16x32_bf16 v[100:103], v[24:27], a[80:83], v[100:103]
    buffer_load_dwordx4 v2, s[4:7], s47 offen offset:0 lds
    s_waitcnt lgkmcnt(6)
    v_mfma_f32_16x16x32_bf16 v[104:107], v[28:31], a[80:83], v[104:107]
    ds_read_b64_tr_b16 v[24:25], v5 offset:49568
    s_mov_b32 s30, 2363392
    v_mfma_f32_16x16x32_bf16 v[120:123], v[28:31], a[84:87], v[120:123]
    ds_read_b64_tr_b16 v[26:27], v5 offset:50592
    s_mov_b32 s31, 0x20000
    v_mfma_f32_16x16x32_bf16 v[136:139], v[28:31], a[88:91], v[136:139]
    ds_read_b128 a[104:107], v166 offset:37248
    ds_read_b128 a[108:111], v166 offset:39296
    v_mfma_f32_16x16x32_bf16 v[152:155], v[28:31], a[92:95], v[152:155]
    buffer_load_dwordx4 v3, s[4:7], s47 offen offset:1024 lds
    s_waitcnt lgkmcnt(8)
    v_mfma_f32_16x16x32_bf16 v[156:159], v[32:35], a[92:95], v[156:159]
    ds_read_b64_tr_b16 v[28:29], v5 offset:51584
    s_lshr_b32 s36, s2, 3
    v_mfma_f32_16x16x32_bf16 v[140:143], v[32:35], a[88:91], v[140:143]
    ds_read_b64_tr_b16 v[30:31], v5 offset:52608
    s_lshl_b32 s36, s36, 6
    v_mfma_f32_16x16x32_bf16 v[124:127], v[32:35], a[84:87], v[124:127]
    buffer_load_dwordx4 v2, s[8:11], s47 offen offset:2048 lds
    v_mfma_f32_16x16x32_bf16 v[108:111], v[32:35], a[80:83], v[108:111]
    buffer_load_dwordx4 v3, s[8:11], s47 offen offset:3072 lds
    s_sub_u32 s101, s51, s46
    s_cmp_lt_u32 s101, 384
    s_cbranch_scc1 L_q3
L_qr3:
    s_waitcnt lgkmcnt(7)
    v_mfma_f32_16x16x32_bf16 v[96:99], v[20:23], a[96:99], v[96:99]
    ds_read_b64_tr_b16 v[32:33], v5 offset:51616
    s_add_u32 m0, s44, 49408
    s_waitcnt lgkmcnt(7)
    v_mfma_f32_16x16x32_bf16 v[112:115], v[20:23], a[100:103], v[112:115]
    ds_read_b64_tr_b16 v[34:35], v5 offset:52640
    s_and_b32 s37, s2, 7
    s_waitcnt lgkmcnt(5)
    v_mfma_f32_16x16x32_bf16 v[128:131], v[20:23], a[104:107], v[128:131]
    buffer_load_dwordx4 v160, s[12:15], s54 offen offset:0 lds
    s_waitcnt lgkmcnt(4)
    v_mfma_f32_16x16x32_bf16 v[144:147], v[20:23], a[108:111], v[144:147]
    buffer_load_dwordx4 v161, s[12:15], s54 offen offset:1024 lds
    v_mfma_f32_16x16x32_bf16 v[148:151], v[24:27], a[108:111], v[148:151]
    ds_read_b64_tr_b16 v[20:21], v5 offset:50048
    v_lshl_add_u32 v42, v8, 4, s36
    v_mfma_f32_16x16x32_bf16 v[132:135], v[24:27], a[104:107], v[132:135]
    ds_read_b64_tr_b16 v[22:23], v5 offset:51072
    v_add_u32 v42, v42, v9
    v_mfma_f32_16x16x32_bf16 v[116:119], v[24:27], a[100:103], v[116:119]
    ds_read_b128 a[112:115], v167 offset:33152
    ds_read_b128 a[116:119], v167 offset:35200
    v_mfma_f32_16x16x32_bf16 v[100:103], v[24:27], a[96:99], v[100:103]
    buffer_load_dwordx4 v162, s[12:15], s54 offen offset:2048 lds
    s_waitcnt lgkmcnt(6)
    v_mfma_f32_16x16x32_bf16 v[104:107], v[28:31], a[96:99], v[104:107]
    ds_read_b64_tr_b16 v[24:25], v5 offset:50080
    v_mul_u32_u24 v42, 1152, v42
    v_mfma_f32_16x16x32_bf16 v[120:123], v[28:31], a[100:103], v[120:123]
    ds_read_b64_tr_b16 v[26:27], v5 offset:51104
    s_lshl_b32 s45, s37, 7
    v_mfma_f32_16x16x32_bf16 v[136:139], v[28:31], a[104:107], v[136:139]
    ds_read_b128 a[120:123], v167 offset:37248
    ds_read_b128 a[124:127], v167 offset:39296
    v_mfma_f32_16x16x32_bf16 v[152:155], v[28:31], a[108:111], v[152:155]
    buffer_load_dwordx4 v163, s[12:15], s54 offen offset:3072 lds
    s_waitcnt lgkmcnt(8)
    v_mfma_f32_16x16x32_bf16 v[156:159], v[32:35], a[108:111], v[156:159]
    ds_read_b64_tr_b16 v[28:29], v5 offset:52096
    s_add_u32 s45, s45, 4096
    v_mfma_f32_16x16x32_bf16 v[140:143], v[32:35], a[104:107], v[140:143]
    ds_read_b64_tr_b16 v[30:31], v5 offset:53120
    v_add_u32 v42, s45, v42
    v_mfma_f32_16x16x32_bf16 v[124:127], v[32:35], a[100:103], v[124:127]
    v_bfe_u32 v43, v9, 1, 1
    v_lshl_add_u32 v43, v38, 2, v43
    v_mfma_f32_16x16x32_bf16 v[108:111], v[32:35], a[96:99], v[108:111]
    v_xor_b32 v43, v43, v10
    s_waitcnt lgkmcnt(7)
    v_mfma_f32_16x16x32_bf16 v[96:99], v[20:23], a[112:115], v[96:99]
    ds_read_b64_tr_b16 v[32:33], v5 offset:52128
    v_lshl_add_u32 v70, v43, 4, v42
    s_waitcnt lgkmcnt(7)
    v_mfma_f32_16x16x32_bf16 v[112:115], v[20:23], a[116:119], v[112:115]
    ds_read_b64_tr_b16 v[34:35], v5 offset:53152
    v_xor_b32 v43, 2, v43
    s_waitcnt lgkmcnt(5)
    v_mfma_f32_16x16x32_bf16 v[128:131], v[20:23], a[120:123], v[128:131]
    v_lshl_add_u32 v71, v43, 4, v42
    v_add_u32 v71, 8192, v71
    s_waitcnt lgkmcnt(4)
    v_mfma_f32_16x16x32_bf16 v[144:147], v[20:23], a[124:127], v[144:147]
    v_lshrrev_b32 v45, 1, v39
    v_mfma_f32_16x16x32_bf16 v[148:151], v[24:27], a[124:127], v[148:151]
    s_waitcnt vmcnt(12)
    s_barrier
    ds_read_b64_tr_b16 v[20:21], v4 offset:0
    s_add_u32 m0, s33, 65792
    v_mfma_f32_16x16x32_bf16 v[132:135], v[24:27], a[120:123], v[132:135]
    ds_read_b64_tr_b16 v[22:23], v4 offset:1024
    s_add_u32 s47, s34, s63
    v_mfma_f32_16x16x32_bf16 v[116:119], v[24:27], a[116:119], v[116:119]
    ds_read_b128 a[128:131], v168 offset:512
    ds_read_b128 a[132:135], v168 offset:2560
    v_mfma_f32_16x16x32_bf16 v[100:103], v[24:27], a[112:115], v[100:103]
    buffer_load_dwordx4 v2, s[4:7], s47 offen offset:0 lds
    s_waitcnt lgkmcnt(6)
    v_mfma_f32_16x16x32_bf16 v[104:107], v[28:31], a[112:115], v[104:107]
    ds_read_b64_tr_b16 v[24:25], v4 offset:32
    v_lshl_add_u32 v46, v45, 2, v37
    v_mfma_f32_16x16x32_bf16 v[120:123], v[28:31], a[116:119], v[120:123]
    ds_read_b64_tr_b16 v[26:27], v4 offset:1056
    v_lshl_add_u32 v46, v46, 3, v36
    v_mfma_f32_16x16x32_bf16 v[136:139], v[28:31], a[120:123], v[136:139]
    ds_read_b128 a[136:139], v168 offset:4608
    ds_read_b128 a[140:143], v168 offset:6656
    v_mfma_f32_16x16x32_bf16 v[152:155], v[28:31], a[124:127], v[152:155]
    buffer_load_dwordx4 v3, s[4:7], s47 offen offset:1024 lds
    s_waitcnt lgkmcnt(8)
    v_mfma_f32_16x16x32_bf16 v[156:159], v[32:35], a[124:127], v[156:159]
    ds_read_b64_tr_b16 v[28:29], v4 offset:2048
    v_lshlrev_b32 v77, 7, v46
    v_mfma_f32_16x16x32_bf16 v[140:143], v[32:35], a[120:123], v[140:143]
    ds_read_b64_tr_b16 v[30:31], v4 offset:3072
    v_and_b32 v46, 1, v39
    v_mfma_f32_16x16x32_bf16 v[124:127], v[32:35], a[116:119], v[124:127]
    buffer_load_dwordx4 v2, s[8:11], s47 offen offset:2048 lds
    v_mfma_f32_16x16x32_bf16 v[108:111], v[32:35], a[112:115], v[108:111]
    buffer_load_dwordx4 v3, s[8:11], s47 offen offset:3072 lds
    s_sub_u32 s101, s52, s46
    s_cmp_lt_u32 s101, 384
    s_cbranch_scc1 L_q4
L_qr4:
    s_waitcnt lgkmcnt(7)
    v_mfma_f32_16x16x32_bf16 v[96:99], v[20:23], a[128:131], v[96:99]
    ds_read_b64_tr_b16 v[32:33], v4 offset:2080
    s_add_u32 m0, s44, 82304
    s_waitcnt lgkmcnt(7)
    v_mfma_f32_16x16x32_bf16 v[112:115], v[20:23], a[132:135], v[112:115]
    ds_read_b64_tr_b16 v[34:35], v4 offset:3104
    v_lshl_add_u32 v77, v46, 3, v77
    s_waitcnt lgkmcnt(5)
    v_mfma_f32_16x16x32_bf16 v[128:131], v[20:23], a[136:139], v[128:131]
    buffer_load_dwordx4 v160, s[12:15], s55 offen offset:0 lds
    s_waitcnt lgkmcnt(4)
    v_mfma_f32_16x16x32_bf16 v[144:147], v[20:23], a[140:143], v[144:147]
    buffer_load_dwordx4 v161, s[12:15], s55 offen offset:1024 lds
    v_mfma_f32_16x16x32_bf16 v[148:151], v[24:27], a[140:143], v[148:151]
    ds_read_b64_tr_b16 v[20:21], v4 offset:512
    v_and_b32 v46, 1, v37
    v_mfma_f32_16x16x32_bf16 v[132:135], v[24:27], a[136:139], v[132:135]
    ds_read_b64_tr_b16 v[22:23], v4 offset:1536
    v_lshl_add_u32 v45, v45, 1, v46
    v_mfma_f32_16x16x32_bf16 v[116:119], v[24:27], a[132:135], v[116:119]
    ds_read_b128 a[144:147], v169 offset:512
    ds_read_b128 a[148:151], v169 offset:2560
    v_mfma_f32_16x16x32_bf16 v[100:103], v[24:27], a[128:131], v[100:103]
    buffer_load_dwordx4 v162, s[12:15], s55 offen offset:2048 lds
    s_waitcnt lgkmcnt(6)
    v_mfma_f32_16x16x32_bf16 v[104:107], v[28:31], a[128:131], v[104:107]
    ds_read_b64_tr_b16 v[24:25], v4 offset:544
    v_lshrrev_b32 v46, 1, v36
    v_mfma_f32_16x16x32_bf16 v[120:123], v[28:31], a[132:135], v[120:123]
    ds_read_b64_tr_b16 v[26:27], v4 offset:1568
    v_lshl_add_u32 v45, v45, 1, v46
    v_mfma_f32_16x16x32_bf16 v[136:139], v[28:31], a[136:139], v[136:139]
    ds_read_b128 a[152:155], v169 offset:4608
    ds_read_b128 a[156:159], v169 offset:6656
    v_mfma_f32_16x16x32_bf16 v[152:155], v[28:31], a[140:143], v[152:155]
    buffer_load_dwordx4 v163, s[12:15], s55 offen offset:3072 lds
    s_waitcnt lgkmcnt(8)
    v_mfma_f32_16x16x32_bf16 v[156:159], v[32:35], a[140:143], v[156:159]
    ds_read_b64_tr_b16 v[28:29], v4 offset:2560
    v_lshlrev_b32 v46, 1, v8
    v_mfma_f32_16x16x32_bf16 v[140:143], v[32:35], a[136:139], v[140:143]
    ds_read_b64_tr_b16 v[30:31], v4 offset:3584
    v_xor_b32 v45, v45, v46
    v_mfma_f32_16x16x32_bf16 v[124:127], v[32:35], a[132:135], v[124:127]
    v_lshl_add_u32 v77, v45, 4, v77
    v_lshrrev_b32 v45, 3, v40
    v_mfma_f32_16x16x32_bf16 v[108:111], v[32:35], a[128:131], v[108:111]
    v_lshl_add_u32 v45, v45, 2, v37
    s_waitcnt lgkmcnt(7)
    v_mfma_f32_16x16x32_bf16 v[96:99], v[20:23], a[144:147], v[96:99]
    ds_read_b64_tr_b16 v[32:33], v4 offset:2592
    v_xor_b32 v45, v45, v10
    s_waitcnt lgkmcnt(7)
    v_mfma_f32_16x16x32_bf16 v[112:115], v[20:23], a[148:151], v[112:115]
    ds_read_b64_tr_b16 v[34:35], v4 offset:3616
    v_lshlrev_b32 v75, 7, v10
    s_waitcnt lgkmcnt(5)
    v_mfma_f32_16x16x32_bf16 v[128:131], v[20:23], a[152:155], v[128:131]
    v_lshl_add_u32 v75, v45, 4, v75
    v_xor_b32 v45, v9, v10
    s_waitcnt lgkmcnt(4)
    v_mfma_f32_16x16x32_bf16 v[144:147], v[20:23], a[156:159], v[144:147]
    v_lshlrev_b32 v76, 7, v9
    v_mfma_f32_16x16x32_bf16 v[148:151], v[24:27], a[156:159], v[148:151]
    s_waitcnt vmcnt(12)
    s_barrier
    ds_read_b64_tr_b16 v[20:21], v4 offset:32896
    s_add_u32 m0, s33, 98688
    v_mfma_f32_16x16x32_bf16 v[132:135], v[24:27], a[152:155], v[132:135]
    ds_read_b64_tr_b16 v[22:23], v4 offset:33920
    s_add_u32 s47, s34, s64
    v_mfma_f32_16x16x32_bf16 v[116:119], v[24:27], a[148:151], v[116:119]
    ds_read_b128 a[160:163], v164 offset:16512
    ds_read_b128 a[164:167], v164 offset:18560
    v_mfma_f32_16x16x32_bf16 v[100:103], v[24:27], a[144:147], v[100:103]
    buffer_load_dwordx4 v2, s[4:7], s47 offen offset:0 lds
    s_waitcnt lgkmcnt(6)
    v_mfma_f32_16x16x32_bf16 v[104:107], v[28:31], a[144:147], v[104:107]
    ds_read_b64_tr_b16 v[24:25], v4 offset:32928
    v_lshl_add_u32 v76, v45, 4, v76
    v_mfma_f32_16x16x32_bf16 v[120:123], v[28:31], a[148:151], v[120:123]
    ds_read_b64_tr_b16 v[26:27], v4 offset:33952
    s_mul_i32 s36, s36, 1152
    v_mfma_f32_16x16x32_bf16 v[136:139], v[28:31], a[152:155], v[136:139]
    ds_read_b128 a[168:171], v164 offset:20608
    ds_read_b128 a[172:175], v164 offset:22656
    v_mfma_f32_16x16x32_bf16 v[152:155], v[28:31], a[156:159], v[152:155]
    buffer_load_dwordx4 v3, s[4:7], s47 offen offset:1024 lds
    s_waitcnt lgkmcnt(8)
    v_mfma_f32_16x16x32_bf16 v[156:159], v[32:35], a[156:159], v[156:159]
    ds_read_b64_tr_b16 v[28:29], v4 offset:34944
    s_lshl_b32 s45, s37, 13
    v_mfma_f32_16x16x32_bf16 v[140:143], v[32:35], a[152:155], v[140:143]
    ds_read_b64_tr_b16 v[30:31], v4 offset:35968
    s_add_u32 s36, s36, s45
    v_mfma_f32_16x16x32_bf16 v[124:127], v[32:35], a[148:151], v[124:127]
    buffer_load_dwordx4 v2, s[8:11], s47 offen offset:2048 lds
    v_mfma_f32_16x16x32_bf16 v[108:111], v[32:35], a[144:147], v[108:111]
    buffer_load_dwordx4 v3, s[8:11], s47 offen offset:3072 lds
    s_sub_u32 s101, s53, s46
    s_cmp_lt_u32 s101, 384
    s_cbranch_scc1 L_q5
L_qr5:
    s_waitcnt lgkmcnt(7)
    v_mfma_f32_16x16x32_bf16 v[96:99], v[20:23], a[160:163], v[96:99]
    ds_read_b64_tr_b16 v[32:33], v4 offset:34976
    s_add_u32 m0, s44, 115200
    s_waitcnt lgkmcnt(7)
    v_mfma_f32_16x16x32_bf16 v[112:115], v[20:23], a[164:167], v[112:115]
    ds_read_b64_tr_b16 v[34:35], v4 offset:36000
    v_lshl_add_u32 v42, v1, 4, s36
    s_waitcnt lgkmcnt(5)
    v_mfma_f32_16x16x32_bf16 v[128:131], v[20:23], a[168:171], v[128:131]
    buffer_load_dwordx4 v160, s[12:15], s56 offen offset:0 lds
    s_waitcnt lgkmcnt(4)
    v_mfma_f32_16x16x32_bf16 v[144:147], v[20:23], a[172:175], v[144:147]
    buffer_load_dwordx4 v161, s[12:15], s56 offen offset:1024 lds
    v_mfma_f32_16x16x32_bf16 v[148:151], v[24:27], a[172:175], v[148:151]
    ds_read_b64_tr_b16 v[20:21], v4 offset:33408
    v_lshl_add_u32 v78, v8, 11, v42
    v_mfma_f32_16x16x32_bf16 v[132:135], v[24:27], a[168:171], v[132:135]
    ds_read_b64_tr_b16 v[22:23], v4 offset:34432
    v_mfma_f32_16x16x32_bf16 v[116:119], v[24:27], a[164:167], v[116:119]
    ds_read_b128 a[176:179], v165 offset:16512
    ds_read_b128 a[180:183], v165 offset:18560
    v_mfma_f32_16x16x32_bf16 v[100:103], v[24:27], a[160:163], v[100:103]
    buffer_load_dwordx4 v162, s[12:15], s56 offen offset:2048 lds
    s_waitcnt lgkmcnt(6)
    v_mfma_f32_16x16x32_bf16 v[104:107], v[28:31], a[160:163], v[104:107]
    ds_read_b64_tr_b16 v[24:25], v4 offset:33440
    v_mfma_f32_16x16x32_bf16 v[120:123], v[28:31], a[164:167], v[120:123]
    ds_read_b64_tr_b16 v[26:27], v4 offset:34464
    v_mfma_f32_16x16x32_bf16 v[136:139], v[28:31], a[168:171], v[136:139]
    ds_read_b128 a[184:187], v165 offset:20608
    ds_read_b128 a[188:191], v165 offset:22656
    v_mfma_f32_16x16x32_bf16 v[152:155], v[28:31], a[172:175], v[152:155]
    buffer_load_dwordx4 v163, s[12:15], s56 offen offset:3072 lds
    s_waitcnt lgkmcnt(8)
    v_mfma_f32_16x16x32_bf16 v[156:159], v[32:35], a[172:175], v[156:159]
    ds_read_b64_tr_b16 v[28:29], v4 offset:35456
    s_mul_i32 s44, s32, 3104
    v_mfma_f32_16x16x32_bf16 v[140:143], v[32:35], a[168:171], v[140:143]
    ds_read_b64_tr_b16 v[30:31], v4 offset:36480
    s_add_u32 m0, s33, 131584
    v_mfma_f32_16x16x32_bf16 v[124:127], v[32:35], a[164:167], v[124:127]
    s_add_u32 s47, s34, s65
    buffer_load_dwordx4 v2, s[4:7], s47 offen offset:0 lds
    v_mfma_f32_16x16x32_bf16 v[108:111], v[32:35], a[160:163], v[108:111]
    buffer_load_dwordx4 v3, s[4:7], s47 offen offset:1024 lds
    s_waitcnt lgkmcnt(7)
    v_mfma_f32_16x16x32_bf16 v[96:99], v[20:23], a[176:179], v[96:99]
    ds_read_b64_tr_b16 v[32:33], v4 offset:35488
    s_waitcnt lgkmcnt(7)
    v_mfma_f32_16x16x32_bf16 v[112:115], v[20:23], a[180:183], v[112:115]
    ds_read_b64_tr_b16 v[34:35], v4 offset:36512
    s_waitcnt lgkmcnt(5)
    v_mfma_f32_16x16x32_bf16 v[128:131], v[20:23], a[184:187], v[128:131]
    buffer_load_dwordx4 v2, s[8:11], s47 offen offset:2048 lds
    s_waitcnt lgkmcnt(4)
    v_mfma_f32_16x16x32_bf16 v[144:147], v[20:23], a[188:191], v[144:147]
    buffer_load_dwordx4 v3, s[8:11], s47 offen offset:3072 lds
    v_mfma_f32_16x16x32_bf16 v[148:151], v[24:27], a[188:191], v[148:151]
    s_waitcnt vmcnt(16)
    s_barrier
    ds_read_b64_tr_b16 v[20:21], v5 offset:256
    s_add_u32 s34, s34, s3
    v_mfma_f32_16x16x32_bf16 v[132:135], v[24:27], a[184:187], v[132:135]
    ds_read_b64_tr_b16 v[22:23], v5 offset:1280
    s_add_u32 m0, s33, 0
    v_mfma_f32_16x16x32_bf16 v[116:119], v[24:27], a[180:183], v[116:119]
    ds_read_b128 a[192:195], v164 offset:49408
    ds_read_b128 a[196:199], v164 offset:51456
    v_mfma_f32_16x16x32_bf16 v[100:103], v[24:27], a[176:179], v[100:103]
    s_add_u32 s47, s34, s57
    s_waitcnt lgkmcnt(6)
    v_mfma_f32_16x16x32_bf16 v[104:107], v[28:31], a[176:179], v[104:107]
    ds_read_b64_tr_b16 v[24:25], v5 offset:288
    v_mfma_f32_16x16x32_bf16 v[120:123], v[28:31], a[180:183], v[120:123]
    ds_read_b64_tr_b16 v[26:27], v5 offset:1312
    v_mfma_f32_16x16x32_bf16 v[136:139], v[28:31], a[184:187], v[136:139]
    ds_read_b128 a[200:203], v164 offset:53504
    ds_read_b128 a[204:207], v164 offset:55552
    v_mfma_f32_16x16x32_bf16 v[152:155], v[28:31], a[188:191], v[152:155]
    buffer_load_dwordx4 v2, s[4:7], s47 offen offset:0 lds
    s_waitcnt lgkmcnt(8)
    v_mfma_f32_16x16x32_bf16 v[156:159], v[32:35], a[188:191], v[156:159]
    ds_read_b64_tr_b16 v[28:29], v5 offset:2304
    v_mfma_f32_16x16x32_bf16 v[140:143], v[32:35], a[184:187], v[140:143]
    ds_read_b64_tr_b16 v[30:31], v5 offset:3328
    v_mfma_f32_16x16x32_bf16 v[124:127], v[32:35], a[180:183], v[124:127]
    buffer_load_dwordx4 v3, s[4:7], s47 offen offset:1024 lds
    v_mfma_f32_16x16x32_bf16 v[108:111], v[32:35], a[176:179], v[108:111]
    buffer_load_dwordx4 v2, s[8:11], s47 offen offset:2048 lds
    s_sub_u32 s101, s54, s46
    s_cmp_lt_u32 s101, 384
    s_cbranch_scc1 L_q6
L_qr6:
    s_waitcnt lgkmcnt(7)
    v_mfma_f32_16x16x32_bf16 v[96:99], v[20:23], a[192:195], v[96:99]
    ds_read_b64_tr_b16 v[32:33], v5 offset:2336
    s_waitcnt lgkmcnt(7)
    v_mfma_f32_16x16x32_bf16 v[112:115], v[20:23], a[196:199], v[112:115]
    ds_read_b64_tr_b16 v[34:35], v5 offset:3360
    s_waitcnt lgkmcnt(5)
    v_mfma_f32_16x16x32_bf16 v[128:131], v[20:23], a[200:203], v[128:131]
    buffer_load_dwordx4 v3, s[8:11], s47 offen offset:3072 lds
    s_waitcnt lgkmcnt(4)
    v_mfma_f32_16x16x32_bf16 v[144:147], v[20:23], a[204:207], v[144:147]
    v_mfma_f32_16x16x32_bf16 v[148:151], v[24:27], a[204:207], v[148:151]
    ds_read_b64_tr_b16 v[20:21], v5 offset:768
    v_mfma_f32_16x16x32_bf16 v[132:135], v[24:27], a[200:203], v[132:135]
    ds_read_b64_tr_b16 v[22:23], v5 offset:1792
    v_mfma_f32_16x16x32_bf16 v[116:119], v[24:27], a[196:199], v[116:119]
    ds_read_b128 a[208:211], v165 offset:49408
    ds_read_b128 a[212:215], v165 offset:51456
    v_mfma_f32_16x16x32_bf16 v[100:103], v[24:27], a[192:195], v[100:103]
    s_waitcnt lgkmcnt(6)
    v_mfma_f32_16x16x32_bf16 v[104:107], v[28:31], a[192:195], v[104:107]
    ds_read_b64_tr_b16 v[24:25], v5 offset:800
    v_mfma_f32_16x16x32_bf16 v[120:123], v[28:31], a[196:199], v[120:123]
    ds_read_b64_tr_b16 v[26:27], v5 offset:1824
    v_mfma_f32_16x16x32_bf16 v[136:139], v[28:31], a[200:203], v[136:139]
    ds_read_b128 a[216:219], v165 offset:53504
    ds_read_b128 a[220:223], v165 offset:55552
    v_mfma_f32_16x16x32_bf16 v[152:155], v[28:31], a[204:207], v[152:155]
    s_waitcnt lgkmcnt(8)
    v_mfma_f32_16x16x32_bf16 v[156:159], v[32:35], a[204:207], v[156:159]
    ds_read_b64_tr_b16 v[28:29], v5 offset:2816
    v_mfma_f32_16x16x32_bf16 v[140:143], v[32:35], a[200:203], v[140:143]
    ds_read_b64_tr_b16 v[30:31], v5 offset:3840
    v_mfma_f32_16x16x32_bf16 v[124:127], v[32:35], a[196:199], v[124:127]
    v_mfma_f32_16x16x32_bf16 v[108:111], v[32:35], a[192:195], v[108:111]
    s_waitcnt lgkmcnt(7)
    v_mfma_f32_16x16x32_bf16 v[96:99], v[20:23], a[208:211], v[96:99]
    ds_read_b64_tr_b16 v[32:33], v5 offset:2848
    s_waitcnt lgkmcnt(7)
    v_mfma_f32_16x16x32_bf16 v[112:115], v[20:23], a[212:215], v[112:115]
    ds_read_b64_tr_b16 v[34:35], v5 offset:3872
    s_waitcnt lgkmcnt(5)
    v_mfma_f32_16x16x32_bf16 v[128:131], v[20:23], a[216:219], v[128:131]
    s_waitcnt lgkmcnt(4)
    v_mfma_f32_16x16x32_bf16 v[144:147], v[20:23], a[220:223], v[144:147]
    v_mfma_f32_16x16x32_bf16 v[148:151], v[24:27], a[220:223], v[148:151]
    s_waitcnt vmcnt(12)
    s_barrier
    ds_read_b64_tr_b16 v[20:21], v5 offset:33152
    s_add_u32 m0, s33, 16512
    v_mfma_f32_16x16x32_bf16 v[132:135], v[24:27], a[216:219], v[132:135]
    ds_read_b64_tr_b16 v[22:23], v5 offset:34176
    s_add_u32 s47, s34, s58
    v_mfma_f32_16x16x32_bf16 v[116:119], v[24:27], a[212:215], v[116:119]
    ds_read_b128 a[224:227], v166 offset:16768
    ds_read_b128 a[228:231], v166 offset:18816
    v_mfma_f32_16x16x32_bf16 v[100:103], v[24:27], a[208:211], v[100:103]
    buffer_load_dwordx4 v2, s[4:7], s47 offen offset:0 lds
    s_waitcnt lgkmcnt(6)
    v_mfma_f32_16x16x32_bf16 v[104:107], v[28:31], a[208:211], v[104:107]
    ds_read_b64_tr_b16 v[24:25], v5 offset:33184
    v_mfma_f32_16x16x32_bf16 v[120:123], v[28:31], a[212:215], v[120:123]
    ds_read_b64_tr_b16 v[26:27], v5 offset:34208
    v_mfma_f32_16x16x32_bf16 v[136:139], v[28:31], a[216:219], v[136:139]
    ds_read_b128 a[232:235], v166 offset:20864
    ds_read_b128 a[236:239], v166 offset:22912
    v_mfma_f32_16x16x32_bf16 v[152:155], v[28:31], a[220:223], v[152:155]
    buffer_load_dwordx4 v3, s[4:7], s47 offen offset:1024 lds
    s_waitcnt lgkmcnt(8)
    v_mfma_f32_16x16x32_bf16 v[156:159], v[32:35], a[220:223], v[156:159]
    ds_read_b64_tr_b16 v[28:29], v5 offset:35200
    v_mfma_f32_16x16x32_bf16 v[140:143], v[32:35], a[216:219], v[140:143]
    ds_read_b64_tr_b16 v[30:31], v5 offset:36224
    v_mfma_f32_16x16x32_bf16 v[124:127], v[32:35], a[212:215], v[124:127]
    buffer_load_dwordx4 v2, s[8:11], s47 offen offset:2048 lds
    v_mfma_f32_16x16x32_bf16 v[108:111], v[32:35], a[208:211], v[108:111]
    buffer_load_dwordx4 v3, s[8:11], s47 offen offset:3072 lds
    s_sub_u32 s101, s55, s46
    s_cmp_lt_u32 s101, 384
    s_cbranch_scc1 L_q7
L_qr7:
    s_waitcnt lgkmcnt(7)
    v_mfma_f32_16x16x32_bf16 v[96:99], v[20:23], a[224:227], v[96:99]
    ds_read_b64_tr_b16 v[32:33], v5 offset:35232
    s_waitcnt lgkmcnt(7)
    v_mfma_f32_16x16x32_bf16 v[112:115], v[20:23], a[228:231], v[112:115]
    ds_read_b64_tr_b16 v[34:35], v5 offset:36256
    s_waitcnt lgkmcnt(5)
    v_mfma_f32_16x16x32_bf16 v[128:131], v[20:23], a[232:235], v[128:131]
    s_waitcnt lgkmcnt(4)
    v_mfma_f32_16x16x32_bf16 v[144:147], v[20:23], a[236:239], v[144:147]
    v_mfma_f32_16x16x32_bf16 v[148:151], v[24:27], a[236:239], v[148:151]
    ds_read_b64_tr_b16 v[20:21], v5 offset:33664
    v_mfma_f32_16x16x32_bf16 v[132:135], v[24:27], a[232:235], v[132:135]
    ds_read_b64_tr_b16 v[22:23], v5 offset:34688
    v_mfma_f32_16x16x32_bf16 v[116:119], v[24:27], a[228:231], v[116:119]
    ds_read_b128 a[240:243], v167 offset:16768
    ds_read_b128 a[244:247], v167 offset:18816
    v_mfma_f32_16x16x32_bf16 v[100:103], v[24:27], a[224:227], v[100:103]
    s_waitcnt lgkmcnt(6)
    v_mfma_f32_16x16x32_bf16 v[104:107], v[28:31], a[224:227], v[104:107]
    ds_read_b64_tr_b16 v[24:25], v5 offset:33696
    v_mfma_f32_16x16x32_bf16 v[120:123], v[28:31], a[228:231], v[120:123]
    ds_read_b64_tr_b16 v[26:27], v5 offset:34720
    v_mfma_f32_16x16x32_bf16 v[136:139], v[28:31], a[232:235], v[136:139]
    ds_read_b128 a[248:251], v167 offset:20864
    ds_read_b128 a[252:255], v167 offset:22912
    v_mfma_f32_16x16x32_bf16 v[152:155], v[28:31], a[236:239], v[152:155]
    s_waitcnt lgkmcnt(8)
    v_mfma_f32_16x16x32_bf16 v[156:159], v[32:35], a[236:239], v[156:159]
    ds_read_b64_tr_b16 v[28:29], v5 offset:35712
    v_mfma_f32_16x16x32_bf16 v[140:143], v[32:35], a[232:235], v[140:143]
    ds_read_b64_tr_b16 v[30:31], v5 offset:36736
    v_mfma_f32_16x16x32_bf16 v[124:127], v[32:35], a[228:231], v[124:127]
    v_mfma_f32_16x16x32_bf16 v[108:111], v[32:35], a[224:227], v[108:111]
    s_waitcnt lgkmcnt(7)
    v_mfma_f32_16x16x32_bf16 v[96:99], v[20:23], a[240:243], v[96:99]
    ds_read_b64_tr_b16 v[32:33], v5 offset:35744
    s_waitcnt lgkmcnt(7)
    v_mfma_f32_16x16x32_bf16 v[112:115], v[20:23], a[244:247], v[112:115]
    ds_read_b64_tr_b16 v[34:35], v5 offset:36768
    s_waitcnt lgkmcnt(5)
    v_mfma_f32_16x16x32_bf16 v[128:131], v[20:23], a[248:251], v[128:131]
    s_waitcnt lgkmcnt(4)
    v_mfma_f32_16x16x32_bf16 v[144:147], v[20:23], a[252:255], v[144:147]
    v_mfma_f32_16x16x32_bf16 v[148:151], v[24:27], a[252:255], v[148:151]
    s_waitcnt vmcnt(8)
    s_barrier
    ds_read_b64_tr_b16 v[20:21], v6 offset:512
    v_mfma_f32_16x16x32_bf16 v[132:135], v[24:27], a[248:251], v[132:135]
    ds_read_b64_tr_b16 v[22:23], v6 offset:1536
    v_mfma_f32_16x16x32_bf16 v[116:119], v[24:27], a[244:247], v[116:119]
    ds_read_b128 v[224:227], v166 offset:49664
    ds_read_b128 v[228:231], v166 offset:51712
    v_mfma_f32_16x16x32_bf16 v[100:103], v[24:27], a[240:243], v[100:103]
    s_waitcnt lgkmcnt(6)
    v_mfma_f32_16x16x32_bf16 v[104:107], v[28:31], a[240:243], v[104:107]
    ds_read_b64_tr_b16 v[24:25], v6 offset:544
    v_mfma_f32_16x16x32_bf16 v[120:123], v[28:31], a[244:247], v[120:123]
    ds_read_b64_tr_b16 v[26:27], v6 offset:1568
    v_mfma_f32_16x16x32_bf16 v[136:139], v[28:31], a[248:251], v[136:139]
    ds_read_b128 v[232:235], v166 offset:53760
    ds_read_b128 v[236:239], v166 offset:55808
    v_mfma_f32_16x16x32_bf16 v[152:155], v[28:31], a[252:255], v[152:155]
    s_waitcnt lgkmcnt(8)
    v_mfma_f32_16x16x32_bf16 v[156:159], v[32:35], a[252:255], v[156:159]
    ds_read_b64_tr_b16 v[28:29], v6 offset:2560
    v_mfma_f32_16x16x32_bf16 v[140:143], v[32:35], a[248:251], v[140:143]
    ds_read_b64_tr_b16 v[30:31], v6 offset:3584
    v_mfma_f32_16x16x32_bf16 v[124:127], v[32:35], a[244:247], v[124:127]
    v_mfma_f32_16x16x32_bf16 v[108:111], v[32:35], a[240:243], v[108:111]
    s_sub_u32 s101, s56, s46
    s_cmp_lt_u32 s101, 384
    s_cbranch_scc1 L_q8
L_qr8:
    s_waitcnt lgkmcnt(7)
    v_mfma_f32_16x16x32_bf16 v[96:99], v[20:23], v[224:227], v[96:99]
    ds_read_b64_tr_b16 v[32:33], v6 offset:2592
    s_waitcnt lgkmcnt(7)
    v_mfma_f32_16x16x32_bf16 v[112:115], v[20:23], v[228:231], v[112:115]
    ds_read_b64_tr_b16 v[34:35], v6 offset:3616
    s_waitcnt lgkmcnt(5)
    v_mfma_f32_16x16x32_bf16 v[128:131], v[20:23], v[232:235], v[128:131]
    s_waitcnt lgkmcnt(4)
    v_mfma_f32_16x16x32_bf16 v[144:147], v[20:23], v[236:239], v[144:147]
    v_mfma_f32_16x16x32_bf16 v[148:151], v[24:27], v[236:239], v[148:151]
    ds_read_b64_tr_b16 v[20:21], v6 offset:1024
    v_mfma_f32_16x16x32_bf16 v[132:135], v[24:27], v[232:235], v[132:135]
    ds_read_b64_tr_b16 v[22:23], v6 offset:2048
    v_mfma_f32_16x16x32_bf16 v[116:119], v[24:27], v[228:231], v[116:119]
    ds_read_b128 v[240:243], v167 offset:49664
    ds_read_b128 v[244:247], v167 offset:51712
    v_mfma_f32_16x16x32_bf16 v[100:103], v[24:27], v[224:227], v[100:103]
    s_add_u32 m0, s33, 33024
    s_waitcnt lgkmcnt(6)
    v_mfma_f32_16x16x32_bf16 v[104:107], v[28:31], v[224:227], v[104:107]
    ds_read_b64_tr_b16 v[24:25], v6 offset:1056
    s_add_u32 s47, s34, s59
    v_mfma_f32_16x16x32_bf16 v[120:123], v[28:31], v[228:231], v[120:123]
    ds_read_b64_tr_b16 v[26:27], v6 offset:2080
    v_mfma_f32_16x16x32_bf16 v[136:139], v[28:31], v[232:235], v[136:139]
    ds_read_b128 v[248:251], v167 offset:53760
    ds_read_b128 v[252:255], v167 offset:55808
    v_mfma_f32_16x16x32_bf16 v[152:155], v[28:31], v[236:239], v[152:155]
    buffer_load_dwordx4 v2, s[4:7], s47 offen offset:0 lds
    s_waitcnt lgkmcnt(8)
    v_mfma_f32_16x16x32_bf16 v[156:159], v[32:35], v[236:239], v[156:159]
    ds_read_b64_tr_b16 v[28:29], v6 offset:3072
    v_mfma_f32_16x16x32_bf16 v[140:143], v[32:35], v[232:235], v[140:143]
    ds_read_b64_tr_b16 v[30:31], v6 offset:4096
    v_mfma_f32_16x16x32_bf16 v[124:127], v[32:35], v[228:231], v[124:127]
    buffer_load_dwordx4 v3, s[4:7], s47 offen offset:1024 lds
    v_mfma_f32_16x16x32_bf16 v[108:111], v[32:35], v[224:227], v[108:111]
    buffer_load_dwordx4 v2, s[8:11], s47 offen offset:2048 lds
    s_waitcnt lgkmcnt(7)
    v_mfma_f32_16x16x32_bf16 v[96:99], v[20:23], v[240:243], v[96:99]
    ds_read_b64_tr_b16 v[32:33], v6 offset:3104
    s_waitcnt lgkmcnt(7)
    v_mfma_f32_16x16x32_bf16 v[112:115], v[20:23], v[244:247], v[112:115]
    ds_read_b64_tr_b16 v[34:35], v6 offset:4128
    s_waitcnt lgkmcnt(5)
    v_mfma_f32_16x16x32_bf16 v[128:131], v[20:23], v[248:251], v[128:131]
    buffer_load_dwordx4 v3, s[8:11], s47 offen offset:3072 lds
    s_waitcnt lgkmcnt(4)
    v_mfma_f32_16x16x32_bf16 v[144:147], v[20:23], v[252:255], v[144:147]
    s_add_u32 m0, s33, 49536
    v_mfma_f32_16x16x32_bf16 v[148:151], v[24:27], v[252:255], v[148:151]
    s_waitcnt vmcnt(4)
    s_barrier
    ds_read_b64_tr_b16 v[20:21], v4 offset:0
    s_add_u32 s47, s34, s60
    v_mfma_f32_16x16x32_bf16 v[132:135], v[24:27], v[248:251], v[132:135]
    ds_read_b64_tr_b16 v[22:23], v4 offset:1024
    v_mfma_f32_16x16x32_bf16 v[116:119], v[24:27], v[244:247], v[116:119]
    buffer_load_dwordx4 v2, s[4:7], s47 offen offset:0 lds
    v_mfma_f32_16x16x32_bf16 v[100:103], v[24:27], v[240:243], v[100:103]
    buffer_load_dwordx4 v3, s[4:7], s47 offen offset:1024 lds
    s_waitcnt lgkmcnt(4)
    v_mfma_f32_16x16x32_bf16 v[104:107], v[28:31], v[240:243], v[104:107]
    ds_read_b64_tr_b16 v[24:25], v4 offset:32
    v_mfma_f32_16x16x32_bf16 v[120:123], v[28:31], v[244:247], v[120:123]
    ds_read_b64_tr_b16 v[26:27], v4 offset:1056
    v_mfma_f32_16x16x32_bf16 v[136:139], v[28:31], v[248:251], v[136:139]
    buffer_load_dwordx4 v2, s[8:11], s47 offen offset:2048 lds
    v_mfma_f32_16x16x32_bf16 v[152:155], v[28:31], v[252:255], v[152:155]
    buffer_load_dwordx4 v3, s[8:11], s47 offen offset:3072 lds
    s_waitcnt lgkmcnt(4)
    v_mfma_f32_16x16x32_bf16 v[156:159], v[32:35], v[252:255], v[156:159]
    ds_read_b64_tr_b16 v[28:29], v4 offset:2048
    s_add_u32 m0, s33, 66048
    v_mfma_f32_16x16x32_bf16 v[140:143], v[32:35], v[248:251], v[140:143]
    ds_read_b64_tr_b16 v[30:31], v4 offset:3072
    s_add_u32 s47, s34, s61
    v_mfma_f32_16x16x32_bf16 v[124:127], v[32:35], v[244:247], v[124:127]
    buffer_load_dwordx4 v2, s[4:7], s47 offen offset:0 lds
    v_mfma_f32_16x16x32_bf16 v[108:111], v[32:35], v[240:243], v[108:111]
    buffer_load_dwordx4 v3, s[4:7], s47 offen offset:1024 lds
    s_waitcnt lgkmcnt(4)
    v_mfma_f32_16x16x32_bf16 v[160:163], v[20:23], a[0:3], 0
    ds_read_b64_tr_b16 v[32:33], v4 offset:2080
    v_mfma_f32_16x16x32_bf16 v[176:179], v[20:23], a[4:7], 0
    ds_read_b64_tr_b16 v[34:35], v4 offset:3104
    v_mfma_f32_16x16x32_bf16 v[192:195], v[20:23], a[8:11], 0
    v_mfma_f32_16x16x32_bf16 v[208:211], v[20:23], a[12:15], 0
    buffer_load_dwordx4 v2, s[8:11], s47 offen offset:2048 lds
    s_waitcnt lgkmcnt(4)
    v_mfma_f32_16x16x32_bf16 v[212:215], v[24:27], a[12:15], 0
    ds_read_b64_tr_b16 v[20:21], v4 offset:512
    v_mul_f32 v96, s39, v96
    v_mfma_f32_16x16x32_bf16 v[196:199], v[24:27], a[8:11], 0
    ds_read_b64_tr_b16 v[22:23], v4 offset:1536
    v_mul_f32 v97, s39, v97
    v_mfma_f32_16x16x32_bf16 v[180:183], v[24:27], a[4:7], 0
    v_exp_f32 v96, v96
    v_mfma_f32_16x16x32_bf16 v[164:167], v[24:27], a[0:3], 0
    buffer_load_dwordx4 v3, s[8:11], s47 offen offset:3072 lds
    s_waitcnt lgkmcnt(4)
    v_mfma_f32_16x16x32_bf16 v[168:171], v[28:31], a[0:3], 0
    ds_read_b64_tr_b16 v[24:25], v4 offset:544
    s_lshl_b32 s47, s32, 11
    v_mfma_f32_16x16x32_bf16 v[184:187], v[28:31], a[4:7], 0
    ds_read_b64_tr_b16 v[26:27], v4 offset:1568
    s_add_u32 m0, s47, 82560
    v_mfma_f32_16x16x32_bf16 v[200:203], v[28:31], a[8:11], 0
    v_exp_f32 v97, v97
    v_mfma_f32_16x16x32_bf16 v[216:219], v[28:31], a[12:15], 0
    buffer_load_dwordx4 v70, s[24:27], 0 offen offset:0 lds
    s_waitcnt lgkmcnt(4)
    v_mfma_f32_16x16x32_bf16 v[220:223], v[32:35], a[12:15], 0
    ds_read_b64_tr_b16 v[28:29], v4 offset:2560
    v_mul_f32 v98, s39, v98
    v_mfma_f32_16x16x32_bf16 v[204:207], v[32:35], a[8:11], 0
    ds_read_b64_tr_b16 v[30:31], v4 offset:3584
    v_mul_f32 v99, s39, v99
    v_mfma_f32_16x16x32_bf16 v[188:191], v[32:35], a[4:7], 0
    v_exp_f32 v98, v98
    v_mfma_f32_16x16x32_bf16 v[172:175], v[32:35], a[0:3], 0
    buffer_load_dwordx4 v71, s[24:27], 0 offen offset:1024 lds
    s_waitcnt lgkmcnt(4)
    v_mfma_f32_16x16x32_bf16 v[160:163], v[20:23], a[16:19], v[160:163]
    ds_read_b64_tr_b16 v[32:33], v4 offset:2592
    s_add_u32 m0, s47, 90752
    v_mfma_f32_16x16x32_bf16 v[176:179], v[20:23], a[20:23], v[176:179]
    ds_read_b64_tr_b16 v[34:35], v4 offset:3616
    v_mul_f32 v100, s39, v100
    v_mfma_f32_16x16x32_bf16 v[192:195], v[20:23], a[24:27], v[192:195]
    v_exp_f32 v99, v99
    v_mfma_f32_16x16x32_bf16 v[208:211], v[20:23], a[28:31], v[208:211]
    buffer_load_dwordx4 v70, s[28:31], 0 offen offset:0 lds
    s_waitcnt lgkmcnt(4)
    v_mfma_f32_16x16x32_bf16 v[212:215], v[24:27], a[28:31], v[212:215]
    ds_read_b64_tr_b16 v[20:21], v4 offset:16512
    v_mul_f32 v101, s39, v101
    v_mfma_f32_16x16x32_bf16 v[196:199], v[24:27], a[24:27], v[196:199]
    ds_read_b64_tr_b16 v[22:23], v4 offset:17536
    v_mul_f32 v102, s39, v102
    v_mfma_f32_16x16x32_bf16 v[180:183], v[24:27], a[20:23], v[180:183]
    v_exp_f32 v100, v100
    v_mfma_f32_16x16x32_bf16 v[164:167], v[24:27], a[16:19], v[164:167]
    buffer_load_dwordx4 v71, s[28:31], 0 offen offset:1024 lds
    s_waitcnt lgkmcnt(4)
    v_mfma_f32_16x16x32_bf16 v[168:171], v[28:31], a[16:19], v[168:171]
    ds_read_b64_tr_b16 v[24:25], v4 offset:16544
    s_add_u32 m0, s33, 103040
    v_mfma_f32_16x16x32_bf16 v[184:187], v[28:31], a[20:23], v[184:187]
    ds_read_b64_tr_b16 v[26:27], v4 offset:17568
    s_add_u32 s47, s34, s62
    v_mfma_f32_16x16x32_bf16 v[200:203], v[28:31], a[24:27], v[200:203]
    v_exp_f32 v101, v101
    v_mfma_f32_16x16x32_bf16 v[216:219], v[28:31], a[28:31], v[216:219]
    buffer_load_dwordx4 v2, s[4:7], s47 offen offset:0 lds
    s_waitcnt lgkmcnt(4)
    v_mfma_f32_16x16x32_bf16 v[220:223], v[32:35], a[28:31], v[220:223]
    ds_read_b64_tr_b16 v[28:29], v4 offset:18560
    v_mul_f32 v103, s39, v103
    v_mfma_f32_16x16x32_bf16 v[204:207], v[32:35], a[24:27], v[204:207]
    ds_read_b64_tr_b16 v[30:31], v4 offset:19584
    v_add_f32 v96, 1.0, v96
    v_mfma_f32_16x16x32_bf16 v[188:191], v[32:35], a[20:23], v[188:191]
    v_exp_f32 v102, v102
    v_mfma_f32_16x16x32_bf16 v[172:175], v[32:35], a[16:19], v[172:175]
    buffer_load_dwordx4 v3, s[4:7], s47 offen offset:1024 lds
    s_waitcnt lgkmcnt(4)
    v_mfma_f32_16x16x32_bf16 v[160:163], v[20:23], a[32:35], v[160:163]
    ds_read_b64_tr_b16 v[32:33], v4 offset:18592
    v_add_f32 v97, 1.0, v97
    v_mfma_f32_16x16x32_bf16 v[176:179], v[20:23], a[36:39], v[176:179]
    ds_read_b64_tr_b16 v[34:35], v4 offset:19616
    v_add_f32 v98, 1.0, v98
    v_mfma_f32_16x16x32_bf16 v[192:195], v[20:23], a[40:43], v[192:195]
    v_exp_f32 v103, v103
    v_mfma_f32_16x16x32_bf16 v[208:211], v[20:23], a[44:47], v[208:211]
    buffer_load_dwordx4 v2, s[8:11], s47 offen offset:2048 lds
    s_waitcnt lgkmcnt(4)
    v_mfma_f32_16x16x32_bf16 v[212:215], v[24:27], a[44:47], v[212:215]
    ds_read_b64_tr_b16 v[20:21], v4 offset:17024
    v_add_f32 v99, 1.0, v99
    v_mfma_f32_16x16x32_bf16 v[196:199], v[24:27], a[40:43], v[196:199]
    ds_read_b64_tr_b16 v[22:23], v4 offset:18048
    v_add_f32 v100, 1.0, v100
    v_mfma_f32_16x16x32_bf16 v[180:183], v[24:27], a[36:39], v[180:183]
    v_rcp_f32 v96, v96
    v_mfma_f32_16x16x32_bf16 v[164:167], v[24:27], a[32:35], v[164:167]
    buffer_load_dwordx4 v3, s[8:11], s47 offen offset:3072 lds
    s_waitcnt lgkmcnt(4)
    v_mfma_f32_16x16x32_bf16 v[168:171], v[28:31], a[32:35], v[168:171]
    ds_read_b64_tr_b16 v[24:25], v4 offset:17056
    v_add_f32 v101, 1.0, v101
    v_mfma_f32_16x16x32_bf16 v[184:187], v[28:31], a[36:39], v[184:187]
    ds_read_b64_tr_b16 v[26:27], v4 offset:18080
    v_add_f32 v102, 1.0, v102
    v_mfma_f32_16x16x32_bf16 v[200:203], v[28:31], a[40:43], v[200:203]
    v_rcp_f32 v97, v97
    v_mfma_f32_16x16x32_bf16 v[216:219], v[28:31], a[44:47], v[216:219]
    v_add_f32 v103, 1.0, v103
    s_waitcnt lgkmcnt(4)
    v_mfma_f32_16x16x32_bf16 v[220:223], v[32:35], a[44:47], v[220:223]
    ds_read_b64_tr_b16 v[28:29], v4 offset:19072
    v_mul_f32 v96, v96, v104
    v_mfma_f32_16x16x32_bf16 v[204:207], v[32:35], a[40:43], v[204:207]
    ds_read_b64_tr_b16 v[30:31], v4 offset:20096
    v_mul_f32 v97, v97, v105
    v_mfma_f32_16x16x32_bf16 v[188:191], v[32:35], a[36:39], v[188:191]
    v_rcp_f32 v98, v98
    v_mfma_f32_16x16x32_bf16 v[172:175], v[32:35], a[32:35], v[172:175]
    v_mul_f32 v98, v98, v106
    s_waitcnt lgkmcnt(4)
    v_mfma_f32_16x16x32_bf16 v[160:163], v[20:23], a[48:51], v[160:163]
    ds_read_b64_tr_b16 v[32:33], v4 offset:19104
    v_cvt_pk_bf16_f32 v80, v96, v97
    v_mfma_f32_16x16x32_bf16 v[176:179], v[20:23], a[52:55], v[176:179]
    ds_read_b64_tr_b16 v[34:35], v4 offset:20128
    v_mul_f32 v112, s39, v112
    v_mfma_f32_16x16x32_bf16 v[192:195], v[20:23], a[56:59], v[192:195]
    v_rcp_f32 v99, v99
    v_mfma_f32_16x16x32_bf16 v[208:211], v[20:23], a[60:63], v[208:211]
    v_mul_f32 v99, v99, v107
    s_waitcnt lgkmcnt(4)
    v_mfma_f32_16x16x32_bf16 v[212:215], v[24:27], a[60:63], v[212:215]
    s_waitcnt vmcnt(12)
    s_barrier
    ds_read_b64_tr_b16 v[20:21], v4 offset:33024
    s_add_u32 m0, s33, 119552
    v_mfma_f32_16x16x32_bf16 v[196:199], v[24:27], a[56:59], v[196:199]
    ds_read_b64_tr_b16 v[22:23], v4 offset:34048
    s_add_u32 s47, s34, s63
    v_mfma_f32_16x16x32_bf16 v[180:183], v[24:27], a[52:55], v[180:183]
    v_rcp_f32 v100, v100
    v_mfma_f32_16x16x32_bf16 v[164:167], v[24:27], a[48:51], v[164:167]
    buffer_load_dwordx4 v2, s[4:7], s47 offen offset:0 lds
    s_waitcnt lgkmcnt(4)
    v_mfma_f32_16x16x32_bf16 v[168:171], v[28:31], a[48:51], v[168:171]
    ds_read_b64_tr_b16 v[24:25], v4 offset:33056
    v_mul_f32 v100, v100, v108
    v_mfma_f32_16x16x32_bf16 v[184:187], v[28:31], a[52:55], v[184:187]
    ds_read_b64_tr_b16 v[26:27], v4 offset:34080
    v_cvt_pk_bf16_f32 v81, v98, v99
    v_mfma_f32_16x16x32_bf16 v[200:203], v[28:31], a[56:59], v[200:203]
    v_rcp_f32 v101, v101
    v_mfma_f32_16x16x32_bf16 v[216:219], v[28:31], a[60:63], v[216:219]
    buffer_load_dwordx4 v3, s[4:7], s47 offen offset:1024 lds
    s_waitcnt lgkmcnt(4)
    v_mfma_f32_16x16x32_bf16 v[220:223], v[32:35], a[60:63], v[220:223]
    ds_read_b64_tr_b16 v[28:29], v4 offset:35072
    v_mul_f32 v101, v101, v109
    v_mfma_f32_16x16x32_bf16 v[204:207], v[32:35], a[56:59], v[204:207]
    ds_read_b64_tr_b16 v[30:31], v4 offset:36096
    v_cvt_pk_bf16_f32 v82, v100, v101
    v_mfma_f32_16x16x32_bf16 v[188:191], v[32:35], a[52:55], v[188:191]
    v_rcp_f32 v102, v102
    v_mfma_f32_16x16x32_bf16 v[172:175], v[32:35], a[48:51], v[172:175]
    buffer_load_dwordx4 v2, s[8:11], s47 offen offset:2048 lds
    s_waitcnt lgkmcnt(4)
    v_mfma_f32_16x16x32_bf16 v[160:163], v[20:23], a[64:67], v[160:163]
    ds_read_b64_tr_b16 v[32:33], v4 offset:35104
    v_mul_f32 v102, v102, v110
    v_mfma_f32_16x16x32_bf16 v[176:179], v[20:23], a[68:71], v[176:179]
    ds_read_b64_tr_b16 v[34:35], v4 offset:36128
    v_mul_f32 v113, s39, v113
    v_mfma_f32_16x16x32_bf16 v[192:195], v[20:23], a[72:75], v[192:195]
    v_rcp_f32 v103, v103
    v_mfma_f32_16x16x32_bf16 v[208:211], v[20:23], a[76:79], v[208:211]
    buffer_load_dwordx4 v3, s[8:11], s47 offen offset:3072 lds
    s_waitcnt lgkmcnt(4)
    v_mfma_f32_16x16x32_bf16 v[212:215], v[24:27], a[76:79], v[212:215]
    ds_read_b64_tr_b16 v[20:21], v4 offset:33536
    s_add_u32 m0, s33, 136064
    v_mfma_f32_16x16x32_bf16 v[196:199], v[24:27], a[72:75], v[196:199]
    ds_read_b64_tr_b16 v[22:23], v4 offset:34560
    s_add_u32 s47, s34, s64
    v_mfma_f32_16x16x32_bf16 v[180:183], v[24:27], a[68:71], v[180:183]
    v_exp_f32 v112, v112
    v_mfma_f32_16x16x32_bf16 v[164:167], v[24:27], a[64:67], v[164:167]
    buffer_load_dwordx4 v2, s[4:7], s47 offen offset:0 lds
    s_waitcnt lgkmcnt(4)
    v_mfma_f32_16x16x32_bf16 v[168:171], v[28:31], a[64:67], v[168:171]
    ds_read_b64_tr_b16 v[24:25], v4 offset:33568
    v_mul_f32 v103, v103, v111
    v_mfma_f32_16x16x32_bf16 v[184:187], v[28:31], a[68:71], v[184:187]
    ds_read_b64_tr_b16 v[26:27], v4 offset:34592
    v_cvt_pk_bf16_f32 v83, v102, v103
    v_mfma_f32_16x16x32_bf16 v[200:203], v[28:31], a[72:75], v[200:203]
    v_exp_f32 v113, v113
    v_mfma_f32_16x16x32_bf16 v[216:219], v[28:31], a[76:79], v[216:219]
    buffer_load_dwordx4 v3, s[4:7], s47 offen offset:1024 lds
    s_waitcnt lgkmcnt(4)
    v_mfma_f32_16x16x32_bf16 v[220:223], v[32:35], a[76:79], v[220:223]
    ds_read_b64_tr_b16 v[28:29], v4 offset:35584
    v_mul_f32 v114, s39, v114
    v_mfma_f32_16x16x32_bf16 v[204:207], v[32:35], a[72:75], v[204:207]
    ds_read_b64_tr_b16 v[30:31], v4 offset:36608
    v_mul_f32 v115, s39, v115
    v_mfma_f32_16x16x32_bf16 v[188:191], v[32:35], a[68:71], v[188:191]
    v_exp_f32 v114, v114
    v_mfma_f32_16x16x32_bf16 v[172:175], v[32:35], a[64:67], v[172:175]
    buffer_load_dwordx4 v2, s[8:11], s47 offen offset:2048 lds
    s_waitcnt lgkmcnt(4)
    v_mfma_f32_16x16x32_bf16 v[160:163], v[20:23], a[80:83], v[160:163]
    ds_read_b64_tr_b16 v[32:33], v4 offset:35616
    v_mul_f32 v116, s39, v116
    v_mfma_f32_16x16x32_bf16 v[176:179], v[20:23], a[84:87], v[176:179]
    ds_read_b64_tr_b16 v[34:35], v4 offset:36640
    v_mul_f32 v117, s39, v117
    v_mfma_f32_16x16x32_bf16 v[192:195], v[20:23], a[88:91], v[192:195]
    v_exp_f32 v115, v115
    v_mfma_f32_16x16x32_bf16 v[208:211], v[20:23], a[92:95], v[208:211]
    buffer_load_dwordx4 v3, s[8:11], s47 offen offset:3072 lds
    s_waitcnt lgkmcnt(4)
    v_mfma_f32_16x16x32_bf16 v[212:215], v[24:27], a[92:95], v[212:215]
    ds_read_b64_tr_b16 v[20:21], v4 offset:49536
    s_add_u32 m0, s33, 0
    v_mfma_f32_16x16x32_bf16 v[196:199], v[24:27], a[88:91], v[196:199]
    ds_read_b64_tr_b16 v[22:23], v4 offset:50560
    s_add_u32 s47, s34, s65
    v_mfma_f32_16x16x32_bf16 v[180:183], v[24:27], a[84:87], v[180:183]
    v_exp_f32 v116, v116
    v_mfma_f32_16x16x32_bf16 v[164:167], v[24:27], a[80:83], v[164:167]
    buffer_load_dwordx4 v2, s[4:7], s47 offen offset:0 lds
    s_waitcnt lgkmcnt(4)
    v_mfma_f32_16x16x32_bf16 v[168:171], v[28:31], a[80:83], v[168:171]
    ds_read_b64_tr_b16 v[24:25], v4 offset:49568
    v_mul_f32 v118, s39, v118
    v_mfma_f32_16x16x32_bf16 v[184:187], v[28:31], a[84:87], v[184:187]
    ds_read_b64_tr_b16 v[26:27], v4 offset:50592
    v_mul_f32 v119, s39, v119
    v_mfma_f32_16x16x32_bf16 v[200:203], v[28:31], a[88:91], v[200:203]
    v_exp_f32 v117, v117
    v_mfma_f32_16x16x32_bf16 v[216:219], v[28:31], a[92:95], v[216:219]
    buffer_load_dwordx4 v3, s[4:7], s47 offen offset:1024 lds
    s_waitcnt lgkmcnt(4)
    v_mfma_f32_16x16x32_bf16 v[220:223], v[32:35], a[92:95], v[220:223]
    ds_read_b64_tr_b16 v[28:29], v4 offset:51584
    v_add_f32 v112, 1.0, v112
    v_mfma_f32_16x16x32_bf16 v[204:207], v[32:35], a[88:91], v[204:207]
    ds_read_b64_tr_b16 v[30:31], v4 offset:52608
    v_add_f32 v113, 1.0, v113
    v_mfma_f32_16x16x32_bf16 v[188:191], v[32:35], a[84:87], v[188:191]
    v_exp_f32 v118, v118
    v_mfma_f32_16x16x32_bf16 v[172:175], v[32:35], a[80:83], v[172:175]
    buffer_load_dwordx4 v2, s[8:11], s47 offen offset:2048 lds
    s_waitcnt lgkmcnt(4)
    v_mfma_f32_16x16x32_bf16 v[160:163], v[20:23], a[96:99], v[160:163]
    ds_read_b64_tr_b16 v[32:33], v4 offset:51616
    v_add_f32 v114, 1.0, v114
    v_mfma_f32_16x16x32_bf16 v[176:179], v[20:23], a[100:103], v[176:179]
    ds_read_b64_tr_b16 v[34:35], v4 offset:52640
    v_add_f32 v115, 1.0, v115
    v_mfma_f32_16x16x32_bf16 v[192:195], v[20:23], a[104:107], v[192:195]
    v_exp_f32 v119, v119
    v_mfma_f32_16x16x32_bf16 v[208:211], v[20:23], a[108:111], v[208:211]
    buffer_load_dwordx4 v3, s[8:11], s47 offen offset:3072 lds
    s_waitcnt lgkmcnt(4)
    v_mfma_f32_16x16x32_bf16 v[212:215], v[24:27], a[108:111], v[212:215]
    ds_read_b64_tr_b16 v[20:21], v4 offset:50048
    v_add_f32 v116, 1.0, v116
    v_mfma_f32_16x16x32_bf16 v[196:199], v[24:27], a[104:107], v[196:199]
    ds_read_b64_tr_b16 v[22:23], v4 offset:51072
    v_add_f32 v117, 1.0, v117
    v_mfma_f32_16x16x32_bf16 v[180:183], v[24:27], a[100:103], v[180:183]
    v_rcp_f32 v112, v112
    v_mfma_f32_16x16x32_bf16 v[164:167], v[24:27], a[96:99], v[164:167]
    v_add_f32 v118, 1.0, v118
    s_waitcnt lgkmcnt(4)
    v_mfma_f32_16x16x32_bf16 v[168:171], v[28:31], a[96:99], v[168:171]
    ds_read_b64_tr_b16 v[24:25], v4 offset:50080
    v_add_f32 v119, 1.0, v119
    v_mfma_f32_16x16x32_bf16 v[184:187], v[28:31], a[100:103], v[184:187]
    ds_read_b64_tr_b16 v[26:27], v4 offset:51104
    v_mul_f32 v112, v112, v120
    v_mfma_f32_16x16x32_bf16 v[200:203], v[28:31], a[104:107], v[200:203]
    v_rcp_f32 v113, v113
    v_mfma_f32_16x16x32_bf16 v[216:219], v[28:31], a[108:111], v[216:219]
    v_mul_f32 v113, v113, v121
    s_waitcnt lgkmcnt(4)
    v_mfma_f32_16x16x32_bf16 v[220:223], v[32:35], a[108:111], v[220:223]
    ds_read_b64_tr_b16 v[28:29], v4 offset:52096
    v_cvt_pk_bf16_f32 v84, v112, v113
    v_mfma_f32_16x16x32_bf16 v[204:207], v[32:35], a[104:107], v[204:207]
    ds_read_b64_tr_b16 v[30:31], v4 offset:53120
    v_mul_f32 v128, s39, v128
    v_mfma_f32_16x16x32_bf16 v[188:191], v[32:35], a[100:103], v[188:191]
    v_rcp_f32 v114, v114
    v_mfma_f32_16x16x32_bf16 v[172:175], v[32:35], a[96:99], v[172:175]
    v_mul_f32 v114, v114, v122
    s_waitcnt lgkmcnt(4)
    v_mfma_f32_16x16x32_bf16 v[160:163], v[20:23], a[112:115], v[160:163]
    ds_read_b64_tr_b16 v[32:33], v4 offset:52128
    v_mul_f32 v129, s39, v129
    v_mfma_f32_16x16x32_bf16 v[176:179], v[20:23], a[116:119], v[176:179]
    ds_read_b64_tr_b16 v[34:35], v4 offset:53152
    v_mul_f32 v130, s39, v130
    v_mfma_f32_16x16x32_bf16 v[192:195], v[20:23], a[120:123], v[192:195]
    v_rcp_f32 v115, v115
    v_mfma_f32_16x16x32_bf16 v[208:211], v[20:23], a[124:127], v[208:211]
    v_mul_f32 v115, v115, v123
    s_waitcnt lgkmcnt(4)
    v_mfma_f32_16x16x32_bf16 v[212:215], v[24:27], a[124:127], v[212:215]
    s_waitcnt vmcnt(12)
    s_barrier
    ds_read_b64_tr_b16 v[20:21], v5 offset:512
    s_add_u32 s34, s34, s3
    v_mfma_f32_16x16x32_bf16 v[196:199], v[24:27], a[120:123], v[196:199]
    ds_read_b64_tr_b16 v[22:23], v5 offset:1536
    s_add_u32 m0, s33, 16512
    v_mfma_f32_16x16x32_bf16 v[180:183], v[24:27], a[116:119], v[180:183]
    v_rcp_f32 v116, v116
    v_mfma_f32_16x16x32_bf16 v[164:167], v[24:27], a[112:115], v[164:167]
    s_add_u32 s47, s34, s57
    s_waitcnt lgkmcnt(4)
    v_mfma_f32_16x16x32_bf16 v[168:171], v[28:31], a[112:115], v[168:171]
    ds_read_b64_tr_b16 v[24:25], v5 offset:544
    v_mul_f32 v116, v116, v124
    v_mfma_f32_16x16x32_bf16 v[184:187], v[28:31], a[116:119], v[184:187]
    ds_read_b64_tr_b16 v[26:27], v5 offset:1568
    v_cvt_pk_bf16_f32 v85, v114, v115
    v_mfma_f32_16x16x32_bf16 v[200:203], v[28:31], a[120:123], v[200:203]
    v_rcp_f32 v117, v117
    v_mfma_f32_16x16x32_bf16 v[216:219], v[28:31], a[124:127], v[216:219]
    buffer_load_dwordx4 v2, s[4:7], s47 offen offset:0 lds
    s_waitcnt lgkmcnt(4)
    v_mfma_f32_16x16x32_bf16 v[220:223], v[32:35], a[124:127], v[220:223]
    ds_read_b64_tr_b16 v[28:29], v5 offset:2560
    v_mul_f32 v117, v117, v125
    v_mfma_f32_16x16x32_bf16 v[204:207], v[32:35], a[120:123], v[204:207]
    ds_read_b64_tr_b16 v[30:31], v5 offset:3584
    v_cvt_pk_bf16_f32 v86, v116, v117
    v_mfma_f32_16x16x32_bf16 v[188:191], v[32:35], a[116:119], v[188:191]
    v_rcp_f32 v118, v118
    v_mfma_f32_16x16x32_bf16 v[172:175], v[32:35], a[112:115], v[172:175]
    buffer_load_dwordx4 v3, s[4:7], s47 offen offset:1024 lds
    s_waitcnt lgkmcnt(4)
    v_mfma_f32_16x16x32_bf16 v[160:163], v[20:23], a[128:131], v[160:163]
    ds_read_b64_tr_b16 v[32:33], v5 offset:2592
    v_mul_f32 v118, v118, v126
    v_mfma_f32_16x16x32_bf16 v[176:179], v[20:23], a[132:135], v[176:179]
    ds_read_b64_tr_b16 v[34:35], v5 offset:3616
    v_mul_f32 v131, s39, v131
    v_mfma_f32_16x16x32_bf16 v[192:195], v[20:23], a[136:139], v[192:195]
    v_rcp_f32 v119, v119
    v_mfma_f32_16x16x32_bf16 v[208:211], v[20:23], a[140:143], v[208:211]
    buffer_load_dwordx4 v2, s[8:11], s47 offen offset:2048 lds
    s_waitcnt lgkmcnt(4)
    v_mfma_f32_16x16x32_bf16 v[212:215], v[24:27], a[140:143], v[212:215]
    ds_read_b64_tr_b16 v[20:21], v5 offset:1024
    v_mul_f32 v119, v119, v127
    v_mfma_f32_16x16x32_bf16 v[196:199], v[24:27], a[136:139], v[196:199]
    ds_read_b64_tr_b16 v[22:23], v5 offset:2048
    v_cvt_pk_bf16_f32 v87, v118, v119
    v_mfma_f32_16x16x32_bf16 v[180:183], v[24:27], a[132:135], v[180:183]
    v_exp_f32 v128, v128
    v_mfma_f32_16x16x32_bf16 v[164:167], v[24:27], a[128:131], v[164:167]
    buffer_load_dwordx4 v3, s[8:11], s47 offen offset:3072 lds
    s_waitcnt lgkmcnt(4)
    v_mfma_f32_16x16x32_bf16 v[168:171], v[28:31], a[128:131], v[168:171]
    ds_read_b64_tr_b16 v[24:25], v5 offset:1056
    s_add_u32 m0, s33, 33024
    v_mfma_f32_16x16x32_bf16 v[184:187], v[28:31], a[132:135], v[184:187]
    ds_read_b64_tr_b16 v[26:27], v5 offset:2080
    s_add_u32 s47, s34, s58
    v_mfma_f32_16x16x32_bf16 v[200:203], v[28:31], a[136:139], v[200:203]
    v_exp_f32 v129, v129
    v_mfma_f32_16x16x32_bf16 v[216:219], v[28:31], a[140:143], v[216:219]
    buffer_load_dwordx4 v2, s[4:7], s47 offen offset:0 lds
    s_waitcnt lgkmcnt(4)
    v_mfma_f32_16x16x32_bf16 v[220:223], v[32:35], a[140:143], v[220:223]
    ds_read_b64_tr_b16 v[28:29], v5 offset:3072
    v_mul_f32 v132, s39, v132
    v_mfma_f32_16x16x32_bf16 v[204:207], v[32:35], a[136:139], v[204:207]
    ds_read_b64_tr_b16 v[30:31], v5 offset:4096
    v_mul_f32 v133, s39, v133
    v_mfma_f32_16x16x32_bf16 v[188:191], v[32:35], a[132:135], v[188:191]
    v_exp_f32 v130, v130
    v_mfma_f32_16x16x32_bf16 v[172:175], v[32:35], a[128:131], v[172:175]
    buffer_load_dwordx4 v3, s[4:7], s47 offen offset:1024 lds
    s_waitcnt lgkmcnt(4)
    v_mfma_f32_16x16x32_bf16 v[160:163], v[20:23], a[144:147], v[160:163]
    ds_read_b64_tr_b16 v[32:33], v5 offset:3104
    v_mul_f32 v134, s39, v134
    v_mfma_f32_16x16x32_bf16 v[176:179], v[20:23], a[148:151], v[176:179]
    ds_read_b64_tr_b16 v[34:35], v5 offset:4128
    v_mul_f32 v135, s39, v135
    v_mfma_f32_16x16x32_bf16 v[192:195], v[20:23], a[152:155], v[192:195]
    v_exp_f32 v131, v131
    v_mfma_f32_16x16x32_bf16 v[208:211], v[20:23], a[156:159], v[208:211]
    buffer_load_dwordx4 v2, s[8:11], s47 offen offset:2048 lds
    s_waitcnt lgkmcnt(4)
    v_mfma_f32_16x16x32_bf16 v[212:215], v[24:27], a[156:159], v[212:215]
    ds_read_b64_tr_b16 v[20:21], v5 offset:37504
    v_add_f32 v128, 1.0, v128
    v_mfma_f32_16x16x32_bf16 v[196:199], v[24:27], a[152:155], v[196:199]
    ds_read_b64_tr_b16 v[22:23], v5 offset:38528
    v_add_f32 v129, 1.0, v129
    v_mfma_f32_16x16x32_bf16 v[180:183], v[24:27], a[148:151], v[180:183]
    v_exp_f32 v132, v132
    v_mfma_f32_16x16x32_bf16 v[164:167], v[24:27], a[144:147], v[164:167]
    buffer_load_dwordx4 v3, s[8:11], s47 offen offset:3072 lds
    s_waitcnt lgkmcnt(4)
    v_mfma_f32_16x16x32_bf16 v[168:171], v[28:31], a[144:147], v[168:171]
    ds_read_b64_tr_b16 v[24:25], v5 offset:37536
    v_add_f32 v130, 1.0, v130
    v_mfma_f32_16x16x32_bf16 v[184:187], v[28:31], a[148:151], v[184:187]
    ds_read_b64_tr_b16 v[26:27], v5 offset:38560
    v_add_f32 v131, 1.0, v131
    v_mfma_f32_16x16x32_bf16 v[200:203], v[28:31], a[152:155], v[200:203]
    v_exp_f32 v133, v133
    v_mfma_f32_16x16x32_bf16 v[216:219], v[28:31], a[156:159], v[216:219]
    v_add_f32 v132, 1.0, v132
    s_waitcnt lgkmcnt(4)
    v_mfma_f32_16x16x32_bf16 v[220:223], v[32:35], a[156:159], v[220:223]
    ds_read_b64_tr_b16 v[28:29], v5 offset:39552
    v_add_f32 v133, 1.0, v133
    v_mfma_f32_16x16x32_bf16 v[204:207], v[32:35], a[152:155], v[204:207]
    ds_read_b64_tr_b16 v[30:31], v5 offset:40576
    v_mul_f32 v144, s39, v144
    v_mfma_f32_16x16x32_bf16 v[188:191], v[32:35], a[148:151], v[188:191]
    v_exp_f32 v134, v134
    v_mfma_f32_16x16x32_bf16 v[172:175], v[32:35], a[144:147], v[172:175]
    v_add_f32 v134, 1.0, v134
    s_waitcnt lgkmcnt(4)
    v_mfma_f32_16x16x32_bf16 v[160:163], v[20:23], a[160:163], v[160:163]
    ds_read_b64_tr_b16 v[32:33], v5 offset:39584
    v_mul_f32 v145, s39, v145
    v_mfma_f32_16x16x32_bf16 v[176:179], v[20:23], a[164:167], v[176:179]
    ds_read_b64_tr_b16 v[34:35], v5 offset:40608
    v_mul_f32 v146, s39, v146
    v_mfma_f32_16x16x32_bf16 v[192:195], v[20:23], a[168:171], v[192:195]
    v_exp_f32 v135, v135
    v_mfma_f32_16x16x32_bf16 v[208:211], v[20:23], a[172:175], v[208:211]
    buffer_load_dword v16, v61, s[80:83], 0 offen offset:0 sc1
    s_waitcnt lgkmcnt(4)
    v_mfma_f32_16x16x32_bf16 v[212:215], v[24:27], a[172:175], v[212:215]
    ds_read_b64_tr_b16 v[20:21], v5 offset:38016
    v_add_f32 v135, 1.0, v135
    v_mfma_f32_16x16x32_bf16 v[196:199], v[24:27], a[168:171], v[196:199]
    ds_read_b64_tr_b16 v[22:23], v5 offset:39040
    v_mul_f32 v147, s39, v147
    v_mfma_f32_16x16x32_bf16 v[180:183], v[24:27], a[164:167], v[180:183]
    v_rcp_f32 v128, v128
    v_mfma_f32_16x16x32_bf16 v[164:167], v[24:27], a[160:163], v[164:167]
    v_mul_f32 v128, v128, v136
    s_waitcnt lgkmcnt(4)
    v_mfma_f32_16x16x32_bf16 v[168:171], v[28:31], a[160:163], v[168:171]
    ds_read_b64_tr_b16 v[24:25], v5 offset:38048
    v_mul_f32 v148, s39, v148
    v_mfma_f32_16x16x32_bf16 v[184:187], v[28:31], a[164:167], v[184:187]
    ds_read_b64_tr_b16 v[26:27], v5 offset:39072
    v_mul_f32 v149, s39, v149
    v_mfma_f32_16x16x32_bf16 v[200:203], v[28:31], a[168:171], v[200:203]
    v_rcp_f32 v129, v129
    v_mfma_f32_16x16x32_bf16 v[216:219], v[28:31], a[172:175], v[216:219]
    v_mul_f32 v129, v129, v137
    s_waitcnt lgkmcnt(4)
    v_mfma_f32_16x16x32_bf16 v[220:223], v[32:35], a[172:175], v[220:223]
    ds_read_b64_tr_b16 v[28:29], v5 offset:40064
    v_cvt_pk_bf16_f32 v88, v128, v129
    v_mfma_f32_16x16x32_bf16 v[204:207], v[32:35], a[168:171], v[204:207]
    ds_read_b64_tr_b16 v[30:31], v5 offset:41088
    v_mul_f32 v150, s39, v150
    v_mfma_f32_16x16x32_bf16 v[188:191], v[32:35], a[164:167], v[188:191]
    v_rcp_f32 v130, v130
    v_mfma_f32_16x16x32_bf16 v[172:175], v[32:35], a[160:163], v[172:175]
    v_mul_f32 v130, v130, v138
    s_waitcnt lgkmcnt(4)
    v_mfma_f32_16x16x32_bf16 v[160:163], v[20:23], a[176:179], v[160:163]
    ds_read_b64_tr_b16 v[32:33], v5 offset:40096
    v_mul_f32 v151, s39, v151
    v_mfma_f32_16x16x32_bf16 v[176:179], v[20:23], a[180:183], v[176:179]
    ds_read_b64_tr_b16 v[34:35], v5 offset:41120
    v_mfma_f32_16x16x32_bf16 v[192:195], v[20:23], a[184:187], v[192:195]
    v_rcp_f32 v131, v131
    v_mfma_f32_16x16x32_bf16 v[208:211], v[20:23], a[188:191], v[208:211]
    v_mul_f32 v131, v131, v139
    s_waitcnt lgkmcnt(4)
    v_mfma_f32_16x16x32_bf16 v[212:215], v[24:27], a[188:191], v[212:215]
    s_waitcnt vmcnt(13)
    s_barrier
    ds_read_b64_tr_b16 v[20:21], v5 offset:54016
    v_add_u32 v72, 82560, v77
    v_mfma_f32_16x16x32_bf16 v[196:199], v[24:27], a[184:187], v[196:199]
    ds_read_b64_tr_b16 v[22:23], v5 offset:55040
    v_xor_b32 v73, 16, v77
    v_mfma_f32_16x16x32_bf16 v[180:183], v[24:27], a[180:183], v[180:183]
    v_rcp_f32 v132, v132
    v_mfma_f32_16x16x32_bf16 v[164:167], v[24:27], a[176:179], v[164:167]
    v_add_u32 v73, 82560, v73
    s_waitcnt lgkmcnt(4)
    v_mfma_f32_16x16x32_bf16 v[168:171], v[28:31], a[176:179], v[168:171]
    ds_read_b64_tr_b16 v[24:25], v5 offset:54048
    v_mul_f32 v132, v132, v140
    v_mfma_f32_16x16x32_bf16 v[184:187], v[28:31], a[180:183], v[184:187]
    ds_read_b64_tr_b16 v[26:27], v5 offset:55072
    v_cvt_pk_bf16_f32 v89, v130, v131
    v_mfma_f32_16x16x32_bf16 v[200:203], v[28:31], a[184:187], v[200:203]
    s_lshl_b32 s36, s32, 10
    s_add_u32 s36, s36, 98944
    v_add_u32 v68, s36, v75
    v_add_u32 v69, s36, v76
    v_mfma_f32_16x16x32_bf16 v[216:219], v[28:31], a[188:191], v[216:219]
    ds_read_b64_tr_b16 v[36:37], v72 offset:0
    s_waitcnt lgkmcnt(5)
    v_mfma_f32_16x16x32_bf16 v[220:223], v[32:35], a[188:191], v[220:223]
    ds_read_b64_tr_b16 v[28:29], v5 offset:56064
    ds_read_b64_tr_b16 v[38:39], v72 offset:512
    v_mfma_f32_16x16x32_bf16 v[204:207], v[32:35], a[184:187], v[204:207]
    ds_read_b64_tr_b16 v[30:31], v5 offset:57088
    ds_read_b64_tr_b16 v[40:41], v73 offset:0
    v_mfma_f32_16x16x32_bf16 v[188:191], v[32:35], a[180:183], v[188:191]
    v_rcp_f32 v133, v133
    v_mfma_f32_16x16x32_bf16 v[172:175], v[32:35], a[176:179], v[172:175]
    s_add_u32 m0, s33, 49536
    s_waitcnt lgkmcnt(7)
    v_mfma_f32_16x16x32_bf16 v[160:163], v[20:23], a[192:195], v[160:163]
    ds_read_b64_tr_b16 v[32:33], v5 offset:56096
    s_add_u32 s47, s34, s59
    v_mfma_f32_16x16x32_bf16 v[176:179], v[20:23], a[196:199], v[176:179]
    ds_read_b64_tr_b16 v[34:35], v5 offset:57120
    ds_read_b64_tr_b16 v[42:43], v73 offset:512
    v_mfma_f32_16x16x32_bf16 v[192:195], v[20:23], a[200:203], v[192:195]
    v_rcp_f32 v134, v134
    v_mfma_f32_16x16x32_bf16 v[208:211], v[20:23], a[204:207], v[208:211]
    buffer_load_dwordx4 v2, s[4:7], s47 offen offset:0 lds
    s_waitcnt lgkmcnt(8)
    v_mfma_f32_16x16x32_bf16 v[212:215], v[24:27], a[204:207], v[212:215]
    ds_read_b64_tr_b16 v[20:21], v5 offset:54528
    ds_read_b64_tr_b16 v[44:45], v72 offset:8192
    v_mfma_f32_16x16x32_bf16 v[196:199], v[24:27], a[200:203], v[196:199]
    ds_read_b64_tr_b16 v[22:23], v5 offset:55552
    ds_read_b64_tr_b16 v[46:47], v72 offset:8704
    v_mfma_f32_16x16x32_bf16 v[180:183], v[24:27], a[196:199], v[180:183]
    s_waitcnt lgkmcnt(9)
    ds_write_b128 v68, v[36:39]
    v_mfma_f32_16x16x32_bf16 v[164:167], v[24:27], a[192:195], v[164:167]
    buffer_load_dwordx4 v3, s[4:7], s47 offen offset:1024 lds
    s_waitcnt lgkmcnt(9)
    v_mfma_f32_16x16x32_bf16 v[168:171], v[28:31], a[192:195], v[168:171]
    ds_read_b64_tr_b16 v[24:25], v5 offset:54560
    ds_read_b128 v[36:39], v69
    v_mfma_f32_16x16x32_bf16 v[184:187], v[28:31], a[196:199], v[184:187]
    ds_read_b64_tr_b16 v[26:27], v5 offset:55584
    ds_read_b64_tr_b16 v[64:65], v73 offset:8192
    v_mfma_f32_16x16x32_bf16 v[200:203], v[28:31], a[200:203], v[200:203]
    v_rcp_f32 v135, v135
    v_mfma_f32_16x16x32_bf16 v[216:219], v[28:31], a[204:207], v[216:219]
    buffer_load_dwordx4 v2, s[8:11], s47 offen offset:2048 lds
    s_waitcnt lgkmcnt(10)
    v_mfma_f32_16x16x32_bf16 v[220:223], v[32:35], a[204:207], v[220:223]
    ds_read_b64_tr_b16 v[28:29], v5 offset:56576
    ds_read_b64_tr_b16 v[66:67], v73 offset:8704
    v_mfma_f32_16x16x32_bf16 v[204:207], v[32:35], a[200:203], v[204:207]
    ds_read_b64_tr_b16 v[30:31], v5 offset:57600
    v_mul_f32 v133, v133, v141
    v_mfma_f32_16x16x32_bf16 v[188:191], v[32:35], a[196:199], v[188:191]
    v_exp_f32 v144, v144
    v_mfma_f32_16x16x32_bf16 v[172:175], v[32:35], a[192:195], v[172:175]
    buffer_load_dwordx4 v3, s[8:11], s47 offen offset:3072 lds
    s_waitcnt lgkmcnt(9)
    v_mfma_f32_16x16x32_bf16 v[160:163], v[20:23], a[208:211], v[160:163]
    ds_read_b64_tr_b16 v[32:33], v5 offset:56608
    s_add_u32 m0, s33, 66048
    v_mfma_f32_16x16x32_bf16 v[176:179], v[20:23], a[212:215], v[176:179]
    ds_read_b64_tr_b16 v[34:35], v5 offset:57632
    s_add_u32 s47, s34, s60
    v_mfma_f32_16x16x32_bf16 v[192:195], v[20:23], a[216:219], v[192:195]
    ds_write_b128 v68, v[40:43]
    v_mfma_f32_16x16x32_bf16 v[208:211], v[20:23], a[220:223], v[208:211]
    s_mov_b32 s100, 1048576
    s_waitcnt lgkmcnt(8)
    buffer_store_dwordx4 v[36:39], v78, s[16:19], s100 offen sc1
    s_waitcnt lgkmcnt(7)
    v_mfma_f32_16x16x32_bf16 v[212:215], v[24:27], a[220:223], v[212:215]
    ds_read_b64_tr_b16 v[20:21], v6 offset:4992
    ds_read_b128 v[40:43], v69
    v_mfma_f32_16x16x32_bf16 v[196:199], v[24:27], a[216:219], v[196:199]
    ds_read_b64_tr_b16 v[22:23], v6 offset:6016
    v_mul_f32 v134, v134, v142
    v_mfma_f32_16x16x32_bf16 v[180:183], v[24:27], a[212:215], v[180:183]
    v_exp_f32 v145, v145
    v_mfma_f32_16x16x32_bf16 v[164:167], v[24:27], a[208:211], v[164:167]
    buffer_load_dwordx4 v2, s[4:7], s47 offen offset:0 lds
    s_waitcnt lgkmcnt(6)
    v_mfma_f32_16x16x32_bf16 v[168:171], v[28:31], a[208:211], v[168:171]
    ds_read_b64_tr_b16 v[24:25], v6 offset:5024
    v_mul_f32 v135, v135, v143
    v_mfma_f32_16x16x32_bf16 v[184:187], v[28:31], a[212:215], v[184:187]
    ds_read_b64_tr_b16 v[26:27], v6 offset:6048
    v_cvt_pk_bf16_f32 v90, v132, v133
    v_mfma_f32_16x16x32_bf16 v[200:203], v[28:31], a[216:219], v[200:203]
    v_exp_f32 v146, v146
    v_mfma_f32_16x16x32_bf16 v[216:219], v[28:31], a[220:223], v[216:219]
    buffer_load_dwordx4 v3, s[4:7], s47 offen offset:1024 lds
    s_waitcnt lgkmcnt(6)
    v_mfma_f32_16x16x32_bf16 v[220:223], v[32:35], a[220:223], v[220:223]
    ds_read_b64_tr_b16 v[28:29], v6 offset:7040
    v_cvt_pk_bf16_f32 v91, v134, v135
    v_mfma_f32_16x16x32_bf16 v[204:207], v[32:35], a[216:219], v[204:207]
    ds_read_b64_tr_b16 v[30:31], v6 offset:8064
    v_add_f32 v144, 1.0, v144
    v_mfma_f32_16x16x32_bf16 v[188:191], v[32:35], a[212:215], v[188:191]
    ds_write_b128 v68, v[44:47]
    v_mfma_f32_16x16x32_bf16 v[172:175], v[32:35], a[208:211], v[172:175]
    s_mov_b32 s100, 1049600
    s_waitcnt lgkmcnt(6)
    buffer_store_dwordx4 v[40:43], v78, s[16:19], s100 offen sc1
    s_waitcnt lgkmcnt(5)
    v_mfma_f32_16x16x32_bf16 v[160:163], v[20:23], a[224:227], v[160:163]
    ds_read_b64_tr_b16 v[32:33], v6 offset:7072
    ds_read_b128 v[44:47], v69
    v_mfma_f32_16x16x32_bf16 v[176:179], v[20:23], a[228:231], v[176:179]
    ds_read_b64_tr_b16 v[34:35], v6 offset:8096
    v_add_f32 v145, 1.0, v145
    v_mfma_f32_16x16x32_bf16 v[192:195], v[20:23], a[232:235], v[192:195]
    v_exp_f32 v147, v147
    v_mfma_f32_16x16x32_bf16 v[208:211], v[20:23], a[236:239], v[208:211]
    buffer_load_dwordx4 v2, s[8:11], s47 offen offset:2048 lds
    s_waitcnt lgkmcnt(6)
    v_mfma_f32_16x16x32_bf16 v[212:215], v[24:27], a[236:239], v[212:215]
    ds_read_b64_tr_b16 v[20:21], v6 offset:5504
    v_add_f32 v146, 1.0, v146
    v_mfma_f32_16x16x32_bf16 v[196:199], v[24:27], a[232:235], v[196:199]
    ds_read_b64_tr_b16 v[22:23], v6 offset:6528
    v_add_f32 v147, 1.0, v147
    v_mfma_f32_16x16x32_bf16 v[180:183], v[24:27], a[228:231], v[180:183]
    v_exp_f32 v148, v148
    v_mfma_f32_16x16x32_bf16 v[164:167], v[24:27], a[224:227], v[164:167]
    buffer_load_dwordx4 v3, s[8:11], s47 offen offset:3072 lds
    s_waitcnt lgkmcnt(6)
    v_mfma_f32_16x16x32_bf16 v[168:171], v[28:31], a[224:227], v[168:171]
    ds_read_b64_tr_b16 v[24:25], v6 offset:5536
    v_add_f32 v148, 1.0, v148
    v_mfma_f32_16x16x32_bf16 v[184:187], v[28:31], a[228:231], v[184:187]
    ds_read_b64_tr_b16 v[26:27], v6 offset:6560
    v_mfma_f32_16x16x32_bf16 v[200:203], v[28:31], a[232:235], v[200:203]
    s_waitcnt vmcnt(10)
    v_cmp_eq_u32 vcc, 0, v16
    s_cbranch_vccnz L_slow_tag
L_ret_tag:
    v_mfma_f32_16x16x32_bf16 v[216:219], v[28:31], a[236:239], v[216:219]
    s_mov_b32 s100, 4194304
    s_waitcnt lgkmcnt(5)
    buffer_store_dwordx4 v[44:47], v78, s[16:19], s100 offen sc1
    s_waitcnt lgkmcnt(4)
    v_mfma_f32_16x16x32_bf16 v[220:223], v[32:35], a[236:239], v[220:223]
    ds_read_b64_tr_b16 v[28:29], v6 offset:7552
    v_mov_b32 v17, v16
    v_mfma_f32_16x16x32_bf16 v[204:207], v[32:35], a[232:235], v[204:207]
    ds_read_b64_tr_b16 v[30:31], v6 offset:8576
    v_readfirstlane_b32 s66, v16
    v_mfma_f32_16x16x32_bf16 v[188:191], v[32:35], a[228:231], v[188:191]
    ds_write_b128 v68, v[64:67]
    v_mfma_f32_16x16x32_bf16 v[172:175], v[32:35], a[224:227], v[172:175]
    ds_read_b128 v[64:67], v69
    s_waitcnt lgkmcnt(6)
    v_mfma_f32_16x16x32_bf16 v[160:163], v[20:23], a[240:243], v[160:163]
    ds_read_b64_tr_b16 v[32:33], v6 offset:7584
    v_mfma_f32_16x16x32_bf16 v[176:179], v[20:23], a[244:247], v[176:179]
    ds_read_b64_tr_b16 v[34:35], v6 offset:8608
    v_mfma_f32_16x16x32_bf16 v[192:195], v[20:23], a[248:251], v[192:195]
    v_exp_f32 v149, v149
    v_mfma_f32_16x16x32_bf16 v[208:211], v[20:23], a[252:255], v[208:211]
    v_add_f32 v149, 1.0, v149
    s_waitcnt lgkmcnt(6)
    v_mfma_f32_16x16x32_bf16 v[212:215], v[24:27], a[252:255], v[212:215]
    s_barrier
    ds_read_b64_tr_b16 v[20:21], v4 offset:0
    s_add_u32 m0, s33, 103040
    v_mfma_f32_16x16x32_bf16 v[196:199], v[24:27], a[248:251], v[196:199]
    ds_read_b64_tr_b16 v[22:23], v4 offset:1024
    s_add_u32 s47, s34, s61
    v_mfma_f32_16x16x32_bf16 v[180:183], v[24:27], a[244:247], v[180:183]
    v_exp_f32 v150, v150
    v_mfma_f32_16x16x32_bf16 v[164:167], v[24:27], a[240:243], v[164:167]
    s_mov_b32 s100, 4195328
    s_waitcnt lgkmcnt(4)
    buffer_store_dwordx4 v[64:67], v78, s[16:19], s100 offen sc1
    v_mfma_f32_16x16x32_bf16 v[168:171], v[28:31], a[240:243], v[168:171]
    ds_read_b64_tr_b16 v[24:25], v4 offset:32
    v_add_f32 v150, 1.0, v150
    v_mfma_f32_16x16x32_bf16 v[184:187], v[28:31], a[244:247], v[184:187]
    ds_read_b64_tr_b16 v[26:27], v4 offset:1056
    v_mfma_f32_16x16x32_bf16 v[200:203], v[28:31], a[248:251], v[200:203]
    v_exp_f32 v151, v151
    v_mfma_f32_16x16x32_bf16 v[216:219], v[28:31], a[252:255], v[216:219]
    buffer_load_dwordx4 v2, s[4:7], s47 offen offset:0 lds
    s_waitcnt lgkmcnt(4)
    v_mfma_f32_16x16x32_bf16 v[220:223], v[32:35], a[252:255], v[220:223]
    ds_read_b64_tr_b16 v[28:29], v4 offset:2048
    v_add_f32 v151, 1.0, v151
    v_mfma_f32_16x16x32_bf16 v[204:207], v[32:35], a[248:251], v[204:207]
    ds_read_b64_tr_b16 v[30:31], v4 offset:3072
    v_mfma_f32_16x16x32_bf16 v[188:191], v[32:35], a[244:247], v[188:191]
    v_rcp_f32 v144, v144
    v_mfma_f32_16x16x32_bf16 v[172:175], v[32:35], a[240:243], v[172:175]
    buffer_load_dwordx4 v3, s[4:7], s47 offen offset:1024 lds
    s_waitcnt lgkmcnt(4)
    v_mfma_f32_16x16x32_bf16 v[160:163], v[20:23], v[224:227], v[160:163]
    ds_read_b64_tr_b16 v[32:33], v4 offset:2080
    v_mul_f32 v144, v144, v152
    v_mfma_f32_16x16x32_bf16 v[176:179], v[20:23], v[228:231], v[176:179]
    ds_read_b64_tr_b16 v[34:35], v4 offset:3104
    v_mfma_f32_16x16x32_bf16 v[192:195], v[20:23], v[232:235], v[192:195]
    v_rcp_f32 v145, v145
    v_mfma_f32_16x16x32_bf16 v[208:211], v[20:23], v[236:239], v[208:211]
    buffer_load_dwordx4 v2, s[8:11], s47 offen offset:2048 lds
    s_waitcnt lgkmcnt(4)
    v_mfma_f32_16x16x32_bf16 v[212:215], v[24:27], v[236:239], v[212:215]
    ds_read_b64_tr_b16 v[20:21], v4 offset:512
    v_mul_f32 v145, v145, v153
    v_mfma_f32_16x16x32_bf16 v[196:199], v[24:27], v[232:235], v[196:199]
    ds_read_b64_tr_b16 v[22:23], v4 offset:1536
    v_cvt_pk_bf16_f32 v92, v144, v145
    v_mfma_f32_16x16x32_bf16 v[180:183], v[24:27], v[228:231], v[180:183]
    v_rcp_f32 v146, v146
    v_mfma_f32_16x16x32_bf16 v[164:167], v[24:27], v[224:227], v[164:167]
    buffer_load_dwordx4 v3, s[8:11], s47 offen offset:3072 lds
    s_waitcnt lgkmcnt(4)
    v_mfma_f32_16x16x32_bf16 v[168:171], v[28:31], v[224:227], v[168:171]
    ds_read_b64_tr_b16 v[24:25], v4 offset:544
    s_add_u32 m0, s33, 119552
    v_mfma_f32_16x16x32_bf16 v[184:187], v[28:31], v[228:231], v[184:187]
    ds_read_b64_tr_b16 v[26:27], v4 offset:1568
    s_add_u32 s47, s34, s62
    v_mfma_f32_16x16x32_bf16 v[200:203], v[28:31], v[232:235], v[200:203]
    v_rcp_f32 v147, v147
    v_mfma_f32_16x16x32_bf16 v[216:219], v[28:31], v[236:239], v[216:219]
    buffer_load_dwordx4 v2, s[4:7], s47 offen offset:0 lds
    s_waitcnt lgkmcnt(4)
    v_mfma_f32_16x16x32_bf16 v[220:223], v[32:35], v[236:239], v[220:223]
    ds_read_b64_tr_b16 v[28:29], v4 offset:2560
    v_mul_f32 v146, v146, v154
    v_mfma_f32_16x16x32_bf16 v[204:207], v[32:35], v[232:235], v[204:207]
    ds_read_b64_tr_b16 v[30:31], v4 offset:3584
    v_mul_f32 v147, v147, v155
    v_mfma_f32_16x16x32_bf16 v[188:191], v[32:35], v[228:231], v[188:191]
    v_rcp_f32 v148, v148
    v_mfma_f32_16x16x32_bf16 v[172:175], v[32:35], v[224:227], v[172:175]
    buffer_load_dwordx4 v3, s[4:7], s47 offen offset:1024 lds
    s_waitcnt lgkmcnt(4)
    v_mfma_f32_16x16x32_bf16 v[160:163], v[20:23], v[240:243], v[160:163]
    ds_read_b64_tr_b16 v[32:33], v4 offset:2592
    v_mul_f32 v148, v148, v156
    v_mfma_f32_16x16x32_bf16 v[176:179], v[20:23], v[244:247], v[176:179]
    ds_read_b64_tr_b16 v[34:35], v4 offset:3616
    v_cvt_pk_bf16_f32 v93, v146, v147
    v_mfma_f32_16x16x32_bf16 v[192:195], v[20:23], v[248:251], v[192:195]
    v_rcp_f32 v149, v149
    v_mfma_f32_16x16x32_bf16 v[208:211], v[20:23], v[252:255], v[208:211]
    buffer_load_dwordx4 v2, s[8:11], s47 offen offset:2048 lds
    s_waitcnt lgkmcnt(4)
    v_mfma_f32_16x16x32_bf16 v[212:215], v[24:27], v[252:255], v[212:215]
    ds_read_b64_tr_b16 v[20:21], v4 offset:16512
    v_mul_f32 v149, v149, v157
    v_mfma_f32_16x16x32_bf16 v[196:199], v[24:27], v[248:251], v[196:199]
    ds_read_b64_tr_b16 v[22:23], v4 offset:17536
    v_cvt_pk_bf16_f32 v94, v148, v149
    v_mfma_f32_16x16x32_bf16 v[180:183], v[24:27], v[244:247], v[180:183]
    v_rcp_f32 v150, v150
    v_mfma_f32_16x16x32_bf16 v[164:167], v[24:27], v[240:243], v[164:167]
    buffer_load_dwordx4 v3, s[8:11], s47 offen offset:3072 lds
    s_waitcnt lgkmcnt(4)
    v_mfma_f32_16x16x32_bf16 v[168:171], v[28:31], v[240:243], v[168:171]
    ds_read_b64_tr_b16 v[24:25], v4 offset:16544
    v_mul_f32 v150, v150, v158
    v_mfma_f32_16x16x32_bf16 v[184:187], v[28:31], v[244:247], v[184:187]
    ds_read_b64_tr_b16 v[26:27], v4 offset:17568
    v_mfma_f32_16x16x32_bf16 v[200:203], v[28:31], v[248:251], v[200:203]
    v_rcp_f32 v151, v151
    v_mfma_f32_16x16x32_bf16 v[216:219], v[28:31], v[252:255], v[216:219]
    v_mul_f32 v151, v151, v159
    s_waitcnt lgkmcnt(4)
    v_mfma_f32_16x16x32_bf16 v[220:223], v[32:35], v[252:255], v[220:223]
    ds_read_b64_tr_b16 v[28:29], v4 offset:18560
    v_cvt_pk_bf16_f32 v95, v150, v151
    v_mfma_f32_16x16x32_bf16 v[204:207], v[32:35], v[248:251], v[204:207]
    ds_read_b64_tr_b16 v[30:31], v4 offset:19584
    v_mfma_f32_16x16x32_bf16 v[188:191], v[32:35], v[244:247], v[188:191]
    v_mfma_f32_16x16x32_bf16 v[172:175], v[32:35], v[240:243], v[172:175]
    s_cmp_eq_u32 s42, 3
    s_cbranch_scc1 L_conv
    s_waitcnt lgkmcnt(4)
    v_mfma_f32_16x16x32_bf16 v[96:99], v[20:23], a[0:3], 0
    ds_read_b64_tr_b16 v[32:33], v4 offset:18592
    v_bfe_u32 v10, v1, 1, 1
    v_mfma_f32_16x16x32_bf16 v[112:115], v[20:23], a[4:7], 0
    ds_read_b64_tr_b16 v[34:35], v4 offset:19616
    v_and_b32 v10, v10, v1
    v_mfma_f32_16x16x32_bf16 v[128:131], v[20:23], a[8:11], 0
    v_lshlrev_b32 v10, 10, v10
    v_sub_u32 v10, v15, v10
    v_mfma_f32_16x16x32_bf16 v[144:147], v[20:23], a[12:15], 0
    v_mov_b32 v60, v48
    s_waitcnt lgkmcnt(4)
    v_mfma_f32_16x16x32_bf16 v[148:151], v[24:27], a[12:15], 0
    ds_read_b64_tr_b16 v[20:21], v4 offset:17024
    v_mov_b32 v61, v49
    v_mfma_f32_16x16x32_bf16 v[132:135], v[24:27], a[8:11], 0
    ds_read_b64_tr_b16 v[22:23], v4 offset:18048
    v_mov_b32 v8, v50
    v_mfma_f32_16x16x32_bf16 v[116:119], v[24:27], a[4:7], 0
    v_mov_b32 v9, v51
    v_mul_f32 v160, s39, v160
    v_mfma_f32_16x16x32_bf16 v[100:103], v[24:27], a[0:3], 0
    v_mul_f32 v161, s39, v161
    s_waitcnt lgkmcnt(4)
    v_mfma_f32_16x16x32_bf16 v[104:107], v[28:31], a[0:3], 0
    ds_read_b64_tr_b16 v[24:25], v4 offset:17056
    v_mul_f32 v162, s39, v162
    v_mfma_f32_16x16x32_bf16 v[120:123], v[28:31], a[4:7], 0
    ds_read_b64_tr_b16 v[26:27], v4 offset:18080
    v_mul_f32 v163, s39, v163
    v_mfma_f32_16x16x32_bf16 v[136:139], v[28:31], a[8:11], 0
    v_exp_f32 v160, v160
    v_mfma_f32_16x16x32_bf16 v[152:155], v[28:31], a[12:15], 0
    v_mul_f32 v164, s39, v164
    s_waitcnt lgkmcnt(4)
    v_mfma_f32_16x16x32_bf16 v[156:159], v[32:35], a[12:15], 0
    ds_read_b64_tr_b16 v[28:29], v4 offset:19072
    v_mul_f32 v165, s39, v165
    v_mfma_f32_16x16x32_bf16 v[140:143], v[32:35], a[8:11], 0
    ds_read_b64_tr_b16 v[30:31], v4 offset:20096
    v_mul_f32 v166, s39, v166
    v_mfma_f32_16x16x32_bf16 v[124:127], v[32:35], a[4:7], 0
    v_exp_f32 v161, v161
    v_mfma_f32_16x16x32_bf16 v[108:111], v[32:35], a[0:3], 0
    v_mul_f32 v167, s39, v167
    s_waitcnt lgkmcnt(4)
    v_mfma_f32_16x16x32_bf16 v[96:99], v[20:23], a[16:19], v[96:99]
    ds_read_b64_tr_b16 v[32:33], v4 offset:19104
    v_add_f32 v160, 1.0, v160
    v_mfma_f32_16x16x32_bf16 v[112:115], v[20:23], a[20:23], v[112:115]
    ds_read_b64_tr_b16 v[34:35], v4 offset:20128
    v_add_f32 v161, 1.0, v161
    v_mfma_f32_16x16x32_bf16 v[128:131], v[20:23], a[24:27], v[128:131]
    v_exp_f32 v162, v162
    v_mfma_f32_16x16x32_bf16 v[144:147], v[20:23], a[28:31], v[144:147]
    v_add_f32 v162, 1.0, v162
    s_waitcnt lgkmcnt(4)
    v_mfma_f32_16x16x32_bf16 v[148:151], v[24:27], a[28:31], v[148:151]
    s_waitcnt vmcnt(16)
    s_barrier
    ds_read_b64_tr_b16 v[20:21], v4 offset:33024
    s_add_u32 m0, s33, 136064
    v_mfma_f32_16x16x32_bf16 v[132:135], v[24:27], a[24:27], v[132:135]
    ds_read_b64_tr_b16 v[22:23], v4 offset:34048
    s_add_u32 s47, s34, s63
    v_mfma_f32_16x16x32_bf16 v[116:119], v[24:27], a[20:23], v[116:119]
    v_exp_f32 v163, v163
    v_mfma_f32_16x16x32_bf16 v[100:103], v[24:27], a[16:19], v[100:103]
    buffer_load_dwordx4 v2, s[4:7], s47 offen offset:0 lds
    s_waitcnt lgkmcnt(4)
    v_mfma_f32_16x16x32_bf16 v[104:107], v[28:31], a[16:19], v[104:107]
    ds_read_b64_tr_b16 v[24:25], v4 offset:33056
    v_add_f32 v163, 1.0, v163
    v_mfma_f32_16x16x32_bf16 v[120:123], v[28:31], a[20:23], v[120:123]
    ds_read_b64_tr_b16 v[26:27], v4 offset:34080
    v_mul_f32 v176, s39, v176
    v_mfma_f32_16x16x32_bf16 v[136:139], v[28:31], a[24:27], v[136:139]
    v_exp_f32 v164, v164
    v_mfma_f32_16x16x32_bf16 v[152:155], v[28:31], a[28:31], v[152:155]
    buffer_load_dwordx4 v3, s[4:7], s47 offen offset:1024 lds
    s_waitcnt lgkmcnt(4)
    v_mfma_f32_16x16x32_bf16 v[156:159], v[32:35], a[28:31], v[156:159]
    ds_read_b64_tr_b16 v[28:29], v4 offset:35072
    v_add_f32 v164, 1.0, v164
    v_mfma_f32_16x16x32_bf16 v[140:143], v[32:35], a[24:27], v[140:143]
    ds_read_b64_tr_b16 v[30:31], v4 offset:36096
    v_mul_f32 v177, s39, v177
    v_mfma_f32_16x16x32_bf16 v[124:127], v[32:35], a[20:23], v[124:127]
    v_exp_f32 v165, v165
    v_mfma_f32_16x16x32_bf16 v[108:111], v[32:35], a[16:19], v[108:111]
    buffer_load_dwordx4 v2, s[8:11], s47 offen offset:2048 lds
    s_waitcnt lgkmcnt(4)
    v_mfma_f32_16x16x32_bf16 v[96:99], v[20:23], a[32:35], v[96:99]
    ds_read_b64_tr_b16 v[32:33], v4 offset:35104
    v_add_f32 v165, 1.0, v165
    v_mfma_f32_16x16x32_bf16 v[112:115], v[20:23], a[36:39], v[112:115]
    ds_read_b64_tr_b16 v[34:35], v4 offset:36128
    v_mul_f32 v178, s39, v178
    v_mfma_f32_16x16x32_bf16 v[128:131], v[20:23], a[40:43], v[128:131]
    v_exp_f32 v166, v166
    v_mfma_f32_16x16x32_bf16 v[144:147], v[20:23], a[44:47], v[144:147]
    buffer_load_dwordx4 v3, s[8:11], s47 offen offset:3072 lds
    s_waitcnt lgkmcnt(4)
    v_mfma_f32_16x16x32_bf16 v[148:151], v[24:27], a[44:47], v[148:151]
    ds_read_b64_tr_b16 v[20:21], v4 offset:33536
    s_add_u32 m0, s33, 0
    v_mfma_f32_16x16x32_bf16 v[132:135], v[24:27], a[40:43], v[132:135]
    ds_read_b64_tr_b16 v[22:23], v4 offset:34560
    s_add_u32 s47, s34, s64
    v_mfma_f32_16x16x32_bf16 v[116:119], v[24:27], a[36:39], v[116:119]
    v_exp_f32 v167, v167
    v_mfma_f32_16x16x32_bf16 v[100:103], v[24:27], a[32:35], v[100:103]
    buffer_load_dwordx4 v2, s[4:7], s47 offen offset:0 lds
    s_waitcnt lgkmcnt(4)
    v_mfma_f32_16x16x32_bf16 v[104:107], v[28:31], a[32:35], v[104:107]
    ds_read_b64_tr_b16 v[24:25], v4 offset:33568
    v_add_f32 v166, 1.0, v166
    v_mfma_f32_16x16x32_bf16 v[120:123], v[28:31], a[36:39], v[120:123]
    ds_read_b64_tr_b16 v[26:27], v4 offset:34592
    v_add_f32 v167, 1.0, v167
    v_mfma_f32_16x16x32_bf16 v[136:139], v[28:31], a[40:43], v[136:139]
    v_rcp_f32 v160, v160
    v_mfma_f32_16x16x32_bf16 v[152:155], v[28:31], a[44:47], v[152:155]
    buffer_load_dwordx4 v3, s[4:7], s47 offen offset:1024 lds
    s_waitcnt lgkmcnt(4)
    v_mfma_f32_16x16x32_bf16 v[156:159], v[32:35], a[44:47], v[156:159]
    ds_read_b64_tr_b16 v[28:29], v4 offset:35584
    v_mul_f32 v160, v160, v168
    v_mfma_f32_16x16x32_bf16 v[140:143], v[32:35], a[40:43], v[140:143]
    ds_read_b64_tr_b16 v[30:31], v4 offset:36608
    v_mul_f32 v179, s39, v179
    v_mfma_f32_16x16x32_bf16 v[124:127], v[32:35], a[36:39], v[124:127]
    v_rcp_f32 v161, v161
    v_mfma_f32_16x16x32_bf16 v[108:111], v[32:35], a[32:35], v[108:111]
    buffer_load_dwordx4 v2, s[8:11], s47 offen offset:2048 lds
    s_waitcnt lgkmcnt(4)
    v_mfma_f32_16x16x32_bf16 v[96:99], v[20:23], a[48:51], v[96:99]
    ds_read_b64_tr_b16 v[32:33], v4 offset:35616
    v_mul_f32 v161, v161, v169
    v_mfma_f32_16x16x32_bf16 v[112:115], v[20:23], a[52:55], v[112:115]
    ds_read_b64_tr_b16 v[34:35], v4 offset:36640
    v_mul_f32 v180, s39, v180
    v_mfma_f32_16x16x32_bf16 v[128:131], v[20:23], a[56:59], v[128:131]
    v_rcp_f32 v162, v162
    v_mfma_f32_16x16x32_bf16 v[144:147], v[20:23], a[60:63], v[144:147]
    buffer_load_dwordx4 v3, s[8:11], s47 offen offset:3072 lds
    s_waitcnt lgkmcnt(4)
    v_mfma_f32_16x16x32_bf16 v[148:151], v[24:27], a[60:63], v[148:151]
    ds_read_b64_tr_b16 v[20:21], v4 offset:49536
    s_add_u32 m0, s33, 82560
    v_mfma_f32_16x16x32_bf16 v[132:135], v[24:27], a[56:59], v[132:135]
    ds_read_b64_tr_b16 v[22:23], v4 offset:50560
    s_add_u32 s47, s34, s65
    v_mfma_f32_16x16x32_bf16 v[116:119], v[24:27], a[52:55], v[116:119]
    v_rcp_f32 v163, v163
    v_mfma_f32_16x16x32_bf16 v[100:103], v[24:27], a[48:51], v[100:103]
    buffer_load_dwordx4 v2, s[4:7], s47 offen offset:0 lds
    s_waitcnt lgkmcnt(4)
    v_mfma_f32_16x16x32_bf16 v[104:107], v[28:31], a[48:51], v[104:107]
    ds_read_b64_tr_b16 v[24:25], v4 offset:49568
    v_mul_f32 v162, v162, v170
    v_mfma_f32_16x16x32_bf16 v[120:123], v[28:31], a[52:55], v[120:123]
    ds_read_b64_tr_b16 v[26:27], v4 offset:50592
    v_mul_f32 v163, v163, v171
    v_mfma_f32_16x16x32_bf16 v[136:139], v[28:31], a[56:59], v[136:139]
    v_rcp_f32 v164, v164
    v_mfma_f32_16x16x32_bf16 v[152:155], v[28:31], a[60:63], v[152:155]
    buffer_load_dwordx4 v3, s[4:7], s47 offen offset:1024 lds
    s_waitcnt lgkmcnt(4)
    v_mfma_f32_16x16x32_bf16 v[156:159], v[32:35], a[60:63], v[156:159]
    ds_read_b64_tr_b16 v[28:29], v4 offset:51584
    v_mul_f32 v164, v164, v172
    v_mfma_f32_16x16x32_bf16 v[140:143], v[32:35], a[56:59], v[140:143]
    ds_read_b64_tr_b16 v[30:31], v4 offset:52608
    v_mul_f32 v181, s39, v181
    v_mfma_f32_16x16x32_bf16 v[124:127], v[32:35], a[52:55], v[124:127]
    v_rcp_f32 v165, v165
    v_mfma_f32_16x16x32_bf16 v[108:111], v[32:35], a[48:51], v[108:111]
    buffer_load_dwordx4 v2, s[8:11], s47 offen offset:2048 lds
    s_waitcnt lgkmcnt(4)
    v_mfma_f32_16x16x32_bf16 v[96:99], v[20:23], a[64:67], v[96:99]
    ds_read_b64_tr_b16 v[32:33], v4 offset:51616
    v_mul_f32 v165, v165, v173
    v_mfma_f32_16x16x32_bf16 v[112:115], v[20:23], a[68:71], v[112:115]
    ds_read_b64_tr_b16 v[34:35], v4 offset:52640
    v_mul_f32 v182, s39, v182
    v_mfma_f32_16x16x32_bf16 v[128:131], v[20:23], a[72:75], v[128:131]
    v_rcp_f32 v166, v166
    v_mfma_f32_16x16x32_bf16 v[144:147], v[20:23], a[76:79], v[144:147]
    buffer_load_dwordx4 v3, s[8:11], s47 offen offset:3072 lds
    s_waitcnt lgkmcnt(4)
    v_mfma_f32_16x16x32_bf16 v[148:151], v[24:27], a[76:79], v[148:151]
    ds_read_b64_tr_b16 v[20:21], v4 offset:50048
    v_mul_f32 v166, v166, v174
    v_mfma_f32_16x16x32_bf16 v[132:135], v[24:27], a[72:75], v[132:135]
    ds_read_b64_tr_b16 v[22:23], v4 offset:51072
    v_mul_f32 v183, s39, v183
    v_mfma_f32_16x16x32_bf16 v[116:119], v[24:27], a[68:71], v[116:119]
    v_rcp_f32 v167, v167
    v_mfma_f32_16x16x32_bf16 v[100:103], v[24:27], a[64:67], v[100:103]
    v_mul_f32 v167, v167, v175
    s_waitcnt lgkmcnt(4)
    v_mfma_f32_16x16x32_bf16 v[104:107], v[28:31], a[64:67], v[104:107]
    ds_read_b64_tr_b16 v[24:25], v4 offset:50080
    v_mul_f32 v192, s39, v192
    v_mfma_f32_16x16x32_bf16 v[120:123], v[28:31], a[68:71], v[120:123]
    ds_read_b64_tr_b16 v[26:27], v4 offset:51104
    v_mul_f32 v193, s39, v193
    v_mfma_f32_16x16x32_bf16 v[136:139], v[28:31], a[72:75], v[136:139]
    v_exp_f32 v176, v176
    v_mfma_f32_16x16x32_bf16 v[152:155], v[28:31], a[76:79], v[152:155]
    v_add_f32 v176, 1.0, v176
    s_waitcnt lgkmcnt(4)
    v_mfma_f32_16x16x32_bf16 v[156:159], v[32:35], a[76:79], v[156:159]
    ds_read_b64_tr_b16 v[28:29], v4 offset:52096
    v_mul_f32 v194, s39, v194
    v_mfma_f32_16x16x32_bf16 v[140:143], v[32:35], a[72:75], v[140:143]
    ds_read_b64_tr_b16 v[30:31], v4 offset:53120
    v_mul_f32 v195, s39, v195
    v_mfma_f32_16x16x32_bf16 v[124:127], v[32:35], a[68:71], v[124:127]
    v_exp_f32 v177, v177
    v_mfma_f32_16x16x32_bf16 v[108:111], v[32:35], a[64:67], v[108:111]
    v_add_f32 v177, 1.0, v177
    s_waitcnt lgkmcnt(4)
    v_mfma_f32_16x16x32_bf16 v[96:99], v[20:23], a[80:83], v[96:99]
    ds_read_b64_tr_b16 v[32:33], v4 offset:52128
    v_mul_f32 v196, s39, v196
    v_mfma_f32_16x16x32_bf16 v[112:115], v[20:23], a[84:87], v[112:115]
    ds_read_b64_tr_b16 v[34:35], v4 offset:53152
    v_mul_f32 v197, s39, v197
    v_mfma_f32_16x16x32_bf16 v[128:131], v[20:23], a[88:91], v[128:131]
    v_exp_f32 v178, v178
    v_mfma_f32_16x16x32_bf16 v[144:147], v[20:23], a[92:95], v[144:147]
    v_add_f32 v178, 1.0, v178
    s_waitcnt lgkmcnt(4)
    v_mfma_f32_16x16x32_bf16 v[148:151], v[24:27], a[92:95], v[148:151]
    s_waitcnt vmcnt(16)
    s_barrier
    ds_read_b64_tr_b16 v[20:21], v5 offset:512
    s_add_u32 s34, s34, s3
    v_mfma_f32_16x16x32_bf16 v[132:135], v[24:27], a[88:91], v[132:135]
    ds_read_b64_tr_b16 v[22:23], v5 offset:1536
    s_add_u32 m0, s33, 16512
    v_mfma_f32_16x16x32_bf16 v[116:119], v[24:27], a[84:87], v[116:119]
    v_exp_f32 v179, v179
    v_mfma_f32_16x16x32_bf16 v[100:103], v[24:27], a[80:83], v[100:103]
    buffer_store_dword v17, v62, s[16:19], 0 offen offset:512 sc1
    s_waitcnt lgkmcnt(4)
    v_mfma_f32_16x16x32_bf16 v[104:107], v[28:31], a[80:83], v[104:107]
    ds_read_b64_tr_b16 v[24:25], v5 offset:544
    s_add_u32 s47, s34, s57
    v_mfma_f32_16x16x32_bf16 v[120:123], v[28:31], a[84:87], v[120:123]
    ds_read_b64_tr_b16 v[26:27], v5 offset:1568
    v_add_f32 v179, 1.0, v179
    v_mfma_f32_16x16x32_bf16 v[136:139], v[28:31], a[88:91], v[136:139]
    v_exp_f32 v180, v180
    v_mfma_f32_16x16x32_bf16 v[152:155], v[28:31], a[92:95], v[152:155]
    buffer_load_dwordx4 v2, s[4:7], s47 offen offset:0 lds
    s_waitcnt lgkmcnt(4)
    v_mfma_f32_16x16x32_bf16 v[156:159], v[32:35], a[92:95], v[156:159]
    ds_read_b64_tr_b16 v[28:29], v5 offset:2560
    v_add_f32 v180, 1.0, v180
    v_mfma_f32_16x16x32_bf16 v[140:143], v[32:35], a[88:91], v[140:143]
    ds_read_b64_tr_b16 v[30:31], v5 offset:3584
    v_mul_f32 v198, s39, v198
    v_mfma_f32_16x16x32_bf16 v[124:127], v[32:35], a[84:87], v[124:127]
    v_exp_f32 v181, v181
    v_mfma_f32_16x16x32_bf16 v[108:111], v[32:35], a[80:83], v[108:111]
    buffer_load_dwordx4 v3, s[4:7], s47 offen offset:1024 lds
    s_waitcnt lgkmcnt(4)
    v_mfma_f32_16x16x32_bf16 v[96:99], v[20:23], a[96:99], v[96:99]
    ds_read_b64_tr_b16 v[32:33], v5 offset:2592
    v_add_f32 v181, 1.0, v181
    v_mfma_f32_16x16x32_bf16 v[112:115], v[20:23], a[100:103], v[112:115]
    ds_read_b64_tr_b16 v[34:35], v5 offset:3616
    v_mul_f32 v199, s39, v199
    v_mfma_f32_16x16x32_bf16 v[128:131], v[20:23], a[104:107], v[128:131]
    v_exp_f32 v182, v182
    v_mfma_f32_16x16x32_bf16 v[144:147], v[20:23], a[108:111], v[144:147]
    buffer_load_dwordx4 v2, s[8:11], s47 offen offset:2048 lds
    s_waitcnt lgkmcnt(4)
    v_mfma_f32_16x16x32_bf16 v[148:151], v[24:27], a[108:111], v[148:151]
    ds_read_b64_tr_b16 v[20:21], v5 offset:1024
    v_add_f32 v182, 1.0, v182
    v_mfma_f32_16x16x32_bf16 v[132:135], v[24:27], a[104:107], v[132:135]
    ds_read_b64_tr_b16 v[22:23], v5 offset:2048
    v_mul_f32 v208, s39, v208
    v_mfma_f32_16x16x32_bf16 v[116:119], v[24:27], a[100:103], v[116:119]
    v_exp_f32 v183, v183
    v_mfma_f32_16x16x32_bf16 v[100:103], v[24:27], a[96:99], v[100:103]
    buffer_load_dwordx4 v3, s[8:11], s47 offen offset:3072 lds
    s_waitcnt lgkmcnt(4)
    v_mfma_f32_16x16x32_bf16 v[104:107], v[28:31], a[96:99], v[104:107]
    ds_read_b64_tr_b16 v[24:25], v5 offset:1056
    s_add_u32 m0, s33, 33024
    v_mfma_f32_16x16x32_bf16 v[120:123], v[28:31], a[100:103], v[120:123]
    ds_read_b64_tr_b16 v[26:27], v5 offset:2080
    s_add_u32 s47, s34, s58
    v_mfma_f32_16x16x32_bf16 v[136:139], v[28:31], a[104:107], v[136:139]
    v_rcp_f32 v176, v176
    v_mfma_f32_16x16x32_bf16 v[152:155], v[28:31], a[108:111], v[152:155]
    buffer_store_dwordx4 v[80:83], v7, s[16:19], s38 offen offset:0 sc1
    s_waitcnt lgkmcnt(4)
    v_mfma_f32_16x16x32_bf16 v[156:159], v[32:35], a[108:111], v[156:159]
    ds_read_b64_tr_b16 v[28:29], v5 offset:3072
    v_add_f32 v183, 1.0, v183
    v_mfma_f32_16x16x32_bf16 v[140:143], v[32:35], a[104:107], v[140:143]
    ds_read_b64_tr_b16 v[30:31], v5 offset:4096
    v_mul_f32 v176, v176, v184
    v_mfma_f32_16x16x32_bf16 v[124:127], v[32:35], a[100:103], v[124:127]
    v_rcp_f32 v177, v177
    v_mfma_f32_16x16x32_bf16 v[108:111], v[32:35], a[96:99], v[108:111]
    buffer_store_dwordx4 v[84:87], v7, s[16:19], s38 offen offset:1024 sc1
    s_waitcnt lgkmcnt(4)
    v_mfma_f32_16x16x32_bf16 v[96:99], v[20:23], a[112:115], v[96:99]
    ds_read_b64_tr_b16 v[32:33], v5 offset:3104
    v_mul_f32 v177, v177, v185
    v_mfma_f32_16x16x32_bf16 v[112:115], v[20:23], a[116:119], v[112:115]
    ds_read_b64_tr_b16 v[34:35], v5 offset:4128
    v_mul_f32 v209, s39, v209
    v_mfma_f32_16x16x32_bf16 v[128:131], v[20:23], a[120:123], v[128:131]
    v_rcp_f32 v178, v178
    v_mfma_f32_16x16x32_bf16 v[144:147], v[20:23], a[124:127], v[144:147]
    buffer_store_dwordx4 v[88:91], v7, s[16:19], s38 offen offset:2048 sc1
    s_waitcnt lgkmcnt(4)
    v_mfma_f32_16x16x32_bf16 v[148:151], v[24:27], a[124:127], v[148:151]
    ds_read_b64_tr_b16 v[20:21], v5 offset:37504
    v_mul_f32 v178, v178, v186
    v_mfma_f32_16x16x32_bf16 v[132:135], v[24:27], a[120:123], v[132:135]
    ds_read_b64_tr_b16 v[22:23], v5 offset:38528
    v_mul_f32 v210, s39, v210
    v_mfma_f32_16x16x32_bf16 v[116:119], v[24:27], a[116:119], v[116:119]
    v_rcp_f32 v179, v179
    v_mfma_f32_16x16x32_bf16 v[100:103], v[24:27], a[112:115], v[100:103]
    buffer_store_dwordx4 v[92:95], v7, s[16:19], s38 offen offset:3072 sc1
    s_waitcnt lgkmcnt(4)
    v_mfma_f32_16x16x32_bf16 v[104:107], v[28:31], a[112:115], v[104:107]
    ds_read_b64_tr_b16 v[24:25], v5 offset:37536
    s_add_u32 s38, s38, s96
    v_mfma_f32_16x16x32_bf16 v[120:123], v[28:31], a[116:119], v[120:123]
    ds_read_b64_tr_b16 v[26:27], v5 offset:38560
    v_min_u32 v19, 2, v1
    v_mfma_f32_16x16x32_bf16 v[136:139], v[28:31], a[120:123], v[136:139]
    s_mul_i32 s98, s43, 3
    s_add_u32 s98, s98, s42
    s_lshl_b32 s98, s98, 2
    s_add_u32 s98, s98, s32
    s_mul_i32 s98, s98, 384
    v_lshl_add_u32 v19, v19, 7, s98
    v_mfma_f32_16x16x32_bf16 v[152:155], v[28:31], a[124:127], v[152:155]
    buffer_load_dwordx4 v2, s[4:7], s47 offen offset:0 lds
    s_waitcnt lgkmcnt(4)
    v_mfma_f32_16x16x32_bf16 v[156:159], v[32:35], a[124:127], v[156:159]
    ds_read_b64_tr_b16 v[28:29], v5 offset:39552
    v_min_u32 v19, (L_code_end - L_cpmlp0 - 64), v19
    v_mfma_f32_16x16x32_bf16 v[140:143], v[32:35], a[120:123], v[140:143]
    ds_read_b64_tr_b16 v[30:31], v5 offset:40576
    v_cvt_pk_bf16_f32 v80, v160, v161
    v_mfma_f32_16x16x32_bf16 v[124:127], v[32:35], a[116:119], v[124:127]
    v_rcp_f32 v180, v180
    v_mfma_f32_16x16x32_bf16 v[108:111], v[32:35], a[112:115], v[108:111]
L_cpmlp0:
    s_getpc_b64 s[98:99]
    global_load_dword v74, v19, s[98:99]
    s_waitcnt lgkmcnt(4)
    v_mfma_f32_16x16x32_bf16 v[96:99], v[20:23], a[128:131], v[96:99]
    ds_read_b64_tr_b16 v[32:33], v5 offset:39584
    v_cvt_pk_bf16_f32 v81, v162, v163
    v_mfma_f32_16x16x32_bf16 v[112:115], v[20:23], a[132:135], v[112:115]
    ds_read_b64_tr_b16 v[34:35], v5 offset:40608
    v_cvt_pk_bf16_f32 v82, v164, v165
    v_mfma_f32_16x16x32_bf16 v[128:131], v[20:23], a[136:139], v[128:131]
    v_rcp_f32 v181, v181
    v_mfma_f32_16x16x32_bf16 v[144:147], v[20:23], a[140:143], v[144:147]
    buffer_load_dwordx4 v3, s[4:7], s47 offen offset:1024 lds
    s_waitcnt lgkmcnt(4)
    v_mfma_f32_16x16x32_bf16 v[148:151], v[24:27], a[140:143], v[148:151]
    ds_read_b64_tr_b16 v[20:21], v5 offset:38016
    v_cvt_pk_bf16_f32 v83, v166, v167
    v_mfma_f32_16x16x32_bf16 v[132:135], v[24:27], a[136:139], v[132:135]
    ds_read_b64_tr_b16 v[22:23], v5 offset:39040
    v_mul_f32 v179, v179, v187
    v_mfma_f32_16x16x32_bf16 v[116:119], v[24:27], a[132:135], v[116:119]
    v_rcp_f32 v182, v182
    v_mfma_f32_16x16x32_bf16 v[100:103], v[24:27], a[128:131], v[100:103]
    buffer_load_dwordx4 v2, s[8:11], s47 offen offset:2048 lds
    s_waitcnt lgkmcnt(4)
    v_mfma_f32_16x16x32_bf16 v[104:107], v[28:31], a[128:131], v[104:107]
    ds_read_b64_tr_b16 v[24:25], v5 offset:38048
    v_mul_f32 v180, v180, v188
    v_mfma_f32_16x16x32_bf16 v[120:123], v[28:31], a[132:135], v[120:123]
    ds_read_b64_tr_b16 v[26:27], v5 offset:39072
    v_mul_f32 v181, v181, v189
    v_mfma_f32_16x16x32_bf16 v[136:139], v[28:31], a[136:139], v[136:139]
    v_rcp_f32 v183, v183
    v_mfma_f32_16x16x32_bf16 v[152:155], v[28:31], a[140:143], v[152:155]
    buffer_load_dwordx4 v3, s[8:11], s47 offen offset:3072 lds
    s_waitcnt lgkmcnt(4)
    v_mfma_f32_16x16x32_bf16 v[156:159], v[32:35], a[140:143], v[156:159]
    ds_read_b64_tr_b16 v[28:29], v5 offset:40064
    v_mul_f32 v182, v182, v190
    v_mfma_f32_16x16x32_bf16 v[140:143], v[32:35], a[136:139], v[140:143]
    ds_read_b64_tr_b16 v[30:31], v5 offset:41088
    v_mul_f32 v183, v183, v191
    v_mfma_f32_16x16x32_bf16 v[124:127], v[32:35], a[132:135], v[124:127]
    v_exp_f32 v192, v192
    v_mfma_f32_16x16x32_bf16 v[108:111], v[32:35], a[128:131], v[108:111]
    v_cvt_pk_bf16_f32 v84, v176, v177
    s_waitcnt lgkmcnt(4)
    v_mfma_f32_16x16x32_bf16 v[96:99], v[20:23], a[144:147], v[96:99]
    ds_read_b64_tr_b16 v[32:33], v5 offset:40096
    v_cvt_pk_bf16_f32 v85, v178, v179
    v_mfma_f32_16x16x32_bf16 v[112:115], v[20:23], a[148:151], v[112:115]
    ds_read_b64_tr_b16 v[34:35], v5 offset:41120
    v_cvt_pk_bf16_f32 v86, v180, v181
    v_mfma_f32_16x16x32_bf16 v[128:131], v[20:23], a[152:155], v[128:131]
    v_exp_f32 v193, v193
    v_mfma_f32_16x16x32_bf16 v[144:147], v[20:23], a[156:159], v[144:147]
    v_cvt_pk_bf16_f32 v87, v182, v183
    s_waitcnt lgkmcnt(4)
    v_mfma_f32_16x16x32_bf16 v[148:151], v[24:27], a[156:159], v[148:151]
    s_waitcnt vmcnt(22)
    s_barrier
    ds_read_b64_tr_b16 v[20:21], v5 offset:54016
    v_add_f32 v192, 1.0, v192
    v_mfma_f32_16x16x32_bf16 v[132:135], v[24:27], a[152:155], v[132:135]
    ds_read_b64_tr_b16 v[22:23], v5 offset:55040
    v_add_f32 v193, 1.0, v193
    v_mfma_f32_16x16x32_bf16 v[116:119], v[24:27], a[148:151], v[116:119]
    v_exp_f32 v194, v194
    v_mfma_f32_16x16x32_bf16 v[100:103], v[24:27], a[144:147], v[100:103]
    v_add_f32 v194, 1.0, v194
    s_waitcnt lgkmcnt(4)
    v_mfma_f32_16x16x32_bf16 v[104:107], v[28:31], a[144:147], v[104:107]
    ds_read_b64_tr_b16 v[24:25], v5 offset:54048
    v_mul_f32 v211, s39, v211
    v_mfma_f32_16x16x32_bf16 v[120:123], v[28:31], a[148:151], v[120:123]
    ds_read_b64_tr_b16 v[26:27], v5 offset:55072
    v_mul_f32 v212, s39, v212
    v_mfma_f32_16x16x32_bf16 v[136:139], v[28:31], a[152:155], v[136:139]
    v_exp_f32 v195, v195
    v_mfma_f32_16x16x32_bf16 v[152:155], v[28:31], a[156:159], v[152:155]
    v_add_f32 v195, 1.0, v195
    s_waitcnt lgkmcnt(4)
    v_mfma_f32_16x16x32_bf16 v[156:159], v[32:35], a[156:159], v[156:159]
    ds_read_b64_tr_b16 v[28:29], v5 offset:56064
    v_mul_f32 v213, s39, v213
    v_mfma_f32_16x16x32_bf16 v[140:143], v[32:35], a[152:155], v[140:143]
    ds_read_b64_tr_b16 v[30:31], v5 offset:57088
    v_mul_f32 v214, s39, v214
    v_mfma_f32_16x16x32_bf16 v[124:127], v[32:35], a[148:151], v[124:127]
    v_exp_f32 v196, v196
    v_mfma_f32_16x16x32_bf16 v[108:111], v[32:35], a[144:147], v[108:111]
    v_add_f32 v196, 1.0, v196
    s_waitcnt lgkmcnt(4)
    v_mfma_f32_16x16x32_bf16 v[96:99], v[20:23], a[160:163], v[96:99]
    ds_read_b64_tr_b16 v[32:33], v5 offset:56096
    v_mul_f32 v215, s39, v215
    v_mfma_f32_16x16x32_bf16 v[112:115], v[20:23], a[164:167], v[112:115]
    ds_read_b64_tr_b16 v[34:35], v5 offset:57120
    v_mfma_f32_16x16x32_bf16 v[128:131], v[20:23], a[168:171], v[128:131]
    v_exp_f32 v197, v197
    v_mfma_f32_16x16x32_bf16 v[144:147], v[20:23], a[172:175], v[144:147]
    v_add_f32 v197, 1.0, v197
    s_waitcnt lgkmcnt(4)
    v_mfma_f32_16x16x32_bf16 v[148:151], v[24:27], a[172:175], v[148:151]
    ds_read_b64_tr_b16 v[20:21], v5 offset:54528
    v_mfma_f32_16x16x32_bf16 v[132:135], v[24:27], a[168:171], v[132:135]
    ds_read_b64_tr_b16 v[22:23], v5 offset:55552
    v_mfma_f32_16x16x32_bf16 v[116:119], v[24:27], a[164:167], v[116:119]
    v_exp_f32 v198, v198
    v_mfma_f32_16x16x32_bf16 v[100:103], v[24:27], a[160:163], v[100:103]
    v_add_f32 v198, 1.0, v198
    s_waitcnt lgkmcnt(4)
    v_mfma_f32_16x16x32_bf16 v[104:107], v[28:31], a[160:163], v[104:107]
    ds_read_b64_tr_b16 v[24:25], v5 offset:54560
    v_mfma_f32_16x16x32_bf16 v[120:123], v[28:31], a[164:167], v[120:123]
    ds_read_b64_tr_b16 v[26:27], v5 offset:55584
    v_mfma_f32_16x16x32_bf16 v[136:139], v[28:31], a[168:171], v[136:139]
    v_exp_f32 v199, v199
    v_mfma_f32_16x16x32_bf16 v[152:155], v[28:31], a[172:175], v[152:155]
    v_add_f32 v199, 1.0, v199
    s_waitcnt lgkmcnt(4)
    v_mfma_f32_16x16x32_bf16 v[156:159], v[32:35], a[172:175], v[156:159]
    ds_read_b64_tr_b16 v[28:29], v5 offset:56576
    v_mfma_f32_16x16x32_bf16 v[140:143], v[32:35], a[168:171], v[140:143]
    ds_read_b64_tr_b16 v[30:31], v5 offset:57600
    v_mfma_f32_16x16x32_bf16 v[124:127], v[32:35], a[164:167], v[124:127]
    v_rcp_f32 v192, v192
    v_mfma_f32_16x16x32_bf16 v[108:111], v[32:35], a[160:163], v[108:111]
    v_mul_f32 v192, v192, v200
    s_waitcnt lgkmcnt(4)
    v_mfma_f32_16x16x32_bf16 v[96:99], v[20:23], a[176:179], v[96:99]
    ds_read_b64_tr_b16 v[32:33], v5 offset:56608
    v_mfma_f32_16x16x32_bf16 v[112:115], v[20:23], a[180:183], v[112:115]
    ds_read_b64_tr_b16 v[34:35], v5 offset:57632
    v_mfma_f32_16x16x32_bf16 v[128:131], v[20:23], a[184:187], v[128:131]
    v_rcp_f32 v193, v193
    v_mfma_f32_16x16x32_bf16 v[144:147], v[20:23], a[188:191], v[144:147]
    s_add_u32 m0, s33, 49536
    s_waitcnt lgkmcnt(4)
    v_mfma_f32_16x16x32_bf16 v[148:151], v[24:27], a[188:191], v[148:151]
    ds_read_b64_tr_b16 v[20:21], v6 offset:4992
    s_add_u32 s47, s34, s59
    v_mfma_f32_16x16x32_bf16 v[132:135], v[24:27], a[184:187], v[132:135]
    ds_read_b64_tr_b16 v[22:23], v6 offset:6016
    v_mul_f32 v193, v193, v201
    v_mfma_f32_16x16x32_bf16 v[116:119], v[24:27], a[180:183], v[116:119]
    v_rcp_f32 v194, v194
    v_mfma_f32_16x16x32_bf16 v[100:103], v[24:27], a[176:179], v[100:103]
    buffer_load_dwordx4 v2, s[4:7], s47 offen offset:0 lds
    s_waitcnt lgkmcnt(4)
    v_mfma_f32_16x16x32_bf16 v[104:107], v[28:31], a[176:179], v[104:107]
    ds_read_b64_tr_b16 v[24:25], v6 offset:5024
    v_mul_f32 v194, v194, v202
    v_mfma_f32_16x16x32_bf16 v[120:123], v[28:31], a[180:183], v[120:123]
    ds_read_b64_tr_b16 v[26:27], v6 offset:6048
    v_cvt_pk_bf16_f32 v88, v192, v193
    v_mfma_f32_16x16x32_bf16 v[136:139], v[28:31], a[184:187], v[136:139]
    v_rcp_f32 v195, v195
    v_mfma_f32_16x16x32_bf16 v[152:155], v[28:31], a[188:191], v[152:155]
    buffer_load_dwordx4 v3, s[4:7], s47 offen offset:1024 lds
    s_waitcnt lgkmcnt(4)
    v_mfma_f32_16x16x32_bf16 v[156:159], v[32:35], a[188:191], v[156:159]
    ds_read_b64_tr_b16 v[28:29], v6 offset:7040
    v_mul_f32 v195, v195, v203
    v_mfma_f32_16x16x32_bf16 v[140:143], v[32:35], a[184:187], v[140:143]
    ds_read_b64_tr_b16 v[30:31], v6 offset:8064
    v_cvt_pk_bf16_f32 v89, v194, v195
    v_mfma_f32_16x16x32_bf16 v[124:127], v[32:35], a[180:183], v[124:127]
    v_rcp_f32 v196, v196
    v_mfma_f32_16x16x32_bf16 v[108:111], v[32:35], a[176:179], v[108:111]
    buffer_load_dwordx4 v2, s[8:11], s47 offen offset:2048 lds
    s_waitcnt lgkmcnt(4)
    v_mfma_f32_16x16x32_bf16 v[96:99], v[20:23], a[192:195], v[96:99]
    ds_read_b64_tr_b16 v[32:33], v6 offset:7072
    v_mul_f32 v196, v196, v204
    v_mfma_f32_16x16x32_bf16 v[112:115], v[20:23], a[196:199], v[112:115]
    ds_read_b64_tr_b16 v[34:35], v6 offset:8096
    v_mfma_f32_16x16x32_bf16 v[128:131], v[20:23], a[200:203], v[128:131]
    v_rcp_f32 v197, v197
    v_mfma_f32_16x16x32_bf16 v[144:147], v[20:23], a[204:207], v[144:147]
    buffer_load_dwordx4 v3, s[8:11], s47 offen offset:3072 lds
    s_waitcnt lgkmcnt(4)
    v_mfma_f32_16x16x32_bf16 v[148:151], v[24:27], a[204:207], v[148:151]
    ds_read_b64_tr_b16 v[20:21], v6 offset:5504
    s_add_u32 m0, s33, 66048
    v_mfma_f32_16x16x32_bf16 v[132:135], v[24:27], a[200:203], v[132:135]
    ds_read_b64_tr_b16 v[22:23], v6 offset:6528
    s_add_u32 s47, s34, s60
    v_mfma_f32_16x16x32_bf16 v[116:119], v[24:27], a[196:199], v[116:119]
    v_rcp_f32 v198, v198
    v_mfma_f32_16x16x32_bf16 v[100:103], v[24:27], a[192:195], v[100:103]
    buffer_load_dwordx4 v2, s[4:7], s47 offen offset:0 lds
    s_waitcnt lgkmcnt(4)
    v_mfma_f32_16x16x32_bf16 v[104:107], v[28:31], a[192:195], v[104:107]
    ds_read_b64_tr_b16 v[24:25], v6 offset:5536
    v_mul_f32 v197, v197, v205
    v_mfma_f32_16x16x32_bf16 v[120:123], v[28:31], a[196:199], v[120:123]
    ds_read_b64_tr_b16 v[26:27], v6 offset:6560
    v_mul_f32 v198, v198, v206
    v_mfma_f32_16x16x32_bf16 v[136:139], v[28:31], a[200:203], v[136:139]
    v_rcp_f32 v199, v199
    v_mfma_f32_16x16x32_bf16 v[152:155], v[28:31], a[204:207], v[152:155]
    buffer_load_dwordx4 v3, s[4:7], s47 offen offset:1024 lds
    s_waitcnt lgkmcnt(4)
    v_mfma_f32_16x16x32_bf16 v[156:159], v[32:35], a[204:207], v[156:159]
    ds_read_b64_tr_b16 v[28:29], v6 offset:7552
    v_mul_f32 v199, v199, v207
    v_mfma_f32_16x16x32_bf16 v[140:143], v[32:35], a[200:203], v[140:143]
    ds_read_b64_tr_b16 v[30:31], v6 offset:8576
    v_cvt_pk_bf16_f32 v90, v196, v197
    v_mfma_f32_16x16x32_bf16 v[124:127], v[32:35], a[196:199], v[124:127]
    v_exp_f32 v208, v208
    v_mfma_f32_16x16x32_bf16 v[108:111], v[32:35], a[192:195], v[108:111]
    buffer_load_dwordx4 v2, s[8:11], s47 offen offset:2048 lds
    s_waitcnt lgkmcnt(4)
    v_mfma_f32_16x16x32_bf16 v[96:99], v[20:23], a[208:211], v[96:99]
    ds_read_b64_tr_b16 v[32:33], v6 offset:7584
    v_cvt_pk_bf16_f32 v91, v198, v199
    v_mfma_f32_16x16x32_bf16 v[112:115], v[20:23], a[212:215], v[112:115]
    ds_read_b64_tr_b16 v[34:35], v6 offset:8608
    v_add_f32 v208, 1.0, v208
    v_mfma_f32_16x16x32_bf16 v[128:131], v[20:23], a[216:219], v[128:131]
    v_exp_f32 v209, v209
    v_mfma_f32_16x16x32_bf16 v[144:147], v[20:23], a[220:223], v[144:147]
    buffer_load_dwordx4 v3, s[8:11], s47 offen offset:3072 lds
    s_waitcnt lgkmcnt(4)
    v_mfma_f32_16x16x32_bf16 v[148:151], v[24:27], a[220:223], v[148:151]
    s_waitcnt vmcnt(22)
    s_barrier
    ds_read_b64_tr_b16 v[20:21], v4 offset:0
    s_add_u32 m0, s33, 99072
    v_mfma_f32_16x16x32_bf16 v[132:135], v[24:27], a[216:219], v[132:135]
    ds_read_b64_tr_b16 v[22:23], v4 offset:1024
    s_add_u32 s47, s34, s61
    v_mfma_f32_16x16x32_bf16 v[116:119], v[24:27], a[212:215], v[116:119]
    v_exp_f32 v210, v210
    v_mfma_f32_16x16x32_bf16 v[100:103], v[24:27], a[208:211], v[100:103]
    buffer_load_dwordx4 v2, s[4:7], s47 offen offset:0 lds
    s_waitcnt lgkmcnt(4)
    v_mfma_f32_16x16x32_bf16 v[104:107], v[28:31], a[208:211], v[104:107]
    ds_read_b64_tr_b16 v[24:25], v4 offset:32
    v_add_f32 v209, 1.0, v209
    v_mfma_f32_16x16x32_bf16 v[120:123], v[28:31], a[212:215], v[120:123]
    ds_read_b64_tr_b16 v[26:27], v4 offset:1056
    v_add_f32 v210, 1.0, v210
    v_mfma_f32_16x16x32_bf16 v[136:139], v[28:31], a[216:219], v[136:139]
    v_exp_f32 v211, v211
    v_mfma_f32_16x16x32_bf16 v[152:155], v[28:31], a[220:223], v[152:155]
    buffer_load_dwordx4 v3, s[4:7], s47 offen offset:1024 lds
    s_waitcnt lgkmcnt(4)
    v_mfma_f32_16x16x32_bf16 v[156:159], v[32:35], a[220:223], v[156:159]
    ds_read_b64_tr_b16 v[28:29], v4 offset:2048
    v_add_f32 v211, 1.0, v211
    v_mfma_f32_16x16x32_bf16 v[140:143], v[32:35], a[216:219], v[140:143]
    ds_read_b64_tr_b16 v[30:31], v4 offset:3072
    v_mfma_f32_16x16x32_bf16 v[124:127], v[32:35], a[212:215], v[124:127]
    v_exp_f32 v212, v212
    v_mfma_f32_16x16x32_bf16 v[108:111], v[32:35], a[208:211], v[108:111]
    buffer_load_dwordx4 v2, s[8:11], s47 offen offset:2048 lds
    s_waitcnt lgkmcnt(4)
    v_mfma_f32_16x16x32_bf16 v[96:99], v[20:23], a[224:227], v[96:99]
    ds_read_b64_tr_b16 v[32:33], v4 offset:2080
    v_add_f32 v212, 1.0, v212
    v_mfma_f32_16x16x32_bf16 v[112:115], v[20:23], a[228:231], v[112:115]
    ds_read_b64_tr_b16 v[34:35], v4 offset:3104
    v_mfma_f32_16x16x32_bf16 v[128:131], v[20:23], a[232:235], v[128:131]
    v_exp_f32 v213, v213
    v_mfma_f32_16x16x32_bf16 v[144:147], v[20:23], a[236:239], v[144:147]
    buffer_load_dwordx4 v3, s[8:11], s47 offen offset:3072 lds
    s_waitcnt lgkmcnt(4)
    v_mfma_f32_16x16x32_bf16 v[148:151], v[24:27], a[236:239], v[148:151]
    ds_read_b64_tr_b16 v[20:21], v4 offset:512
    s_add_u32 m0, s33, 115584
    v_mfma_f32_16x16x32_bf16 v[132:135], v[24:27], a[232:235], v[132:135]
    ds_read_b64_tr_b16 v[22:23], v4 offset:1536
    s_add_u32 s47, s34, s62
    v_mfma_f32_16x16x32_bf16 v[116:119], v[24:27], a[228:231], v[116:119]
    v_exp_f32 v214, v214
    v_mfma_f32_16x16x32_bf16 v[100:103], v[24:27], a[224:227], v[100:103]
    buffer_load_dwordx4 v2, s[4:7], s47 offen offset:0 lds
    s_waitcnt lgkmcnt(4)
    v_mfma_f32_16x16x32_bf16 v[104:107], v[28:31], a[224:227], v[104:107]
    ds_read_b64_tr_b16 v[24:25], v4 offset:544
    v_add_f32 v213, 1.0, v213
    v_mfma_f32_16x16x32_bf16 v[120:123], v[28:31], a[228:231], v[120:123]
    ds_read_b64_tr_b16 v[26:27], v4 offset:1568
    v_add_f32 v214, 1.0, v214
    v_mfma_f32_16x16x32_bf16 v[136:139], v[28:31], a[232:235], v[136:139]
    v_exp_f32 v215, v215
    v_mfma_f32_16x16x32_bf16 v[152:155], v[28:31], a[236:239], v[152:155]
    buffer_load_dwordx4 v3, s[4:7], s47 offen offset:1024 lds
    s_waitcnt lgkmcnt(4)
    v_mfma_f32_16x16x32_bf16 v[156:159], v[32:35], a[236:239], v[156:159]
    ds_read_b64_tr_b16 v[28:29], v4 offset:2560
    v_add_f32 v215, 1.0, v215
    v_mfma_f32_16x16x32_bf16 v[140:143], v[32:35], a[232:235], v[140:143]
    ds_read_b64_tr_b16 v[30:31], v4 offset:3584
    v_mfma_f32_16x16x32_bf16 v[124:127], v[32:35], a[228:231], v[124:127]
    v_rcp_f32 v208, v208
    v_mfma_f32_16x16x32_bf16 v[108:111], v[32:35], a[224:227], v[108:111]
    buffer_load_dwordx4 v2, s[8:11], s47 offen offset:2048 lds
    s_waitcnt lgkmcnt(4)
    v_mfma_f32_16x16x32_bf16 v[96:99], v[20:23], a[240:243], v[96:99]
    ds_read_b64_tr_b16 v[32:33], v4 offset:2592
    v_mul_f32 v208, v208, v216
    v_mfma_f32_16x16x32_bf16 v[112:115], v[20:23], a[244:247], v[112:115]
    ds_read_b64_tr_b16 v[34:35], v4 offset:3616
    v_mfma_f32_16x16x32_bf16 v[128:131], v[20:23], a[248:251], v[128:131]
    v_rcp_f32 v209, v209
    v_mfma_f32_16x16x32_bf16 v[144:147], v[20:23], a[252:255], v[144:147]
    buffer_load_dwordx4 v3, s[8:11], s47 offen offset:3072 lds
    s_waitcnt lgkmcnt(4)
    v_mfma_f32_16x16x32_bf16 v[148:151], v[24:27], a[252:255], v[148:151]
    ds_read_b64_tr_b16 v[20:21], v5 offset:17024
    v_mul_f32 v209, v209, v217
    v_mfma_f32_16x16x32_bf16 v[132:135], v[24:27], a[248:251], v[132:135]
    ds_read_b64_tr_b16 v[22:23], v5 offset:18048
    v_cvt_pk_bf16_f32 v92, v208, v209
    v_mfma_f32_16x16x32_bf16 v[116:119], v[24:27], a[244:247], v[116:119]
    v_rcp_f32 v210, v210
    v_mfma_f32_16x16x32_bf16 v[100:103], v[24:27], a[240:243], v[100:103]
    v_mul_f32 v210, v210, v218
    s_waitcnt lgkmcnt(4)
    v_mfma_f32_16x16x32_bf16 v[104:107], v[28:31], a[240:243], v[104:107]
    ds_read_b64_tr_b16 v[24:25], v5 offset:17056
    v_mfma_f32_16x16x32_bf16 v[120:123], v[28:31], a[244:247], v[120:123]
    ds_read_b64_tr_b16 v[26:27], v5 offset:18080
    v_mfma_f32_16x16x32_bf16 v[136:139], v[28:31], a[248:251], v[136:139]
    v_rcp_f32 v211, v211
    v_mfma_f32_16x16x32_bf16 v[152:155], v[28:31], a[252:255], v[152:155]
    v_mul_f32 v211, v211, v219
    s_waitcnt lgkmcnt(4)
    v_mfma_f32_16x16x32_bf16 v[156:159], v[32:35], a[252:255], v[156:159]
    ds_read_b64_tr_b16 v[28:29], v5 offset:19072
    v_cvt_pk_bf16_f32 v93, v210, v211
    v_mfma_f32_16x16x32_bf16 v[140:143], v[32:35], a[248:251], v[140:143]
    ds_read_b64_tr_b16 v[30:31], v5 offset:20096
    v_mfma_f32_16x16x32_bf16 v[124:127], v[32:35], a[244:247], v[124:127]
    v_rcp_f32 v212, v212
    v_mfma_f32_16x16x32_bf16 v[108:111], v[32:35], a[240:243], v[108:111]
    v_mul_f32 v212, v212, v220
    s_waitcnt lgkmcnt(4)
    v_mfma_f32_16x16x32_bf16 v[96:99], v[20:23], v[224:227], v[96:99]
    ds_read_b64_tr_b16 v[32:33], v5 offset:19104
    v_mfma_f32_16x16x32_bf16 v[112:115], v[20:23], v[228:231], v[112:115]
    ds_read_b64_tr_b16 v[34:35], v5 offset:20128
    v_mfma_f32_16x16x32_bf16 v[128:131], v[20:23], v[232:235], v[128:131]
    v_rcp_f32 v213, v213
    v_mfma_f32_16x16x32_bf16 v[144:147], v[20:23], v[236:239], v[144:147]
    v_mul_f32 v213, v213, v221
    s_waitcnt lgkmcnt(4)
    v_mfma_f32_16x16x32_bf16 v[148:151], v[24:27], v[236:239], v[148:151]
    ds_read_b64_tr_b16 v[20:21], v5 offset:17536
    v_cvt_pk_bf16_f32 v94, v212, v213
    v_mfma_f32_16x16x32_bf16 v[132:135], v[24:27], v[232:235], v[132:135]
    ds_read_b64_tr_b16 v[22:23], v5 offset:18560
    v_mfma_f32_16x16x32_bf16 v[116:119], v[24:27], v[228:231], v[116:119]
    v_rcp_f32 v214, v214
    v_mfma_f32_16x16x32_bf16 v[100:103], v[24:27], v[224:227], v[100:103]
    v_mul_f32 v214, v214, v222
    s_waitcnt lgkmcnt(4)
    v_mfma_f32_16x16x32_bf16 v[104:107], v[28:31], v[224:227], v[104:107]
    ds_read_b64_tr_b16 v[24:25], v5 offset:17568
    v_mfma_f32_16x16x32_bf16 v[120:123], v[28:31], v[228:231], v[120:123]
    ds_read_b64_tr_b16 v[26:27], v5 offset:18592
    v_mfma_f32_16x16x32_bf16 v[136:139], v[28:31], v[232:235], v[136:139]
    v_rcp_f32 v215, v215
    v_mfma_f32_16x16x32_bf16 v[152:155], v[28:31], v[236:239], v[152:155]
    v_mul_f32 v215, v215, v223
    s_waitcnt lgkmcnt(4)
    v_mfma_f32_16x16x32_bf16 v[156:159], v[32:35], v[236:239], v[156:159]
    ds_read_b64_tr_b16 v[28:29], v5 offset:19584
    v_cvt_pk_bf16_f32 v95, v214, v215
    v_mfma_f32_16x16x32_bf16 v[140:143], v[32:35], v[232:235], v[140:143]
    ds_read_b64_tr_b16 v[30:31], v5 offset:20608
    v_mfma_f32_16x16x32_bf16 v[124:127], v[32:35], v[228:231], v[124:127]
    v_mfma_f32_16x16x32_bf16 v[108:111], v[32:35], v[224:227], v[108:111]
    s_waitcnt lgkmcnt(4)
    v_mfma_f32_16x16x32_bf16 v[96:99], v[20:23], v[240:243], v[96:99]
    ds_read_b64_tr_b16 v[32:33], v5 offset:19616
    v_mfma_f32_16x16x32_bf16 v[112:115], v[20:23], v[244:247], v[112:115]
    ds_read_b64_tr_b16 v[34:35], v5 offset:20640
    v_mfma_f32_16x16x32_bf16 v[128:131], v[20:23], v[248:251], v[128:131]
    v_mfma_f32_16x16x32_bf16 v[144:147], v[20:23], v[252:255], v[144:147]
    s_waitcnt lgkmcnt(4)
    v_mfma_f32_16x16x32_bf16 v[148:151], v[24:27], v[252:255], v[148:151]
    s_waitcnt vmcnt(16)
    s_barrier
    ds_read_b64_tr_b16 v[20:21], v4 offset:16512
    s_add_u32 m0, s33, 132096
    v_mfma_f32_16x16x32_bf16 v[132:135], v[24:27], v[248:251], v[132:135]
    ds_read_b64_tr_b16 v[22:23], v4 offset:17536
    s_add_u32 s47, s34, s63
    v_mfma_f32_16x16x32_bf16 v[116:119], v[24:27], v[244:247], v[116:119]
    v_mfma_f32_16x16x32_bf16 v[100:103], v[24:27], v[240:243], v[100:103]
    buffer_load_dwordx4 v2, s[4:7], s47 offen offset:0 lds
    s_waitcnt lgkmcnt(4)
    v_mfma_f32_16x16x32_bf16 v[104:107], v[28:31], v[240:243], v[104:107]
    ds_read_b64_tr_b16 v[24:25], v4 offset:16544
    v_mfma_f32_16x16x32_bf16 v[120:123], v[28:31], v[244:247], v[120:123]
    ds_read_b64_tr_b16 v[26:27], v4 offset:17568
    v_mfma_f32_16x16x32_bf16 v[136:139], v[28:31], v[248:251], v[136:139]
    v_mfma_f32_16x16x32_bf16 v[152:155], v[28:31], v[252:255], v[152:155]
    buffer_load_dwordx4 v3, s[4:7], s47 offen offset:1024 lds
    s_waitcnt lgkmcnt(4)
    v_mfma_f32_16x16x32_bf16 v[156:159], v[32:35], v[252:255], v[156:159]
    ds_read_b64_tr_b16 v[28:29], v4 offset:18560
    v_mfma_f32_16x16x32_bf16 v[140:143], v[32:35], v[248:251], v[140:143]
    ds_read_b64_tr_b16 v[30:31], v4 offset:19584
    v_mfma_f32_16x16x32_bf16 v[124:127], v[32:35], v[244:247], v[124:127]
    v_mfma_f32_16x16x32_bf16 v[108:111], v[32:35], v[240:243], v[108:111]
    buffer_load_dwordx4 v2, s[8:11], s47 offen offset:2048 lds
    s_waitcnt lgkmcnt(4)
    v_mfma_f32_16x16x32_bf16 v[160:163], v[20:23], a[0:3], 0
    ds_read_b64_tr_b16 v[32:33], v4 offset:18592
    v_mfma_f32_16x16x32_bf16 v[176:179], v[20:23], a[4:7], 0
    ds_read_b64_tr_b16 v[34:35], v4 offset:19616
    v_mfma_f32_16x16x32_bf16 v[192:195], v[20:23], a[8:11], 0
    v_mfma_f32_16x16x32_bf16 v[208:211], v[20:23], a[12:15], 0
    buffer_load_dwordx4 v3, s[8:11], s47 offen offset:3072 lds
    s_waitcnt lgkmcnt(4)
    v_mfma_f32_16x16x32_bf16 v[212:215], v[24:27], a[12:15], 0
    ds_read_b64_tr_b16 v[20:21], v4 offset:17024
    s_add_u32 m0, s33, 0
    v_mfma_f32_16x16x32_bf16 v[196:199], v[24:27], a[8:11], 0
    ds_read_b64_tr_b16 v[22:23], v4 offset:18048
    s_add_u32 s47, s34, s64
    v_mfma_f32_16x16x32_bf16 v[180:183], v[24:27], a[4:7], 0
    v_mul_f32 v96, s39, v96
    v_mul_f32 v97, s39, v97
    v_mfma_f32_16x16x32_bf16 v[164:167], v[24:27], a[0:3], 0
    buffer_load_dwordx4 v2, s[4:7], s47 offen offset:0 lds
    s_waitcnt lgkmcnt(4)
    v_mfma_f32_16x16x32_bf16 v[168:171], v[28:31], a[0:3], 0
    ds_read_b64_tr_b16 v[24:25], v4 offset:17056
    s_mul_i32 s68, s43, 12
    v_mfma_f32_16x16x32_bf16 v[184:187], v[28:31], a[4:7], 0
    ds_read_b64_tr_b16 v[26:27], v4 offset:18080
    s_lshr_b32 s68, s68, 3
    v_mfma_f32_16x16x32_bf16 v[200:203], v[28:31], a[8:11], 0
    v_exp_f32 v96, v96
    v_mfma_f32_16x16x32_bf16 v[216:219], v[28:31], a[12:15], 0
    buffer_load_dwordx4 v3, s[4:7], s47 offen offset:1024 lds
    s_waitcnt lgkmcnt(4)
    v_mfma_f32_16x16x32_bf16 v[220:223], v[32:35], a[12:15], 0
    ds_read_b64_tr_b16 v[28:29], v4 offset:19072
    s_mul_i32 s46, s42, 4
    v_mfma_f32_16x16x32_bf16 v[204:207], v[32:35], a[8:11], 0
    ds_read_b64_tr_b16 v[30:31], v4 offset:20096
    s_add_u32 s68, s68, s46
    v_mfma_f32_16x16x32_bf16 v[188:191], v[32:35], a[4:7], 0
    v_exp_f32 v97, v97
    v_mfma_f32_16x16x32_bf16 v[172:175], v[32:35], a[0:3], 0
    buffer_load_dwordx4 v2, s[8:11], s47 offen offset:2048 lds
    s_waitcnt lgkmcnt(4)
    v_mfma_f32_16x16x32_bf16 v[160:163], v[20:23], a[16:19], v[160:163]
    ds_read_b64_tr_b16 v[32:33], v4 offset:19104
    s_cmp_ge_u32 s68, 12
    s_cselect_b32 s46, 12, 0
    v_mfma_f32_16x16x32_bf16 v[176:179], v[20:23], a[20:23], v[176:179]
    ds_read_b64_tr_b16 v[34:35], v4 offset:20128
    s_sub_u32 s68, s68, s46
    v_mfma_f32_16x16x32_bf16 v[192:195], v[20:23], a[24:27], v[192:195]
    s_mul_i32 s68, s68, 36864
    s_mov_b32 s46, 442368
    v_mfma_f32_16x16x32_bf16 v[208:211], v[20:23], a[28:31], v[208:211]
    buffer_load_dwordx4 v3, s[8:11], s47 offen offset:3072 lds
    s_waitcnt lgkmcnt(4)
    v_mfma_f32_16x16x32_bf16 v[212:215], v[24:27], a[28:31], v[212:215]
    ds_read_b64_tr_b16 v[20:21], v4 offset:33024
    s_add_u32 s69, s68, 36864
    v_mfma_f32_16x16x32_bf16 v[196:199], v[24:27], a[24:27], v[196:199]
    ds_read_b64_tr_b16 v[22:23], v4 offset:34048
    s_cmp_eq_u32 s69, s46
    s_cselect_b32 s69, 0, s69
    v_mfma_f32_16x16x32_bf16 v[180:183], v[24:27], a[20:23], v[180:183]
    s_add_u32 s70, s69, 36864
    s_cmp_eq_u32 s70, s46
    s_cselect_b32 s70, 0, s70
    v_mfma_f32_16x16x32_bf16 v[164:167], v[24:27], a[16:19], v[164:167]
    s_add_u32 s71, s70, 36864
    s_waitcnt lgkmcnt(4)
    v_mfma_f32_16x16x32_bf16 v[168:171], v[28:31], a[16:19], v[168:171]
    ds_read_b64_tr_b16 v[24:25], v4 offset:33056
    s_cmp_eq_u32 s71, s46
    s_cselect_b32 s71, 0, s71
    v_mfma_f32_16x16x32_bf16 v[184:187], v[28:31], a[20:23], v[184:187]
    ds_read_b64_tr_b16 v[26:27], v4 offset:34080
    s_add_u32 s72, s71, 36864
    v_mfma_f32_16x16x32_bf16 v[200:203], v[28:31], a[24:27], v[200:203]
    s_cmp_eq_u32 s72, s46
    s_cselect_b32 s72, 0, s72
    s_add_u32 s73, s72, 36864
    v_mfma_f32_16x16x32_bf16 v[216:219], v[28:31], a[28:31], v[216:219]
    s_cmp_eq_u32 s73, s46
    s_cselect_b32 s73, 0, s73
    s_waitcnt lgkmcnt(4)
    v_mfma_f32_16x16x32_bf16 v[220:223], v[32:35], a[28:31], v[220:223]
    ds_read_b64_tr_b16 v[28:29], v4 offset:35072
    s_add_u32 s74, s73, 36864
    v_mfma_f32_16x16x32_bf16 v[204:207], v[32:35], a[24:27], v[204:207]
    ds_read_b64_tr_b16 v[30:31], v4 offset:36096
    s_cmp_eq_u32 s74, s46
    s_cselect_b32 s74, 0, s74
    v_mfma_f32_16x16x32_bf16 v[188:191], v[32:35], a[20:23], v[188:191]
    s_add_u32 s75, s74, 36864
    s_cmp_eq_u32 s75, s46
    s_cselect_b32 s75, 0, s75
    v_mfma_f32_16x16x32_bf16 v[172:175], v[32:35], a[16:19], v[172:175]
    s_add_u32 s76, s75, 36864
    s_waitcnt lgkmcnt(4)
    v_mfma_f32_16x16x32_bf16 v[160:163], v[20:23], a[32:35], v[160:163]
    ds_read_b64_tr_b16 v[32:33], v4 offset:35104
    s_cmp_eq_u32 s76, s46
    s_cselect_b32 s76, 0, s76
    v_mfma_f32_16x16x32_bf16 v[176:179], v[20:23], a[36:39], v[176:179]
    ds_read_b64_tr_b16 v[34:35], v4 offset:36128
    s_add_u32 s77, s76, 36864
    v_mfma_f32_16x16x32_bf16 v[192:195], v[20:23], a[40:43], v[192:195]
    s_cmp_eq_u32 s77, s46
    s_cselect_b32 s77, 0, s77
    s_add_u32 s78, s77, 36864
    v_mfma_f32_16x16x32_bf16 v[208:211], v[20:23], a[44:47], v[208:211]
    s_cmp_eq_u32 s78, s46
    s_cselect_b32 s78, 0, s78
    s_waitcnt lgkmcnt(4)
    v_mfma_f32_16x16x32_bf16 v[212:215], v[24:27], a[44:47], v[212:215]
    ds_read_b64_tr_b16 v[20:21], v4 offset:33536
    s_add_u32 s79, s78, 36864
    v_mfma_f32_16x16x32_bf16 v[196:199], v[24:27], a[40:43], v[196:199]
    ds_read_b64_tr_b16 v[22:23], v4 offset:34560
    s_cmp_eq_u32 s79, s46
    s_cselect_b32 s79, 0, s79
    v_mfma_f32_16x16x32_bf16 v[180:183], v[24:27], a[36:39], v[180:183]
    s_mul_i32 s80, s42, 73728
    s_mov_b32 s46, 221184
    v_mfma_f32_16x16x32_bf16 v[164:167], v[24:27], a[32:35], v[164:167]
    s_add_u32 s81, s80, 73728
    s_waitcnt lgkmcnt(4)
    v_mfma_f32_16x16x32_bf16 v[168:171], v[28:31], a[32:35], v[168:171]
    ds_read_b64_tr_b16 v[24:25], v4 offset:33568
    s_cmp_eq_u32 s81, s46
    s_cselect_b32 s81, 0, s81
    v_mfma_f32_16x16x32_bf16 v[184:187], v[28:31], a[36:39], v[184:187]
    ds_read_b64_tr_b16 v[26:27], v4 offset:34592
    s_add_u32 s82, s81, 73728
    v_mfma_f32_16x16x32_bf16 v[200:203], v[28:31], a[40:43], v[200:203]
    s_cmp_eq_u32 s82, s46
    s_cselect_b32 s82, 0, s82
    v_mul_f32 v98, s39, v98
    v_mfma_f32_16x16x32_bf16 v[216:219], v[28:31], a[44:47], v[216:219]
    v_mul_f32 v99, s39, v99
    s_waitcnt lgkmcnt(4)
    v_mfma_f32_16x16x32_bf16 v[220:223], v[32:35], a[44:47], v[220:223]
    ds_read_b64_tr_b16 v[28:29], v4 offset:35584
    v_mul_f32 v100, s39, v100
    v_mfma_f32_16x16x32_bf16 v[204:207], v[32:35], a[40:43], v[204:207]
    ds_read_b64_tr_b16 v[30:31], v4 offset:36608
    v_mul_f32 v101, s39, v101
    v_mfma_f32_16x16x32_bf16 v[188:191], v[32:35], a[36:39], v[188:191]
    v_exp_f32 v98, v98
    v_mfma_f32_16x16x32_bf16 v[172:175], v[32:35], a[32:35], v[172:175]
    v_mul_f32 v102, s39, v102
    s_waitcnt lgkmcnt(4)
    v_mfma_f32_16x16x32_bf16 v[160:163], v[20:23], a[48:51], v[160:163]
    ds_read_b64_tr_b16 v[32:33], v4 offset:35616
    v_mul_f32 v103, s39, v103
    v_mfma_f32_16x16x32_bf16 v[176:179], v[20:23], a[52:55], v[176:179]
    ds_read_b64_tr_b16 v[34:35], v4 offset:36640
    v_add_f32 v96, 1.0, v96
    v_mfma_f32_16x16x32_bf16 v[192:195], v[20:23], a[56:59], v[192:195]
    v_exp_f32 v99, v99
    v_mfma_f32_16x16x32_bf16 v[208:211], v[20:23], a[60:63], v[208:211]
    v_add_f32 v97, 1.0, v97
    s_waitcnt lgkmcnt(4)
    v_mfma_f32_16x16x32_bf16 v[212:215], v[24:27], a[60:63], v[212:215]
    s_waitcnt vmcnt(16)
    s_barrier
    ds_read_b64_tr_b16 v[20:21], v4 offset:49536
    s_add_u32 m0, s33, 16512
    v_mfma_f32_16x16x32_bf16 v[196:199], v[24:27], a[56:59], v[196:199]
    ds_read_b64_tr_b16 v[22:23], v4 offset:50560
    s_add_u32 s47, s34, s65
    v_mfma_f32_16x16x32_bf16 v[180:183], v[24:27], a[52:55], v[180:183]
    v_exp_f32 v100, v100
    v_mfma_f32_16x16x32_bf16 v[164:167], v[24:27], a[48:51], v[164:167]
    buffer_load_dwordx4 v2, s[4:7], s47 offen offset:0 lds
    s_waitcnt lgkmcnt(4)
    v_mfma_f32_16x16x32_bf16 v[168:171], v[28:31], a[48:51], v[168:171]
    ds_read_b64_tr_b16 v[24:25], v4 offset:49568
    v_add_f32 v98, 1.0, v98
    v_mfma_f32_16x16x32_bf16 v[184:187], v[28:31], a[52:55], v[184:187]
    ds_read_b64_tr_b16 v[26:27], v4 offset:50592
    v_add_f32 v99, 1.0, v99
    v_mfma_f32_16x16x32_bf16 v[200:203], v[28:31], a[56:59], v[200:203]
    v_exp_f32 v101, v101
    v_mfma_f32_16x16x32_bf16 v[216:219], v[28:31], a[60:63], v[216:219]
    buffer_load_dwordx4 v3, s[4:7], s47 offen offset:1024 lds
    s_waitcnt lgkmcnt(4)
    v_mfma_f32_16x16x32_bf16 v[220:223], v[32:35], a[60:63], v[220:223]
    ds_read_b64_tr_b16 v[28:29], v4 offset:51584
    v_add_f32 v100, 1.0, v100
    v_mfma_f32_16x16x32_bf16 v[204:207], v[32:35], a[56:59], v[204:207]
    ds_read_b64_tr_b16 v[30:31], v4 offset:52608
    v_add_f32 v101, 1.0, v101
    v_mfma_f32_16x16x32_bf16 v[188:191], v[32:35], a[52:55], v[188:191]
    v_exp_f32 v102, v102
    v_mfma_f32_16x16x32_bf16 v[172:175], v[32:35], a[48:51], v[172:175]
    buffer_load_dwordx4 v2, s[8:11], s47 offen offset:2048 lds
    s_waitcnt lgkmcnt(4)
    v_mfma_f32_16x16x32_bf16 v[160:163], v[20:23], a[64:67], v[160:163]
    ds_read_b64_tr_b16 v[32:33], v4 offset:51616
    v_add_f32 v102, 1.0, v102
    v_mfma_f32_16x16x32_bf16 v[176:179], v[20:23], a[68:71], v[176:179]
    ds_read_b64_tr_b16 v[34:35], v4 offset:52640
    v_mul_f32 v112, s39, v112
    v_mfma_f32_16x16x32_bf16 v[192:195], v[20:23], a[72:75], v[192:195]
    v_exp_f32 v103, v103
    v_mfma_f32_16x16x32_bf16 v[208:211], v[20:23], a[76:79], v[208:211]
    buffer_load_dwordx4 v3, s[8:11], s47 offen offset:3072 lds
    s_waitcnt lgkmcnt(4)
    v_mfma_f32_16x16x32_bf16 v[212:215], v[24:27], a[76:79], v[212:215]
    ds_read_b64_tr_b16 v[20:21], v4 offset:50048
    s_add_u32 s34, s34, s3
    v_mfma_f32_16x16x32_bf16 v[196:199], v[24:27], a[72:75], v[196:199]
    ds_read_b64_tr_b16 v[22:23], v4 offset:51072
    s_add_u32 m0, s33, 82560
    v_mfma_f32_16x16x32_bf16 v[180:183], v[24:27], a[68:71], v[180:183]
    v_rcp_f32 v96, v96
    v_mfma_f32_16x16x32_bf16 v[164:167], v[24:27], a[64:67], v[164:167]
    s_add_u32 s47, s34, s57
    s_waitcnt lgkmcnt(4)
    v_mfma_f32_16x16x32_bf16 v[168:171], v[28:31], a[64:67], v[168:171]
    ds_read_b64_tr_b16 v[24:25], v4 offset:50080
    v_add_f32 v103, 1.0, v103
    v_mfma_f32_16x16x32_bf16 v[184:187], v[28:31], a[68:71], v[184:187]
    ds_read_b64_tr_b16 v[26:27], v4 offset:51104
    v_mul_f32 v96, v96, v104
    v_mfma_f32_16x16x32_bf16 v[200:203], v[28:31], a[72:75], v[200:203]
    v_rcp_f32 v97, v97
    v_mfma_f32_16x16x32_bf16 v[216:219], v[28:31], a[76:79], v[216:219]
    buffer_load_dwordx4 v2, s[4:7], s47 offen offset:0 lds
    s_waitcnt lgkmcnt(4)
    v_mfma_f32_16x16x32_bf16 v[220:223], v[32:35], a[76:79], v[220:223]
    ds_read_b64_tr_b16 v[28:29], v4 offset:52096
    v_mul_f32 v97, v97, v105
    v_mfma_f32_16x16x32_bf16 v[204:207], v[32:35], a[72:75], v[204:207]
    ds_read_b64_tr_b16 v[30:31], v4 offset:53120
    v_mul_f32 v113, s39, v113
    v_mfma_f32_16x16x32_bf16 v[188:191], v[32:35], a[68:71], v[188:191]
    v_rcp_f32 v98, v98
    v_mfma_f32_16x16x32_bf16 v[172:175], v[32:35], a[64:67], v[172:175]
    buffer_load_dwordx4 v3, s[4:7], s47 offen offset:1024 lds
    s_waitcnt lgkmcnt(4)
    v_mfma_f32_16x16x32_bf16 v[160:163], v[20:23], a[80:83], v[160:163]
    ds_read_b64_tr_b16 v[32:33], v4 offset:52128
    v_mul_f32 v98, v98, v106
    v_mfma_f32_16x16x32_bf16 v[176:179], v[20:23], a[84:87], v[176:179]
    ds_read_b64_tr_b16 v[34:35], v4 offset:53152
    v_mul_f32 v114, s39, v114
    v_mfma_f32_16x16x32_bf16 v[192:195], v[20:23], a[88:91], v[192:195]
    v_rcp_f32 v99, v99
    v_mfma_f32_16x16x32_bf16 v[208:211], v[20:23], a[92:95], v[208:211]
    buffer_load_dwordx4 v2, s[8:11], s47 offen offset:2048 lds
    s_waitcnt lgkmcnt(4)
    v_mfma_f32_16x16x32_bf16 v[212:215], v[24:27], a[92:95], v[212:215]
    ds_read_b64_tr_b16 v[20:21], v5 offset:512
    v_mul_f32 v99, v99, v107
    v_mfma_f32_16x16x32_bf16 v[196:199], v[24:27], a[88:91], v[196:199]
    ds_read_b64_tr_b16 v[22:23], v5 offset:1536
    v_mul_f32 v115, s39, v115
    v_mfma_f32_16x16x32_bf16 v[180:183], v[24:27], a[84:87], v[180:183]
    v_rcp_f32 v100, v100
    v_mfma_f32_16x16x32_bf16 v[164:167], v[24:27], a[80:83], v[164:167]
    buffer_load_dwordx4 v3, s[8:11], s47 offen offset:3072 lds
    s_waitcnt lgkmcnt(4)
    v_mfma_f32_16x16x32_bf16 v[168:171], v[28:31], a[80:83], v[168:171]
    ds_read_b64_tr_b16 v[24:25], v5 offset:544
    v_mul_f32 v100, v100, v108
    v_mfma_f32_16x16x32_bf16 v[184:187], v[28:31], a[84:87], v[184:187]
    ds_read_b64_tr_b16 v[26:27], v5 offset:1568
    v_mul_f32 v116, s39, v116
    v_mfma_f32_16x16x32_bf16 v[200:203], v[28:31], a[88:91], v[200:203]
    v_rcp_f32 v101, v101
    v_mfma_f32_16x16x32_bf16 v[216:219], v[28:31], a[92:95], v[216:219]
    buffer_store_dwordx4 v[80:83], v7, s[16:19], s38 offen offset:0 sc1
    s_waitcnt lgkmcnt(4)
    v_mfma_f32_16x16x32_bf16 v[220:223], v[32:35], a[92:95], v[220:223]
    ds_read_b64_tr_b16 v[28:29], v5 offset:2560
    v_mul_f32 v101, v101, v109
    v_mfma_f32_16x16x32_bf16 v[204:207], v[32:35], a[88:91], v[204:207]
    ds_read_b64_tr_b16 v[30:31], v5 offset:3584
    v_mul_f32 v117, s39, v117
    v_mfma_f32_16x16x32_bf16 v[188:191], v[32:35], a[84:87], v[188:191]
    v_rcp_f32 v102, v102
    v_mfma_f32_16x16x32_bf16 v[172:175], v[32:35], a[80:83], v[172:175]
    buffer_store_dwordx4 v[84:87], v7, s[16:19], s38 offen offset:1024 sc1
    s_waitcnt lgkmcnt(4)
    v_mfma_f32_16x16x32_bf16 v[160:163], v[20:23], a[96:99], v[160:163]
    ds_read_b64_tr_b16 v[32:33], v5 offset:2592
    v_mul_f32 v102, v102, v110
    v_mfma_f32_16x16x32_bf16 v[176:179], v[20:23], a[100:103], v[176:179]
    ds_read_b64_tr_b16 v[34:35], v5 offset:3616
    v_mul_f32 v118, s39, v118
    v_mfma_f32_16x16x32_bf16 v[192:195], v[20:23], a[104:107], v[192:195]
    v_rcp_f32 v103, v103
    v_mfma_f32_16x16x32_bf16 v[208:211], v[20:23], a[108:111], v[208:211]
    buffer_store_dwordx4 v[88:91], v7, s[16:19], s38 offen offset:2048 sc1
    s_waitcnt lgkmcnt(4)
    v_mfma_f32_16x16x32_bf16 v[212:215], v[24:27], a[108:111], v[212:215]
    ds_read_b64_tr_b16 v[20:21], v5 offset:1024
    v_mul_f32 v103, v103, v111
    v_mfma_f32_16x16x32_bf16 v[196:199], v[24:27], a[104:107], v[196:199]
    ds_read_b64_tr_b16 v[22:23], v5 offset:2048
    v_mul_f32 v119, s39, v119
    v_mfma_f32_16x16x32_bf16 v[180:183], v[24:27], a[100:103], v[180:183]
    v_exp_f32 v112, v112
    v_mfma_f32_16x16x32_bf16 v[164:167], v[24:27], a[96:99], v[164:167]
    buffer_store_dwordx4 v[92:95], v7, s[16:19], s38 offen offset:3072 sc1
    s_waitcnt lgkmcnt(4)
    v_mfma_f32_16x16x32_bf16 v[168:171], v[28:31], a[96:99], v[168:171]
    ds_read_b64_tr_b16 v[24:25], v5 offset:1056
    s_add_u32 s38, s38, s96
    v_mfma_f32_16x16x32_bf16 v[184:187], v[28:31], a[100:103], v[184:187]
    ds_read_b64_tr_b16 v[26:27], v5 offset:2080
    v_cvt_pk_bf16_f32 v80, v96, v97
    v_mfma_f32_16x16x32_bf16 v[200:203], v[28:31], a[104:107], v[200:203]
    v_exp_f32 v113, v113
    v_mfma_f32_16x16x32_bf16 v[216:219], v[28:31], a[108:111], v[216:219]
    v_cvt_pk_bf16_f32 v81, v98, v99
    s_waitcnt lgkmcnt(4)
    v_mfma_f32_16x16x32_bf16 v[220:223], v[32:35], a[108:111], v[220:223]
    ds_read_b64_tr_b16 v[28:29], v5 offset:3072
    v_cvt_pk_bf16_f32 v82, v100, v101
    v_mfma_f32_16x16x32_bf16 v[204:207], v[32:35], a[104:107], v[204:207]
    ds_read_b64_tr_b16 v[30:31], v5 offset:4096
    v_cvt_pk_bf16_f32 v83, v102, v103
    v_mfma_f32_16x16x32_bf16 v[188:191], v[32:35], a[100:103], v[188:191]
    v_exp_f32 v114, v114
    v_mfma_f32_16x16x32_bf16 v[172:175], v[32:35], a[96:99], v[172:175]
    v_add_f32 v112, 1.0, v112
    s_waitcnt lgkmcnt(4)
    v_mfma_f32_16x16x32_bf16 v[160:163], v[20:23], a[112:115], v[160:163]
    ds_read_b64_tr_b16 v[32:33], v5 offset:3104
    v_add_f32 v113, 1.0, v113
    v_mfma_f32_16x16x32_bf16 v[176:179], v[20:23], a[116:119], v[176:179]
    ds_read_b64_tr_b16 v[34:35], v5 offset:4128
    v_add_f32 v114, 1.0, v114
    v_mfma_f32_16x16x32_bf16 v[192:195], v[20:23], a[120:123], v[192:195]
    v_exp_f32 v115, v115
    v_mfma_f32_16x16x32_bf16 v[208:211], v[20:23], a[124:127], v[208:211]
    v_add_f32 v115, 1.0, v115
    s_waitcnt lgkmcnt(4)
    v_mfma_f32_16x16x32_bf16 v[212:215], v[24:27], a[124:127], v[212:215]
    s_waitcnt vmcnt(20)
    s_barrier
    ds_read_b64_tr_b16 v[20:21], v5 offset:33536
    s_add_u32 m0, s33, 33024
    v_mfma_f32_16x16x32_bf16 v[196:199], v[24:27], a[120:123], v[196:199]
    ds_read_b64_tr_b16 v[22:23], v5 offset:34560
    s_add_u32 s47, s34, s58
    v_mfma_f32_16x16x32_bf16 v[180:183], v[24:27], a[116:119], v[180:183]
    v_exp_f32 v116, v116
    v_mfma_f32_16x16x32_bf16 v[164:167], v[24:27], a[112:115], v[164:167]
    buffer_load_dwordx4 v2, s[4:7], s47 offen offset:0 lds
    s_waitcnt lgkmcnt(4)
    v_mfma_f32_16x16x32_bf16 v[168:171], v[28:31], a[112:115], v[168:171]
    ds_read_b64_tr_b16 v[24:25], v5 offset:33568
    v_add_f32 v116, 1.0, v116
    v_mfma_f32_16x16x32_bf16 v[184:187], v[28:31], a[116:119], v[184:187]
    ds_read_b64_tr_b16 v[26:27], v5 offset:34592
    v_mul_f32 v128, s39, v128
    v_mfma_f32_16x16x32_bf16 v[200:203], v[28:31], a[120:123], v[200:203]
    v_exp_f32 v117, v117
    v_mfma_f32_16x16x32_bf16 v[216:219], v[28:31], a[124:127], v[216:219]
    buffer_load_dwordx4 v3, s[4:7], s47 offen offset:1024 lds
    s_waitcnt lgkmcnt(4)
    v_mfma_f32_16x16x32_bf16 v[220:223], v[32:35], a[124:127], v[220:223]
    ds_read_b64_tr_b16 v[28:29], v5 offset:35584
    v_add_f32 v117, 1.0, v117
    v_mfma_f32_16x16x32_bf16 v[204:207], v[32:35], a[120:123], v[204:207]
    ds_read_b64_tr_b16 v[30:31], v5 offset:36608
    v_mul_f32 v129, s39, v129
    v_mfma_f32_16x16x32_bf16 v[188:191], v[32:35], a[116:119], v[188:191]
    v_exp_f32 v118, v118
    v_mfma_f32_16x16x32_bf16 v[172:175], v[32:35], a[112:115], v[172:175]
    buffer_load_dwordx4 v2, s[8:11], s47 offen offset:2048 lds
    s_waitcnt lgkmcnt(4)
    v_mfma_f32_16x16x32_bf16 v[160:163], v[20:23], a[128:131], v[160:163]
    ds_read_b64_tr_b16 v[32:33], v5 offset:35616
    v_add_f32 v118, 1.0, v118
    v_mfma_f32_16x16x32_bf16 v[176:179], v[20:23], a[132:135], v[176:179]
    ds_read_b64_tr_b16 v[34:35], v5 offset:36640
    v_mul_f32 v130, s39, v130
    v_mfma_f32_16x16x32_bf16 v[192:195], v[20:23], a[136:139], v[192:195]
    v_exp_f32 v119, v119
    v_mfma_f32_16x16x32_bf16 v[208:211], v[20:23], a[140:143], v[208:211]
    buffer_load_dwordx4 v3, s[8:11], s47 offen offset:3072 lds
    s_waitcnt lgkmcnt(4)
    v_mfma_f32_16x16x32_bf16 v[212:215], v[24:27], a[140:143], v[212:215]
    ds_read_b64_tr_b16 v[20:21], v5 offset:34048
    s_add_u32 m0, s33, 49536
    v_mfma_f32_16x16x32_bf16 v[196:199], v[24:27], a[136:139], v[196:199]
    ds_read_b64_tr_b16 v[22:23], v5 offset:35072
    s_add_u32 s47, s34, s59
    v_mfma_f32_16x16x32_bf16 v[180:183], v[24:27], a[132:135], v[180:183]
    v_rcp_f32 v112, v112
    v_mfma_f32_16x16x32_bf16 v[164:167], v[24:27], a[128:131], v[164:167]
    buffer_load_dwordx4 v2, s[4:7], s47 offen offset:0 lds
    s_waitcnt lgkmcnt(4)
    v_mfma_f32_16x16x32_bf16 v[168:171], v[28:31], a[128:131], v[168:171]
    ds_read_b64_tr_b16 v[24:25], v5 offset:34080
    v_add_f32 v119, 1.0, v119
    v_mfma_f32_16x16x32_bf16 v[184:187], v[28:31], a[132:135], v[184:187]
    ds_read_b64_tr_b16 v[26:27], v5 offset:35104
    v_mul_f32 v112, v112, v120
    v_mfma_f32_16x16x32_bf16 v[200:203], v[28:31], a[136:139], v[200:203]
    v_rcp_f32 v113, v113
    v_mfma_f32_16x16x32_bf16 v[216:219], v[28:31], a[140:143], v[216:219]
    buffer_load_dwordx4 v3, s[4:7], s47 offen offset:1024 lds
    s_waitcnt lgkmcnt(4)
    v_mfma_f32_16x16x32_bf16 v[220:223], v[32:35], a[140:143], v[220:223]
    ds_read_b64_tr_b16 v[28:29], v5 offset:36096
    v_mul_f32 v113, v113, v121
    v_mfma_f32_16x16x32_bf16 v[204:207], v[32:35], a[136:139], v[204:207]
    ds_read_b64_tr_b16 v[30:31], v5 offset:37120
    v_cvt_pk_bf16_f32 v84, v112, v113
    v_mfma_f32_16x16x32_bf16 v[188:191], v[32:35], a[132:135], v[188:191]
    v_rcp_f32 v114, v114
    v_mfma_f32_16x16x32_bf16 v[172:175], v[32:35], a[128:131], v[172:175]
    buffer_load_dwordx4 v2, s[8:11], s47 offen offset:2048 lds
    s_waitcnt lgkmcnt(4)
    v_mfma_f32_16x16x32_bf16 v[160:163], v[20:23], a[144:147], v[160:163]
    ds_read_b64_tr_b16 v[32:33], v5 offset:36128
    v_mul_f32 v114, v114, v122
    v_mfma_f32_16x16x32_bf16 v[176:179], v[20:23], a[148:151], v[176:179]
    ds_read_b64_tr_b16 v[34:35], v5 offset:37152
    v_mul_f32 v131, s39, v131
    v_mfma_f32_16x16x32_bf16 v[192:195], v[20:23], a[152:155], v[192:195]
    v_rcp_f32 v115, v115
    v_mfma_f32_16x16x32_bf16 v[208:211], v[20:23], a[156:159], v[208:211]
    buffer_load_dwordx4 v3, s[8:11], s47 offen offset:3072 lds
    s_waitcnt lgkmcnt(4)
    v_mfma_f32_16x16x32_bf16 v[212:215], v[24:27], a[156:159], v[212:215]
    ds_read_b64_tr_b16 v[20:21], v5 offset:50048
    v_mul_f32 v115, v115, v123
    v_mfma_f32_16x16x32_bf16 v[196:199], v[24:27], a[152:155], v[196:199]
    ds_read_b64_tr_b16 v[22:23], v5 offset:51072
    v_cvt_pk_bf16_f32 v85, v114, v115
    v_mfma_f32_16x16x32_bf16 v[180:183], v[24:27], a[148:151], v[180:183]
    v_rcp_f32 v116, v116
    v_mfma_f32_16x16x32_bf16 v[164:167], v[24:27], a[144:147], v[164:167]
    v_mul_f32 v116, v116, v124
    s_waitcnt lgkmcnt(4)
    v_mfma_f32_16x16x32_bf16 v[168:171], v[28:31], a[144:147], v[168:171]
    ds_read_b64_tr_b16 v[24:25], v5 offset:50080
    v_mul_f32 v132, s39, v132
    v_mfma_f32_16x16x32_bf16 v[184:187], v[28:31], a[148:151], v[184:187]
    ds_read_b64_tr_b16 v[26:27], v5 offset:51104
    v_mul_f32 v133, s39, v133
    v_mfma_f32_16x16x32_bf16 v[200:203], v[28:31], a[152:155], v[200:203]
    v_rcp_f32 v117, v117
    v_mfma_f32_16x16x32_bf16 v[216:219], v[28:31], a[156:159], v[216:219]
    v_mul_f32 v117, v117, v125
    s_waitcnt lgkmcnt(4)
    v_mfma_f32_16x16x32_bf16 v[220:223], v[32:35], a[156:159], v[220:223]
    ds_read_b64_tr_b16 v[28:29], v5 offset:52096
    v_cvt_pk_bf16_f32 v86, v116, v117
    v_mfma_f32_16x16x32_bf16 v[204:207], v[32:35], a[152:155], v[204:207]
    ds_read_b64_tr_b16 v[30:31], v5 offset:53120
    v_mul_f32 v134, s39, v134
    v_mfma_f32_16x16x32_bf16 v[188:191], v[32:35], a[148:151], v[188:191]
    v_rcp_f32 v118, v118
    v_mfma_f32_16x16x32_bf16 v[172:175], v[32:35], a[144:147], v[172:175]
    v_mul_f32 v118, v118, v126
    s_waitcnt lgkmcnt(4)
    v_mfma_f32_16x16x32_bf16 v[160:163], v[20:23], a[160:163], v[160:163]
    ds_read_b64_tr_b16 v[32:33], v5 offset:52128
    v_mul_f32 v135, s39, v135
    v_mfma_f32_16x16x32_bf16 v[176:179], v[20:23], a[164:167], v[176:179]
    ds_read_b64_tr_b16 v[34:35], v5 offset:53152
    v_mul_f32 v144, s39, v144
    v_mfma_f32_16x16x32_bf16 v[192:195], v[20:23], a[168:171], v[192:195]
    v_rcp_f32 v119, v119
    v_mfma_f32_16x16x32_bf16 v[208:211], v[20:23], a[172:175], v[208:211]
    v_mul_f32 v119, v119, v127
    s_waitcnt lgkmcnt(4)
    v_mfma_f32_16x16x32_bf16 v[212:215], v[24:27], a[172:175], v[212:215]
    ds_read_b64_tr_b16 v[20:21], v5 offset:50560
    v_cvt_pk_bf16_f32 v87, v118, v119
    v_mfma_f32_16x16x32_bf16 v[196:199], v[24:27], a[168:171], v[196:199]
    ds_read_b64_tr_b16 v[22:23], v5 offset:51584
    v_mul_f32 v145, s39, v145
    v_mfma_f32_16x16x32_bf16 v[180:183], v[24:27], a[164:167], v[180:183]
    v_exp_f32 v128, v128
    v_mfma_f32_16x16x32_bf16 v[164:167], v[24:27], a[160:163], v[164:167]
    v_add_f32 v128, 1.0, v128
    s_waitcnt lgkmcnt(4)
    v_mfma_f32_16x16x32_bf16 v[168:171], v[28:31], a[160:163], v[168:171]
    ds_read_b64_tr_b16 v[24:25], v5 offset:50592
    v_mul_f32 v146, s39, v146
    v_mfma_f32_16x16x32_bf16 v[184:187], v[28:31], a[164:167], v[184:187]
    ds_read_b64_tr_b16 v[26:27], v5 offset:51616
    v_mul_f32 v147, s39, v147
    v_mfma_f32_16x16x32_bf16 v[200:203], v[28:31], a[168:171], v[200:203]
    v_exp_f32 v129, v129
    v_mfma_f32_16x16x32_bf16 v[216:219], v[28:31], a[172:175], v[216:219]
    v_add_f32 v129, 1.0, v129
    s_waitcnt lgkmcnt(4)
    v_mfma_f32_16x16x32_bf16 v[220:223], v[32:35], a[172:175], v[220:223]
    ds_read_b64_tr_b16 v[28:29], v5 offset:52608
    v_mul_f32 v148, s39, v148
    v_mfma_f32_16x16x32_bf16 v[204:207], v[32:35], a[168:171], v[204:207]
    ds_read_b64_tr_b16 v[30:31], v5 offset:53632
    v_mul_f32 v149, s39, v149
    v_mfma_f32_16x16x32_bf16 v[188:191], v[32:35], a[164:167], v[188:191]
    v_exp_f32 v130, v130
    v_mfma_f32_16x16x32_bf16 v[172:175], v[32:35], a[160:163], v[172:175]
    v_add_f32 v130, 1.0, v130
    s_waitcnt lgkmcnt(4)
    v_mfma_f32_16x16x32_bf16 v[160:163], v[20:23], a[176:179], v[160:163]
    ds_read_b64_tr_b16 v[32:33], v5 offset:52640
    v_mul_f32 v150, s39, v150
    v_mfma_f32_16x16x32_bf16 v[176:179], v[20:23], a[180:183], v[176:179]
    ds_read_b64_tr_b16 v[34:35], v5 offset:53664
    v_mul_f32 v151, s39, v151
    v_mfma_f32_16x16x32_bf16 v[192:195], v[20:23], a[184:187], v[192:195]
    v_exp_f32 v131, v131
    v_mfma_f32_16x16x32_bf16 v[208:211], v[20:23], a[188:191], v[208:211]
    v_add_f32 v131, 1.0, v131
    s_waitcnt lgkmcnt(4)
    v_mfma_f32_16x16x32_bf16 v[212:215], v[24:27], a[188:191], v[212:215]
    s_waitcnt vmcnt(20)
    s_barrier
    ds_read_b64_tr_b16 v[20:21], v6 offset:1024
    s_add_u32 m0, s33, 66048
    v_mfma_f32_16x16x32_bf16 v[196:199], v[24:27], a[184:187], v[196:199]
    ds_read_b64_tr_b16 v[22:23], v6 offset:2048
    s_add_u32 s47, s34, s60
    v_mfma_f32_16x16x32_bf16 v[180:183], v[24:27], a[180:183], v[180:183]
    v_exp_f32 v132, v132
    v_mfma_f32_16x16x32_bf16 v[164:167], v[24:27], a[176:179], v[164:167]
    buffer_load_dwordx4 v2, s[4:7], s47 offen offset:0 lds
    s_waitcnt lgkmcnt(4)
    v_mfma_f32_16x16x32_bf16 v[168:171], v[28:31], a[176:179], v[168:171]
    ds_read_b64_tr_b16 v[24:25], v6 offset:1056
    v_add_f32 v132, 1.0, v132
    v_mfma_f32_16x16x32_bf16 v[184:187], v[28:31], a[180:183], v[184:187]
    ds_read_b64_tr_b16 v[26:27], v6 offset:2080
    v_mfma_f32_16x16x32_bf16 v[200:203], v[28:31], a[184:187], v[200:203]
    v_exp_f32 v133, v133
    v_mfma_f32_16x16x32_bf16 v[216:219], v[28:31], a[188:191], v[216:219]
    buffer_load_dwordx4 v3, s[4:7], s47 offen offset:1024 lds
    s_waitcnt lgkmcnt(4)
    v_mfma_f32_16x16x32_bf16 v[220:223], v[32:35], a[188:191], v[220:223]
    ds_read_b64_tr_b16 v[28:29], v6 offset:3072
    v_add_f32 v133, 1.0, v133
    v_mfma_f32_16x16x32_bf16 v[204:207], v[32:35], a[184:187], v[204:207]
    ds_read_b64_tr_b16 v[30:31], v6 offset:4096
    v_mfma_f32_16x16x32_bf16 v[188:191], v[32:35], a[180:183], v[188:191]
    v_exp_f32 v134, v134
    v_mfma_f32_16x16x32_bf16 v[172:175], v[32:35], a[176:179], v[172:175]
    buffer_load_dwordx4 v2, s[8:11], s47 offen offset:2048 lds
    s_waitcnt lgkmcnt(4)
    v_mfma_f32_16x16x32_bf16 v[160:163], v[20:23], a[192:195], v[160:163]
    ds_read_b64_tr_b16 v[32:33], v6 offset:3104
    v_add_f32 v134, 1.0, v134
    v_mfma_f32_16x16x32_bf16 v[176:179], v[20:23], a[196:199], v[176:179]
    ds_read_b64_tr_b16 v[34:35], v6 offset:4128
    v_mfma_f32_16x16x32_bf16 v[192:195], v[20:23], a[200:203], v[192:195]
    v_exp_f32 v135, v135
    v_mfma_f32_16x16x32_bf16 v[208:211], v[20:23], a[204:207], v[208:211]
    buffer_load_dwordx4 v3, s[8:11], s47 offen offset:3072 lds
    s_waitcnt lgkmcnt(4)
    v_mfma_f32_16x16x32_bf16 v[212:215], v[24:27], a[204:207], v[212:215]
    ds_read_b64_tr_b16 v[20:21], v6 offset:1536
    s_add_u32 m0, s33, 99072
    v_mfma_f32_16x16x32_bf16 v[196:199], v[24:27], a[200:203], v[196:199]
    ds_read_b64_tr_b16 v[22:23], v6 offset:2560
    s_add_u32 s47, s34, s61
    v_mfma_f32_16x16x32_bf16 v[180:183], v[24:27], a[196:199], v[180:183]
    v_rcp_f32 v128, v128
    v_mfma_f32_16x16x32_bf16 v[164:167], v[24:27], a[192:195], v[164:167]
    buffer_load_dwordx4 v2, s[4:7], s47 offen offset:0 lds
    s_waitcnt lgkmcnt(4)
    v_mfma_f32_16x16x32_bf16 v[168:171], v[28:31], a[192:195], v[168:171]
    ds_read_b64_tr_b16 v[24:25], v6 offset:1568
    v_add_f32 v135, 1.0, v135
    v_mfma_f32_16x16x32_bf16 v[184:187], v[28:31], a[196:199], v[184:187]
    ds_read_b64_tr_b16 v[26:27], v6 offset:2592
    v_mul_f32 v128, v128, v136
    v_mfma_f32_16x16x32_bf16 v[200:203], v[28:31], a[200:203], v[200:203]
    v_rcp_f32 v129, v129
    v_mfma_f32_16x16x32_bf16 v[216:219], v[28:31], a[204:207], v[216:219]
    buffer_load_dwordx4 v3, s[4:7], s47 offen offset:1024 lds
    s_waitcnt lgkmcnt(4)
    v_mfma_f32_16x16x32_bf16 v[220:223], v[32:35], a[204:207], v[220:223]
    ds_read_b64_tr_b16 v[28:29], v6 offset:3584
    v_mul_f32 v129, v129, v137
    v_mfma_f32_16x16x32_bf16 v[204:207], v[32:35], a[200:203], v[204:207]
    ds_read_b64_tr_b16 v[30:31], v6 offset:4608
    v_cvt_pk_bf16_f32 v88, v128, v129
    v_mfma_f32_16x16x32_bf16 v[188:191], v[32:35], a[196:199], v[188:191]
    v_rcp_f32 v130, v130
    v_mfma_f32_16x16x32_bf16 v[172:175], v[32:35], a[192:195], v[172:175]
    buffer_load_dwordx4 v2, s[8:11], s47 offen offset:2048 lds
    s_waitcnt lgkmcnt(4)
    v_mfma_f32_16x16x32_bf16 v[160:163], v[20:23], a[208:211], v[160:163]
    ds_read_b64_tr_b16 v[32:33], v6 offset:3616
    v_mul_f32 v130, v130, v138
    v_mfma_f32_16x16x32_bf16 v[176:179], v[20:23], a[212:215], v[176:179]
    ds_read_b64_tr_b16 v[34:35], v6 offset:4640
    v_mfma_f32_16x16x32_bf16 v[192:195], v[20:23], a[216:219], v[192:195]
    v_rcp_f32 v131, v131
    v_mfma_f32_16x16x32_bf16 v[208:211], v[20:23], a[220:223], v[208:211]
    buffer_load_dwordx4 v3, s[8:11], s47 offen offset:3072 lds
    s_waitcnt lgkmcnt(4)
    v_mfma_f32_16x16x32_bf16 v[212:215], v[24:27], a[220:223], v[212:215]
    ds_read_b64_tr_b16 v[20:21], v4 offset:0
    v_mul_f32 v131, v131, v139
    v_mfma_f32_16x16x32_bf16 v[196:199], v[24:27], a[216:219], v[196:199]
    ds_read_b64_tr_b16 v[22:23], v4 offset:1024
    v_cvt_pk_bf16_f32 v89, v130, v131
    v_mfma_f32_16x16x32_bf16 v[180:183], v[24:27], a[212:215], v[180:183]
    v_rcp_f32 v132, v132
    v_mfma_f32_16x16x32_bf16 v[164:167], v[24:27], a[208:211], v[164:167]
    v_mul_f32 v132, v132, v140
    s_waitcnt lgkmcnt(4)
    v_mfma_f32_16x16x32_bf16 v[168:171], v[28:31], a[208:211], v[168:171]
    ds_read_b64_tr_b16 v[24:25], v4 offset:32
    v_mfma_f32_16x16x32_bf16 v[184:187], v[28:31], a[212:215], v[184:187]
    ds_read_b64_tr_b16 v[26:27], v4 offset:1056
    v_mfma_f32_16x16x32_bf16 v[200:203], v[28:31], a[216:219], v[200:203]
    v_rcp_f32 v133, v133
    v_mfma_f32_16x16x32_bf16 v[216:219], v[28:31], a[220:223], v[216:219]
    v_mul_f32 v133, v133, v141
    s_waitcnt lgkmcnt(4)
    v_mfma_f32_16x16x32_bf16 v[220:223], v[32:35], a[220:223], v[220:223]
    ds_read_b64_tr_b16 v[28:29], v4 offset:2048
    v_cvt_pk_bf16_f32 v90, v132, v133
    v_mfma_f32_16x16x32_bf16 v[204:207], v[32:35], a[216:219], v[204:207]
    ds_read_b64_tr_b16 v[30:31], v4 offset:3072
    v_mfma_f32_16x16x32_bf16 v[188:191], v[32:35], a[212:215], v[188:191]
    v_rcp_f32 v134, v134
    v_mfma_f32_16x16x32_bf16 v[172:175], v[32:35], a[208:211], v[172:175]
    v_mul_f32 v134, v134, v142
    s_waitcnt lgkmcnt(4)
    v_mfma_f32_16x16x32_bf16 v[160:163], v[20:23], a[224:227], v[160:163]
    ds_read_b64_tr_b16 v[32:33], v4 offset:2080
    v_mfma_f32_16x16x32_bf16 v[176:179], v[20:23], a[228:231], v[176:179]
    ds_read_b64_tr_b16 v[34:35], v4 offset:3104
    v_mfma_f32_16x16x32_bf16 v[192:195], v[20:23], a[232:235], v[192:195]
    v_rcp_f32 v135, v135
    v_mfma_f32_16x16x32_bf16 v[208:211], v[20:23], a[236:239], v[208:211]
    v_mul_f32 v135, v135, v143
    s_waitcnt lgkmcnt(4)
    v_mfma_f32_16x16x32_bf16 v[212:215], v[24:27], a[236:239], v[212:215]
    ds_read_b64_tr_b16 v[20:21], v4 offset:512
    v_cvt_pk_bf16_f32 v91, v134, v135
    v_mfma_f32_16x16x32_bf16 v[196:199], v[24:27], a[232:235], v[196:199]
    ds_read_b64_tr_b16 v[22:23], v4 offset:1536
    v_mfma_f32_16x16x32_bf16 v[180:183], v[24:27], a[228:231], v[180:183]
    v_exp_f32 v144, v144
    v_mfma_f32_16x16x32_bf16 v[164:167], v[24:27], a[224:227], v[164:167]
    v_add_f32 v144, 1.0, v144
    s_waitcnt lgkmcnt(4)
    v_mfma_f32_16x16x32_bf16 v[168:171], v[28:31], a[224:227], v[168:171]
    ds_read_b64_tr_b16 v[24:25], v4 offset:544
    v_mfma_f32_16x16x32_bf16 v[184:187], v[28:31], a[228:231], v[184:187]
    ds_read_b64_tr_b16 v[26:27], v4 offset:1568
    v_mfma_f32_16x16x32_bf16 v[200:203], v[28:31], a[232:235], v[200:203]
    v_exp_f32 v145, v145
    v_mfma_f32_16x16x32_bf16 v[216:219], v[28:31], a[236:239], v[216:219]
    v_add_f32 v145, 1.0, v145
    s_waitcnt lgkmcnt(4)
    v_mfma_f32_16x16x32_bf16 v[220:223], v[32:35], a[236:239], v[220:223]
    ds_read_b64_tr_b16 v[28:29], v4 offset:2560
    v_mfma_f32_16x16x32_bf16 v[204:207], v[32:35], a[232:235], v[204:207]
    ds_read_b64_tr_b16 v[30:31], v4 offset:3584
    v_mfma_f32_16x16x32_bf16 v[188:191], v[32:35], a[228:231], v[188:191]
    v_exp_f32 v146, v146
    v_mfma_f32_16x16x32_bf16 v[172:175], v[32:35], a[224:227], v[172:175]
    v_add_f32 v146, 1.0, v146
    s_waitcnt lgkmcnt(4)
    v_mfma_f32_16x16x32_bf16 v[160:163], v[20:23], a[240:243], v[160:163]
    ds_read_b64_tr_b16 v[32:33], v4 offset:2592
    v_mfma_f32_16x16x32_bf16 v[176:179], v[20:23], a[244:247], v[176:179]
    ds_read_b64_tr_b16 v[34:35], v4 offset:3616
    v_mfma_f32_16x16x32_bf16 v[192:195], v[20:23], a[248:251], v[192:195]
    v_exp_f32 v147, v147
    v_mfma_f32_16x16x32_bf16 v[208:211], v[20:23], a[252:255], v[208:211]
    v_add_f32 v147, 1.0, v147
    s_waitcnt lgkmcnt(4)
    v_mfma_f32_16x16x32_bf16 v[212:215], v[24:27], a[252:255], v[212:215]
    s_waitcnt vmcnt(16)
    s_barrier
    ds_read_b64_tr_b16 v[20:21], v4 offset:16512
    s_add_u32 m0, s33, 115584
    v_mfma_f32_16x16x32_bf16 v[196:199], v[24:27], a[248:251], v[196:199]
    ds_read_b64_tr_b16 v[22:23], v4 offset:17536
    s_add_u32 s47, s34, s62
    v_mfma_f32_16x16x32_bf16 v[180:183], v[24:27], a[244:247], v[180:183]
    v_exp_f32 v148, v148
    v_mfma_f32_16x16x32_bf16 v[164:167], v[24:27], a[240:243], v[164:167]
    buffer_store_dword v17, v62, s[16:19], 0 offen offset:0 sc1
    s_waitcnt lgkmcnt(4)
    v_mfma_f32_16x16x32_bf16 v[168:171], v[28:31], a[240:243], v[168:171]
    ds_read_b64_tr_b16 v[24:25], v4 offset:16544
    v_add_f32 v148, 1.0, v148
    v_mfma_f32_16x16x32_bf16 v[184:187], v[28:31], a[244:247], v[184:187]
    ds_read_b64_tr_b16 v[26:27], v4 offset:17568
    v_mfma_f32_16x16x32_bf16 v[200:203], v[28:31], a[248:251], v[200:203]
    v_exp_f32 v149, v149
    v_mfma_f32_16x16x32_bf16 v[216:219], v[28:31], a[252:255], v[216:219]
    buffer_load_dwordx4 v2, s[4:7], s47 offen offset:0 lds
    s_waitcnt lgkmcnt(4)
    v_mfma_f32_16x16x32_bf16 v[220:223], v[32:35], a[252:255], v[220:223]
    ds_read_b64_tr_b16 v[28:29], v4 offset:18560
    v_add_f32 v149, 1.0, v149
    v_mfma_f32_16x16x32_bf16 v[204:207], v[32:35], a[248:251], v[204:207]
    ds_read_b64_tr_b16 v[30:31], v4 offset:19584
    v_mfma_f32_16x16x32_bf16 v[188:191], v[32:35], a[244:247], v[188:191]
    v_exp_f32 v150, v150
    v_mfma_f32_16x16x32_bf16 v[172:175], v[32:35], a[240:243], v[172:175]
    buffer_load_dwordx4 v3, s[4:7], s47 offen offset:1024 lds
    s_waitcnt lgkmcnt(4)
    v_mfma_f32_16x16x32_bf16 v[160:163], v[20:23], v[224:227], v[160:163]
    ds_read_b64_tr_b16 v[32:33], v4 offset:18592
    v_add_f32 v150, 1.0, v150
    v_mfma_f32_16x16x32_bf16 v[176:179], v[20:23], v[228:231], v[176:179]
    ds_read_b64_tr_b16 v[34:35], v4 offset:19616
    v_mfma_f32_16x16x32_bf16 v[192:195], v[20:23], v[232:235], v[192:195]
    v_exp_f32 v151, v151
    v_mfma_f32_16x16x32_bf16 v[208:211], v[20:23], v[236:239], v[208:211]
    buffer_load_dwordx4 v2, s[8:11], s47 offen offset:2048 lds
    s_waitcnt lgkmcnt(4)
    v_mfma_f32_16x16x32_bf16 v[212:215], v[24:27], v[236:239], v[212:215]
    ds_read_b64_tr_b16 v[20:21], v4 offset:17024
    v_add_f32 v151, 1.0, v151
    v_mfma_f32_16x16x32_bf16 v[196:199], v[24:27], v[232:235], v[196:199]
    ds_read_b64_tr_b16 v[22:23], v4 offset:18048
    v_mfma_f32_16x16x32_bf16 v[180:183], v[24:27], v[228:231], v[180:183]
    v_rcp_f32 v144, v144
    v_mfma_f32_16x16x32_bf16 v[164:167], v[24:27], v[224:227], v[164:167]
    buffer_load_dwordx4 v3, s[8:11], s47 offen offset:3072 lds
    s_waitcnt lgkmcnt(4)
    v_mfma_f32_16x16x32_bf16 v[168:171], v[28:31], v[224:227], v[168:171]
    ds_read_b64_tr_b16 v[24:25], v4 offset:17056
    s_add_u32 m0, s33, 132096
    v_mfma_f32_16x16x32_bf16 v[184:187], v[28:31], v[228:231], v[184:187]
    ds_read_b64_tr_b16 v[26:27], v4 offset:18080
    s_add_u32 s47, s34, s63
    v_mfma_f32_16x16x32_bf16 v[200:203], v[28:31], v[232:235], v[200:203]
    v_rcp_f32 v145, v145
    v_mfma_f32_16x16x32_bf16 v[216:219], v[28:31], v[236:239], v[216:219]
    buffer_load_dwordx4 v2, s[4:7], s47 offen offset:0 lds
    s_waitcnt lgkmcnt(4)
    v_mfma_f32_16x16x32_bf16 v[220:223], v[32:35], v[236:239], v[220:223]
    ds_read_b64_tr_b16 v[28:29], v4 offset:19072
    v_mul_f32 v144, v144, v152
    v_mfma_f32_16x16x32_bf16 v[204:207], v[32:35], v[232:235], v[204:207]
    ds_read_b64_tr_b16 v[30:31], v4 offset:20096
    v_mul_f32 v145, v145, v153
    v_mfma_f32_16x16x32_bf16 v[188:191], v[32:35], v[228:231], v[188:191]
    v_rcp_f32 v146, v146
    v_mfma_f32_16x16x32_bf16 v[172:175], v[32:35], v[224:227], v[172:175]
    buffer_load_dwordx4 v3, s[4:7], s47 offen offset:1024 lds
    s_waitcnt lgkmcnt(4)
    v_mfma_f32_16x16x32_bf16 v[160:163], v[20:23], v[240:243], v[160:163]
    ds_read_b64_tr_b16 v[32:33], v4 offset:19104
    v_mul_f32 v146, v146, v154
    v_mfma_f32_16x16x32_bf16 v[176:179], v[20:23], v[244:247], v[176:179]
    ds_read_b64_tr_b16 v[34:35], v4 offset:20128
    v_cvt_pk_bf16_f32 v92, v144, v145
    v_mfma_f32_16x16x32_bf16 v[192:195], v[20:23], v[248:251], v[192:195]
    v_rcp_f32 v147, v147
    v_mfma_f32_16x16x32_bf16 v[208:211], v[20:23], v[252:255], v[208:211]
    buffer_load_dwordx4 v2, s[8:11], s47 offen offset:2048 lds
    s_waitcnt lgkmcnt(4)
    v_mfma_f32_16x16x32_bf16 v[212:215], v[24:27], v[252:255], v[212:215]
    ds_read_b64_tr_b16 v[20:21], v5 offset:17024
    v_mul_f32 v147, v147, v155
    v_mfma_f32_16x16x32_bf16 v[196:199], v[24:27], v[248:251], v[196:199]
    ds_read_b64_tr_b16 v[22:23], v5 offset:18048
    v_cvt_pk_bf16_f32 v93, v146, v147
    v_mfma_f32_16x16x32_bf16 v[180:183], v[24:27], v[244:247], v[180:183]
    v_rcp_f32 v148, v148
    v_mfma_f32_16x16x32_bf16 v[164:167], v[24:27], v[240:243], v[164:167]
    buffer_load_dwordx4 v3, s[8:11], s47 offen offset:3072 lds
    s_waitcnt lgkmcnt(4)
    v_mfma_f32_16x16x32_bf16 v[168:171], v[28:31], v[240:243], v[168:171]
    ds_read_b64_tr_b16 v[24:25], v5 offset:17056
    v_mul_f32 v148, v148, v156
    v_mfma_f32_16x16x32_bf16 v[184:187], v[28:31], v[244:247], v[184:187]
    ds_read_b64_tr_b16 v[26:27], v5 offset:18080
    v_mfma_f32_16x16x32_bf16 v[200:203], v[28:31], v[248:251], v[200:203]
    v_rcp_f32 v149, v149
    v_mfma_f32_16x16x32_bf16 v[216:219], v[28:31], v[252:255], v[216:219]
    v_mul_f32 v149, v149, v157
    s_waitcnt lgkmcnt(4)
    v_mfma_f32_16x16x32_bf16 v[220:223], v[32:35], v[252:255], v[220:223]
    ds_read_b64_tr_b16 v[28:29], v5 offset:19072
    v_cvt_pk_bf16_f32 v94, v148, v149
    v_mfma_f32_16x16x32_bf16 v[204:207], v[32:35], v[248:251], v[204:207]
    ds_read_b64_tr_b16 v[30:31], v5 offset:20096
    v_mfma_f32_16x16x32_bf16 v[188:191], v[32:35], v[244:247], v[188:191]
    v_rcp_f32 v150, v150
    v_mfma_f32_16x16x32_bf16 v[172:175], v[32:35], v[240:243], v[172:175]
    v_mul_f32 v150, v150, v158
    v_rcp_f32 v151, v151
    s_nop 0
    v_mul_f32 v151, v151, v159
    v_cvt_pk_bf16_f32 v95, v150, v151
    s_waitcnt lgkmcnt(4)
    v_mfma_f32_16x16x32_bf16 v[96:99], v[20:23], a[0:3], 0
    ds_read_b64_tr_b16 v[32:33], v5 offset:19104
    v_mfma_f32_16x16x32_bf16 v[112:115], v[20:23], a[4:7], 0
    ds_read_b64_tr_b16 v[34:35], v5 offset:20128
    v_mfma_f32_16x16x32_bf16 v[128:131], v[20:23], a[8:11], 0
    v_mfma_f32_16x16x32_bf16 v[144:147], v[20:23], a[12:15], 0
    s_waitcnt lgkmcnt(4)
    v_mfma_f32_16x16x32_bf16 v[148:151], v[24:27], a[12:15], 0
    ds_read_b64_tr_b16 v[20:21], v5 offset:17536
    v_mul_f32 v160, s39, v160
    v_mfma_f32_16x16x32_bf16 v[132:135], v[24:27], a[8:11], 0
    ds_read_b64_tr_b16 v[22:23], v5 offset:18560
    v_mul_f32 v161, s39, v161
    v_mfma_f32_16x16x32_bf16 v[116:119], v[24:27], a[4:7], 0
    v_exp_f32 v160, v160
    v_mfma_f32_16x16x32_bf16 v[100:103], v[24:27], a[0:3], 0
    v_mul_f32 v162, s39, v162
    s_waitcnt lgkmcnt(4)
    v_mfma_f32_16x16x32_bf16 v[104:107], v[28:31], a[0:3], 0
    ds_read_b64_tr_b16 v[24:25], v5 offset:17568
    v_mul_f32 v163, s39, v163
    v_mfma_f32_16x16x32_bf16 v[120:123], v[28:31], a[4:7], 0
    ds_read_b64_tr_b16 v[26:27], v5 offset:18592
    v_mul_f32 v164, s39, v164
    v_mfma_f32_16x16x32_bf16 v[136:139], v[28:31], a[8:11], 0
    v_exp_f32 v161, v161
    v_mfma_f32_16x16x32_bf16 v[152:155], v[28:31], a[12:15], 0
    buffer_store_dwordx4 v[80:83], v7, s[16:19], s38 offen offset:0 sc1
    s_waitcnt lgkmcnt(4)
    v_mfma_f32_16x16x32_bf16 v[156:159], v[32:35], a[12:15], 0
    ds_read_b64_tr_b16 v[28:29], v5 offset:19584
    v_mul_f32 v165, s39, v165
    v_mfma_f32_16x16x32_bf16 v[140:143], v[32:35], a[8:11], 0
    ds_read_b64_tr_b16 v[30:31], v5 offset:20608
    v_mul_f32 v166, s39, v166
    v_mfma_f32_16x16x32_bf16 v[124:127], v[32:35], a[4:7], 0
    v_exp_f32 v162, v162
    v_mfma_f32_16x16x32_bf16 v[108:111], v[32:35], a[0:3], 0
    buffer_store_dwordx4 v[84:87], v7, s[16:19], s38 offen offset:1024 sc1
    s_waitcnt lgkmcnt(4)
    v_mfma_f32_16x16x32_bf16 v[96:99], v[20:23], a[16:19], v[96:99]
    ds_read_b64_tr_b16 v[32:33], v5 offset:19616
    v_min_u32 v19, 2, v1
    v_mfma_f32_16x16x32_bf16 v[112:115], v[20:23], a[20:23], v[112:115]
    ds_read_b64_tr_b16 v[34:35], v5 offset:20640
    v_mul_f32 v167, s39, v167
    v_mfma_f32_16x16x32_bf16 v[128:131], v[20:23], a[24:27], v[128:131]
    s_mul_i32 s98, s43, 3
    s_add_u32 s98, s98, s42
    s_lshl_b32 s98, s98, 2
    s_add_u32 s98, s98, s32
    s_mul_i32 s98, s98, 384
    v_lshl_add_u32 v19, v19, 7, s98
    v_mfma_f32_16x16x32_bf16 v[144:147], v[20:23], a[28:31], v[144:147]
    buffer_store_dwordx4 v[88:91], v7, s[16:19], s38 offen offset:2048 sc1
    s_waitcnt lgkmcnt(4)
    v_mfma_f32_16x16x32_bf16 v[148:151], v[24:27], a[28:31], v[148:151]
    s_waitcnt vmcnt(20)
    s_barrier
    ds_read_b64_tr_b16 v[20:21], v4 offset:33024
    s_add_u32 m0, s33, 0
    v_mfma_f32_16x16x32_bf16 v[132:135], v[24:27], a[24:27], v[132:135]
    ds_read_b64_tr_b16 v[22:23], v4 offset:34048
    s_add_u32 s47, s34, s64
    v_mfma_f32_16x16x32_bf16 v[116:119], v[24:27], a[20:23], v[116:119]
    v_exp_f32 v163, v163
    v_mfma_f32_16x16x32_bf16 v[100:103], v[24:27], a[16:19], v[100:103]
    buffer_store_dwordx4 v[92:95], v7, s[16:19], s38 offen offset:3072 sc1
    s_waitcnt lgkmcnt(4)
    v_mfma_f32_16x16x32_bf16 v[104:107], v[28:31], a[16:19], v[104:107]
    ds_read_b64_tr_b16 v[24:25], v4 offset:33056
    s_add_u32 s38, s38, s96
    v_mfma_f32_16x16x32_bf16 v[120:123], v[28:31], a[20:23], v[120:123]
    ds_read_b64_tr_b16 v[26:27], v4 offset:34080
    v_min_u32 v19, (L_code_end - L_cpmlp1 - 64), v19
    v_mfma_f32_16x16x32_bf16 v[136:139], v[28:31], a[24:27], v[136:139]
    v_exp_f32 v164, v164
    v_mfma_f32_16x16x32_bf16 v[152:155], v[28:31], a[28:31], v[152:155]
    buffer_load_dword v16, v10, s[16:19], 0 offen offset:0 sc1
    s_waitcnt lgkmcnt(4)
    v_mfma_f32_16x16x32_bf16 v[156:159], v[32:35], a[28:31], v[156:159]
    ds_read_b64_tr_b16 v[28:29], v4 offset:35072
    v_add_f32 v160, 1.0, v160
    v_mfma_f32_16x16x32_bf16 v[140:143], v[32:35], a[24:27], v[140:143]
    ds_read_b64_tr_b16 v[30:31], v4 offset:36096
    v_add_f32 v161, 1.0, v161
    v_mfma_f32_16x16x32_bf16 v[124:127], v[32:35], a[20:23], v[124:127]
    v_exp_f32 v165, v165
    v_mfma_f32_16x16x32_bf16 v[108:111], v[32:35], a[16:19], v[108:111]
L_cpmlp1:
    s_getpc_b64 s[98:99]
    global_load_dword v74, v19, s[98:99]
    s_waitcnt lgkmcnt(4)
    v_mfma_f32_16x16x32_bf16 v[96:99], v[20:23], a[32:35], v[96:99]
    ds_read_b64_tr_b16 v[32:33], v4 offset:35104
    v_add_f32 v162, 1.0, v162
    v_mfma_f32_16x16x32_bf16 v[112:115], v[20:23], a[36:39], v[112:115]
    ds_read_b64_tr_b16 v[34:35], v4 offset:36128
    v_add_f32 v163, 1.0, v163
    v_mfma_f32_16x16x32_bf16 v[128:131], v[20:23], a[40:43], v[128:131]
    v_exp_f32 v166, v166
    v_mfma_f32_16x16x32_bf16 v[144:147], v[20:23], a[44:47], v[144:147]
    buffer_load_dwordx4 v2, s[4:7], s47 offen offset:0 lds
    s_waitcnt lgkmcnt(4)
    v_mfma_f32_16x16x32_bf16 v[148:151], v[24:27], a[44:47], v[148:151]
    ds_read_b64_tr_b16 v[20:21], v4 offset:33536
    v_add_f32 v164, 1.0, v164
    v_mfma_f32_16x16x32_bf16 v[132:135], v[24:27], a[40:43], v[132:135]
    ds_read_b64_tr_b16 v[22:23], v4 offset:34560
    v_add_f32 v165, 1.0, v165
    v_mfma_f32_16x16x32_bf16 v[116:119], v[24:27], a[36:39], v[116:119]
    v_exp_f32 v167, v167
    v_mfma_f32_16x16x32_bf16 v[100:103], v[24:27], a[32:35], v[100:103]
    buffer_load_dwordx4 v3, s[4:7], s47 offen offset:1024 lds
    s_waitcnt lgkmcnt(4)
    v_mfma_f32_16x16x32_bf16 v[104:107], v[28:31], a[32:35], v[104:107]
    ds_read_b64_tr_b16 v[24:25], v4 offset:33568
    v_add_f32 v166, 1.0, v166
    v_mfma_f32_16x16x32_bf16 v[120:123], v[28:31], a[36:39], v[120:123]
    ds_read_b64_tr_b16 v[26:27], v4 offset:34592
    v_add_f32 v167, 1.0, v167
    v_mfma_f32_16x16x32_bf16 v[136:139], v[28:31], a[40:43], v[136:139]
    v_rcp_f32 v160, v160
    v_mfma_f32_16x16x32_bf16 v[152:155], v[28:31], a[44:47], v[152:155]
    buffer_load_dwordx4 v2, s[8:11], s47 offen offset:2048 lds
    s_waitcnt lgkmcnt(4)
    v_mfma_f32_16x16x32_bf16 v[156:159], v[32:35], a[44:47], v[156:159]
    ds_read_b64_tr_b16 v[28:29], v4 offset:35584
    v_mul_f32 v160, v160, v168
    v_mfma_f32_16x16x32_bf16 v[140:143], v[32:35], a[40:43], v[140:143]
    ds_read_b64_tr_b16 v[30:31], v4 offset:36608
    v_mul_f32 v176, s39, v176
    v_mfma_f32_16x16x32_bf16 v[124:127], v[32:35], a[36:39], v[124:127]
    v_rcp_f32 v161, v161
    v_mfma_f32_16x16x32_bf16 v[108:111], v[32:35], a[32:35], v[108:111]
    buffer_load_dwordx4 v3, s[8:11], s47 offen offset:3072 lds
    s_waitcnt lgkmcnt(4)
    v_mfma_f32_16x16x32_bf16 v[96:99], v[20:23], a[48:51], v[96:99]
    ds_read_b64_tr_b16 v[32:33], v4 offset:35616
    s_add_u32 m0, s33, 16512
    v_mfma_f32_16x16x32_bf16 v[112:115], v[20:23], a[52:55], v[112:115]
    ds_read_b64_tr_b16 v[34:35], v4 offset:36640
    s_add_u32 s47, s34, s65
    v_mfma_f32_16x16x32_bf16 v[128:131], v[20:23], a[56:59], v[128:131]
    v_rcp_f32 v162, v162
    v_mfma_f32_16x16x32_bf16 v[144:147], v[20:23], a[60:63], v[144:147]
    buffer_load_dwordx4 v2, s[4:7], s47 offen offset:0 lds
    s_waitcnt lgkmcnt(4)
    v_mfma_f32_16x16x32_bf16 v[148:151], v[24:27], a[60:63], v[148:151]
    ds_read_b64_tr_b16 v[20:21], v4 offset:49536
    v_mul_f32 v161, v161, v169
    v_mfma_f32_16x16x32_bf16 v[132:135], v[24:27], a[56:59], v[132:135]
    ds_read_b64_tr_b16 v[22:23], v4 offset:50560
    v_mul_f32 v162, v162, v170
    v_mfma_f32_16x16x32_bf16 v[116:119], v[24:27], a[52:55], v[116:119]
    v_rcp_f32 v163, v163
    v_mfma_f32_16x16x32_bf16 v[100:103], v[24:27], a[48:51], v[100:103]
    buffer_load_dwordx4 v3, s[4:7], s47 offen offset:1024 lds
    s_waitcnt lgkmcnt(4)
    v_mfma_f32_16x16x32_bf16 v[104:107], v[28:31], a[48:51], v[104:107]
    ds_read_b64_tr_b16 v[24:25], v4 offset:49568
    v_mul_f32 v163, v163, v171
    v_mfma_f32_16x16x32_bf16 v[120:123], v[28:31], a[52:55], v[120:123]
    ds_read_b64_tr_b16 v[26:27], v4 offset:50592
    v_cvt_pk_bf16_f32 v168, v160, v161
    v_mfma_f32_16x16x32_bf16 v[136:139], v[28:31], a[56:59], v[136:139]
    v_rcp_f32 v164, v164
    v_mfma_f32_16x16x32_bf16 v[152:155], v[28:31], a[60:63], v[152:155]
    buffer_load_dwordx4 v2, s[8:11], s47 offen offset:2048 lds
    s_waitcnt lgkmcnt(4)
    v_mfma_f32_16x16x32_bf16 v[156:159], v[32:35], a[60:63], v[156:159]
    ds_read_b64_tr_b16 v[28:29], v4 offset:51584
    v_mul_f32 v164, v164, v172
    v_mfma_f32_16x16x32_bf16 v[140:143], v[32:35], a[56:59], v[140:143]
    ds_read_b64_tr_b16 v[30:31], v4 offset:52608
    v_cvt_pk_bf16_f32 v169, v162, v163
    v_mfma_f32_16x16x32_bf16 v[124:127], v[32:35], a[52:55], v[124:127]
    v_rcp_f32 v165, v165
    v_mfma_f32_16x16x32_bf16 v[108:111], v[32:35], a[48:51], v[108:111]
    buffer_load_dwordx4 v3, s[8:11], s47 offen offset:3072 lds
    s_waitcnt lgkmcnt(4)
    v_mfma_f32_16x16x32_bf16 v[96:99], v[20:23], a[64:67], v[96:99]
    ds_read_b64_tr_b16 v[32:33], v4 offset:51616
    v_mul_f32 v165, v165, v173
    v_mfma_f32_16x16x32_bf16 v[112:115], v[20:23], a[68:71], v[112:115]
    ds_read_b64_tr_b16 v[34:35], v4 offset:52640
    v_cvt_pk_bf16_f32 v170, v164, v165
    v_mfma_f32_16x16x32_bf16 v[128:131], v[20:23], a[72:75], v[128:131]
    v_rcp_f32 v166, v166
    v_mfma_f32_16x16x32_bf16 v[144:147], v[20:23], a[76:79], v[144:147]
    v_mul_f32 v166, v166, v174
    s_waitcnt lgkmcnt(4)
    v_mfma_f32_16x16x32_bf16 v[148:151], v[24:27], a[76:79], v[148:151]
    ds_read_b64_tr_b16 v[20:21], v4 offset:50048
    v_mul_f32 v177, s39, v177
    v_mfma_f32_16x16x32_bf16 v[132:135], v[24:27], a[72:75], v[132:135]
    ds_read_b64_tr_b16 v[22:23], v4 offset:51072
    v_mul_f32 v178, s39, v178
    v_mfma_f32_16x16x32_bf16 v[116:119], v[24:27], a[68:71], v[116:119]
    s_waitcnt vmcnt(9)
    v_cmp_ne_u32 vcc, s66, v16
    s_cbranch_vccnz L_slow_mlpF1
L_ret_mlpF1:
    v_mfma_f32_16x16x32_bf16 v[100:103], v[24:27], a[64:67], v[100:103]
    buffer_load_dwordx4 a[0:3], v14, s[16:19], s68 offen offset:0 sc1
    s_waitcnt lgkmcnt(4)
    v_mfma_f32_16x16x32_bf16 v[104:107], v[28:31], a[64:67], v[104:107]
    ds_read_b64_tr_b16 v[24:25], v4 offset:50080
    v_mul_f32 v179, s39, v179
    v_mfma_f32_16x16x32_bf16 v[120:123], v[28:31], a[68:71], v[120:123]
    ds_read_b64_tr_b16 v[26:27], v4 offset:51104
    v_mul_f32 v180, s39, v180
    v_mfma_f32_16x16x32_bf16 v[136:139], v[28:31], a[72:75], v[136:139]
    v_rcp_f32 v167, v167
    v_mfma_f32_16x16x32_bf16 v[152:155], v[28:31], a[76:79], v[152:155]
    buffer_load_dwordx4 a[4:7], v14, s[16:19], s68 offen offset:1024 sc1
    s_waitcnt lgkmcnt(4)
    v_mfma_f32_16x16x32_bf16 v[156:159], v[32:35], a[76:79], v[156:159]
    ds_read_b64_tr_b16 v[28:29], v4 offset:52096
    v_mul_f32 v167, v167, v175
    v_mfma_f32_16x16x32_bf16 v[140:143], v[32:35], a[72:75], v[140:143]
    ds_read_b64_tr_b16 v[30:31], v4 offset:53120
    v_cvt_pk_bf16_f32 v171, v166, v167
    v_mfma_f32_16x16x32_bf16 v[124:127], v[32:35], a[68:71], v[124:127]
    v_exp_f32 v176, v176
    v_mfma_f32_16x16x32_bf16 v[108:111], v[32:35], a[64:67], v[108:111]
    buffer_store_dwordx4 v[168:171], v7, s[16:19], s38 offen offset:0 sc1
    s_waitcnt lgkmcnt(4)
    v_mfma_f32_16x16x32_bf16 v[96:99], v[20:23], a[80:83], v[96:99]
    ds_read_b64_tr_b16 v[32:33], v4 offset:52128
    v_mul_f32 v181, s39, v181
    v_mfma_f32_16x16x32_bf16 v[112:115], v[20:23], a[84:87], v[112:115]
    ds_read_b64_tr_b16 v[34:35], v4 offset:53152
    v_mul_f32 v182, s39, v182
    v_mfma_f32_16x16x32_bf16 v[128:131], v[20:23], a[88:91], v[128:131]
    v_exp_f32 v177, v177
    v_mfma_f32_16x16x32_bf16 v[144:147], v[20:23], a[92:95], v[144:147]
    buffer_load_dwordx4 a[8:11], v14, s[16:19], s69 offen offset:0 sc1
    s_waitcnt lgkmcnt(4)
    v_mfma_f32_16x16x32_bf16 v[148:151], v[24:27], a[92:95], v[148:151]
    s_barrier
    ds_read_b64_tr_b16 v[20:21], v5 offset:512
    v_mul_f32 v183, s39, v183
    v_mfma_f32_16x16x32_bf16 v[132:135], v[24:27], a[88:91], v[132:135]
    ds_read_b64_tr_b16 v[22:23], v5 offset:1536
    v_add_f32 v176, 1.0, v176
    v_mfma_f32_16x16x32_bf16 v[116:119], v[24:27], a[84:87], v[116:119]
    v_exp_f32 v178, v178
    v_mfma_f32_16x16x32_bf16 v[100:103], v[24:27], a[80:83], v[100:103]
    buffer_load_dwordx4 a[12:15], v14, s[16:19], s69 offen offset:1024 sc1
    s_waitcnt lgkmcnt(4)
    v_mfma_f32_16x16x32_bf16 v[104:107], v[28:31], a[80:83], v[104:107]
    ds_read_b64_tr_b16 v[24:25], v5 offset:544
    v_add_f32 v177, 1.0, v177
    v_mfma_f32_16x16x32_bf16 v[120:123], v[28:31], a[84:87], v[120:123]
    ds_read_b64_tr_b16 v[26:27], v5 offset:1568
    v_add_f32 v178, 1.0, v178
    v_mfma_f32_16x16x32_bf16 v[136:139], v[28:31], a[88:91], v[136:139]
    v_exp_f32 v179, v179
    v_mfma_f32_16x16x32_bf16 v[152:155], v[28:31], a[92:95], v[152:155]
    buffer_load_dwordx4 a[16:19], v14, s[16:19], s70 offen offset:0 sc1
    s_waitcnt lgkmcnt(4)
    v_mfma_f32_16x16x32_bf16 v[156:159], v[32:35], a[92:95], v[156:159]
    ds_read_b64_tr_b16 v[28:29], v5 offset:2560
    v_add_f32 v179, 1.0, v179
    v_mfma_f32_16x16x32_bf16 v[140:143], v[32:35], a[88:91], v[140:143]
    ds_read_b64_tr_b16 v[30:31], v5 offset:3584
    v_mul_f32 v192, s39, v192
    v_mfma_f32_16x16x32_bf16 v[124:127], v[32:35], a[84:87], v[124:127]
    v_exp_f32 v180, v180
    v_mfma_f32_16x16x32_bf16 v[108:111], v[32:35], a[80:83], v[108:111]
    buffer_load_dwordx4 a[20:23], v14, s[16:19], s70 offen offset:1024 sc1
    s_waitcnt lgkmcnt(4)
    v_mfma_f32_16x16x32_bf16 v[96:99], v[20:23], a[96:99], v[96:99]
    ds_read_b64_tr_b16 v[32:33], v5 offset:2592
    v_add_f32 v180, 1.0, v180
    v_mfma_f32_16x16x32_bf16 v[112:115], v[20:23], a[100:103], v[112:115]
    ds_read_b64_tr_b16 v[34:35], v5 offset:3616
    v_mul_f32 v193, s39, v193
    v_mfma_f32_16x16x32_bf16 v[128:131], v[20:23], a[104:107], v[128:131]
    v_exp_f32 v181, v181
    v_mfma_f32_16x16x32_bf16 v[144:147], v[20:23], a[108:111], v[144:147]
    buffer_load_dwordx4 a[24:27], v14, s[16:19], s71 offen offset:0 sc1
    s_waitcnt lgkmcnt(4)
    v_mfma_f32_16x16x32_bf16 v[148:151], v[24:27], a[108:111], v[148:151]
    ds_read_b64_tr_b16 v[20:21], v5 offset:1024
    v_add_f32 v181, 1.0, v181
    v_mfma_f32_16x16x32_bf16 v[132:135], v[24:27], a[104:107], v[132:135]
    ds_read_b64_tr_b16 v[22:23], v5 offset:2048
    v_mul_f32 v194, s39, v194
    v_mfma_f32_16x16x32_bf16 v[116:119], v[24:27], a[100:103], v[116:119]
    v_exp_f32 v182, v182
    v_mfma_f32_16x16x32_bf16 v[100:103], v[24:27], a[96:99], v[100:103]
    buffer_load_dwordx4 a[28:31], v14, s[16:19], s71 offen offset:1024 sc1
    s_waitcnt lgkmcnt(4)
    v_mfma_f32_16x16x32_bf16 v[104:107], v[28:31], a[96:99], v[104:107]
    ds_read_b64_tr_b16 v[24:25], v5 offset:1056
    v_add_f32 v182, 1.0, v182
    v_mfma_f32_16x16x32_bf16 v[120:123], v[28:31], a[100:103], v[120:123]
    ds_read_b64_tr_b16 v[26:27], v5 offset:2080
    v_mul_f32 v195, s39, v195
    v_mfma_f32_16x16x32_bf16 v[136:139], v[28:31], a[104:107], v[136:139]
    v_exp_f32 v183, v183
    v_mfma_f32_16x16x32_bf16 v[152:155], v[28:31], a[108:111], v[152:155]
    buffer_load_dwordx4 a[32:35], v14, s[16:19], s72 offen offset:0 sc1
    s_waitcnt lgkmcnt(4)
    v_mfma_f32_16x16x32_bf16 v[156:159], v[32:35], a[108:111], v[156:159]
    ds_read_b64_tr_b16 v[28:29], v5 offset:3072
    v_add_f32 v183, 1.0, v183
    v_mfma_f32_16x16x32_bf16 v[140:143], v[32:35], a[104:107], v[140:143]
    ds_read_b64_tr_b16 v[30:31], v5 offset:4096
    v_mul_f32 v196, s39, v196
    v_mfma_f32_16x16x32_bf16 v[124:127], v[32:35], a[100:103], v[124:127]
    v_rcp_f32 v176, v176
    v_mfma_f32_16x16x32_bf16 v[108:111], v[32:35], a[96:99], v[108:111]
    buffer_load_dwordx4 a[36:39], v14, s[16:19], s72 offen offset:1024 sc1
    s_waitcnt lgkmcnt(4)
    v_mfma_f32_16x16x32_bf16 v[96:99], v[20:23], a[112:115], v[96:99]
    ds_read_b64_tr_b16 v[32:33], v5 offset:3104
    v_mul_f32 v176, v176, v184
    v_mfma_f32_16x16x32_bf16 v[112:115], v[20:23], a[116:119], v[112:115]
    ds_read_b64_tr_b16 v[34:35], v5 offset:4128
    v_mul_f32 v197, s39, v197
    v_mfma_f32_16x16x32_bf16 v[128:131], v[20:23], a[120:123], v[128:131]
    v_rcp_f32 v177, v177
    v_mfma_f32_16x16x32_bf16 v[144:147], v[20:23], a[124:127], v[144:147]
    buffer_load_dwordx4 a[40:43], v14, s[16:19], s73 offen offset:0 sc1
    s_waitcnt lgkmcnt(4)
    v_mfma_f32_16x16x32_bf16 v[148:151], v[24:27], a[124:127], v[148:151]
    ds_read_b64_tr_b16 v[20:21], v5 offset:33536
    v_mul_f32 v177, v177, v185
    v_mfma_f32_16x16x32_bf16 v[132:135], v[24:27], a[120:123], v[132:135]
    ds_read_b64_tr_b16 v[22:23], v5 offset:34560
    v_cvt_pk_bf16_f32 v184, v176, v177
    v_mfma_f32_16x16x32_bf16 v[116:119], v[24:27], a[116:119], v[116:119]
    v_rcp_f32 v178, v178
    v_mfma_f32_16x16x32_bf16 v[100:103], v[24:27], a[112:115], v[100:103]
    buffer_load_dwordx4 a[44:47], v14, s[16:19], s73 offen offset:1024 sc1
    s_waitcnt lgkmcnt(4)
    v_mfma_f32_16x16x32_bf16 v[104:107], v[28:31], a[112:115], v[104:107]
    ds_read_b64_tr_b16 v[24:25], v5 offset:33568
    v_mul_f32 v178, v178, v186
    v_mfma_f32_16x16x32_bf16 v[120:123], v[28:31], a[116:119], v[120:123]
    ds_read_b64_tr_b16 v[26:27], v5 offset:34592
    v_mul_f32 v198, s39, v198
    v_mfma_f32_16x16x32_bf16 v[136:139], v[28:31], a[120:123], v[136:139]
    v_rcp_f32 v179, v179
    v_mfma_f32_16x16x32_bf16 v[152:155], v[28:31], a[124:127], v[152:155]
    buffer_load_dwordx4 a[48:51], v14, s[16:19], s74 offen offset:0 sc1
    s_waitcnt lgkmcnt(4)
    v_mfma_f32_16x16x32_bf16 v[156:159], v[32:35], a[124:127], v[156:159]
    ds_read_b64_tr_b16 v[28:29], v5 offset:35584
    v_mul_f32 v179, v179, v187
    v_mfma_f32_16x16x32_bf16 v[140:143], v[32:35], a[120:123], v[140:143]
    ds_read_b64_tr_b16 v[30:31], v5 offset:36608
    v_cvt_pk_bf16_f32 v185, v178, v179
    v_mfma_f32_16x16x32_bf16 v[124:127], v[32:35], a[116:119], v[124:127]
    v_rcp_f32 v180, v180
    v_mfma_f32_16x16x32_bf16 v[108:111], v[32:35], a[112:115], v[108:111]
    buffer_load_dwordx4 a[52:55], v14, s[16:19], s74 offen offset:1024 sc1
    s_waitcnt lgkmcnt(4)
    v_mfma_f32_16x16x32_bf16 v[96:99], v[20:23], a[128:131], v[96:99]
    ds_read_b64_tr_b16 v[32:33], v5 offset:35616
    v_mul_f32 v180, v180, v188
    v_mfma_f32_16x16x32_bf16 v[112:115], v[20:23], a[132:135], v[112:115]
    ds_read_b64_tr_b16 v[34:35], v5 offset:36640
    v_mul_f32 v199, s39, v199
    v_mfma_f32_16x16x32_bf16 v[128:131], v[20:23], a[136:139], v[128:131]
    v_rcp_f32 v181, v181
    v_mfma_f32_16x16x32_bf16 v[144:147], v[20:23], a[140:143], v[144:147]
    buffer_load_dwordx4 a[56:59], v14, s[16:19], s75 offen offset:0 sc1
    s_waitcnt lgkmcnt(4)
    v_mfma_f32_16x16x32_bf16 v[148:151], v[24:27], a[140:143], v[148:151]
    ds_read_b64_tr_b16 v[20:21], v5 offset:34048
    v_mul_f32 v181, v181, v189
    v_mfma_f32_16x16x32_bf16 v[132:135], v[24:27], a[136:139], v[132:135]
    ds_read_b64_tr_b16 v[22:23], v5 offset:35072
    v_cvt_pk_bf16_f32 v186, v180, v181
    v_mfma_f32_16x16x32_bf16 v[116:119], v[24:27], a[132:135], v[116:119]
    v_rcp_f32 v182, v182
    v_mfma_f32_16x16x32_bf16 v[100:103], v[24:27], a[128:131], v[100:103]
    buffer_load_dwordx4 a[60:63], v14, s[16:19], s75 offen offset:1024 sc1
    s_waitcnt lgkmcnt(4)
    v_mfma_f32_16x16x32_bf16 v[104:107], v[28:31], a[128:131], v[104:107]
    ds_read_b64_tr_b16 v[24:25], v5 offset:34080
    v_mul_f32 v182, v182, v190
    v_mfma_f32_16x16x32_bf16 v[120:123], v[28:31], a[132:135], v[120:123]
    ds_read_b64_tr_b16 v[26:27], v5 offset:35104
    v_mul_f32 v208, s39, v208
    v_mfma_f32_16x16x32_bf16 v[136:139], v[28:31], a[136:139], v[136:139]
    v_rcp_f32 v183, v183
    v_mfma_f32_16x16x32_bf16 v[152:155], v[28:31], a[140:143], v[152:155]
    buffer_load_dwordx4 a[64:67], v14, s[16:19], s76 offen offset:0 sc1
    s_waitcnt lgkmcnt(4)
    v_mfma_f32_16x16x32_bf16 v[156:159], v[32:35], a[140:143], v[156:159]
    ds_read_b64_tr_b16 v[28:29], v5 offset:36096
    v_mul_f32 v183, v183, v191
    v_mfma_f32_16x16x32_bf16 v[140:143], v[32:35], a[136:139], v[140:143]
    ds_read_b64_tr_b16 v[30:31], v5 offset:37120
    v_cvt_pk_bf16_f32 v187, v182, v183
    v_mfma_f32_16x16x32_bf16 v[124:127], v[32:35], a[132:135], v[124:127]
    v_exp_f32 v192, v192
    v_mfma_f32_16x16x32_bf16 v[108:111], v[32:35], a[128:131], v[108:111]
    buffer_store_dwordx4 v[184:187], v7, s[16:19], s38 offen offset:1024 sc1
    s_waitcnt lgkmcnt(4)
    v_mfma_f32_16x16x32_bf16 v[96:99], v[20:23], a[144:147], v[96:99]
    ds_read_b64_tr_b16 v[32:33], v5 offset:36128
    v_add_f32 v192, 1.0, v192
    v_mfma_f32_16x16x32_bf16 v[112:115], v[20:23], a[148:151], v[112:115]
    ds_read_b64_tr_b16 v[34:35], v5 offset:37152
    v_mul_f32 v209, s39, v209
    v_mfma_f32_16x16x32_bf16 v[128:131], v[20:23], a[152:155], v[128:131]
    v_exp_f32 v193, v193
    v_mfma_f32_16x16x32_bf16 v[144:147], v[20:23], a[156:159], v[144:147]
    buffer_load_dwordx4 a[68:71], v14, s[16:19], s76 offen offset:1024 sc1
    s_waitcnt lgkmcnt(4)
    v_mfma_f32_16x16x32_bf16 v[148:151], v[24:27], a[156:159], v[148:151]
    s_barrier
    ds_read_b64_tr_b16 v[20:21], v5 offset:50048
    v_add_f32 v193, 1.0, v193
    v_mfma_f32_16x16x32_bf16 v[132:135], v[24:27], a[152:155], v[132:135]
    ds_read_b64_tr_b16 v[22:23], v5 offset:51072
    v_mul_f32 v210, s39, v210
    v_mfma_f32_16x16x32_bf16 v[116:119], v[24:27], a[148:151], v[116:119]
    v_exp_f32 v194, v194
    v_mfma_f32_16x16x32_bf16 v[100:103], v[24:27], a[144:147], v[100:103]
    buffer_store_dword v17, v62, s[16:19], 0 offen offset:640 sc1
    s_waitcnt lgkmcnt(4)
    v_mfma_f32_16x16x32_bf16 v[104:107], v[28:31], a[144:147], v[104:107]
    ds_read_b64_tr_b16 v[24:25], v5 offset:50080
    v_add_f32 v194, 1.0, v194
    v_mfma_f32_16x16x32_bf16 v[120:123], v[28:31], a[148:151], v[120:123]
    ds_read_b64_tr_b16 v[26:27], v5 offset:51104
    v_mul_f32 v211, s39, v211
    v_mfma_f32_16x16x32_bf16 v[136:139], v[28:31], a[152:155], v[136:139]
    v_exp_f32 v195, v195
    v_mfma_f32_16x16x32_bf16 v[152:155], v[28:31], a[156:159], v[152:155]
    buffer_load_dwordx4 a[72:75], v14, s[16:19], s77 offen offset:0 sc1
    s_waitcnt lgkmcnt(4)
    v_mfma_f32_16x16x32_bf16 v[156:159], v[32:35], a[156:159], v[156:159]
    ds_read_b64_tr_b16 v[28:29], v5 offset:52096
    v_add_f32 v195, 1.0, v195
    v_mfma_f32_16x16x32_bf16 v[140:143], v[32:35], a[152:155], v[140:143]
    ds_read_b64_tr_b16 v[30:31], v5 offset:53120
    v_mul_f32 v212, s39, v212
    v_mfma_f32_16x16x32_bf16 v[124:127], v[32:35], a[148:151], v[124:127]
    v_exp_f32 v196, v196
    v_mfma_f32_16x16x32_bf16 v[108:111], v[32:35], a[144:147], v[108:111]
    buffer_load_dwordx4 a[76:79], v14, s[16:19], s77 offen offset:1024 sc1
    s_waitcnt lgkmcnt(4)
    v_mfma_f32_16x16x32_bf16 v[96:99], v[20:23], a[160:163], v[96:99]
    ds_read_b64_tr_b16 v[32:33], v5 offset:52128
    s_nop 0
    v_mfma_f32_16x16x32_bf16 v[112:115], v[20:23], a[164:167], v[112:115]
    ds_read_b64_tr_b16 v[34:35], v5 offset:53152
    s_add_u32 m0, s44, 148608
    v_mfma_f32_16x16x32_bf16 v[128:131], v[20:23], a[168:171], v[128:131]
    v_exp_f32 v197, v197
    v_mfma_f32_16x16x32_bf16 v[144:147], v[20:23], a[172:175], v[144:147]
    buffer_load_dwordx4 v11, s[20:23], s68 offen offset:0 lds
    s_waitcnt lgkmcnt(4)
    v_mfma_f32_16x16x32_bf16 v[148:151], v[24:27], a[172:175], v[148:151]
    ds_read_b64_tr_b16 v[20:21], v5 offset:50560
    v_add_f32 v196, 1.0, v196
    v_mfma_f32_16x16x32_bf16 v[132:135], v[24:27], a[168:171], v[132:135]
    ds_read_b64_tr_b16 v[22:23], v5 offset:51584
    v_add_f32 v197, 1.0, v197
    v_mfma_f32_16x16x32_bf16 v[116:119], v[24:27], a[164:167], v[116:119]
    v_exp_f32 v198, v198
    v_mfma_f32_16x16x32_bf16 v[100:103], v[24:27], a[160:163], v[100:103]
    buffer_load_dwordx4 v12, s[20:23], s68 offen offset:1024 lds
    s_waitcnt lgkmcnt(4)
    v_mfma_f32_16x16x32_bf16 v[104:107], v[28:31], a[160:163], v[104:107]
    ds_read_b64_tr_b16 v[24:25], v5 offset:50592
    v_add_f32 v198, 1.0, v198
    v_mfma_f32_16x16x32_bf16 v[120:123], v[28:31], a[164:167], v[120:123]
    ds_read_b64_tr_b16 v[26:27], v5 offset:51616
    v_mul_f32 v213, s39, v213
    v_mfma_f32_16x16x32_bf16 v[136:139], v[28:31], a[168:171], v[136:139]
    v_exp_f32 v199, v199
    v_mfma_f32_16x16x32_bf16 v[152:155], v[28:31], a[172:175], v[152:155]
    buffer_load_dwordx4 v13, s[20:23], s68 offen offset:2048 lds
    s_waitcnt lgkmcnt(4)
    v_mfma_f32_16x16x32_bf16 v[156:159], v[32:35], a[172:175], v[156:159]
    ds_read_b64_tr_b16 v[28:29], v5 offset:52608
    s_add_u32 m0, s44, 33024
    v_mfma_f32_16x16x32_bf16 v[140:143], v[32:35], a[168:171], v[140:143]
    ds_read_b64_tr_b16 v[30:31], v5 offset:53632
    v_add_f32 v199, 1.0, v199
    v_mfma_f32_16x16x32_bf16 v[124:127], v[32:35], a[164:167], v[124:127]
    v_rcp_f32 v192, v192
    v_mfma_f32_16x16x32_bf16 v[108:111], v[32:35], a[160:163], v[108:111]
    buffer_load_dwordx4 v11, s[20:23], s69 offen offset:0 lds
    s_waitcnt lgkmcnt(4)
    v_mfma_f32_16x16x32_bf16 v[96:99], v[20:23], a[176:179], v[96:99]
    ds_read_b64_tr_b16 v[32:33], v5 offset:52640
    v_mul_f32 v192, v192, v200
    v_mfma_f32_16x16x32_bf16 v[112:115], v[20:23], a[180:183], v[112:115]
    ds_read_b64_tr_b16 v[34:35], v5 offset:53664
    v_mul_f32 v214, s39, v214
    v_mfma_f32_16x16x32_bf16 v[128:131], v[20:23], a[184:187], v[128:131]
    v_rcp_f32 v193, v193
    v_mfma_f32_16x16x32_bf16 v[144:147], v[20:23], a[188:191], v[144:147]
    buffer_load_dwordx4 v12, s[20:23], s69 offen offset:1024 lds
    s_waitcnt lgkmcnt(4)
    v_mfma_f32_16x16x32_bf16 v[148:151], v[24:27], a[188:191], v[148:151]
    ds_read_b64_tr_b16 v[20:21], v6 offset:1024
    v_mul_f32 v193, v193, v201
    v_mfma_f32_16x16x32_bf16 v[132:135], v[24:27], a[184:187], v[132:135]
    ds_read_b64_tr_b16 v[22:23], v6 offset:2048
    v_cvt_pk_bf16_f32 v200, v192, v193
    v_mfma_f32_16x16x32_bf16 v[116:119], v[24:27], a[180:183], v[116:119]
    v_rcp_f32 v194, v194
    v_mfma_f32_16x16x32_bf16 v[100:103], v[24:27], a[176:179], v[100:103]
    buffer_load_dwordx4 v13, s[20:23], s69 offen offset:2048 lds
    s_waitcnt lgkmcnt(4)
    v_mfma_f32_16x16x32_bf16 v[104:107], v[28:31], a[176:179], v[104:107]
    ds_read_b64_tr_b16 v[24:25], v6 offset:1056
    s_add_u32 m0, s44, 82560
    v_mfma_f32_16x16x32_bf16 v[120:123], v[28:31], a[180:183], v[120:123]
    ds_read_b64_tr_b16 v[26:27], v6 offset:2080
    v_mul_f32 v194, v194, v202
    v_mfma_f32_16x16x32_bf16 v[136:139], v[28:31], a[184:187], v[136:139]
    v_rcp_f32 v195, v195
    v_mfma_f32_16x16x32_bf16 v[152:155], v[28:31], a[188:191], v[152:155]
    buffer_load_dwordx4 v11, s[20:23], s70 offen offset:0 lds
    s_waitcnt lgkmcnt(4)
    v_mfma_f32_16x16x32_bf16 v[156:159], v[32:35], a[188:191], v[156:159]
    ds_read_b64_tr_b16 v[28:29], v6 offset:3072
    v_mul_f32 v195, v195, v203
    v_mfma_f32_16x16x32_bf16 v[140:143], v[32:35], a[184:187], v[140:143]
    ds_read_b64_tr_b16 v[30:31], v6 offset:4096
    v_cvt_pk_bf16_f32 v201, v194, v195
    v_mfma_f32_16x16x32_bf16 v[124:127], v[32:35], a[180:183], v[124:127]
    v_rcp_f32 v196, v196
    v_mfma_f32_16x16x32_bf16 v[108:111], v[32:35], a[176:179], v[108:111]
    buffer_load_dwordx4 v12, s[20:23], s70 offen offset:1024 lds
    s_waitcnt lgkmcnt(4)
    v_mfma_f32_16x16x32_bf16 v[96:99], v[20:23], a[192:195], v[96:99]
    ds_read_b64_tr_b16 v[32:33], v6 offset:3104
    v_mul_f32 v196, v196, v204
    v_mfma_f32_16x16x32_bf16 v[112:115], v[20:23], a[196:199], v[112:115]
    ds_read_b64_tr_b16 v[34:35], v6 offset:4128
    v_mul_f32 v215, s39, v215
    v_mfma_f32_16x16x32_bf16 v[128:131], v[20:23], a[200:203], v[128:131]
    v_rcp_f32 v197, v197
    v_mfma_f32_16x16x32_bf16 v[144:147], v[20:23], a[204:207], v[144:147]
    buffer_load_dwordx4 v13, s[20:23], s70 offen offset:2048 lds
    s_waitcnt lgkmcnt(4)
    v_mfma_f32_16x16x32_bf16 v[148:151], v[24:27], a[204:207], v[148:151]
    ds_read_b64_tr_b16 v[20:21], v6 offset:1536
    v_mul_f32 v197, v197, v205
    v_mfma_f32_16x16x32_bf16 v[132:135], v[24:27], a[200:203], v[132:135]
    ds_read_b64_tr_b16 v[22:23], v6 offset:2560
    v_cvt_pk_bf16_f32 v202, v196, v197
    v_mfma_f32_16x16x32_bf16 v[116:119], v[24:27], a[196:199], v[116:119]
    v_rcp_f32 v198, v198
    v_mfma_f32_16x16x32_bf16 v[100:103], v[24:27], a[192:195], v[100:103]
    buffer_load_dwordx4 a[80:83], v14, s[16:19], s78 offen offset:0 sc1
    s_waitcnt lgkmcnt(4)
    v_mfma_f32_16x16x32_bf16 v[104:107], v[28:31], a[192:195], v[104:107]
    ds_read_b64_tr_b16 v[24:25], v6 offset:1568
    v_mul_f32 v198, v198, v206
    v_mfma_f32_16x16x32_bf16 v[120:123], v[28:31], a[196:199], v[120:123]
    ds_read_b64_tr_b16 v[26:27], v6 offset:2592
    v_mfma_f32_16x16x32_bf16 v[136:139], v[28:31], a[200:203], v[136:139]
    v_rcp_f32 v199, v199
    v_mfma_f32_16x16x32_bf16 v[152:155], v[28:31], a[204:207], v[152:155]
    buffer_load_dwordx4 a[84:87], v14, s[16:19], s78 offen offset:1024 sc1
    s_waitcnt lgkmcnt(4)
    v_mfma_f32_16x16x32_bf16 v[156:159], v[32:35], a[204:207], v[156:159]
    ds_read_b64_tr_b16 v[28:29], v6 offset:3584
    v_mul_f32 v199, v199, v207
    v_mfma_f32_16x16x32_bf16 v[140:143], v[32:35], a[200:203], v[140:143]
    ds_read_b64_tr_b16 v[30:31], v6 offset:4608
    v_cvt_pk_bf16_f32 v203, v198, v199
    v_mfma_f32_16x16x32_bf16 v[124:127], v[32:35], a[196:199], v[124:127]
    v_exp_f32 v208, v208
    v_mfma_f32_16x16x32_bf16 v[108:111], v[32:35], a[192:195], v[108:111]
    buffer_store_dwordx4 v[200:203], v7, s[16:19], s38 offen offset:2048 sc1
    s_waitcnt lgkmcnt(4)
    v_mfma_f32_16x16x32_bf16 v[96:99], v[20:23], a[208:211], v[96:99]
    ds_read_b64_tr_b16 v[32:33], v6 offset:3616
    v_add_f32 v208, 1.0, v208
    v_mfma_f32_16x16x32_bf16 v[112:115], v[20:23], a[212:215], v[112:115]
    ds_read_b64_tr_b16 v[34:35], v6 offset:4640
    v_mfma_f32_16x16x32_bf16 v[128:131], v[20:23], a[216:219], v[128:131]
    v_exp_f32 v209, v209
    v_mfma_f32_16x16x32_bf16 v[144:147], v[20:23], a[220:223], v[144:147]
    buffer_load_dwordx4 a[88:91], v14, s[16:19], s79 offen offset:0 sc1
    s_waitcnt lgkmcnt(4)
    v_mfma_f32_16x16x32_bf16 v[148:151], v[24:27], a[220:223], v[148:151]
    s_waitcnt vmcnt(36)
    s_barrier
    ds_read_b64_tr_b16 v[20:21], v4 offset:0
    v_add_f32 v209, 1.0, v209
    v_mfma_f32_16x16x32_bf16 v[132:135], v[24:27], a[216:219], v[132:135]
    ds_read_b64_tr_b16 v[22:23], v4 offset:1024
    v_mfma_f32_16x16x32_bf16 v[116:119], v[24:27], a[212:215], v[116:119]
    v_exp_f32 v210, v210
    v_mfma_f32_16x16x32_bf16 v[100:103], v[24:27], a[208:211], v[100:103]
    buffer_load_dwordx4 a[92:95], v14, s[16:19], s79 offen offset:1024 sc1
    s_waitcnt lgkmcnt(4)
    v_mfma_f32_16x16x32_bf16 v[104:107], v[28:31], a[208:211], v[104:107]
    ds_read_b64_tr_b16 v[24:25], v4 offset:32
    v_add_f32 v210, 1.0, v210
    v_mfma_f32_16x16x32_bf16 v[120:123], v[28:31], a[212:215], v[120:123]
    ds_read_b64_tr_b16 v[26:27], v4 offset:1056
    v_mfma_f32_16x16x32_bf16 v[136:139], v[28:31], a[216:219], v[136:139]
    v_exp_f32 v211, v211
    v_mfma_f32_16x16x32_bf16 v[152:155], v[28:31], a[220:223], v[152:155]
    v_add_f32 v211, 1.0, v211
    s_waitcnt lgkmcnt(4)
    v_mfma_f32_16x16x32_bf16 v[156:159], v[32:35], a[220:223], v[156:159]
    ds_read_b64_tr_b16 v[28:29], v4 offset:2048
    v_mfma_f32_16x16x32_bf16 v[140:143], v[32:35], a[216:219], v[140:143]
    ds_read_b64_tr_b16 v[30:31], v4 offset:3072
    v_mfma_f32_16x16x32_bf16 v[124:127], v[32:35], a[212:215], v[124:127]
    v_exp_f32 v212, v212
    v_mfma_f32_16x16x32_bf16 v[108:111], v[32:35], a[208:211], v[108:111]
    v_add_f32 v212, 1.0, v212
    s_waitcnt lgkmcnt(4)
    v_mfma_f32_16x16x32_bf16 v[96:99], v[20:23], a[224:227], v[96:99]
    ds_read_b64_tr_b16 v[32:33], v4 offset:2080
    v_mfma_f32_16x16x32_bf16 v[112:115], v[20:23], a[228:231], v[112:115]
    ds_read_b64_tr_b16 v[34:35], v4 offset:3104
    v_mfma_f32_16x16x32_bf16 v[128:131], v[20:23], a[232:235], v[128:131]
    v_exp_f32 v213, v213
    v_mfma_f32_16x16x32_bf16 v[144:147], v[20:23], a[236:239], v[144:147]
    v_add_f32 v213, 1.0, v213
    s_waitcnt lgkmcnt(4)
    v_mfma_f32_16x16x32_bf16 v[148:151], v[24:27], a[236:239], v[148:151]
    ds_read_b64_tr_b16 v[20:21], v4 offset:512
    v_mfma_f32_16x16x32_bf16 v[132:135], v[24:27], a[232:235], v[132:135]
    ds_read_b64_tr_b16 v[22:23], v4 offset:1536
    v_mfma_f32_16x16x32_bf16 v[116:119], v[24:27], a[228:231], v[116:119]
    v_exp_f32 v214, v214
    v_mfma_f32_16x16x32_bf16 v[100:103], v[24:27], a[224:227], v[100:103]
    v_add_f32 v214, 1.0, v214
    s_waitcnt lgkmcnt(4)
    v_mfma_f32_16x16x32_bf16 v[104:107], v[28:31], a[224:227], v[104:107]
    ds_read_b64_tr_b16 v[24:25], v4 offset:544
    v_mfma_f32_16x16x32_bf16 v[120:123], v[28:31], a[228:231], v[120:123]
    ds_read_b64_tr_b16 v[26:27], v4 offset:1568
    v_mfma_f32_16x16x32_bf16 v[136:139], v[28:31], a[232:235], v[136:139]
    v_exp_f32 v215, v215
    v_mfma_f32_16x16x32_bf16 v[152:155], v[28:31], a[236:239], v[152:155]
    buffer_load_dword v16, v10, s[16:19], 0 offen offset:640 sc1
    s_waitcnt lgkmcnt(4)
    v_mfma_f32_16x16x32_bf16 v[156:159], v[32:35], a[236:239], v[156:159]
    ds_read_b64_tr_b16 v[28:29], v4 offset:2560
    s_add_u32 m0, s44, 45440
    v_mfma_f32_16x16x32_bf16 v[140:143], v[32:35], a[232:235], v[140:143]
    ds_read_b64_tr_b16 v[30:31], v4 offset:3584
    v_add_f32 v215, 1.0, v215
    v_mfma_f32_16x16x32_bf16 v[124:127], v[32:35], a[228:231], v[124:127]
    v_rcp_f32 v208, v208
    v_mfma_f32_16x16x32_bf16 v[108:111], v[32:35], a[224:227], v[108:111]
    buffer_load_dwordx4 v11, s[20:23], s71 offen offset:0 lds
    s_waitcnt lgkmcnt(4)
    v_mfma_f32_16x16x32_bf16 v[96:99], v[20:23], a[240:243], v[96:99]
    ds_read_b64_tr_b16 v[32:33], v4 offset:2592
    v_mul_f32 v208, v208, v216
    v_mfma_f32_16x16x32_bf16 v[112:115], v[20:23], a[244:247], v[112:115]
    ds_read_b64_tr_b16 v[34:35], v4 offset:3616
    v_mfma_f32_16x16x32_bf16 v[128:131], v[20:23], a[248:251], v[128:131]
    v_rcp_f32 v209, v209
    v_mfma_f32_16x16x32_bf16 v[144:147], v[20:23], a[252:255], v[144:147]
    buffer_load_dwordx4 v12, s[20:23], s71 offen offset:1024 lds
    s_waitcnt lgkmcnt(4)
    v_mfma_f32_16x16x32_bf16 v[148:151], v[24:27], a[252:255], v[148:151]
    ds_read_b64_tr_b16 v[20:21], v4 offset:16512
    v_mul_f32 v209, v209, v217
    v_mfma_f32_16x16x32_bf16 v[132:135], v[24:27], a[248:251], v[132:135]
    ds_read_b64_tr_b16 v[22:23], v4 offset:17536
    v_cvt_pk_bf16_f32 v216, v208, v209
    v_mfma_f32_16x16x32_bf16 v[116:119], v[24:27], a[244:247], v[116:119]
    v_rcp_f32 v210, v210
    v_mfma_f32_16x16x32_bf16 v[100:103], v[24:27], a[240:243], v[100:103]
    buffer_load_dwordx4 v13, s[20:23], s71 offen offset:2048 lds
    s_waitcnt lgkmcnt(4)
    v_mfma_f32_16x16x32_bf16 v[104:107], v[28:31], a[240:243], v[104:107]
    ds_read_b64_tr_b16 v[24:25], v4 offset:16544
    s_add_u32 m0, s44, 57856
    v_mfma_f32_16x16x32_bf16 v[120:123], v[28:31], a[244:247], v[120:123]
    ds_read_b64_tr_b16 v[26:27], v4 offset:17568
    v_mul_f32 v210, v210, v218
    v_mfma_f32_16x16x32_bf16 v[136:139], v[28:31], a[248:251], v[136:139]
    v_rcp_f32 v211, v211
    v_mfma_f32_16x16x32_bf16 v[152:155], v[28:31], a[252:255], v[152:155]
    buffer_load_dwordx4 v11, s[20:23], s72 offen offset:0 lds
    s_waitcnt lgkmcnt(4)
    v_mfma_f32_16x16x32_bf16 v[156:159], v[32:35], a[252:255], v[156:159]
    ds_read_b64_tr_b16 v[28:29], v4 offset:18560
    v_mul_f32 v211, v211, v219
    v_mfma_f32_16x16x32_bf16 v[140:143], v[32:35], a[248:251], v[140:143]
    ds_read_b64_tr_b16 v[30:31], v4 offset:19584
    v_cvt_pk_bf16_f32 v217, v210, v211
    v_mfma_f32_16x16x32_bf16 v[124:127], v[32:35], a[244:247], v[124:127]
    v_rcp_f32 v212, v212
    v_mfma_f32_16x16x32_bf16 v[108:111], v[32:35], a[240:243], v[108:111]
    buffer_load_dwordx4 v12, s[20:23], s72 offen offset:1024 lds
    s_waitcnt lgkmcnt(4)
    v_mfma_f32_16x16x32_bf16 v[96:99], v[20:23], v[224:227], v[96:99]
    ds_read_b64_tr_b16 v[32:33], v4 offset:18592
    v_mul_f32 v212, v212, v220
    v_mfma_f32_16x16x32_bf16 v[112:115], v[20:23], v[228:231], v[112:115]
    ds_read_b64_tr_b16 v[34:35], v4 offset:19616
    v_mfma_f32_16x16x32_bf16 v[128:131], v[20:23], v[232:235], v[128:131]
    v_rcp_f32 v213, v213
    v_mfma_f32_16x16x32_bf16 v[144:147], v[20:23], v[236:239], v[144:147]
    buffer_load_dwordx4 v13, s[20:23], s72 offen offset:2048 lds
    s_waitcnt lgkmcnt(4)
    v_mfma_f32_16x16x32_bf16 v[148:151], v[24:27], v[236:239], v[148:151]
    ds_read_b64_tr_b16 v[20:21], v4 offset:17024
    s_add_u32 m0, s44, 94976
    v_mfma_f32_16x16x32_bf16 v[132:135], v[24:27], v[232:235], v[132:135]
    ds_read_b64_tr_b16 v[22:23], v4 offset:18048
    v_mul_f32 v213, v213, v221
    v_mfma_f32_16x16x32_bf16 v[116:119], v[24:27], v[228:231], v[116:119]
    v_rcp_f32 v214, v214
    v_mfma_f32_16x16x32_bf16 v[100:103], v[24:27], v[224:227], v[100:103]
    buffer_load_dwordx4 v11, s[20:23], s73 offen offset:0 lds
    s_waitcnt lgkmcnt(4)
    v_mfma_f32_16x16x32_bf16 v[104:107], v[28:31], v[224:227], v[104:107]
    ds_read_b64_tr_b16 v[24:25], v4 offset:17056
    v_mul_f32 v214, v214, v222
    v_mfma_f32_16x16x32_bf16 v[120:123], v[28:31], v[228:231], v[120:123]
    ds_read_b64_tr_b16 v[26:27], v4 offset:18080
    v_cvt_pk_bf16_f32 v218, v212, v213
    v_mfma_f32_16x16x32_bf16 v[136:139], v[28:31], v[232:235], v[136:139]
    v_rcp_f32 v215, v215
    v_mfma_f32_16x16x32_bf16 v[152:155], v[28:31], v[236:239], v[152:155]
    buffer_load_dwordx4 v12, s[20:23], s73 offen offset:1024 lds
    s_waitcnt lgkmcnt(4)
    v_mfma_f32_16x16x32_bf16 v[156:159], v[32:35], v[236:239], v[156:159]
    ds_read_b64_tr_b16 v[28:29], v4 offset:19072
    v_mul_f32 v215, v215, v223
    v_mfma_f32_16x16x32_bf16 v[140:143], v[32:35], v[232:235], v[140:143]
    ds_read_b64_tr_b16 v[30:31], v4 offset:20096
    v_cvt_pk_bf16_f32 v219, v214, v215
    v_mfma_f32_16x16x32_bf16 v[124:127], v[32:35], v[228:231], v[124:127]
    v_mfma_f32_16x16x32_bf16 v[108:111], v[32:35], v[224:227], v[108:111]
    buffer_store_dwordx4 v[216:219], v7, s[16:19], s38 offen offset:3072 sc1
    s_waitcnt lgkmcnt(4)
    v_mfma_f32_16x16x32_bf16 v[96:99], v[20:23], v[240:243], v[96:99]
    ds_read_b64_tr_b16 v[32:33], v4 offset:19104
    s_add_u32 s38, s38, s96
    v_mfma_f32_16x16x32_bf16 v[112:115], v[20:23], v[244:247], v[112:115]
    ds_read_b64_tr_b16 v[34:35], v4 offset:20128
    v_mfma_f32_16x16x32_bf16 v[128:131], v[20:23], v[248:251], v[128:131]
    s_waitcnt vmcnt(15)
    s_barrier
    v_sub_u32 v4, v4, v18
    v_sub_u32 v5, v5, v18
    v_sub_u32 v6, v6, v18
    ds_read_b64_tr_b16 v[36:37], v6 offset:17536
    v_mfma_f32_16x16x32_bf16 v[144:147], v[20:23], v[252:255], v[144:147]
    ds_read_b64_tr_b16 v[38:39], v6 offset:18048
    s_waitcnt lgkmcnt(6)
    v_mfma_f32_16x16x32_bf16 v[148:151], v[24:27], v[252:255], v[148:151]
    ds_read_b64_tr_b16 v[40:41], v6 offset:17568
    v_mfma_f32_16x16x32_bf16 v[132:135], v[24:27], v[248:251], v[132:135]
    ds_read_b64_tr_b16 v[42:43], v6 offset:18080
    v_mfma_f32_16x16x32_bf16 v[116:119], v[24:27], v[244:247], v[116:119]
    ds_read_b64_tr_b16 v[44:45], v6 offset:17600
    v_mfma_f32_16x16x32_bf16 v[100:103], v[24:27], v[240:243], v[100:103]
    ds_read_b64_tr_b16 v[46:47], v6 offset:18112
    s_waitcnt lgkmcnt(8)
    v_mfma_f32_16x16x32_bf16 v[104:107], v[28:31], v[240:243], v[104:107]
    ds_read_b64_tr_b16 v[48:49], v6 offset:17632
    v_mfma_f32_16x16x32_bf16 v[120:123], v[28:31], v[244:247], v[120:123]
    ds_read_b64_tr_b16 v[50:51], v6 offset:18144
    v_mfma_f32_16x16x32_bf16 v[136:139], v[28:31], v[248:251], v[136:139]
    ds_read_b64_tr_b16 v[20:21], v6 offset:18560
    v_mfma_f32_16x16x32_bf16 v[152:155], v[28:31], v[252:255], v[152:155]
    ds_read_b64_tr_b16 v[22:23], v6 offset:19072
    s_waitcnt lgkmcnt(10)
    v_mfma_f32_16x16x32_bf16 v[156:159], v[32:35], v[252:255], v[156:159]
    ds_read_b64_tr_b16 v[24:25], v6 offset:18592
    v_mfma_f32_16x16x32_bf16 v[140:143], v[32:35], v[248:251], v[140:143]
    ds_read_b64_tr_b16 v[26:27], v6 offset:19104
    v_mfma_f32_16x16x32_bf16 v[124:127], v[32:35], v[244:247], v[124:127]
    ds_read_b64_tr_b16 v[28:29], v6 offset:18624
    v_mfma_f32_16x16x32_bf16 v[108:111], v[32:35], v[240:243], v[108:111]
    ds_read_b64_tr_b16 v[30:31], v6 offset:19136
    s_waitcnt lgkmcnt(12)
    v_mfma_f32_16x16x32_bf16 v[160:163], v[36:39], a[0:3], 0
    s_waitcnt vmcnt(9)
    v_cmp_ne_u32 vcc, s66, v16
    s_cbranch_vccnz L_slow_mlpF1b
L_ret_mlpF1b:
    v_mfma_f32_16x16x32_bf16 v[164:167], v[36:39], a[4:7], 0
    buffer_load_dwordx4 v13, s[20:23], s73 offen offset:2048 lds
    s_waitcnt lgkmcnt(10)
    v_mfma_f32_16x16x32_bf16 v[172:175], v[40:43], a[4:7], 0
    ds_read_b64_tr_b16 v[32:33], v6 offset:18656
    s_add_u32 m0, s44, 107392
    v_mfma_f32_16x16x32_bf16 v[168:171], v[40:43], a[0:3], 0
    ds_read_b64_tr_b16 v[34:35], v6 offset:19168
    s_waitcnt lgkmcnt(8)
    v_mfma_f32_16x16x32_bf16 v[176:179], v[44:47], a[0:3], 0
    ds_read_b64_tr_b16 v[36:37], v6 offset:19584
    s_add_u32 s100, s80, 442368
    v_mul_f32 v96, s39, v96
    v_mfma_f32_16x16x32_bf16 v[180:183], v[44:47], a[4:7], 0
    ds_read_b64_tr_b16 v[38:39], v6 offset:20096
    v_mul_f32 v97, s39, v97
    v_mfma_f32_16x16x32_bf16 v[188:191], v[48:51], a[4:7], 0
    ds_read_b64_tr_b16 v[40:41], v6 offset:19616
    ds_read_b64_tr_b16 v[42:43], v6 offset:20128
    v_mfma_f32_16x16x32_bf16 v[184:187], v[48:51], a[0:3], 0
    buffer_load_dwordx4 v11, s[20:23], s74 offen offset:0 lds
    s_waitcnt lgkmcnt(8)
    v_mfma_f32_16x16x32_bf16 v[192:195], v[20:23], a[0:3], 0
    ds_read_b64_tr_b16 v[44:45], v6 offset:19648
    ds_read_b64_tr_b16 v[46:47], v6 offset:20160
    v_mul_f32 v98, s39, v98
    v_mfma_f32_16x16x32_bf16 v[196:199], v[20:23], a[4:7], 0
    v_exp_f32 v96, v96
    v_mfma_f32_16x16x32_bf16 v[204:207], v[24:27], a[4:7], 0
    ds_read_b64_tr_b16 v[48:49], v6 offset:19680
    ds_read_b64_tr_b16 v[50:51], v6 offset:20192
    v_mfma_f32_16x16x32_bf16 v[200:203], v[24:27], a[0:3], 0
    buffer_load_dwordx4 v12, s[20:23], s74 offen offset:1024 lds
    s_waitcnt lgkmcnt(8)
    v_mfma_f32_16x16x32_bf16 v[208:211], v[28:31], a[0:3], 0
    ds_read_b64_tr_b16 v[20:21], v4 offset:33024
    ds_read_b64_tr_b16 v[22:23], v4 offset:33536
    v_mul_f32 v99, s39, v99
    v_mfma_f32_16x16x32_bf16 v[212:215], v[28:31], a[4:7], 0
    v_exp_f32 v97, v97
    v_mfma_f32_16x16x32_bf16 v[220:223], v[32:35], a[4:7], 0
    ds_read_b64_tr_b16 v[24:25], v4 offset:33056
    ds_read_b64_tr_b16 v[26:27], v4 offset:33568
    v_mfma_f32_16x16x32_bf16 v[216:219], v[32:35], a[0:3], 0
    buffer_load_dwordx4 v13, s[20:23], s74 offen offset:2048 lds
    s_waitcnt lgkmcnt(8)
    v_mfma_f32_16x16x32_bf16 v[64:67], v[36:39], a[0:3], 0
    ds_read_b64_tr_b16 v[28:29], v4 offset:33088
    ds_read_b64_tr_b16 v[30:31], v4 offset:33600
    s_add_u32 m0, s44, 119808
    v_mfma_f32_16x16x32_bf16 v[68:71], v[36:39], a[4:7], 0
    v_exp_f32 v98, v98
    v_mfma_f32_16x16x32_bf16 v[76:79], v[40:43], a[4:7], 0
    ds_read_b64_tr_b16 v[32:33], v4 offset:33120
    ds_read_b64_tr_b16 v[34:35], v4 offset:33632
    v_mfma_f32_16x16x32_bf16 v[72:75], v[40:43], a[0:3], 0
    buffer_load_dwordx4 v11, s[20:23], s75 offen offset:0 lds
    s_waitcnt lgkmcnt(8)
    v_mfma_f32_16x16x32_bf16 v[80:83], v[44:47], a[0:3], 0
    ds_read_b64_tr_b16 v[36:37], v4 offset:34048
    ds_read_b64_tr_b16 v[38:39], v4 offset:34560
    v_mul_f32 v100, s39, v100
    v_mfma_f32_16x16x32_bf16 v[84:87], v[44:47], a[4:7], 0
    v_exp_f32 v99, v99
    v_mfma_f32_16x16x32_bf16 v[92:95], v[48:51], a[4:7], 0
    ds_read_b64_tr_b16 v[40:41], v4 offset:34080
    ds_read_b64_tr_b16 v[42:43], v4 offset:34592
    v_mfma_f32_16x16x32_bf16 v[88:91], v[48:51], a[0:3], 0
    buffer_load_dwordx4 v12, s[20:23], s75 offen offset:1024 lds
    s_waitcnt lgkmcnt(8)
    v_mfma_f32_16x16x32_bf16 v[160:163], v[20:23], a[8:11], v[160:163]
    ds_read_b64_tr_b16 v[44:45], v4 offset:34112
    ds_read_b64_tr_b16 v[46:47], v4 offset:34624
    v_mul_f32 v101, s39, v101
    v_mfma_f32_16x16x32_bf16 v[164:167], v[20:23], a[12:15], v[164:167]
    v_exp_f32 v100, v100
    v_mfma_f32_16x16x32_bf16 v[172:175], v[24:27], a[12:15], v[172:175]
    ds_read_b64_tr_b16 v[48:49], v4 offset:34144
    ds_read_b64_tr_b16 v[50:51], v4 offset:34656
    v_mfma_f32_16x16x32_bf16 v[168:171], v[24:27], a[8:11], v[168:171]
    buffer_load_dwordx4 v13, s[20:23], s75 offen offset:2048 lds
    s_waitcnt lgkmcnt(8)
    v_mfma_f32_16x16x32_bf16 v[176:179], v[28:31], a[8:11], v[176:179]
    ds_read_b64_tr_b16 v[20:21], v4 offset:35072
    ds_read_b64_tr_b16 v[22:23], v4 offset:35584
    s_add_u32 m0, s44, 132224
    v_mfma_f32_16x16x32_bf16 v[180:183], v[28:31], a[12:15], v[180:183]
    v_exp_f32 v101, v101
    v_mfma_f32_16x16x32_bf16 v[188:191], v[32:35], a[12:15], v[188:191]
    ds_read_b64_tr_b16 v[24:25], v4 offset:35104
    ds_read_b64_tr_b16 v[26:27], v4 offset:35616
    v_mfma_f32_16x16x32_bf16 v[184:187], v[32:35], a[8:11], v[184:187]
    buffer_load_dwordx4 v11, s[20:23], s76 offen offset:0 lds
    s_waitcnt lgkmcnt(8)
    v_mfma_f32_16x16x32_bf16 v[192:195], v[36:39], a[8:11], v[192:195]
    ds_read_b64_tr_b16 v[28:29], v4 offset:35136
    v_mul_f32 v102, s39, v102
    v_mul_f32 v103, s39, v103
    v_mfma_f32_16x16x32_bf16 v[196:199], v[36:39], a[12:15], v[196:199]
    ds_read_b64_tr_b16 v[30:31], v4 offset:35648
    v_add_f32 v96, 1.0, v96
    v_mfma_f32_16x16x32_bf16 v[204:207], v[40:43], a[12:15], v[204:207]
    ds_read_b64_tr_b16 v[32:33], v4 offset:35168
    ds_read_b64_tr_b16 v[34:35], v4 offset:35680
    v_mfma_f32_16x16x32_bf16 v[200:203], v[40:43], a[8:11], v[200:203]
    buffer_load_dwordx4 v12, s[20:23], s76 offen offset:1024 lds
    s_waitcnt lgkmcnt(8)
    v_mfma_f32_16x16x32_bf16 v[208:211], v[44:47], a[8:11], v[208:211]
    ds_read_b64_tr_b16 v[36:37], v5 offset:17024
    ds_read_b64_tr_b16 v[38:39], v5 offset:17536
    v_add_f32 v97, 1.0, v97
    v_mfma_f32_16x16x32_bf16 v[212:215], v[44:47], a[12:15], v[212:215]
    v_exp_f32 v102, v102
    v_mfma_f32_16x16x32_bf16 v[220:223], v[48:51], a[12:15], v[220:223]
    ds_read_b64_tr_b16 v[40:41], v5 offset:17056
    ds_read_b64_tr_b16 v[42:43], v5 offset:17568
    v_mfma_f32_16x16x32_bf16 v[216:219], v[48:51], a[8:11], v[216:219]
    buffer_load_dwordx4 v13, s[20:23], s76 offen offset:2048 lds
    s_waitcnt lgkmcnt(8)
    v_mfma_f32_16x16x32_bf16 v[64:67], v[20:23], a[8:11], v[64:67]
    ds_read_b64_tr_b16 v[44:45], v5 offset:17088
    ds_read_b64_tr_b16 v[46:47], v5 offset:17600
    s_add_u32 m0, s44, 0
    v_mfma_f32_16x16x32_bf16 v[68:71], v[20:23], a[12:15], v[68:71]
    v_exp_f32 v103, v103
    v_mfma_f32_16x16x32_bf16 v[76:79], v[24:27], a[12:15], v[76:79]
    ds_read_b64_tr_b16 v[48:49], v5 offset:17120
    ds_read_b64_tr_b16 v[50:51], v5 offset:17632
    v_mfma_f32_16x16x32_bf16 v[72:75], v[24:27], a[8:11], v[72:75]
    buffer_load_dwordx4 v11, s[20:23], s77 offen offset:0 lds
    s_waitcnt lgkmcnt(8)
    v_mfma_f32_16x16x32_bf16 v[80:83], v[28:31], a[8:11], v[80:83]
    ds_read_b64_tr_b16 v[20:21], v5 offset:18048
    ds_read_b64_tr_b16 v[22:23], v5 offset:18560
    v_add_f32 v98, 1.0, v98
    v_mfma_f32_16x16x32_bf16 v[84:87], v[28:31], a[12:15], v[84:87]
    v_rcp_f32 v96, v96
    v_mfma_f32_16x16x32_bf16 v[92:95], v[32:35], a[12:15], v[92:95]
    ds_read_b64_tr_b16 v[24:25], v5 offset:18080
    ds_read_b64_tr_b16 v[26:27], v5 offset:18592
    v_mfma_f32_16x16x32_bf16 v[88:91], v[32:35], a[8:11], v[88:91]
    buffer_load_dwordx4 v12, s[20:23], s77 offen offset:1024 lds
    s_waitcnt lgkmcnt(8)
    v_mfma_f32_16x16x32_bf16 v[160:163], v[36:39], a[16:19], v[160:163]
    ds_read_b64_tr_b16 v[28:29], v5 offset:18112
    ds_read_b64_tr_b16 v[30:31], v5 offset:18624
    v_add_f32 v99, 1.0, v99
    v_mfma_f32_16x16x32_bf16 v[164:167], v[36:39], a[20:23], v[164:167]
    v_rcp_f32 v97, v97
    v_mfma_f32_16x16x32_bf16 v[172:175], v[40:43], a[20:23], v[172:175]
    ds_read_b64_tr_b16 v[32:33], v5 offset:18144
    ds_read_b64_tr_b16 v[34:35], v5 offset:18656
    v_mfma_f32_16x16x32_bf16 v[168:171], v[40:43], a[16:19], v[168:171]
    buffer_load_dwordx4 v13, s[20:23], s77 offen offset:2048 lds
    s_waitcnt lgkmcnt(8)
    v_mfma_f32_16x16x32_bf16 v[176:179], v[44:47], a[16:19], v[176:179]
    ds_read_b64_tr_b16 v[36:37], v5 offset:19072
    ds_read_b64_tr_b16 v[38:39], v5 offset:19584
    v_add_f32 v100, 1.0, v100
    v_mfma_f32_16x16x32_bf16 v[180:183], v[44:47], a[20:23], v[180:183]
    v_rcp_f32 v98, v98
    v_mfma_f32_16x16x32_bf16 v[188:191], v[48:51], a[20:23], v[188:191]
    ds_read_b64_tr_b16 v[40:41], v5 offset:19104
    ds_read_b64_tr_b16 v[42:43], v5 offset:19616
    v_mfma_f32_16x16x32_bf16 v[184:187], v[48:51], a[16:19], v[184:187]
    buffer_load_dwordx4 a[96:99], v14, s[16:19], s100 offen offset:0 sc1
    s_waitcnt lgkmcnt(8)
    v_mfma_f32_16x16x32_bf16 v[192:195], v[20:23], a[16:19], v[192:195]
    ds_read_b64_tr_b16 v[44:45], v5 offset:19136
    ds_read_b64_tr_b16 v[46:47], v5 offset:19648
    v_add_f32 v101, 1.0, v101
    v_mfma_f32_16x16x32_bf16 v[196:199], v[20:23], a[20:23], v[196:199]
    v_rcp_f32 v99, v99
    v_mfma_f32_16x16x32_bf16 v[204:207], v[24:27], a[20:23], v[204:207]
    ds_read_b64_tr_b16 v[48:49], v5 offset:19168
    ds_read_b64_tr_b16 v[50:51], v5 offset:19680
    v_mfma_f32_16x16x32_bf16 v[200:203], v[24:27], a[16:19], v[200:203]
    buffer_load_dwordx4 a[100:103], v14, s[16:19], s100 offen offset:1024 sc1
    s_waitcnt lgkmcnt(8)
    v_mfma_f32_16x16x32_bf16 v[208:211], v[28:31], a[16:19], v[208:211]
    s_waitcnt vmcnt(14)
    s_barrier
    ds_read_b64_tr_b16 v[20:21], v4 offset:45440
    ds_read_b64_tr_b16 v[22:23], v4 offset:45952
    s_add_u32 m0, s44, 12416
    v_mfma_f32_16x16x32_bf16 v[212:215], v[28:31], a[20:23], v[212:215]
    v_rcp_f32 v100, v100
    v_mfma_f32_16x16x32_bf16 v[220:223], v[32:35], a[20:23], v[220:223]
    ds_read_b64_tr_b16 v[24:25], v4 offset:45472
    ds_read_b64_tr_b16 v[26:27], v4 offset:45984
    v_mfma_f32_16x16x32_bf16 v[216:219], v[32:35], a[16:19], v[216:219]
    buffer_store_dword v17, v62, s[16:19], 0 offen offset:128 sc1
    s_waitcnt lgkmcnt(8)
    v_mfma_f32_16x16x32_bf16 v[64:67], v[36:39], a[16:19], v[64:67]
    ds_read_b64_tr_b16 v[28:29], v4 offset:45504
    ds_read_b64_tr_b16 v[30:31], v4 offset:46016
    s_add_u32 s100, s80, 479232
    v_mfma_f32_16x16x32_bf16 v[68:71], v[36:39], a[20:23], v[68:71]
    v_rcp_f32 v101, v101
    v_mfma_f32_16x16x32_bf16 v[76:79], v[40:43], a[20:23], v[76:79]
    ds_read_b64_tr_b16 v[32:33], v4 offset:45536
    ds_read_b64_tr_b16 v[34:35], v4 offset:46048
    v_mfma_f32_16x16x32_bf16 v[72:75], v[40:43], a[16:19], v[72:75]
    buffer_load_dwordx4 v11, s[20:23], s78 offen offset:0 lds
    s_waitcnt lgkmcnt(8)
    v_mfma_f32_16x16x32_bf16 v[80:83], v[44:47], a[16:19], v[80:83]
    ds_read_b64_tr_b16 v[36:37], v4 offset:46464
    v_add_f32 v102, 1.0, v102
    v_add_f32 v103, 1.0, v103
    v_mfma_f32_16x16x32_bf16 v[84:87], v[44:47], a[20:23], v[84:87]
    ds_read_b64_tr_b16 v[38:39], v4 offset:46976
    v_mul_f32 v96, v96, v104
    v_mfma_f32_16x16x32_bf16 v[92:95], v[48:51], a[20:23], v[92:95]
    ds_read_b64_tr_b16 v[40:41], v4 offset:46496
    ds_read_b64_tr_b16 v[42:43], v4 offset:47008
    v_mfma_f32_16x16x32_bf16 v[88:91], v[48:51], a[16:19], v[88:91]
    buffer_load_dwordx4 v12, s[20:23], s78 offen offset:1024 lds
    s_waitcnt lgkmcnt(8)
    v_mfma_f32_16x16x32_bf16 v[160:163], v[20:23], a[24:27], v[160:163]
    ds_read_b64_tr_b16 v[44:45], v4 offset:46528
    ds_read_b64_tr_b16 v[46:47], v4 offset:47040
    v_mul_f32 v97, v97, v105
    v_mfma_f32_16x16x32_bf16 v[164:167], v[20:23], a[28:31], v[164:167]
    v_rcp_f32 v102, v102
    v_mfma_f32_16x16x32_bf16 v[172:175], v[24:27], a[28:31], v[172:175]
    ds_read_b64_tr_b16 v[48:49], v4 offset:46560
    ds_read_b64_tr_b16 v[50:51], v4 offset:47072
    v_mfma_f32_16x16x32_bf16 v[168:171], v[24:27], a[24:27], v[168:171]
    buffer_load_dwordx4 v13, s[20:23], s78 offen offset:2048 lds
    s_waitcnt lgkmcnt(8)
    v_mfma_f32_16x16x32_bf16 v[176:179], v[28:31], a[24:27], v[176:179]
    ds_read_b64_tr_b16 v[20:21], v4 offset:47488
    ds_read_b64_tr_b16 v[22:23], v4 offset:48000
    s_add_u32 m0, s44, 24832
    v_mfma_f32_16x16x32_bf16 v[180:183], v[28:31], a[28:31], v[180:183]
    v_rcp_f32 v103, v103
    v_mfma_f32_16x16x32_bf16 v[188:191], v[32:35], a[28:31], v[188:191]
    ds_read_b64_tr_b16 v[24:25], v4 offset:47520
    ds_read_b64_tr_b16 v[26:27], v4 offset:48032
    v_mfma_f32_16x16x32_bf16 v[184:187], v[32:35], a[24:27], v[184:187]
    buffer_load_dwordx4 v11, s[20:23], s79 offen offset:0 lds
    s_waitcnt lgkmcnt(8)
    v_mfma_f32_16x16x32_bf16 v[192:195], v[36:39], a[24:27], v[192:195]
    ds_read_b64_tr_b16 v[28:29], v4 offset:47552
    v_mul_f32 v98, v98, v106
    v_mul_f32 v99, v99, v107
    v_mfma_f32_16x16x32_bf16 v[196:199], v[36:39], a[28:31], v[196:199]
    ds_read_b64_tr_b16 v[30:31], v4 offset:48064
    v_mul_f32 v100, v100, v108
    v_mfma_f32_16x16x32_bf16 v[204:207], v[40:43], a[28:31], v[204:207]
    ds_read_b64_tr_b16 v[32:33], v4 offset:47584
    ds_read_b64_tr_b16 v[34:35], v4 offset:48096
    v_mfma_f32_16x16x32_bf16 v[200:203], v[40:43], a[24:27], v[200:203]
    buffer_load_dwordx4 v12, s[20:23], s79 offen offset:1024 lds
    s_waitcnt lgkmcnt(8)
    v_mfma_f32_16x16x32_bf16 v[208:211], v[44:47], a[24:27], v[208:211]
    ds_read_b64_tr_b16 v[36:37], v4 offset:57856
    v_mul_f32 v101, v101, v109
    v_mul_f32 v102, v102, v110
    v_mfma_f32_16x16x32_bf16 v[212:215], v[44:47], a[28:31], v[212:215]
    ds_read_b64_tr_b16 v[38:39], v4 offset:58368
    v_mul_f32 v103, v103, v111
    v_mfma_f32_16x16x32_bf16 v[220:223], v[48:51], a[28:31], v[220:223]
    ds_read_b64_tr_b16 v[40:41], v4 offset:57888
    ds_read_b64_tr_b16 v[42:43], v4 offset:58400
    v_mfma_f32_16x16x32_bf16 v[216:219], v[48:51], a[24:27], v[216:219]
    buffer_load_dwordx4 v13, s[20:23], s79 offen offset:2048 lds
    s_waitcnt lgkmcnt(8)
    v_mfma_f32_16x16x32_bf16 v[64:67], v[20:23], a[24:27], v[64:67]
    ds_read_b64_tr_b16 v[44:45], v4 offset:57920
    s_add_u32 m0, s44, 144640
    s_add_u32 s47, s80, 442368
    v_mfma_f32_16x16x32_bf16 v[68:71], v[20:23], a[28:31], v[68:71]
    ds_read_b64_tr_b16 v[46:47], v4 offset:58432
    v_cvt_pk_bf16_f32 v104, v96, v97
    v_mfma_f32_16x16x32_bf16 v[76:79], v[24:27], a[28:31], v[76:79]
    ds_read_b64_tr_b16 v[48:49], v4 offset:57952
    ds_read_b64_tr_b16 v[50:51], v4 offset:58464
    v_mfma_f32_16x16x32_bf16 v[72:75], v[24:27], a[24:27], v[72:75]
    buffer_load_dwordx4 v11, s[20:23], s47 offen offset:0 lds
    s_waitcnt lgkmcnt(8)
    v_mfma_f32_16x16x32_bf16 v[80:83], v[28:31], a[24:27], v[80:83]
    ds_read_b64_tr_b16 v[20:21], v4 offset:58880
    v_cvt_pk_bf16_f32 v105, v98, v99
    v_cvt_pk_bf16_f32 v106, v100, v101
    v_mfma_f32_16x16x32_bf16 v[84:87], v[28:31], a[28:31], v[84:87]
    ds_read_b64_tr_b16 v[22:23], v4 offset:59392
    v_cvt_pk_bf16_f32 v107, v102, v103
    v_mfma_f32_16x16x32_bf16 v[92:95], v[32:35], a[28:31], v[92:95]
    ds_read_b64_tr_b16 v[24:25], v4 offset:58912
    ds_read_b64_tr_b16 v[26:27], v4 offset:59424
    v_mfma_f32_16x16x32_bf16 v[88:91], v[32:35], a[24:27], v[88:91]
    buffer_store_dwordx4 v[104:107], v7, s[16:19], s38 offen offset:0 sc1
    s_waitcnt lgkmcnt(8)
    v_mfma_f32_16x16x32_bf16 v[160:163], v[36:39], a[32:35], v[160:163]
    ds_read_b64_tr_b16 v[28:29], v4 offset:58944
    v_mul_f32 v112, s39, v112
    v_mul_f32 v113, s39, v113
    v_mfma_f32_16x16x32_bf16 v[164:167], v[36:39], a[36:39], v[164:167]
    ds_read_b64_tr_b16 v[30:31], v4 offset:59456
    v_mul_f32 v114, s39, v114
    v_mfma_f32_16x16x32_bf16 v[172:175], v[40:43], a[36:39], v[172:175]
    ds_read_b64_tr_b16 v[32:33], v4 offset:58976
    ds_read_b64_tr_b16 v[34:35], v4 offset:59488
    v_mfma_f32_16x16x32_bf16 v[168:171], v[40:43], a[32:35], v[168:171]
    buffer_load_dwordx4 v12, s[20:23], s47 offen offset:1024 lds
    s_waitcnt lgkmcnt(8)
    v_mfma_f32_16x16x32_bf16 v[176:179], v[44:47], a[32:35], v[176:179]
    ds_read_b64_tr_b16 v[36:37], v4 offset:59904
    ds_read_b64_tr_b16 v[38:39], v4 offset:60416
    v_mul_f32 v115, s39, v115
    v_mfma_f32_16x16x32_bf16 v[180:183], v[44:47], a[36:39], v[180:183]
    v_exp_f32 v112, v112
    v_mfma_f32_16x16x32_bf16 v[188:191], v[48:51], a[36:39], v[188:191]
    ds_read_b64_tr_b16 v[40:41], v4 offset:59936
    ds_read_b64_tr_b16 v[42:43], v4 offset:60448
    v_mfma_f32_16x16x32_bf16 v[184:187], v[48:51], a[32:35], v[184:187]
    buffer_load_dwordx4 v13, s[20:23], s47 offen offset:2048 lds
    s_waitcnt lgkmcnt(8)
    v_mfma_f32_16x16x32_bf16 v[192:195], v[20:23], a[32:35], v[192:195]
    ds_read_b64_tr_b16 v[44:45], v4 offset:59968
    ds_read_b64_tr_b16 v[46:47], v4 offset:60480
    v_mul_f32 v116, s39, v116
    v_mfma_f32_16x16x32_bf16 v[196:199], v[20:23], a[36:39], v[196:199]
    v_exp_f32 v113, v113
    v_mfma_f32_16x16x32_bf16 v[204:207], v[24:27], a[36:39], v[204:207]
    ds_read_b64_tr_b16 v[48:49], v4 offset:60000
    ds_read_b64_tr_b16 v[50:51], v4 offset:60512
    v_mfma_f32_16x16x32_bf16 v[200:203], v[24:27], a[32:35], v[200:203]
    buffer_load_dwordx4 a[104:107], v14, s[16:19], s100 offen offset:0 sc1
    s_waitcnt lgkmcnt(8)
    v_mfma_f32_16x16x32_bf16 v[208:211], v[28:31], a[32:35], v[208:211]
    ds_read_b64_tr_b16 v[20:21], v5 offset:29440
    ds_read_b64_tr_b16 v[22:23], v5 offset:29952
    v_mul_f32 v117, s39, v117
    v_mfma_f32_16x16x32_bf16 v[212:215], v[28:31], a[36:39], v[212:215]
    v_exp_f32 v114, v114
    v_mfma_f32_16x16x32_bf16 v[220:223], v[32:35], a[36:39], v[220:223]
    ds_read_b64_tr_b16 v[24:25], v5 offset:29472
    ds_read_b64_tr_b16 v[26:27], v5 offset:29984
    v_mfma_f32_16x16x32_bf16 v[216:219], v[32:35], a[32:35], v[216:219]
    buffer_load_dwordx4 a[108:111], v14, s[16:19], s100 offen offset:1024 sc1
    s_waitcnt lgkmcnt(8)
    v_mfma_f32_16x16x32_bf16 v[64:67], v[36:39], a[32:35], v[64:67]
    ds_read_b64_tr_b16 v[28:29], v5 offset:29504
    ds_read_b64_tr_b16 v[30:31], v5 offset:30016
    s_add_u32 s100, s81, 442368
    v_mfma_f32_16x16x32_bf16 v[68:71], v[36:39], a[36:39], v[68:71]
    v_exp_f32 v115, v115
    v_mfma_f32_16x16x32_bf16 v[76:79], v[40:43], a[36:39], v[76:79]
    ds_read_b64_tr_b16 v[32:33], v5 offset:29536
    ds_read_b64_tr_b16 v[34:35], v5 offset:30048
    v_mfma_f32_16x16x32_bf16 v[72:75], v[40:43], a[32:35], v[72:75]
    buffer_load_dwordx4 a[112:115], v14, s[16:19], s100 offen offset:0 sc1
    s_waitcnt lgkmcnt(8)
    v_mfma_f32_16x16x32_bf16 v[80:83], v[44:47], a[32:35], v[80:83]
    ds_read_b64_tr_b16 v[36:37], v5 offset:30464
    ds_read_b64_tr_b16 v[38:39], v5 offset:30976
    v_mul_f32 v118, s39, v118
    v_mfma_f32_16x16x32_bf16 v[84:87], v[44:47], a[36:39], v[84:87]
    v_exp_f32 v116, v116
    v_mfma_f32_16x16x32_bf16 v[92:95], v[48:51], a[36:39], v[92:95]
    ds_read_b64_tr_b16 v[40:41], v5 offset:30496
    ds_read_b64_tr_b16 v[42:43], v5 offset:31008
    v_mfma_f32_16x16x32_bf16 v[88:91], v[48:51], a[32:35], v[88:91]
    buffer_load_dwordx4 a[116:119], v14, s[16:19], s100 offen offset:1024 sc1
    s_waitcnt lgkmcnt(8)
    v_mfma_f32_16x16x32_bf16 v[160:163], v[20:23], a[40:43], v[160:163]
    ds_read_b64_tr_b16 v[44:45], v5 offset:30528
    ds_read_b64_tr_b16 v[46:47], v5 offset:31040
    s_add_u32 s100, s81, 479232
    v_mfma_f32_16x16x32_bf16 v[164:167], v[20:23], a[44:47], v[164:167]
    v_exp_f32 v117, v117
    v_mfma_f32_16x16x32_bf16 v[172:175], v[24:27], a[44:47], v[172:175]
    ds_read_b64_tr_b16 v[48:49], v5 offset:30560
    ds_read_b64_tr_b16 v[50:51], v5 offset:31072
    v_mfma_f32_16x16x32_bf16 v[168:171], v[24:27], a[40:43], v[168:171]
    buffer_load_dwordx4 a[120:123], v14, s[16:19], s100 offen offset:0 sc1
    s_waitcnt lgkmcnt(8)
    v_mfma_f32_16x16x32_bf16 v[176:179], v[28:31], a[40:43], v[176:179]
    ds_read_b64_tr_b16 v[20:21], v5 offset:31488
    ds_read_b64_tr_b16 v[22:23], v5 offset:32000
    v_mul_f32 v119, s39, v119
    v_mfma_f32_16x16x32_bf16 v[180:183], v[28:31], a[44:47], v[180:183]
    v_exp_f32 v118, v118
    v_mfma_f32_16x16x32_bf16 v[188:191], v[32:35], a[44:47], v[188:191]
    ds_read_b64_tr_b16 v[24:25], v5 offset:31520
    ds_read_b64_tr_b16 v[26:27], v5 offset:32032
    v_mfma_f32_16x16x32_bf16 v[184:187], v[32:35], a[40:43], v[184:187]
    buffer_load_dwordx4 a[124:127], v14, s[16:19], s100 offen offset:1024 sc1
    s_waitcnt lgkmcnt(8)
    v_mfma_f32_16x16x32_bf16 v[192:195], v[36:39], a[40:43], v[192:195]
    ds_read_b64_tr_b16 v[28:29], v5 offset:31552
    ds_read_b64_tr_b16 v[30:31], v5 offset:32064
    s_add_u32 s100, s82, 442368
    v_mfma_f32_16x16x32_bf16 v[196:199], v[36:39], a[44:47], v[196:199]
    v_exp_f32 v119, v119
    v_mfma_f32_16x16x32_bf16 v[204:207], v[40:43], a[44:47], v[204:207]
    ds_read_b64_tr_b16 v[32:33], v5 offset:31584
    ds_read_b64_tr_b16 v[34:35], v5 offset:32096
    v_mfma_f32_16x16x32_bf16 v[200:203], v[40:43], a[40:43], v[200:203]
    buffer_load_dword v16, v15, s[16:19], 0 offen offset:128 sc1
    s_waitcnt lgkmcnt(8)
    v_mfma_f32_16x16x32_bf16 v[208:211], v[44:47], a[40:43], v[208:211]
    s_waitcnt vmcnt(23)
    s_barrier
    ds_read_b64_tr_b16 v[36:37], v5 offset:41856
    s_add_u32 m0, s44, 37248
    s_add_u32 s47, s80, 479232
    v_mfma_f32_16x16x32_bf16 v[212:215], v[44:47], a[44:47], v[212:215]
    ds_read_b64_tr_b16 v[38:39], v5 offset:42368
    v_add_f32 v112, 1.0, v112
    v_mfma_f32_16x16x32_bf16 v[220:223], v[48:51], a[44:47], v[220:223]
    ds_read_b64_tr_b16 v[40:41], v5 offset:41888
    ds_read_b64_tr_b16 v[42:43], v5 offset:42400
    v_mfma_f32_16x16x32_bf16 v[216:219], v[48:51], a[40:43], v[216:219]
    buffer_load_dwordx4 v11, s[20:23], s47 offen offset:0 lds
    s_waitcnt lgkmcnt(8)
    v_mfma_f32_16x16x32_bf16 v[64:67], v[20:23], a[40:43], v[64:67]
    ds_read_b64_tr_b16 v[44:45], v5 offset:41920
    ds_read_b64_tr_b16 v[46:47], v5 offset:42432
    v_add_f32 v113, 1.0, v113
    v_mfma_f32_16x16x32_bf16 v[68:71], v[20:23], a[44:47], v[68:71]
    v_rcp_f32 v112, v112
    v_mfma_f32_16x16x32_bf16 v[76:79], v[24:27], a[44:47], v[76:79]
    ds_read_b64_tr_b16 v[48:49], v5 offset:41952
    ds_read_b64_tr_b16 v[50:51], v5 offset:42464
    v_mfma_f32_16x16x32_bf16 v[72:75], v[24:27], a[40:43], v[72:75]
    buffer_load_dwordx4 v12, s[20:23], s47 offen offset:1024 lds
    s_waitcnt lgkmcnt(8)
    v_mfma_f32_16x16x32_bf16 v[80:83], v[28:31], a[40:43], v[80:83]
    ds_read_b64_tr_b16 v[20:21], v5 offset:42880
    ds_read_b64_tr_b16 v[22:23], v5 offset:43392
    v_add_f32 v114, 1.0, v114
    v_mfma_f32_16x16x32_bf16 v[84:87], v[28:31], a[44:47], v[84:87]
    v_rcp_f32 v113, v113
    v_mfma_f32_16x16x32_bf16 v[92:95], v[32:35], a[44:47], v[92:95]
    ds_read_b64_tr_b16 v[24:25], v5 offset:42912
    ds_read_b64_tr_b16 v[26:27], v5 offset:43424
    v_mfma_f32_16x16x32_bf16 v[88:91], v[32:35], a[40:43], v[88:91]
    buffer_load_dwordx4 v13, s[20:23], s47 offen offset:2048 lds
    s_waitcnt lgkmcnt(8)
    v_mfma_f32_16x16x32_bf16 v[160:163], v[36:39], a[48:51], v[160:163]
    ds_read_b64_tr_b16 v[28:29], v5 offset:42944
    ds_read_b64_tr_b16 v[30:31], v5 offset:43456
    s_add_u32 m0, s44, 49664
    v_mfma_f32_16x16x32_bf16 v[164:167], v[36:39], a[52:55], v[164:167]
    v_rcp_f32 v114, v114
    v_mfma_f32_16x16x32_bf16 v[172:175], v[40:43], a[52:55], v[172:175]
    ds_read_b64_tr_b16 v[32:33], v5 offset:42976
    ds_read_b64_tr_b16 v[34:35], v5 offset:43488
    v_mfma_f32_16x16x32_bf16 v[168:171], v[40:43], a[48:51], v[168:171]
    buffer_load_dwordx4 a[128:131], v14, s[16:19], s100 offen offset:0 sc1
    s_waitcnt lgkmcnt(8)
    v_mfma_f32_16x16x32_bf16 v[176:179], v[44:47], a[48:51], v[176:179]
    ds_read_b64_tr_b16 v[36:37], v5 offset:43904
    s_add_u32 s47, s81, 442368
    v_add_f32 v115, 1.0, v115
    v_mfma_f32_16x16x32_bf16 v[180:183], v[44:47], a[52:55], v[180:183]
    ds_read_b64_tr_b16 v[38:39], v5 offset:44416
    v_add_f32 v116, 1.0, v116
    v_mfma_f32_16x16x32_bf16 v[188:191], v[48:51], a[52:55], v[188:191]
    ds_read_b64_tr_b16 v[40:41], v5 offset:43936
    ds_read_b64_tr_b16 v[42:43], v5 offset:44448
    v_mfma_f32_16x16x32_bf16 v[184:187], v[48:51], a[48:51], v[184:187]
    buffer_load_dwordx4 v11, s[20:23], s47 offen offset:0 lds
    s_waitcnt lgkmcnt(8)
    v_mfma_f32_16x16x32_bf16 v[192:195], v[20:23], a[48:51], v[192:195]
    ds_read_b64_tr_b16 v[44:45], v5 offset:43968
    ds_read_b64_tr_b16 v[46:47], v5 offset:44480
    v_add_f32 v117, 1.0, v117
    v_mfma_f32_16x16x32_bf16 v[196:199], v[20:23], a[52:55], v[196:199]
    v_rcp_f32 v115, v115
    v_mfma_f32_16x16x32_bf16 v[204:207], v[24:27], a[52:55], v[204:207]
    ds_read_b64_tr_b16 v[48:49], v5 offset:44000
    ds_read_b64_tr_b16 v[50:51], v5 offset:44512
    v_mfma_f32_16x16x32_bf16 v[200:203], v[24:27], a[48:51], v[200:203]
    buffer_load_dwordx4 v12, s[20:23], s47 offen offset:1024 lds
    s_waitcnt lgkmcnt(8)
    v_mfma_f32_16x16x32_bf16 v[208:211], v[28:31], a[48:51], v[208:211]
    ds_read_b64_tr_b16 v[20:21], v5 offset:54272
    ds_read_b64_tr_b16 v[22:23], v5 offset:54784
    v_add_f32 v118, 1.0, v118
    v_mfma_f32_16x16x32_bf16 v[212:215], v[28:31], a[52:55], v[212:215]
    v_rcp_f32 v116, v116
    v_mfma_f32_16x16x32_bf16 v[220:223], v[32:35], a[52:55], v[220:223]
    ds_read_b64_tr_b16 v[24:25], v5 offset:54304
    ds_read_b64_tr_b16 v[26:27], v5 offset:54816
    v_mfma_f32_16x16x32_bf16 v[216:219], v[32:35], a[48:51], v[216:219]
    buffer_load_dwordx4 v13, s[20:23], s47 offen offset:2048 lds
    s_waitcnt lgkmcnt(8)
    v_mfma_f32_16x16x32_bf16 v[64:67], v[36:39], a[48:51], v[64:67]
    ds_read_b64_tr_b16 v[28:29], v5 offset:54336
    ds_read_b64_tr_b16 v[30:31], v5 offset:54848
    s_add_u32 m0, s44, 62080
    v_mfma_f32_16x16x32_bf16 v[68:71], v[36:39], a[52:55], v[68:71]
    v_rcp_f32 v117, v117
    v_mfma_f32_16x16x32_bf16 v[76:79], v[40:43], a[52:55], v[76:79]
    ds_read_b64_tr_b16 v[32:33], v5 offset:54368
    ds_read_b64_tr_b16 v[34:35], v5 offset:54880
    v_mfma_f32_16x16x32_bf16 v[72:75], v[40:43], a[48:51], v[72:75]
    buffer_load_dwordx4 a[132:135], v14, s[16:19], s100 offen offset:1024 sc1
    s_waitcnt lgkmcnt(8)
    v_mfma_f32_16x16x32_bf16 v[80:83], v[44:47], a[48:51], v[80:83]
    ds_read_b64_tr_b16 v[36:37], v5 offset:55296
    ds_read_b64_tr_b16 v[38:39], v5 offset:55808
    s_add_u32 s47, s81, 479232
    v_mfma_f32_16x16x32_bf16 v[84:87], v[44:47], a[52:55], v[84:87]
    v_rcp_f32 v118, v118
    v_mfma_f32_16x16x32_bf16 v[92:95], v[48:51], a[52:55], v[92:95]
    ds_read_b64_tr_b16 v[40:41], v5 offset:55328
    ds_read_b64_tr_b16 v[42:43], v5 offset:55840
    v_mfma_f32_16x16x32_bf16 v[88:91], v[48:51], a[48:51], v[88:91]
    buffer_load_dwordx4 v11, s[20:23], s47 offen offset:0 lds
    s_waitcnt lgkmcnt(8)
    v_mfma_f32_16x16x32_bf16 v[160:163], v[20:23], a[56:59], v[160:163]
    ds_read_b64_tr_b16 v[44:45], v5 offset:55360
    s_add_u32 s100, s82, 479232
    v_add_f32 v119, 1.0, v119
    v_mfma_f32_16x16x32_bf16 v[164:167], v[20:23], a[60:63], v[164:167]
    ds_read_b64_tr_b16 v[46:47], v5 offset:55872
    v_mul_f32 v112, v112, v120
    v_mfma_f32_16x16x32_bf16 v[172:175], v[24:27], a[60:63], v[172:175]
    ds_read_b64_tr_b16 v[48:49], v5 offset:55392
    ds_read_b64_tr_b16 v[50:51], v5 offset:55904
    v_mfma_f32_16x16x32_bf16 v[168:171], v[24:27], a[56:59], v[168:171]
    buffer_load_dwordx4 v12, s[20:23], s47 offen offset:1024 lds
    s_waitcnt lgkmcnt(8)
    v_mfma_f32_16x16x32_bf16 v[176:179], v[28:31], a[56:59], v[176:179]
    ds_read_b64_tr_b16 v[20:21], v5 offset:56320
    ds_read_b64_tr_b16 v[22:23], v5 offset:56832
    v_mul_f32 v113, v113, v121
    v_mfma_f32_16x16x32_bf16 v[180:183], v[28:31], a[60:63], v[180:183]
    s_waitcnt vmcnt(10)
    v_cmp_ne_u32 vcc, s66, v16
    s_cbranch_vccnz L_slow_mlpF2
L_ret_mlpF2:
    v_mfma_f32_16x16x32_bf16 v[188:191], v[32:35], a[60:63], v[188:191]
    ds_read_b64_tr_b16 v[24:25], v5 offset:56352
    ds_read_b64_tr_b16 v[26:27], v5 offset:56864
    v_mfma_f32_16x16x32_bf16 v[184:187], v[32:35], a[56:59], v[184:187]
    buffer_load_dwordx4 v13, s[20:23], s47 offen offset:2048 lds
    s_waitcnt lgkmcnt(8)
    v_mfma_f32_16x16x32_bf16 v[192:195], v[36:39], a[56:59], v[192:195]
    ds_read_b64_tr_b16 v[28:29], v5 offset:56384
    ds_read_b64_tr_b16 v[30:31], v5 offset:56896
    s_add_u32 m0, s44, 74496
    v_mfma_f32_16x16x32_bf16 v[196:199], v[36:39], a[60:63], v[196:199]
    v_rcp_f32 v119, v119
    v_mfma_f32_16x16x32_bf16 v[204:207], v[40:43], a[60:63], v[204:207]
    ds_read_b64_tr_b16 v[32:33], v5 offset:56416
    ds_read_b64_tr_b16 v[34:35], v5 offset:56928
    v_mfma_f32_16x16x32_bf16 v[200:203], v[40:43], a[56:59], v[200:203]
    buffer_load_dwordx4 a[136:139], v14, s[16:19], s100 offen offset:0 sc1
    s_waitcnt lgkmcnt(8)
    v_mfma_f32_16x16x32_bf16 v[208:211], v[44:47], a[56:59], v[208:211]
    ds_read_b64_tr_b16 v[36:37], v6 offset:1152
    s_add_u32 s47, s82, 442368
    v_mul_f32 v114, v114, v122
    v_mfma_f32_16x16x32_bf16 v[212:215], v[44:47], a[60:63], v[212:215]
    ds_read_b64_tr_b16 v[38:39], v6 offset:1664
    v_mul_f32 v115, v115, v123
    v_mfma_f32_16x16x32_bf16 v[220:223], v[48:51], a[60:63], v[220:223]
    ds_read_b64_tr_b16 v[40:41], v6 offset:1184
    ds_read_b64_tr_b16 v[42:43], v6 offset:1696
    v_mfma_f32_16x16x32_bf16 v[216:219], v[48:51], a[56:59], v[216:219]
    buffer_load_dwordx4 v11, s[20:23], s47 offen offset:0 lds
    s_waitcnt lgkmcnt(8)
    v_mfma_f32_16x16x32_bf16 v[64:67], v[20:23], a[56:59], v[64:67]
    ds_read_b64_tr_b16 v[44:45], v6 offset:1216
    v_mul_f32 v116, v116, v124
    v_mul_f32 v117, v117, v125
    v_mfma_f32_16x16x32_bf16 v[68:71], v[20:23], a[60:63], v[68:71]
    ds_read_b64_tr_b16 v[46:47], v6 offset:1728
    v_mul_f32 v118, v118, v126
    v_mfma_f32_16x16x32_bf16 v[76:79], v[24:27], a[60:63], v[76:79]
    ds_read_b64_tr_b16 v[48:49], v6 offset:1248
    ds_read_b64_tr_b16 v[50:51], v6 offset:1760
    v_mfma_f32_16x16x32_bf16 v[72:75], v[24:27], a[56:59], v[72:75]
    buffer_load_dwordx4 v12, s[20:23], s47 offen offset:1024 lds
    s_waitcnt lgkmcnt(8)
    v_mfma_f32_16x16x32_bf16 v[80:83], v[28:31], a[56:59], v[80:83]
    ds_read_b64_tr_b16 v[20:21], v6 offset:2176
    v_mul_f32 v119, v119, v127
    v_cvt_pk_bf16_f32 v120, v112, v113
    v_mfma_f32_16x16x32_bf16 v[84:87], v[28:31], a[60:63], v[84:87]
    ds_read_b64_tr_b16 v[22:23], v6 offset:2688
    v_cvt_pk_bf16_f32 v121, v114, v115
    v_mfma_f32_16x16x32_bf16 v[92:95], v[32:35], a[60:63], v[92:95]
    ds_read_b64_tr_b16 v[24:25], v6 offset:2208
    ds_read_b64_tr_b16 v[26:27], v6 offset:2720
    v_mfma_f32_16x16x32_bf16 v[88:91], v[32:35], a[56:59], v[88:91]
    buffer_load_dwordx4 v13, s[20:23], s47 offen offset:2048 lds
    s_waitcnt lgkmcnt(8)
    v_mfma_f32_16x16x32_bf16 v[160:163], v[36:39], a[64:67], v[160:163]
    ds_read_b64_tr_b16 v[28:29], v6 offset:2240
    v_cvt_pk_bf16_f32 v122, v116, v117
    v_cvt_pk_bf16_f32 v123, v118, v119
    v_mfma_f32_16x16x32_bf16 v[164:167], v[36:39], a[68:71], v[164:167]
    ds_read_b64_tr_b16 v[30:31], v6 offset:2752
    v_mul_f32 v128, s39, v128
    v_mfma_f32_16x16x32_bf16 v[172:175], v[40:43], a[68:71], v[172:175]
    ds_read_b64_tr_b16 v[32:33], v6 offset:2272
    ds_read_b64_tr_b16 v[34:35], v6 offset:2784
    v_mfma_f32_16x16x32_bf16 v[168:171], v[40:43], a[64:67], v[168:171]
    buffer_store_dwordx4 v[120:123], v7, s[16:19], s38 offen offset:1024 sc1
    s_waitcnt lgkmcnt(8)
    v_mfma_f32_16x16x32_bf16 v[176:179], v[44:47], a[64:67], v[176:179]
    ds_read_b64_tr_b16 v[36:37], v6 offset:3200
    ds_read_b64_tr_b16 v[38:39], v6 offset:3712
    v_mul_f32 v129, s39, v129
    v_mfma_f32_16x16x32_bf16 v[180:183], v[44:47], a[68:71], v[180:183]
    v_exp_f32 v128, v128
    v_mfma_f32_16x16x32_bf16 v[188:191], v[48:51], a[68:71], v[188:191]
    ds_read_b64_tr_b16 v[40:41], v6 offset:3232
    ds_read_b64_tr_b16 v[42:43], v6 offset:3744
    v_mfma_f32_16x16x32_bf16 v[184:187], v[48:51], a[64:67], v[184:187]
    buffer_load_dwordx4 a[140:143], v14, s[16:19], s100 offen offset:1024 sc1
    s_waitcnt lgkmcnt(8)
    v_mfma_f32_16x16x32_bf16 v[192:195], v[20:23], a[64:67], v[192:195]
    ds_read_b64_tr_b16 v[44:45], v6 offset:3264
    ds_read_b64_tr_b16 v[46:47], v6 offset:3776
    s_add_u32 s100, s80, 1105920
    v_mfma_f32_16x16x32_bf16 v[196:199], v[20:23], a[68:71], v[196:199]
    v_exp_f32 v129, v129
    v_mfma_f32_16x16x32_bf16 v[204:207], v[24:27], a[68:71], v[204:207]
    ds_read_b64_tr_b16 v[48:49], v6 offset:3296
    ds_read_b64_tr_b16 v[50:51], v6 offset:3808
    v_mfma_f32_16x16x32_bf16 v[200:203], v[24:27], a[64:67], v[200:203]
    buffer_load_dwordx4 a[144:147], v14, s[16:19], s100 offen offset:0 sc1
    s_waitcnt lgkmcnt(8)
    v_mfma_f32_16x16x32_bf16 v[208:211], v[28:31], a[64:67], v[208:211]
    s_barrier
    ds_read_b64_tr_b16 v[20:21], v4 offset:0
    s_add_u32 m0, s44, 86912
    s_add_u32 s47, s82, 479232
    v_mfma_f32_16x16x32_bf16 v[212:215], v[28:31], a[68:71], v[212:215]
    ds_read_b64_tr_b16 v[22:23], v4 offset:512
    v_mul_f32 v130, s39, v130
    v_mfma_f32_16x16x32_bf16 v[220:223], v[32:35], a[68:71], v[220:223]
    ds_read_b64_tr_b16 v[24:25], v4 offset:32
    ds_read_b64_tr_b16 v[26:27], v4 offset:544
    v_mfma_f32_16x16x32_bf16 v[216:219], v[32:35], a[64:67], v[216:219]
    buffer_load_dwordx4 v11, s[20:23], s47 offen offset:0 lds
    s_waitcnt lgkmcnt(8)
    v_mfma_f32_16x16x32_bf16 v[64:67], v[36:39], a[64:67], v[64:67]
    ds_read_b64_tr_b16 v[28:29], v4 offset:64
    ds_read_b64_tr_b16 v[30:31], v4 offset:576
    v_mul_f32 v131, s39, v131
    v_mfma_f32_16x16x32_bf16 v[68:71], v[36:39], a[68:71], v[68:71]
    v_exp_f32 v130, v130
    v_mfma_f32_16x16x32_bf16 v[76:79], v[40:43], a[68:71], v[76:79]
    ds_read_b64_tr_b16 v[32:33], v4 offset:96
    ds_read_b64_tr_b16 v[34:35], v4 offset:608
    v_mfma_f32_16x16x32_bf16 v[72:75], v[40:43], a[64:67], v[72:75]
    buffer_load_dwordx4 v12, s[20:23], s47 offen offset:1024 lds
    s_waitcnt lgkmcnt(8)
    v_mfma_f32_16x16x32_bf16 v[80:83], v[44:47], a[64:67], v[80:83]
    ds_read_b64_tr_b16 v[36:37], v4 offset:1024
    ds_read_b64_tr_b16 v[38:39], v4 offset:1536
    v_mul_f32 v132, s39, v132
    v_mfma_f32_16x16x32_bf16 v[84:87], v[44:47], a[68:71], v[84:87]
    v_exp_f32 v131, v131
    v_mfma_f32_16x16x32_bf16 v[92:95], v[48:51], a[68:71], v[92:95]
    ds_read_b64_tr_b16 v[40:41], v4 offset:1056
    ds_read_b64_tr_b16 v[42:43], v4 offset:1568
    v_mfma_f32_16x16x32_bf16 v[88:91], v[48:51], a[64:67], v[88:91]
    buffer_load_dwordx4 v13, s[20:23], s47 offen offset:2048 lds
    s_waitcnt lgkmcnt(8)
    v_mfma_f32_16x16x32_bf16 v[160:163], v[20:23], a[72:75], v[160:163]
    ds_read_b64_tr_b16 v[44:45], v4 offset:1088
    ds_read_b64_tr_b16 v[46:47], v4 offset:1600
    s_add_u32 m0, s44, 99328
    v_mfma_f32_16x16x32_bf16 v[164:167], v[20:23], a[76:79], v[164:167]
    v_exp_f32 v132, v132
    v_mfma_f32_16x16x32_bf16 v[172:175], v[24:27], a[76:79], v[172:175]
    ds_read_b64_tr_b16 v[48:49], v4 offset:1120
    ds_read_b64_tr_b16 v[50:51], v4 offset:1632
    v_mfma_f32_16x16x32_bf16 v[168:171], v[24:27], a[72:75], v[168:171]
    buffer_load_dwordx4 a[148:151], v14, s[16:19], s100 offen offset:1024 sc1
    s_waitcnt lgkmcnt(8)
    v_mfma_f32_16x16x32_bf16 v[176:179], v[28:31], a[72:75], v[176:179]
    ds_read_b64_tr_b16 v[20:21], v4 offset:2048
    s_add_u32 s47, s80, 1105920
    s_add_u32 s100, s80, 1142784
    v_mfma_f32_16x16x32_bf16 v[180:183], v[28:31], a[76:79], v[180:183]
    ds_read_b64_tr_b16 v[22:23], v4 offset:2560
    v_mul_f32 v133, s39, v133
    v_mfma_f32_16x16x32_bf16 v[188:191], v[32:35], a[76:79], v[188:191]
    ds_read_b64_tr_b16 v[24:25], v4 offset:2080
    ds_read_b64_tr_b16 v[26:27], v4 offset:2592
    v_mfma_f32_16x16x32_bf16 v[184:187], v[32:35], a[72:75], v[184:187]
    buffer_load_dwordx4 v11, s[20:23], s47 offen offset:0 lds
    s_waitcnt lgkmcnt(8)
    v_mfma_f32_16x16x32_bf16 v[192:195], v[36:39], a[72:75], v[192:195]
    ds_read_b64_tr_b16 v[28:29], v4 offset:2112
    ds_read_b64_tr_b16 v[30:31], v4 offset:2624
    v_mul_f32 v134, s39, v134
    v_mfma_f32_16x16x32_bf16 v[196:199], v[36:39], a[76:79], v[196:199]
    v_exp_f32 v133, v133
    v_mfma_f32_16x16x32_bf16 v[204:207], v[40:43], a[76:79], v[204:207]
    ds_read_b64_tr_b16 v[32:33], v4 offset:2144
    ds_read_b64_tr_b16 v[34:35], v4 offset:2656
    v_mfma_f32_16x16x32_bf16 v[200:203], v[40:43], a[72:75], v[200:203]
    buffer_load_dwordx4 v12, s[20:23], s47 offen offset:1024 lds
    s_waitcnt lgkmcnt(8)
    v_mfma_f32_16x16x32_bf16 v[208:211], v[44:47], a[72:75], v[208:211]
    ds_read_b64_tr_b16 v[36:37], v4 offset:12416
    ds_read_b64_tr_b16 v[38:39], v4 offset:12928
    v_mul_f32 v135, s39, v135
    v_mfma_f32_16x16x32_bf16 v[212:215], v[44:47], a[76:79], v[212:215]
    v_exp_f32 v134, v134
    v_mfma_f32_16x16x32_bf16 v[220:223], v[48:51], a[76:79], v[220:223]
    ds_read_b64_tr_b16 v[40:41], v4 offset:12448
    ds_read_b64_tr_b16 v[42:43], v4 offset:12960
    v_mfma_f32_16x16x32_bf16 v[216:219], v[48:51], a[72:75], v[216:219]
    buffer_load_dwordx4 v13, s[20:23], s47 offen offset:2048 lds
    s_waitcnt lgkmcnt(8)
    v_mfma_f32_16x16x32_bf16 v[64:67], v[20:23], a[72:75], v[64:67]
    ds_read_b64_tr_b16 v[44:45], v4 offset:12480
    ds_read_b64_tr_b16 v[46:47], v4 offset:12992
    s_add_u32 m0, s44, 111744
    v_mfma_f32_16x16x32_bf16 v[68:71], v[20:23], a[76:79], v[68:71]
    v_exp_f32 v135, v135
    v_mfma_f32_16x16x32_bf16 v[76:79], v[24:27], a[76:79], v[76:79]
    ds_read_b64_tr_b16 v[48:49], v4 offset:12512
    ds_read_b64_tr_b16 v[50:51], v4 offset:13024
    v_mfma_f32_16x16x32_bf16 v[72:75], v[24:27], a[72:75], v[72:75]
    buffer_load_dwordx4 a[152:155], v14, s[16:19], s100 offen offset:0 sc1
    s_waitcnt lgkmcnt(8)
    v_mfma_f32_16x16x32_bf16 v[80:83], v[28:31], a[72:75], v[80:83]
    ds_read_b64_tr_b16 v[20:21], v4 offset:13440
    s_add_u32 s47, s80, 1142784
    v_add_f32 v128, 1.0, v128
    v_mfma_f32_16x16x32_bf16 v[84:87], v[28:31], a[76:79], v[84:87]
    ds_read_b64_tr_b16 v[22:23], v4 offset:13952
    v_add_f32 v129, 1.0, v129
    v_mfma_f32_16x16x32_bf16 v[92:95], v[32:35], a[76:79], v[92:95]
    ds_read_b64_tr_b16 v[24:25], v4 offset:13472
    ds_read_b64_tr_b16 v[26:27], v4 offset:13984
    v_mfma_f32_16x16x32_bf16 v[88:91], v[32:35], a[72:75], v[88:91]
    buffer_load_dwordx4 v11, s[20:23], s47 offen offset:0 lds
    s_waitcnt lgkmcnt(8)
    v_mfma_f32_16x16x32_bf16 v[160:163], v[36:39], a[80:83], v[160:163]
    ds_read_b64_tr_b16 v[28:29], v4 offset:13504
    ds_read_b64_tr_b16 v[30:31], v4 offset:14016
    v_add_f32 v130, 1.0, v130
    v_mfma_f32_16x16x32_bf16 v[164:167], v[36:39], a[84:87], v[164:167]
    v_rcp_f32 v128, v128
    v_mfma_f32_16x16x32_bf16 v[172:175], v[40:43], a[84:87], v[172:175]
    ds_read_b64_tr_b16 v[32:33], v4 offset:13536
    ds_read_b64_tr_b16 v[34:35], v4 offset:14048
    v_mfma_f32_16x16x32_bf16 v[168:171], v[40:43], a[80:83], v[168:171]
    buffer_load_dwordx4 v12, s[20:23], s47 offen offset:1024 lds
    s_waitcnt lgkmcnt(8)
    v_mfma_f32_16x16x32_bf16 v[176:179], v[44:47], a[80:83], v[176:179]
    ds_read_b64_tr_b16 v[36:37], v4 offset:14464
    ds_read_b64_tr_b16 v[38:39], v4 offset:14976
    v_add_f32 v131, 1.0, v131
    v_mfma_f32_16x16x32_bf16 v[180:183], v[44:47], a[84:87], v[180:183]
    v_rcp_f32 v129, v129
    v_mfma_f32_16x16x32_bf16 v[188:191], v[48:51], a[84:87], v[188:191]
    ds_read_b64_tr_b16 v[40:41], v4 offset:14496
    ds_read_b64_tr_b16 v[42:43], v4 offset:15008
    v_mfma_f32_16x16x32_bf16 v[184:187], v[48:51], a[80:83], v[184:187]
    buffer_load_dwordx4 v13, s[20:23], s47 offen offset:2048 lds
    s_waitcnt lgkmcnt(8)
    v_mfma_f32_16x16x32_bf16 v[192:195], v[20:23], a[80:83], v[192:195]
    ds_read_b64_tr_b16 v[44:45], v4 offset:14528
    ds_read_b64_tr_b16 v[46:47], v4 offset:15040
    v_add_f32 v132, 1.0, v132
    v_mfma_f32_16x16x32_bf16 v[196:199], v[20:23], a[84:87], v[196:199]
    v_rcp_f32 v130, v130
    v_mfma_f32_16x16x32_bf16 v[204:207], v[24:27], a[84:87], v[204:207]
    ds_read_b64_tr_b16 v[48:49], v4 offset:14560
    ds_read_b64_tr_b16 v[50:51], v4 offset:15072
    v_mfma_f32_16x16x32_bf16 v[200:203], v[24:27], a[80:83], v[200:203]
    buffer_load_dwordx4 a[156:159], v14, s[16:19], s100 offen offset:1024 sc1
    s_waitcnt lgkmcnt(8)
    v_mfma_f32_16x16x32_bf16 v[208:211], v[28:31], a[80:83], v[208:211]
    ds_read_b64_tr_b16 v[20:21], v4 offset:24832
    ds_read_b64_tr_b16 v[22:23], v4 offset:25344
    s_add_u32 s100, s81, 1105920
    v_mfma_f32_16x16x32_bf16 v[212:215], v[28:31], a[84:87], v[212:215]
    v_rcp_f32 v131, v131
    v_mfma_f32_16x16x32_bf16 v[220:223], v[32:35], a[84:87], v[220:223]
    ds_read_b64_tr_b16 v[24:25], v4 offset:24864
    ds_read_b64_tr_b16 v[26:27], v4 offset:25376
    v_mfma_f32_16x16x32_bf16 v[216:219], v[32:35], a[80:83], v[216:219]
    buffer_load_dwordx4 a[160:163], v14, s[16:19], s100 offen offset:0 sc1
    s_waitcnt lgkmcnt(8)
    v_mfma_f32_16x16x32_bf16 v[64:67], v[36:39], a[80:83], v[64:67]
    ds_read_b64_tr_b16 v[28:29], v4 offset:24896
    ds_read_b64_tr_b16 v[30:31], v4 offset:25408
    v_add_f32 v133, 1.0, v133
    v_mfma_f32_16x16x32_bf16 v[68:71], v[36:39], a[84:87], v[68:71]
    v_rcp_f32 v132, v132
    v_mfma_f32_16x16x32_bf16 v[76:79], v[40:43], a[84:87], v[76:79]
    ds_read_b64_tr_b16 v[32:33], v4 offset:24928
    ds_read_b64_tr_b16 v[34:35], v4 offset:25440
    v_mfma_f32_16x16x32_bf16 v[72:75], v[40:43], a[80:83], v[72:75]
    buffer_load_dwordx4 a[164:167], v14, s[16:19], s100 offen offset:1024 sc1
    s_waitcnt lgkmcnt(8)
    v_mfma_f32_16x16x32_bf16 v[80:83], v[44:47], a[80:83], v[80:83]
    ds_read_b64_tr_b16 v[36:37], v4 offset:25856
    ds_read_b64_tr_b16 v[38:39], v4 offset:26368
    s_add_u32 s100, s81, 1142784
    v_mfma_f32_16x16x32_bf16 v[84:87], v[44:47], a[84:87], v[84:87]
    v_rcp_f32 v133, v133
    v_mfma_f32_16x16x32_bf16 v[92:95], v[48:51], a[84:87], v[92:95]
    ds_read_b64_tr_b16 v[40:41], v4 offset:25888
    ds_read_b64_tr_b16 v[42:43], v4 offset:26400
    v_mfma_f32_16x16x32_bf16 v[88:91], v[48:51], a[80:83], v[88:91]
    buffer_load_dwordx4 a[168:171], v14, s[16:19], s100 offen offset:0 sc1
    s_waitcnt lgkmcnt(8)
    v_mfma_f32_16x16x32_bf16 v[160:163], v[20:23], a[88:91], v[160:163]
    ds_read_b64_tr_b16 v[44:45], v4 offset:25920
    v_add_f32 v134, 1.0, v134
    v_add_f32 v135, 1.0, v135
    v_mfma_f32_16x16x32_bf16 v[164:167], v[20:23], a[92:95], v[164:167]
    ds_read_b64_tr_b16 v[46:47], v4 offset:26432
    v_mul_f32 v128, v128, v136
    v_mfma_f32_16x16x32_bf16 v[172:175], v[24:27], a[92:95], v[172:175]
    ds_read_b64_tr_b16 v[48:49], v4 offset:25952
    ds_read_b64_tr_b16 v[50:51], v4 offset:26464
    v_mfma_f32_16x16x32_bf16 v[168:171], v[24:27], a[88:91], v[168:171]
    buffer_load_dwordx4 a[172:175], v14, s[16:19], s100 offen offset:1024 sc1
    s_waitcnt lgkmcnt(8)
    v_mfma_f32_16x16x32_bf16 v[176:179], v[28:31], a[88:91], v[176:179]
    ds_read_b64_tr_b16 v[20:21], v4 offset:26880
    ds_read_b64_tr_b16 v[22:23], v4 offset:27392
    s_add_u32 s100, s82, 1105920
    v_mfma_f32_16x16x32_bf16 v[180:183], v[28:31], a[92:95], v[180:183]
    v_rcp_f32 v134, v134
    v_mfma_f32_16x16x32_bf16 v[188:191], v[32:35], a[92:95], v[188:191]
    ds_read_b64_tr_b16 v[24:25], v4 offset:26912
    ds_read_b64_tr_b16 v[26:27], v4 offset:27424
    v_mfma_f32_16x16x32_bf16 v[184:187], v[32:35], a[88:91], v[184:187]
    buffer_load_dwordx4 a[176:179], v14, s[16:19], s100 offen offset:0 sc1
    s_waitcnt lgkmcnt(8)
    v_mfma_f32_16x16x32_bf16 v[192:195], v[36:39], a[88:91], v[192:195]
    ds_read_b64_tr_b16 v[28:29], v4 offset:26944
    ds_read_b64_tr_b16 v[30:31], v4 offset:27456
    v_mul_f32 v129, v129, v137
    v_mfma_f32_16x16x32_bf16 v[196:199], v[36:39], a[92:95], v[196:199]
    v_rcp_f32 v135, v135
    v_mfma_f32_16x16x32_bf16 v[204:207], v[40:43], a[92:95], v[204:207]
    ds_read_b64_tr_b16 v[32:33], v4 offset:26976
    ds_read_b64_tr_b16 v[34:35], v4 offset:27488
    v_mfma_f32_16x16x32_bf16 v[200:203], v[40:43], a[88:91], v[200:203]
    buffer_load_dwordx4 a[180:183], v14, s[16:19], s100 offen offset:1024 sc1
    s_waitcnt lgkmcnt(8)
    v_mfma_f32_16x16x32_bf16 v[208:211], v[44:47], a[88:91], v[208:211]
    s_waitcnt vmcnt(29)
    s_barrier
    ds_read_b64_tr_b16 v[36:37], v6 offset:13568
    s_add_u32 m0, s44, 124160
    s_add_u32 s47, s81, 1105920
    v_mfma_f32_16x16x32_bf16 v[212:215], v[44:47], a[92:95], v[212:215]
    ds_read_b64_tr_b16 v[38:39], v6 offset:14080
    s_add_u32 s100, s82, 1142784
    v_mfma_f32_16x16x32_bf16 v[220:223], v[48:51], a[92:95], v[220:223]
    ds_read_b64_tr_b16 v[40:41], v6 offset:13600
    ds_read_b64_tr_b16 v[42:43], v6 offset:14112
    v_mfma_f32_16x16x32_bf16 v[216:219], v[48:51], a[88:91], v[216:219]
    buffer_load_dwordx4 v11, s[20:23], s47 offen offset:0 lds
    s_waitcnt lgkmcnt(8)
    v_mfma_f32_16x16x32_bf16 v[64:67], v[20:23], a[88:91], v[64:67]
    ds_read_b64_tr_b16 v[44:45], v6 offset:13632
    v_mul_f32 v130, v130, v138
    v_mul_f32 v131, v131, v139
    v_mfma_f32_16x16x32_bf16 v[68:71], v[20:23], a[92:95], v[68:71]
    ds_read_b64_tr_b16 v[46:47], v6 offset:14144
    v_mul_f32 v132, v132, v140
    v_mfma_f32_16x16x32_bf16 v[76:79], v[24:27], a[92:95], v[76:79]
    ds_read_b64_tr_b16 v[48:49], v6 offset:13664
    ds_read_b64_tr_b16 v[50:51], v6 offset:14176
    v_mfma_f32_16x16x32_bf16 v[72:75], v[24:27], a[88:91], v[72:75]
    buffer_load_dwordx4 v12, s[20:23], s47 offen offset:1024 lds
    s_waitcnt lgkmcnt(8)
    v_mfma_f32_16x16x32_bf16 v[80:83], v[28:31], a[88:91], v[80:83]
    ds_read_b64_tr_b16 v[20:21], v6 offset:14592
    v_mul_f32 v133, v133, v141
    v_mul_f32 v134, v134, v142
    v_mfma_f32_16x16x32_bf16 v[84:87], v[28:31], a[92:95], v[84:87]
    ds_read_b64_tr_b16 v[22:23], v6 offset:15104
    v_mul_f32 v135, v135, v143
    v_mfma_f32_16x16x32_bf16 v[92:95], v[32:35], a[92:95], v[92:95]
    ds_read_b64_tr_b16 v[24:25], v6 offset:14624
    ds_read_b64_tr_b16 v[26:27], v6 offset:15136
    v_mfma_f32_16x16x32_bf16 v[88:91], v[32:35], a[88:91], v[88:91]
    buffer_load_dwordx4 v13, s[20:23], s47 offen offset:2048 lds
    s_waitcnt lgkmcnt(8)
    v_mfma_f32_16x16x32_bf16 v[160:163], v[36:39], a[96:99], v[160:163]
    ds_read_b64_tr_b16 v[28:29], v6 offset:14656
    s_add_u32 m0, s44, 0
    s_add_u32 s47, s81, 1142784
    v_mfma_f32_16x16x32_bf16 v[164:167], v[36:39], a[100:103], v[164:167]
    ds_read_b64_tr_b16 v[30:31], v6 offset:15168
    v_cvt_pk_bf16_f32 v136, v128, v129
    v_mfma_f32_16x16x32_bf16 v[172:175], v[40:43], a[100:103], v[172:175]
    ds_read_b64_tr_b16 v[32:33], v6 offset:14688
    ds_read_b64_tr_b16 v[34:35], v6 offset:15200
    v_mfma_f32_16x16x32_bf16 v[168:171], v[40:43], a[96:99], v[168:171]
    buffer_load_dwordx4 v11, s[20:23], s47 offen offset:0 lds
    s_waitcnt lgkmcnt(8)
    v_mfma_f32_16x16x32_bf16 v[176:179], v[44:47], a[96:99], v[176:179]
    ds_read_b64_tr_b16 v[36:37], v6 offset:15616
    v_cvt_pk_bf16_f32 v137, v130, v131
    v_cvt_pk_bf16_f32 v138, v132, v133
    v_mfma_f32_16x16x32_bf16 v[180:183], v[44:47], a[100:103], v[180:183]
    ds_read_b64_tr_b16 v[38:39], v6 offset:16128
    v_cvt_pk_bf16_f32 v139, v134, v135
    v_mfma_f32_16x16x32_bf16 v[188:191], v[48:51], a[100:103], v[188:191]
    ds_read_b64_tr_b16 v[40:41], v6 offset:15648
    ds_read_b64_tr_b16 v[42:43], v6 offset:16160
    v_mfma_f32_16x16x32_bf16 v[184:187], v[48:51], a[96:99], v[184:187]
    buffer_store_dwordx4 v[136:139], v7, s[16:19], s38 offen offset:2048 sc1
    s_waitcnt lgkmcnt(8)
    v_mfma_f32_16x16x32_bf16 v[192:195], v[20:23], a[96:99], v[192:195]
    ds_read_b64_tr_b16 v[44:45], v6 offset:15680
    v_mul_f32 v144, s39, v144
    v_mul_f32 v145, s39, v145
    v_mfma_f32_16x16x32_bf16 v[196:199], v[20:23], a[100:103], v[196:199]
    ds_read_b64_tr_b16 v[46:47], v6 offset:16192
    v_mul_f32 v146, s39, v146
    v_mfma_f32_16x16x32_bf16 v[204:207], v[24:27], a[100:103], v[204:207]
    ds_read_b64_tr_b16 v[48:49], v6 offset:15712
    ds_read_b64_tr_b16 v[50:51], v6 offset:16224
    v_mfma_f32_16x16x32_bf16 v[200:203], v[24:27], a[96:99], v[200:203]
    buffer_load_dwordx4 v12, s[20:23], s47 offen offset:1024 lds
    s_waitcnt lgkmcnt(8)
    v_mfma_f32_16x16x32_bf16 v[208:211], v[28:31], a[96:99], v[208:211]
    ds_read_b64_tr_b16 v[20:21], v4 offset:37248
    ds_read_b64_tr_b16 v[22:23], v4 offset:37760
    v_mul_f32 v147, s39, v147
    v_mfma_f32_16x16x32_bf16 v[212:215], v[28:31], a[100:103], v[212:215]
    v_exp_f32 v144, v144
    v_mfma_f32_16x16x32_bf16 v[220:223], v[32:35], a[100:103], v[220:223]
    ds_read_b64_tr_b16 v[24:25], v4 offset:37280
    ds_read_b64_tr_b16 v[26:27], v4 offset:37792
    v_mfma_f32_16x16x32_bf16 v[216:219], v[32:35], a[96:99], v[216:219]
    buffer_load_dwordx4 v13, s[20:23], s47 offen offset:2048 lds
    s_waitcnt lgkmcnt(8)
    v_mfma_f32_16x16x32_bf16 v[64:67], v[36:39], a[96:99], v[64:67]
    ds_read_b64_tr_b16 v[28:29], v4 offset:37312
    ds_read_b64_tr_b16 v[30:31], v4 offset:37824
    s_add_u32 m0, s44, 12416
    v_mfma_f32_16x16x32_bf16 v[68:71], v[36:39], a[100:103], v[68:71]
    v_exp_f32 v145, v145
    v_mfma_f32_16x16x32_bf16 v[76:79], v[40:43], a[100:103], v[76:79]
    ds_read_b64_tr_b16 v[32:33], v4 offset:37344
    ds_read_b64_tr_b16 v[34:35], v4 offset:37856
    v_mfma_f32_16x16x32_bf16 v[72:75], v[40:43], a[96:99], v[72:75]
    buffer_load_dwordx4 a[184:187], v14, s[16:19], s100 offen offset:0 sc1
    s_waitcnt lgkmcnt(8)
    v_mfma_f32_16x16x32_bf16 v[80:83], v[44:47], a[96:99], v[80:83]
    ds_read_b64_tr_b16 v[36:37], v4 offset:38272
    ds_read_b64_tr_b16 v[38:39], v4 offset:38784
    s_add_u32 s47, s82, 1105920
    v_mfma_f32_16x16x32_bf16 v[84:87], v[44:47], a[100:103], v[84:87]
    v_exp_f32 v146, v146
    v_mfma_f32_16x16x32_bf16 v[92:95], v[48:51], a[100:103], v[92:95]
    ds_read_b64_tr_b16 v[40:41], v4 offset:38304
    ds_read_b64_tr_b16 v[42:43], v4 offset:38816
    v_mfma_f32_16x16x32_bf16 v[88:91], v[48:51], a[96:99], v[88:91]
    buffer_load_dwordx4 v11, s[20:23], s47 offen offset:0 lds
    s_waitcnt lgkmcnt(8)
    v_mfma_f32_16x16x32_bf16 v[160:163], v[20:23], a[104:107], v[160:163]
    ds_read_b64_tr_b16 v[44:45], v4 offset:38336
    ds_read_b64_tr_b16 v[46:47], v4 offset:38848
    v_mul_f32 v148, s39, v148
    v_mfma_f32_16x16x32_bf16 v[164:167], v[20:23], a[108:111], v[164:167]
    v_exp_f32 v147, v147
    v_mfma_f32_16x16x32_bf16 v[172:175], v[24:27], a[108:111], v[172:175]
    ds_read_b64_tr_b16 v[48:49], v4 offset:38368
    ds_read_b64_tr_b16 v[50:51], v4 offset:38880
    v_mfma_f32_16x16x32_bf16 v[168:171], v[24:27], a[104:107], v[168:171]
    buffer_load_dwordx4 v12, s[20:23], s47 offen offset:1024 lds
    s_waitcnt lgkmcnt(8)
    v_mfma_f32_16x16x32_bf16 v[176:179], v[28:31], a[104:107], v[176:179]
    ds_read_b64_tr_b16 v[20:21], v4 offset:39296
    ds_read_b64_tr_b16 v[22:23], v4 offset:39808
    v_mul_f32 v149, s39, v149
    v_mfma_f32_16x16x32_bf16 v[180:183], v[28:31], a[108:111], v[180:183]
    v_exp_f32 v148, v148
    v_mfma_f32_16x16x32_bf16 v[188:191], v[32:35], a[108:111], v[188:191]
    ds_read_b64_tr_b16 v[24:25], v4 offset:39328
    ds_read_b64_tr_b16 v[26:27], v4 offset:39840
    v_mfma_f32_16x16x32_bf16 v[184:187], v[32:35], a[104:107], v[184:187]
    buffer_load_dwordx4 v13, s[20:23], s47 offen offset:2048 lds
    s_waitcnt lgkmcnt(8)
    v_mfma_f32_16x16x32_bf16 v[192:195], v[36:39], a[104:107], v[192:195]
    ds_read_b64_tr_b16 v[28:29], v4 offset:39360
    ds_read_b64_tr_b16 v[30:31], v4 offset:39872
    v_mul_f32 v150, s39, v150
    v_mfma_f32_16x16x32_bf16 v[196:199], v[36:39], a[108:111], v[196:199]
    v_exp_f32 v149, v149
    v_mfma_f32_16x16x32_bf16 v[204:207], v[40:43], a[108:111], v[204:207]
    ds_read_b64_tr_b16 v[32:33], v4 offset:39392
    ds_read_b64_tr_b16 v[34:35], v4 offset:39904
    v_mfma_f32_16x16x32_bf16 v[200:203], v[40:43], a[104:107], v[200:203]
    buffer_load_dwordx4 a[188:191], v14, s[16:19], s100 offen offset:1024 sc1
    s_waitcnt lgkmcnt(8)
    v_mfma_f32_16x16x32_bf16 v[208:211], v[44:47], a[104:107], v[208:211]
    ds_read_b64_tr_b16 v[36:37], v4 offset:49664
    ds_read_b64_tr_b16 v[38:39], v4 offset:50176
    s_add_u32 s100, s80, 663552
    v_mfma_f32_16x16x32_bf16 v[212:215], v[44:47], a[108:111], v[212:215]
    v_exp_f32 v150, v150
    v_mfma_f32_16x16x32_bf16 v[220:223], v[48:51], a[108:111], v[220:223]
    ds_read_b64_tr_b16 v[40:41], v4 offset:49696
    ds_read_b64_tr_b16 v[42:43], v4 offset:50208
    v_mfma_f32_16x16x32_bf16 v[216:219], v[48:51], a[104:107], v[216:219]
    buffer_load_dwordx4 a[192:195], v14, s[16:19], s100 offen offset:0 sc1
    s_waitcnt lgkmcnt(8)
    v_mfma_f32_16x16x32_bf16 v[64:67], v[20:23], a[104:107], v[64:67]
    ds_read_b64_tr_b16 v[44:45], v4 offset:49728
    v_mul_f32 v151, s39, v151
    v_add_f32 v144, 1.0, v144
    v_mfma_f32_16x16x32_bf16 v[68:71], v[20:23], a[108:111], v[68:71]
    ds_read_b64_tr_b16 v[46:47], v4 offset:50240
    v_add_f32 v145, 1.0, v145
    v_mfma_f32_16x16x32_bf16 v[76:79], v[24:27], a[108:111], v[76:79]
    ds_read_b64_tr_b16 v[48:49], v4 offset:49760
    ds_read_b64_tr_b16 v[50:51], v4 offset:50272
    v_mfma_f32_16x16x32_bf16 v[72:75], v[24:27], a[104:107], v[72:75]
    buffer_load_dwordx4 a[196:199], v14, s[16:19], s100 offen offset:1024 sc1
    s_waitcnt lgkmcnt(8)
    v_mfma_f32_16x16x32_bf16 v[80:83], v[28:31], a[104:107], v[80:83]
    ds_read_b64_tr_b16 v[20:21], v4 offset:50688
    ds_read_b64_tr_b16 v[22:23], v4 offset:51200
    s_add_u32 s100, s80, 700416
    v_mfma_f32_16x16x32_bf16 v[84:87], v[28:31], a[108:111], v[84:87]
    v_exp_f32 v151, v151
    v_mfma_f32_16x16x32_bf16 v[92:95], v[32:35], a[108:111], v[92:95]
    ds_read_b64_tr_b16 v[24:25], v4 offset:50720
    ds_read_b64_tr_b16 v[26:27], v4 offset:51232
    v_mfma_f32_16x16x32_bf16 v[88:91], v[32:35], a[104:107], v[88:91]
    buffer_load_dwordx4 a[200:203], v14, s[16:19], s100 offen offset:0 sc1
    s_waitcnt lgkmcnt(8)
    v_mfma_f32_16x16x32_bf16 v[160:163], v[36:39], a[112:115], v[160:163]
    ds_read_b64_tr_b16 v[28:29], v4 offset:50752
    ds_read_b64_tr_b16 v[30:31], v4 offset:51264
    v_add_f32 v146, 1.0, v146
    v_mfma_f32_16x16x32_bf16 v[164:167], v[36:39], a[116:119], v[164:167]
    v_rcp_f32 v144, v144
    v_mfma_f32_16x16x32_bf16 v[172:175], v[40:43], a[116:119], v[172:175]
    ds_read_b64_tr_b16 v[32:33], v4 offset:50784
    ds_read_b64_tr_b16 v[34:35], v4 offset:51296
    v_mfma_f32_16x16x32_bf16 v[168:171], v[40:43], a[112:115], v[168:171]
    buffer_load_dwordx4 a[204:207], v14, s[16:19], s100 offen offset:1024 sc1
    s_waitcnt lgkmcnt(8)
    v_mfma_f32_16x16x32_bf16 v[176:179], v[44:47], a[112:115], v[176:179]
    ds_read_b64_tr_b16 v[36:37], v4 offset:51712
    ds_read_b64_tr_b16 v[38:39], v4 offset:52224
    s_add_u32 s100, s81, 663552
    v_mfma_f32_16x16x32_bf16 v[180:183], v[44:47], a[116:119], v[180:183]
    v_rcp_f32 v145, v145
    v_mfma_f32_16x16x32_bf16 v[188:191], v[48:51], a[116:119], v[188:191]
    ds_read_b64_tr_b16 v[40:41], v4 offset:51744
    ds_read_b64_tr_b16 v[42:43], v4 offset:52256
    v_mfma_f32_16x16x32_bf16 v[184:187], v[48:51], a[112:115], v[184:187]
    buffer_load_dwordx4 a[208:211], v14, s[16:19], s100 offen offset:0 sc1
    s_waitcnt lgkmcnt(8)
    v_mfma_f32_16x16x32_bf16 v[192:195], v[20:23], a[112:115], v[192:195]
    ds_read_b64_tr_b16 v[44:45], v4 offset:51776
    ds_read_b64_tr_b16 v[46:47], v4 offset:52288
    v_add_f32 v147, 1.0, v147
    v_mfma_f32_16x16x32_bf16 v[196:199], v[20:23], a[116:119], v[196:199]
    v_rcp_f32 v146, v146
    v_mfma_f32_16x16x32_bf16 v[204:207], v[24:27], a[116:119], v[204:207]
    ds_read_b64_tr_b16 v[48:49], v4 offset:51808
    ds_read_b64_tr_b16 v[50:51], v4 offset:52320
    v_mfma_f32_16x16x32_bf16 v[200:203], v[24:27], a[112:115], v[200:203]
    buffer_load_dwordx4 a[212:215], v14, s[16:19], s100 offen offset:1024 sc1
    s_waitcnt lgkmcnt(8)
    v_mfma_f32_16x16x32_bf16 v[208:211], v[28:31], a[112:115], v[208:211]
    s_waitcnt vmcnt(33)
    s_barrier
    ds_read_b64_tr_b16 v[20:21], v4 offset:62080
    ds_read_b64_tr_b16 v[22:23], v4 offset:62592
    s_add_u32 m0, s44, 24832
    v_mfma_f32_16x16x32_bf16 v[212:215], v[28:31], a[116:119], v[212:215]
    v_rcp_f32 v147, v147
    v_mfma_f32_16x16x32_bf16 v[220:223], v[32:35], a[116:119], v[220:223]
    ds_read_b64_tr_b16 v[24:25], v4 offset:62112
    s_add_u32 s47, s82, 1142784
    v_mfma_f32_16x16x32_bf16 v[216:219], v[32:35], a[112:115], v[216:219]
    ds_read_b64_tr_b16 v[26:27], v4 offset:62624
    s_waitcnt lgkmcnt(8)
    v_mfma_f32_16x16x32_bf16 v[64:67], v[36:39], a[112:115], v[64:67]
    ds_read_b64_tr_b16 v[28:29], v4 offset:62144
    s_add_u32 s100, s81, 700416
    v_add_f32 v148, 1.0, v148
    v_mfma_f32_16x16x32_bf16 v[68:71], v[36:39], a[116:119], v[68:71]
    ds_read_b64_tr_b16 v[30:31], v4 offset:62656
    v_add_f32 v149, 1.0, v149
    v_mfma_f32_16x16x32_bf16 v[76:79], v[40:43], a[116:119], v[76:79]
    ds_read_b64_tr_b16 v[32:33], v4 offset:62176
    ds_read_b64_tr_b16 v[34:35], v4 offset:62688
    v_mfma_f32_16x16x32_bf16 v[72:75], v[40:43], a[112:115], v[72:75]
    buffer_load_dwordx4 v11, s[20:23], s47 offen offset:0 lds
    s_waitcnt lgkmcnt(8)
    v_mfma_f32_16x16x32_bf16 v[80:83], v[44:47], a[112:115], v[80:83]
    ds_read_b64_tr_b16 v[36:37], v4 offset:63104
    ds_read_b64_tr_b16 v[38:39], v4 offset:63616
    v_add_f32 v150, 1.0, v150
    v_mfma_f32_16x16x32_bf16 v[84:87], v[44:47], a[116:119], v[84:87]
    v_rcp_f32 v148, v148
    v_mfma_f32_16x16x32_bf16 v[92:95], v[48:51], a[116:119], v[92:95]
    ds_read_b64_tr_b16 v[40:41], v4 offset:63136
    ds_read_b64_tr_b16 v[42:43], v4 offset:63648
    v_mfma_f32_16x16x32_bf16 v[88:91], v[48:51], a[112:115], v[88:91]
    buffer_load_dwordx4 v12, s[20:23], s47 offen offset:1024 lds
    s_waitcnt lgkmcnt(8)
    v_mfma_f32_16x16x32_bf16 v[160:163], v[20:23], a[120:123], v[160:163]
    ds_read_b64_tr_b16 v[44:45], v4 offset:63168
    ds_read_b64_tr_b16 v[46:47], v4 offset:63680
    v_add_f32 v151, 1.0, v151
    v_mfma_f32_16x16x32_bf16 v[164:167], v[20:23], a[124:127], v[164:167]
    v_rcp_f32 v149, v149
    v_mfma_f32_16x16x32_bf16 v[172:175], v[24:27], a[124:127], v[172:175]
    ds_read_b64_tr_b16 v[48:49], v4 offset:63200
    ds_read_b64_tr_b16 v[50:51], v4 offset:63712
    v_mfma_f32_16x16x32_bf16 v[168:171], v[24:27], a[120:123], v[168:171]
    buffer_load_dwordx4 v13, s[20:23], s47 offen offset:2048 lds
    s_waitcnt lgkmcnt(8)
    v_mfma_f32_16x16x32_bf16 v[176:179], v[28:31], a[120:123], v[176:179]
    ds_read_b64_tr_b16 v[20:21], v4 offset:64128
    ds_read_b64_tr_b16 v[22:23], v4 offset:64640
    s_add_u32 m0, s44, 37248
    v_mfma_f32_16x16x32_bf16 v[180:183], v[28:31], a[124:127], v[180:183]
    v_rcp_f32 v150, v150
    v_mfma_f32_16x16x32_bf16 v[188:191], v[32:35], a[124:127], v[188:191]
    ds_read_b64_tr_b16 v[24:25], v4 offset:64160
    ds_read_b64_tr_b16 v[26:27], v4 offset:64672
    v_mfma_f32_16x16x32_bf16 v[184:187], v[32:35], a[120:123], v[184:187]
    buffer_load_dwordx4 a[216:219], v14, s[16:19], s100 offen offset:0 sc1
    s_waitcnt lgkmcnt(8)
    v_mfma_f32_16x16x32_bf16 v[192:195], v[36:39], a[120:123], v[192:195]
    ds_read_b64_tr_b16 v[28:29], v4 offset:64192
    ds_read_b64_tr_b16 v[30:31], v4 offset:64704
    s_add_u32 s47, s80, 663552
    v_mfma_f32_16x16x32_bf16 v[196:199], v[36:39], a[124:127], v[196:199]
    v_rcp_f32 v151, v151
    v_mfma_f32_16x16x32_bf16 v[204:207], v[40:43], a[124:127], v[204:207]
    ds_read_b64_tr_b16 v[32:33], v4 offset:64224
    ds_read_b64_tr_b16 v[34:35], v4 offset:64736
    v_mfma_f32_16x16x32_bf16 v[200:203], v[40:43], a[120:123], v[200:203]
    buffer_load_dwordx4 v11, s[20:23], s47 offen offset:0 lds
    s_waitcnt lgkmcnt(8)
    v_mfma_f32_16x16x32_bf16 v[208:211], v[44:47], a[120:123], v[208:211]
    ds_read_b64_tr_b16 v[36:37], v5 offset:8960
    v_mul_f32 v144, v144, v152
    v_mul_f32 v145, v145, v153
    v_mfma_f32_16x16x32_bf16 v[212:215], v[44:47], a[124:127], v[212:215]
    ds_read_b64_tr_b16 v[38:39], v5 offset:9472
    v_mul_f32 v146, v146, v154
    v_mfma_f32_16x16x32_bf16 v[220:223], v[48:51], a[124:127], v[220:223]
    ds_read_b64_tr_b16 v[40:41], v5 offset:8992
    ds_read_b64_tr_b16 v[42:43], v5 offset:9504
    v_mfma_f32_16x16x32_bf16 v[216:219], v[48:51], a[120:123], v[216:219]
    buffer_load_dwordx4 v12, s[20:23], s47 offen offset:1024 lds
    s_waitcnt lgkmcnt(8)
    v_mfma_f32_16x16x32_bf16 v[64:67], v[20:23], a[120:123], v[64:67]
    ds_read_b64_tr_b16 v[44:45], v5 offset:9024
    v_mul_f32 v147, v147, v155
    v_mul_f32 v148, v148, v156
    v_mfma_f32_16x16x32_bf16 v[68:71], v[20:23], a[124:127], v[68:71]
    ds_read_b64_tr_b16 v[46:47], v5 offset:9536
    v_mul_f32 v149, v149, v157
    v_mfma_f32_16x16x32_bf16 v[76:79], v[24:27], a[124:127], v[76:79]
    ds_read_b64_tr_b16 v[48:49], v5 offset:9056
    ds_read_b64_tr_b16 v[50:51], v5 offset:9568
    v_mfma_f32_16x16x32_bf16 v[72:75], v[24:27], a[120:123], v[72:75]
    buffer_load_dwordx4 v13, s[20:23], s47 offen offset:2048 lds
    s_waitcnt lgkmcnt(8)
    v_mfma_f32_16x16x32_bf16 v[80:83], v[28:31], a[120:123], v[80:83]
    ds_read_b64_tr_b16 v[20:21], v5 offset:9984
    s_add_u32 m0, s44, 136576
    s_add_u32 s47, s80, 700416
    v_mfma_f32_16x16x32_bf16 v[84:87], v[28:31], a[124:127], v[84:87]
    ds_read_b64_tr_b16 v[22:23], v5 offset:10496
    v_mul_f32 v150, v150, v158
    v_mfma_f32_16x16x32_bf16 v[92:95], v[32:35], a[124:127], v[92:95]
    ds_read_b64_tr_b16 v[24:25], v5 offset:10016
    ds_read_b64_tr_b16 v[26:27], v5 offset:10528
    v_mfma_f32_16x16x32_bf16 v[88:91], v[32:35], a[120:123], v[88:91]
    buffer_load_dwordx4 v11, s[20:23], s47 offen offset:0 lds
    s_waitcnt lgkmcnt(8)
    v_mfma_f32_16x16x32_bf16 v[160:163], v[36:39], a[128:131], v[160:163]
    ds_read_b64_tr_b16 v[28:29], v5 offset:10048
    v_mul_f32 v151, v151, v159
    v_cvt_pk_bf16_f32 v152, v144, v145
    v_mfma_f32_16x16x32_bf16 v[164:167], v[36:39], a[132:135], v[164:167]
    ds_read_b64_tr_b16 v[30:31], v5 offset:10560
    v_cvt_pk_bf16_f32 v153, v146, v147
    v_mfma_f32_16x16x32_bf16 v[172:175], v[40:43], a[132:135], v[172:175]
    ds_read_b64_tr_b16 v[32:33], v5 offset:10080
    ds_read_b64_tr_b16 v[34:35], v5 offset:10592
    v_mfma_f32_16x16x32_bf16 v[168:171], v[40:43], a[128:131], v[168:171]
    buffer_load_dwordx4 v12, s[20:23], s47 offen offset:1024 lds
    s_waitcnt lgkmcnt(8)
    v_mfma_f32_16x16x32_bf16 v[176:179], v[44:47], a[128:131], v[176:179]
    ds_read_b64_tr_b16 v[36:37], v5 offset:11008
    v_cvt_pk_bf16_f32 v154, v148, v149
    v_cvt_pk_bf16_f32 v155, v150, v151
    v_mfma_f32_16x16x32_bf16 v[180:183], v[44:47], a[132:135], v[180:183]
    ds_read_b64_tr_b16 v[38:39], v5 offset:11520
    v_mfma_f32_16x16x32_bf16 v[188:191], v[48:51], a[132:135], v[188:191]
    ds_read_b64_tr_b16 v[40:41], v5 offset:11040
    ds_read_b64_tr_b16 v[42:43], v5 offset:11552
    v_mfma_f32_16x16x32_bf16 v[184:187], v[48:51], a[128:131], v[184:187]
    buffer_store_dwordx4 v[152:155], v7, s[16:19], s38 offen offset:3072 sc1
    s_waitcnt lgkmcnt(8)
    v_mfma_f32_16x16x32_bf16 v[192:195], v[20:23], a[128:131], v[192:195]
    ds_read_b64_tr_b16 v[44:45], v5 offset:11072
    s_add_u32 s38, s38, s96
    v_mfma_f32_16x16x32_bf16 v[196:199], v[20:23], a[132:135], v[196:199]
    ds_read_b64_tr_b16 v[46:47], v5 offset:11584
    v_mfma_f32_16x16x32_bf16 v[204:207], v[24:27], a[132:135], v[204:207]
    ds_read_b64_tr_b16 v[48:49], v5 offset:11104
    ds_read_b64_tr_b16 v[50:51], v5 offset:11616
    v_mfma_f32_16x16x32_bf16 v[200:203], v[24:27], a[128:131], v[200:203]
    buffer_load_dwordx4 v13, s[20:23], s47 offen offset:2048 lds
    s_waitcnt lgkmcnt(8)
    v_mfma_f32_16x16x32_bf16 v[208:211], v[28:31], a[128:131], v[208:211]
    ds_read_b64_tr_b16 v[20:21], v5 offset:21376
    ds_read_b64_tr_b16 v[22:23], v5 offset:21888
    v_mfma_f32_16x16x32_bf16 v[212:215], v[28:31], a[132:135], v[212:215]
    buffer_load_dwordx4 a[220:223], v14, s[16:19], s100 offen offset:1024 sc1
    v_mfma_f32_16x16x32_bf16 v[220:223], v[32:35], a[132:135], v[220:223]
    ds_read_b64_tr_b16 v[24:25], v5 offset:21408
    s_add_u32 m0, s44, 148992
    v_mfma_f32_16x16x32_bf16 v[216:219], v[32:35], a[128:131], v[216:219]
    ds_read_b64_tr_b16 v[26:27], v5 offset:21920
    s_waitcnt lgkmcnt(8)
    v_mfma_f32_16x16x32_bf16 v[64:67], v[36:39], a[128:131], v[64:67]
    ds_read_b64_tr_b16 v[28:29], v5 offset:21440
    s_add_u32 s47, s81, 663552
    v_mfma_f32_16x16x32_bf16 v[68:71], v[36:39], a[132:135], v[68:71]
    ds_read_b64_tr_b16 v[30:31], v5 offset:21952
    s_add_u32 s100, s82, 663552
    v_mfma_f32_16x16x32_bf16 v[76:79], v[40:43], a[132:135], v[76:79]
    ds_read_b64_tr_b16 v[32:33], v5 offset:21472
    ds_read_b64_tr_b16 v[34:35], v5 offset:21984
    v_mfma_f32_16x16x32_bf16 v[72:75], v[40:43], a[128:131], v[72:75]
    buffer_load_dwordx4 v11, s[20:23], s47 offen offset:0 lds
    s_waitcnt lgkmcnt(8)
    v_mfma_f32_16x16x32_bf16 v[80:83], v[44:47], a[128:131], v[80:83]
    ds_read_b64_tr_b16 v[36:37], v5 offset:22400
    ds_read_b64_tr_b16 v[38:39], v5 offset:22912
    v_mfma_f32_16x16x32_bf16 v[84:87], v[44:47], a[132:135], v[84:87]
    buffer_load_dwordx4 v12, s[20:23], s47 offen offset:1024 lds
    v_mfma_f32_16x16x32_bf16 v[92:95], v[48:51], a[132:135], v[92:95]
    ds_read_b64_tr_b16 v[40:41], v5 offset:22432
    v_mfma_f32_16x16x32_bf16 v[88:91], v[48:51], a[128:131], v[88:91]
    ds_read_b64_tr_b16 v[42:43], v5 offset:22944
    s_waitcnt lgkmcnt(8)
    v_mfma_f32_16x16x32_bf16 v[160:163], v[20:23], a[136:139], v[160:163]
    ds_read_b64_tr_b16 v[44:45], v5 offset:22464
    ds_read_b64_tr_b16 v[46:47], v5 offset:22976
    v_mfma_f32_16x16x32_bf16 v[164:167], v[20:23], a[140:143], v[164:167]
    buffer_load_dwordx4 v13, s[20:23], s47 offen offset:2048 lds
    v_mfma_f32_16x16x32_bf16 v[172:175], v[24:27], a[140:143], v[172:175]
    ds_read_b64_tr_b16 v[48:49], v5 offset:22496
    ds_read_b64_tr_b16 v[50:51], v5 offset:23008
    v_mfma_f32_16x16x32_bf16 v[168:171], v[24:27], a[136:139], v[168:171]
    buffer_load_dwordx4 a[224:227], v14, s[16:19], s100 offen offset:0 sc1
    s_waitcnt lgkmcnt(8)
    v_mfma_f32_16x16x32_bf16 v[176:179], v[28:31], a[136:139], v[176:179]
    ds_read_b64_tr_b16 v[20:21], v5 offset:23424
    ds_read_b64_tr_b16 v[22:23], v5 offset:23936
    v_mfma_f32_16x16x32_bf16 v[180:183], v[28:31], a[140:143], v[180:183]
    buffer_load_dwordx4 a[228:231], v14, s[16:19], s100 offen offset:1024 sc1
    v_mfma_f32_16x16x32_bf16 v[188:191], v[32:35], a[140:143], v[188:191]
    ds_read_b64_tr_b16 v[24:25], v5 offset:23456
    s_add_u32 s100, s82, 700416
    v_mfma_f32_16x16x32_bf16 v[184:187], v[32:35], a[136:139], v[184:187]
    ds_read_b64_tr_b16 v[26:27], v5 offset:23968
    s_waitcnt lgkmcnt(8)
    v_mfma_f32_16x16x32_bf16 v[192:195], v[36:39], a[136:139], v[192:195]
    ds_read_b64_tr_b16 v[28:29], v5 offset:23488
    ds_read_b64_tr_b16 v[30:31], v5 offset:24000
    v_mfma_f32_16x16x32_bf16 v[196:199], v[36:39], a[140:143], v[196:199]
    buffer_load_dwordx4 a[232:235], v14, s[16:19], s100 offen offset:0 sc1
    v_mfma_f32_16x16x32_bf16 v[204:207], v[40:43], a[140:143], v[204:207]
    ds_read_b64_tr_b16 v[32:33], v5 offset:23520
    ds_read_b64_tr_b16 v[34:35], v5 offset:24032
    v_mfma_f32_16x16x32_bf16 v[200:203], v[40:43], a[136:139], v[200:203]
    buffer_load_dwordx4 a[236:239], v14, s[16:19], s100 offen offset:1024 sc1
    s_waitcnt lgkmcnt(8)
    v_mfma_f32_16x16x32_bf16 v[208:211], v[44:47], a[136:139], v[208:211]
    s_waitcnt vmcnt(9)
    s_barrier
    ds_read_b64_tr_b16 v[36:37], v5 offset:33824
    s_add_u32 m0, s44, 49664
    v_mfma_f32_16x16x32_bf16 v[212:215], v[44:47], a[140:143], v[212:215]
    ds_read_b64_tr_b16 v[38:39], v5 offset:34336
    s_add_u32 s47, s81, 700416
    v_mfma_f32_16x16x32_bf16 v[220:223], v[48:51], a[140:143], v[220:223]
    ds_read_b64_tr_b16 v[40:41], v5 offset:34848
    v_mfma_f32_16x16x32_bf16 v[216:219], v[48:51], a[136:139], v[216:219]
    ds_read_b64_tr_b16 v[42:43], v5 offset:35360
    s_waitcnt lgkmcnt(8)
    v_mfma_f32_16x16x32_bf16 v[64:67], v[20:23], a[136:139], v[64:67]
    ds_read_b64_tr_b16 v[44:45], v5 offset:35872
    ds_read_b64_tr_b16 v[46:47], v5 offset:36384
    v_mfma_f32_16x16x32_bf16 v[68:71], v[20:23], a[140:143], v[68:71]
    buffer_store_dword v17, v62, s[16:19], 0 offen offset:256 sc1
    v_mfma_f32_16x16x32_bf16 v[76:79], v[24:27], a[140:143], v[76:79]
    ds_read_b64_tr_b16 v[48:49], v5 offset:33856
    ds_read_b64_tr_b16 v[50:51], v5 offset:34368
    v_mfma_f32_16x16x32_bf16 v[72:75], v[24:27], a[136:139], v[72:75]
    buffer_load_dwordx4 v11, s[20:23], s47 offen offset:0 lds
    s_waitcnt lgkmcnt(8)
    v_mfma_f32_16x16x32_bf16 v[80:83], v[28:31], a[136:139], v[80:83]
    ds_read_b64_tr_b16 v[20:21], v5 offset:34880
    ds_read_b64_tr_b16 v[22:23], v5 offset:35392
    v_mfma_f32_16x16x32_bf16 v[84:87], v[28:31], a[140:143], v[84:87]
    buffer_load_dwordx4 v12, s[20:23], s47 offen offset:1024 lds
    v_mfma_f32_16x16x32_bf16 v[92:95], v[32:35], a[140:143], v[92:95]
    ds_read_b64_tr_b16 v[24:25], v5 offset:35904
    v_mfma_f32_16x16x32_bf16 v[88:91], v[32:35], a[136:139], v[88:91]
    ds_read_b64_tr_b16 v[26:27], v5 offset:36416
    s_waitcnt lgkmcnt(8)
    v_mfma_f32_16x16x32_bf16 v[168:171], v[36:39], a[144:147], v[168:171]
    ds_read_b64_tr_b16 v[28:29], v5 offset:33888
    ds_read_b64_tr_b16 v[30:31], v5 offset:34400
    v_mfma_f32_16x16x32_bf16 v[172:175], v[36:39], a[148:151], v[172:175]
    buffer_load_dwordx4 v13, s[20:23], s47 offen offset:2048 lds
    v_mfma_f32_16x16x32_bf16 v[204:207], v[40:43], a[148:151], v[204:207]
    ds_read_b64_tr_b16 v[32:33], v5 offset:34912
    s_add_u32 m0, s44, 62080
    v_mfma_f32_16x16x32_bf16 v[200:203], v[40:43], a[144:147], v[200:203]
    ds_read_b64_tr_b16 v[34:35], v5 offset:35424
    s_waitcnt lgkmcnt(8)
    v_mfma_f32_16x16x32_bf16 v[72:75], v[44:47], a[144:147], v[72:75]
    ds_read_b64_tr_b16 v[36:37], v5 offset:35936
    s_add_u32 s47, s82, 663552
    v_mfma_f32_16x16x32_bf16 v[76:79], v[44:47], a[148:151], v[76:79]
    ds_read_b64_tr_b16 v[38:39], v5 offset:36448
    ds_read_b64_tr_b16 a[0:1], v5 offset:33792
    v_mfma_f32_16x16x32_bf16 v[180:183], v[48:51], a[148:151], v[180:183]
    ds_read_b64_tr_b16 v[40:41], v5 offset:46240
    ds_read_b64_tr_b16 a[2:3], v5 offset:34304
    v_mfma_f32_16x16x32_bf16 v[176:179], v[48:51], a[144:147], v[176:179]
    ds_read_b64_tr_b16 v[42:43], v5 offset:46752
    s_waitcnt lgkmcnt(10)
    v_mfma_f32_16x16x32_bf16 v[208:211], v[20:23], a[144:147], v[208:211]
    ds_read_b64_tr_b16 v[44:45], v5 offset:47264
    ds_read_b64_tr_b16 v[46:47], v5 offset:47776
    v_mfma_f32_16x16x32_bf16 v[212:215], v[20:23], a[148:151], v[212:215]
    buffer_load_dwordx4 v11, s[20:23], s47 offen offset:0 lds
    v_mfma_f32_16x16x32_bf16 v[84:87], v[24:27], a[148:151], v[84:87]
    ds_read_b64_tr_b16 v[48:49], v5 offset:48288
    ds_read_b64_tr_b16 v[50:51], v5 offset:48800
    v_mfma_f32_16x16x32_bf16 v[80:83], v[24:27], a[144:147], v[80:83]
    buffer_load_dwordx4 v12, s[20:23], s47 offen offset:1024 lds
    s_waitcnt lgkmcnt(10)
    v_mfma_f32_16x16x32_bf16 v[184:187], v[28:31], a[144:147], v[184:187]
    ds_read_b64_tr_b16 v[20:21], v5 offset:46272
    ds_read_b64_tr_b16 v[22:23], v5 offset:46784
    v_mfma_f32_16x16x32_bf16 v[188:191], v[28:31], a[148:151], v[188:191]
    buffer_load_dwordx4 v13, s[20:23], s47 offen offset:2048 lds
    v_mfma_f32_16x16x32_bf16 v[220:223], v[32:35], a[148:151], v[220:223]
    ds_read_b64_tr_b16 v[24:25], v5 offset:47296
    s_add_u32 m0, s44, 74496
    v_mfma_f32_16x16x32_bf16 v[216:219], v[32:35], a[144:147], v[216:219]
    ds_read_b64_tr_b16 v[26:27], v5 offset:47808
    s_waitcnt lgkmcnt(8)
    v_mfma_f32_16x16x32_bf16 v[88:91], v[36:39], a[144:147], v[88:91]
    ds_read_b64_tr_b16 v[28:29], v5 offset:48320
    s_add_u32 s47, s82, 700416
    v_mfma_f32_16x16x32_bf16 v[92:95], v[36:39], a[148:151], v[92:95]
    ds_read_b64_tr_b16 v[30:31], v5 offset:48832
    ds_read_b64_tr_b16 a[4:5], v5 offset:34816
    v_mfma_f32_16x16x32_bf16 v[172:175], v[40:43], a[156:159], v[172:175]
    ds_read_b64_tr_b16 v[32:33], v5 offset:46304
    ds_read_b64_tr_b16 v[34:35], v5 offset:46816
    v_mfma_f32_16x16x32_bf16 v[168:171], v[40:43], a[152:155], v[168:171]
    buffer_load_dwordx4 v11, s[20:23], s47 offen offset:0 lds
    s_waitcnt lgkmcnt(9)
    v_mfma_f32_16x16x32_bf16 v[200:203], v[44:47], a[152:155], v[200:203]
    ds_read_b64_tr_b16 v[36:37], v5 offset:47328
    ds_read_b64_tr_b16 v[38:39], v5 offset:47840
    v_mfma_f32_16x16x32_bf16 v[204:207], v[44:47], a[156:159], v[204:207]
    buffer_load_dwordx4 v12, s[20:23], s47 offen offset:1024 lds
    v_mfma_f32_16x16x32_bf16 v[76:79], v[48:51], a[156:159], v[76:79]
    ds_read_b64_tr_b16 v[40:41], v5 offset:48352
    ds_read_b64_tr_b16 a[6:7], v5 offset:35328
    v_mfma_f32_16x16x32_bf16 v[72:75], v[48:51], a[152:155], v[72:75]
    ds_read_b64_tr_b16 v[42:43], v5 offset:48864
    s_waitcnt lgkmcnt(10)
    v_mfma_f32_16x16x32_bf16 v[176:179], v[20:23], a[152:155], v[176:179]
    ds_read_b64_tr_b16 v[44:45], v5 offset:58656
    ds_read_b64_tr_b16 v[46:47], v5 offset:59168
    v_mfma_f32_16x16x32_bf16 v[180:183], v[20:23], a[156:159], v[180:183]
    buffer_load_dwordx4 v13, s[20:23], s47 offen offset:2048 lds
    v_mfma_f32_16x16x32_bf16 v[212:215], v[24:27], a[156:159], v[212:215]
    ds_read_b64_tr_b16 v[48:49], v5 offset:59680
    ds_read_b64_tr_b16 a[8:9], v5 offset:35840
    v_mfma_f32_16x16x32_bf16 v[208:211], v[24:27], a[152:155], v[208:211]
    ds_read_b64_tr_b16 v[50:51], v5 offset:60192
    s_waitcnt lgkmcnt(10)
    v_mfma_f32_16x16x32_bf16 v[80:83], v[28:31], a[152:155], v[80:83]
    ds_read_b64_tr_b16 v[20:21], v5 offset:60704
    ds_read_b64_tr_b16 v[22:23], v5 offset:61216
    v_mfma_f32_16x16x32_bf16 v[84:87], v[28:31], a[156:159], v[84:87]
    s_lshl_b32 s36, s40, 7
    s_lshl_b32 s37, s32, 5
    s_add_u32 s36, s36, s37
    v_and_b32 v126, 15, v1
    v_add_u32 v152, s36, v126
    v_mfma_f32_16x16x32_bf16 v[188:191], v[32:35], a[156:159], v[188:191]
    ds_read_b64_tr_b16 v[24:25], v5 offset:58688
    ds_read_b64_tr_b16 a[10:11], v5 offset:36352
    v_mfma_f32_16x16x32_bf16 v[184:187], v[32:35], a[152:155], v[184:187]
    ds_read_b64_tr_b16 v[26:27], v5 offset:59200
    s_waitcnt lgkmcnt(10)
    v_mfma_f32_16x16x32_bf16 v[216:219], v[36:39], a[152:155], v[216:219]
    ds_read_b64_tr_b16 v[28:29], v5 offset:59712
    ds_read_b64_tr_b16 a[12:13], v5 offset:46208
    v_mfma_f32_16x16x32_bf16 v[220:223], v[36:39], a[156:159], v[220:223]
    ds_read_b64_tr_b16 v[30:31], v5 offset:60224
    ds_read_b64_tr_b16 a[14:15], v5 offset:46720
    v_mfma_f32_16x16x32_bf16 v[92:95], v[40:43], a[156:159], v[92:95]
    ds_read_b64_tr_b16 v[32:33], v5 offset:60736
    ds_read_b64_tr_b16 a[16:17], v5 offset:47232
    v_mfma_f32_16x16x32_bf16 v[88:91], v[40:43], a[152:155], v[88:91]
    ds_read_b64_tr_b16 v[34:35], v5 offset:61248
    s_waitcnt lgkmcnt(12)
    v_mfma_f32_16x16x32_bf16 v[168:171], v[44:47], a[160:163], v[168:171]
    ds_read_b64_tr_b16 v[36:37], v5 offset:58720
    ds_read_b64_tr_b16 a[18:19], v5 offset:47744
    v_mfma_f32_16x16x32_bf16 v[172:175], v[44:47], a[164:167], v[172:175]
    ds_read_b64_tr_b16 v[38:39], v5 offset:59232
    ds_read_b64_tr_b16 a[20:21], v5 offset:48256
    v_mfma_f32_16x16x32_bf16 v[204:207], v[48:51], a[164:167], v[204:207]
    ds_read_b64_tr_b16 v[40:41], v5 offset:59744
    ds_read_b64_tr_b16 a[22:23], v5 offset:48768
    v_mfma_f32_16x16x32_bf16 v[200:203], v[48:51], a[160:163], v[200:203]
    ds_read_b64_tr_b16 v[42:43], v5 offset:60256
    s_waitcnt lgkmcnt(14)
    v_mfma_f32_16x16x32_bf16 v[72:75], v[20:23], a[160:163], v[72:75]
    ds_read_b64_tr_b16 v[44:45], v5 offset:60768
    ds_read_b64_tr_b16 a[24:25], v5 offset:58624
    v_mfma_f32_16x16x32_bf16 v[76:79], v[20:23], a[164:167], v[76:79]
    ds_read_b64_tr_b16 v[46:47], v5 offset:61280
    ds_read_b64_tr_b16 a[26:27], v5 offset:59136
    v_mfma_f32_16x16x32_bf16 v[180:183], v[24:27], a[164:167], v[180:183]
    s_barrier
    ds_read_b64_tr_b16 v[48:49], v4 offset:32
    ds_read_b64_tr_b16 a[28:29], v5 offset:59648
    v_mfma_f32_16x16x32_bf16 v[176:179], v[24:27], a[160:163], v[176:179]
    ds_read_b64_tr_b16 v[50:51], v4 offset:544
    s_waitcnt lgkmcnt(14)
    v_mfma_f32_16x16x32_bf16 v[208:211], v[28:31], a[160:163], v[208:211]
    ds_read_b64_tr_b16 v[20:21], v4 offset:1056
    ds_read_b64_tr_b16 a[30:31], v5 offset:60160
    v_mfma_f32_16x16x32_bf16 v[212:215], v[28:31], a[164:167], v[212:215]
    ds_read_b64_tr_b16 v[22:23], v4 offset:1568
    ds_read_b64_tr_b16 a[32:33], v5 offset:60672
    v_mfma_f32_16x16x32_bf16 v[84:87], v[32:35], a[164:167], v[84:87]
    ds_read_b64_tr_b16 v[24:25], v4 offset:2080
    ds_read_b64_tr_b16 a[34:35], v5 offset:61184
    v_mfma_f32_16x16x32_bf16 v[80:83], v[32:35], a[160:163], v[80:83]
    ds_read_b64_tr_b16 v[26:27], v4 offset:2592
    s_waitcnt lgkmcnt(14)
    v_mfma_f32_16x16x32_bf16 v[184:187], v[36:39], a[160:163], v[184:187]
    ds_read_b64_tr_b16 v[28:29], v4 offset:64
    s_add_u32 m0, s44, 86912
    v_mfma_f32_16x16x32_bf16 v[188:191], v[36:39], a[164:167], v[188:191]
    ds_read_b64_tr_b16 v[30:31], v4 offset:576
    s_add_u32 s47, s80, 884736
    v_mfma_f32_16x16x32_bf16 v[220:223], v[40:43], a[164:167], v[220:223]
    ds_read_b64_tr_b16 v[32:33], v4 offset:1088
    ds_read_b64_tr_b16 v[34:35], v4 offset:1600
    v_mfma_f32_16x16x32_bf16 v[216:219], v[40:43], a[160:163], v[216:219]
    buffer_load_dwordx4 v11, s[20:23], s47 offen offset:0 lds
    s_waitcnt lgkmcnt(11)
    v_mfma_f32_16x16x32_bf16 v[88:91], v[44:47], a[160:163], v[88:91]
    ds_read_b64_tr_b16 v[36:37], v4 offset:2112
    ds_read_b64_tr_b16 v[38:39], v4 offset:2624
    v_mfma_f32_16x16x32_bf16 v[92:95], v[44:47], a[164:167], v[92:95]
    buffer_load_dwordx4 v12, s[20:23], s47 offen offset:1024 lds
    v_mfma_f32_16x16x32_bf16 v[172:175], v[48:51], a[172:175], v[172:175]
    ds_read_b64_tr_b16 v[40:41], v4 offset:96
    ds_read_b64_tr_b16 a[36:37], v4 offset:0
    v_mfma_f32_16x16x32_bf16 v[168:171], v[48:51], a[168:171], v[168:171]
    ds_read_b64_tr_b16 v[42:43], v4 offset:608
    s_waitcnt lgkmcnt(9)
    v_mfma_f32_16x16x32_bf16 v[200:203], v[20:23], a[168:171], v[200:203]
    ds_read_b64_tr_b16 v[44:45], v4 offset:1120
    ds_read_b64_tr_b16 v[46:47], v4 offset:1632
    v_mfma_f32_16x16x32_bf16 v[204:207], v[20:23], a[172:175], v[204:207]
    buffer_load_dword v16, v15, s[16:19], 0 offen offset:256 sc1
    v_mfma_f32_16x16x32_bf16 v[76:79], v[24:27], a[172:175], v[76:79]
    ds_read_b64_tr_b16 v[48:49], v4 offset:2144
    ds_read_b64_tr_b16 v[50:51], v4 offset:2656
    v_mfma_f32_16x16x32_bf16 v[72:75], v[24:27], a[168:171], v[72:75]
    buffer_load_dwordx4 v13, s[20:23], s47 offen offset:2048 lds
    s_waitcnt lgkmcnt(9)
    v_mfma_f32_16x16x32_bf16 v[176:179], v[28:31], a[168:171], v[176:179]
    ds_read_b64_tr_b16 v[20:21], v4 offset:12448
    s_add_u32 m0, s44, 99328
    v_mfma_f32_16x16x32_bf16 v[180:183], v[28:31], a[172:175], v[180:183]
    ds_read_b64_tr_b16 v[22:23], v4 offset:12960
    s_add_u32 s47, s80, 921600
    v_mfma_f32_16x16x32_bf16 v[212:215], v[32:35], a[172:175], v[212:215]
    ds_read_b64_tr_b16 v[24:25], v4 offset:13472
    ds_read_b64_tr_b16 a[38:39], v4 offset:512
    v_mfma_f32_16x16x32_bf16 v[208:211], v[32:35], a[168:171], v[208:211]
    ds_read_b64_tr_b16 v[26:27], v4 offset:13984
    s_waitcnt lgkmcnt(9)
    v_mfma_f32_16x16x32_bf16 v[80:83], v[36:39], a[168:171], v[80:83]
    ds_read_b64_tr_b16 v[28:29], v4 offset:14496
    ds_read_b64_tr_b16 v[30:31], v4 offset:15008
    v_mfma_f32_16x16x32_bf16 v[84:87], v[36:39], a[172:175], v[84:87]
    buffer_load_dwordx4 v11, s[20:23], s47 offen offset:0 lds
    v_mfma_f32_16x16x32_bf16 v[188:191], v[40:43], a[172:175], v[188:191]
    ds_read_b64_tr_b16 v[32:33], v4 offset:12480
    ds_read_b64_tr_b16 v[34:35], v4 offset:12992
    v_mfma_f32_16x16x32_bf16 v[184:187], v[40:43], a[168:171], v[184:187]
    buffer_load_dwordx4 v12, s[20:23], s47 offen offset:1024 lds
    s_waitcnt lgkmcnt(9)
    v_mfma_f32_16x16x32_bf16 v[216:219], v[44:47], a[168:171], v[216:219]
    ds_read_b64_tr_b16 v[36:37], v4 offset:13504
    ds_read_b64_tr_b16 v[38:39], v4 offset:14016
    v_mfma_f32_16x16x32_bf16 v[220:223], v[44:47], a[172:175], v[220:223]
    buffer_load_dwordx4 v13, s[20:23], s47 offen offset:2048 lds
    v_mfma_f32_16x16x32_bf16 v[92:95], v[48:51], a[172:175], v[92:95]
    ds_read_b64_tr_b16 v[40:41], v4 offset:14528
    ds_read_b64_tr_b16 a[40:41], v4 offset:1024
    v_mfma_f32_16x16x32_bf16 v[88:91], v[48:51], a[168:171], v[88:91]
    ds_read_b64_tr_b16 v[42:43], v4 offset:15040
    s_waitcnt lgkmcnt(9)
    v_mfma_f32_16x16x32_bf16 v[168:171], v[20:23], a[176:179], v[168:171]
    ds_read_b64_tr_b16 v[44:45], v4 offset:12512
    ds_read_b64_tr_b16 a[42:43], v4 offset:1536
    v_mfma_f32_16x16x32_bf16 v[172:175], v[20:23], a[180:183], v[172:175]
    ds_read_b64_tr_b16 v[46:47], v4 offset:13024
    ds_read_b64_tr_b16 a[44:45], v4 offset:2048
    v_mfma_f32_16x16x32_bf16 v[204:207], v[24:27], a[180:183], v[204:207]
    ds_read_b64_tr_b16 v[48:49], v4 offset:13536
    ds_read_b64_tr_b16 a[46:47], v4 offset:2560
    v_mfma_f32_16x16x32_bf16 v[200:203], v[24:27], a[176:179], v[200:203]
    ds_read_b64_tr_b16 v[50:51], v4 offset:14048
    s_waitcnt lgkmcnt(12)
    v_mfma_f32_16x16x32_bf16 v[72:75], v[28:31], a[176:179], v[72:75]
    ds_read_b64_tr_b16 v[20:21], v4 offset:14560
    ds_read_b64_tr_b16 a[48:49], v4 offset:12416
    v_mfma_f32_16x16x32_bf16 v[76:79], v[28:31], a[180:183], v[76:79]
    ds_read_b64_tr_b16 v[22:23], v4 offset:15072
    ds_read_b64_tr_b16 a[50:51], v4 offset:12928
    v_mfma_f32_16x16x32_bf16 v[180:183], v[32:35], a[180:183], v[180:183]
    ds_read_b64_tr_b16 v[24:25], v4 offset:24864
    ds_read_b64_tr_b16 a[52:53], v4 offset:13440
    v_mfma_f32_16x16x32_bf16 v[176:179], v[32:35], a[176:179], v[176:179]
    ds_read_b64_tr_b16 v[26:27], v4 offset:25376
    s_waitcnt lgkmcnt(14)
    v_mfma_f32_16x16x32_bf16 v[208:211], v[36:39], a[176:179], v[208:211]
    ds_read_b64_tr_b16 v[28:29], v4 offset:25888
    ds_read_b64_tr_b16 a[54:55], v4 offset:13952
    v_mfma_f32_16x16x32_bf16 v[212:215], v[36:39], a[180:183], v[212:215]
    ds_read_b64_tr_b16 v[30:31], v4 offset:26400
    ds_read_b64_tr_b16 a[56:57], v4 offset:14464
    v_mfma_f32_16x16x32_bf16 v[84:87], v[40:43], a[180:183], v[84:87]
    ds_read_b64_tr_b16 v[32:33], v4 offset:26912
    ds_read_b64_tr_b16 a[58:59], v4 offset:14976
    v_mfma_f32_16x16x32_bf16 v[80:83], v[40:43], a[176:179], v[80:83]
    ds_read_b64_tr_b16 v[34:35], v4 offset:27424
    s_waitcnt lgkmcnt(14)
    v_mfma_f32_16x16x32_bf16 v[184:187], v[44:47], a[176:179], v[184:187]
    ds_read_b64_tr_b16 v[36:37], v4 offset:24896
    v_add_u32 v126, v152, v126
    v_mfma_f32_16x16x32_bf16 v[188:191], v[44:47], a[180:183], v[188:191]
    ds_read_b64_tr_b16 v[38:39], v4 offset:25408
    v_lshrrev_b32 v153, 4, v1
    v_mfma_f32_16x16x32_bf16 v[220:223], v[48:51], a[180:183], v[220:223]
    ds_read_b64_tr_b16 v[40:41], v4 offset:25920
    v_lshlrev_b32 v128, 16, v52
    v_mfma_f32_16x16x32_bf16 v[216:219], v[48:51], a[176:179], v[216:219]
    ds_read_b64_tr_b16 v[42:43], v4 offset:26432
    s_waitcnt lgkmcnt(11)
    v_mfma_f32_16x16x32_bf16 v[88:91], v[20:23], a[176:179], v[88:91]
    ds_read_b64_tr_b16 v[44:45], v4 offset:26944
    ds_read_b64_tr_b16 v[46:47], v4 offset:27456
    v_mfma_f32_16x16x32_bf16 v[92:95], v[20:23], a[180:183], v[92:95]
    s_mul_i32 s36, s42, 96
    s_lshl_b32 s37, s41, 3
    s_add_u32 s36, s36, s37
    v_lshl_add_u32 v153, v153, 1, s36
    v_mfma_f32_16x16x32_bf16 v[172:175], v[24:27], a[188:191], v[172:175]
    ds_read_b64_tr_b16 v[48:49], v4 offset:24928
    ds_read_b64_tr_b16 a[60:61], v4 offset:24832
    v_mfma_f32_16x16x32_bf16 v[168:171], v[24:27], a[184:187], v[168:171]
    ds_read_b64_tr_b16 v[50:51], v4 offset:25440
    s_waitcnt lgkmcnt(9)
    v_mfma_f32_16x16x32_bf16 v[200:203], v[28:31], a[184:187], v[200:203]
    ds_read_b64_tr_b16 v[20:21], v4 offset:25952
    ds_read_b64_tr_b16 a[62:63], v4 offset:25344
    v_mfma_f32_16x16x32_bf16 v[204:207], v[28:31], a[188:191], v[204:207]
    ds_read_b64_tr_b16 v[22:23], v4 offset:26464
    ds_read_b64_tr_b16 a[64:65], v4 offset:25856
    v_mfma_f32_16x16x32_bf16 v[76:79], v[32:35], a[188:191], v[76:79]
    ds_read_b64_tr_b16 v[24:25], v4 offset:26976
    ds_read_b64_tr_b16 a[66:67], v4 offset:26368
    v_mfma_f32_16x16x32_bf16 v[72:75], v[32:35], a[184:187], v[72:75]
    ds_read_b64_tr_b16 v[26:27], v4 offset:27488
    s_waitcnt lgkmcnt(12)
    v_mfma_f32_16x16x32_bf16 v[176:179], v[36:39], a[184:187], v[176:179]
    s_waitcnt vmcnt(21)
    s_barrier
    ds_read_b64_tr_b16 v[28:29], v4 offset:37280
    ds_read_b64_tr_b16 v[30:31], v4 offset:37792
    v_mfma_f32_16x16x32_bf16 v[180:183], v[36:39], a[188:191], v[180:183]
    s_waitcnt vmcnt(4)
    v_cmp_ne_u32 vcc, s66, v16
    s_cbranch_vccnz L_slow_mlpF3
L_ret_mlpF3:
    v_mfma_f32_16x16x32_bf16 v[212:215], v[40:43], a[188:191], v[212:215]
    ds_read_b64_tr_b16 v[32:33], v4 offset:38304
    ds_read_b64_tr_b16 a[68:69], v4 offset:26880
    v_mfma_f32_16x16x32_bf16 v[208:211], v[40:43], a[184:187], v[208:211]
    ds_read_b64_tr_b16 v[34:35], v4 offset:38816
    s_waitcnt lgkmcnt(12)
    v_mfma_f32_16x16x32_bf16 v[80:83], v[44:47], a[184:187], v[80:83]
    ds_read_b64_tr_b16 v[36:37], v4 offset:39328
    ds_read_b64_tr_b16 a[70:71], v4 offset:27392
    v_mfma_f32_16x16x32_bf16 v[84:87], v[44:47], a[188:191], v[84:87]
    ds_read_b64_tr_b16 v[38:39], v4 offset:39840
    s_add_u32 m0, s44, 111744
    v_mfma_f32_16x16x32_bf16 v[188:191], v[48:51], a[188:191], v[188:191]
    ds_read_b64_tr_b16 v[40:41], v4 offset:37312
    s_add_u32 s47, s81, 884736
    v_mfma_f32_16x16x32_bf16 v[184:187], v[48:51], a[184:187], v[184:187]
    ds_read_b64_tr_b16 v[42:43], v4 offset:37824
    s_waitcnt lgkmcnt(10)
    v_mfma_f32_16x16x32_bf16 v[216:219], v[20:23], a[184:187], v[216:219]
    ds_read_b64_tr_b16 v[44:45], v4 offset:38336
    ds_read_b64_tr_b16 v[46:47], v4 offset:38848
    v_mfma_f32_16x16x32_bf16 v[220:223], v[20:23], a[188:191], v[220:223]
    buffer_load_dwordx4 v11, s[20:23], s47 offen offset:0 lds
    v_mfma_f32_16x16x32_bf16 v[92:95], v[24:27], a[188:191], v[92:95]
    ds_read_b64_tr_b16 v[48:49], v4 offset:39360
    ds_read_b64_tr_b16 v[50:51], v4 offset:39872
    v_mfma_f32_16x16x32_bf16 v[88:91], v[24:27], a[184:187], v[88:91]
    buffer_load_dwordx4 v12, s[20:23], s47 offen offset:1024 lds
    s_waitcnt lgkmcnt(9)
    v_mfma_f32_16x16x32_bf16 v[168:171], v[28:31], a[192:195], v[168:171]
    ds_read_b64_tr_b16 v[20:21], v4 offset:37344
    ds_read_b64_tr_b16 v[22:23], v4 offset:37856
    v_mfma_f32_16x16x32_bf16 v[172:175], v[28:31], a[196:199], v[172:175]
    buffer_load_dwordx4 v13, s[20:23], s47 offen offset:2048 lds
    v_mfma_f32_16x16x32_bf16 v[204:207], v[32:35], a[196:199], v[204:207]
    ds_read_b64_tr_b16 v[24:25], v4 offset:38368
    s_add_u32 m0, s44, 124160
    v_mfma_f32_16x16x32_bf16 v[200:203], v[32:35], a[192:195], v[200:203]
    ds_read_b64_tr_b16 v[26:27], v4 offset:38880
    s_waitcnt lgkmcnt(8)
    v_mfma_f32_16x16x32_bf16 v[72:75], v[36:39], a[192:195], v[72:75]
    ds_read_b64_tr_b16 v[28:29], v4 offset:39392
    s_add_u32 s47, s81, 921600
    v_mfma_f32_16x16x32_bf16 v[76:79], v[36:39], a[196:199], v[76:79]
    ds_read_b64_tr_b16 v[30:31], v4 offset:39904
    ds_read_b64_tr_b16 a[72:73], v4 offset:37248
    v_mfma_f32_16x16x32_bf16 v[180:183], v[40:43], a[196:199], v[180:183]
    ds_read_b64_tr_b16 v[32:33], v6 offset:5536
    ds_read_b64_tr_b16 v[34:35], v6 offset:6048
    v_mfma_f32_16x16x32_bf16 v[176:179], v[40:43], a[192:195], v[176:179]
    buffer_load_dwordx4 v11, s[20:23], s47 offen offset:0 lds
    s_waitcnt lgkmcnt(9)
    v_mfma_f32_16x16x32_bf16 v[208:211], v[44:47], a[192:195], v[208:211]
    ds_read_b64_tr_b16 v[36:37], v6 offset:6560
    ds_read_b64_tr_b16 v[38:39], v6 offset:7072
    v_mfma_f32_16x16x32_bf16 v[212:215], v[44:47], a[196:199], v[212:215]
    buffer_load_dwordx4 v12, s[20:23], s47 offen offset:1024 lds
    v_mfma_f32_16x16x32_bf16 v[84:87], v[48:51], a[196:199], v[84:87]
    ds_read_b64_tr_b16 v[40:41], v6 offset:7584
    ds_read_b64_tr_b16 a[74:75], v4 offset:37760
    v_mfma_f32_16x16x32_bf16 v[80:83], v[48:51], a[192:195], v[80:83]
    ds_read_b64_tr_b16 v[42:43], v6 offset:8096
    s_waitcnt lgkmcnt(10)
    v_mfma_f32_16x16x32_bf16 v[184:187], v[20:23], a[192:195], v[184:187]
    ds_read_b64_tr_b16 v[44:45], v6 offset:5568
    ds_read_b64_tr_b16 v[46:47], v6 offset:6080
    v_mfma_f32_16x16x32_bf16 v[188:191], v[20:23], a[196:199], v[188:191]
    buffer_load_dwordx4 v13, s[20:23], s47 offen offset:2048 lds
    v_mfma_f32_16x16x32_bf16 v[220:223], v[24:27], a[196:199], v[220:223]
    ds_read_b64_tr_b16 v[48:49], v6 offset:6592
    s_add_u32 m0, s44, 0
    v_mfma_f32_16x16x32_bf16 v[216:219], v[24:27], a[192:195], v[216:219]
    ds_read_b64_tr_b16 v[50:51], v6 offset:7104
    s_waitcnt lgkmcnt(9)
    v_mfma_f32_16x16x32_bf16 v[88:91], v[28:31], a[192:195], v[88:91]
    ds_read_b64_tr_b16 v[20:21], v6 offset:7616
    s_add_u32 s47, s82, 884736
    v_mfma_f32_16x16x32_bf16 v[92:95], v[28:31], a[196:199], v[92:95]
    ds_read_b64_tr_b16 v[22:23], v6 offset:8128
    ds_read_b64_tr_b16 a[76:77], v4 offset:38272
    v_mfma_f32_16x16x32_bf16 v[172:175], v[32:35], a[204:207], v[172:175]
    ds_read_b64_tr_b16 v[24:25], v6 offset:5600
    ds_read_b64_tr_b16 a[78:79], v4 offset:38784
    v_mfma_f32_16x16x32_bf16 v[168:171], v[32:35], a[200:203], v[168:171]
    ds_read_b64_tr_b16 v[26:27], v6 offset:6112
    s_waitcnt lgkmcnt(10)
    v_mfma_f32_16x16x32_bf16 v[200:203], v[36:39], a[200:203], v[200:203]
    ds_read_b64_tr_b16 v[28:29], v6 offset:6624
    ds_read_b64_tr_b16 v[30:31], v6 offset:7136
    v_mfma_f32_16x16x32_bf16 v[204:207], v[36:39], a[204:207], v[204:207]
    buffer_load_dwordx4 v11, s[20:23], s47 offen offset:0 lds
    v_mfma_f32_16x16x32_bf16 v[76:79], v[40:43], a[204:207], v[76:79]
    ds_read_b64_tr_b16 v[32:33], v6 offset:7648
    ds_read_b64_tr_b16 v[34:35], v6 offset:8160
    v_mfma_f32_16x16x32_bf16 v[72:75], v[40:43], a[200:203], v[72:75]
    buffer_load_dwordx4 v12, s[20:23], s47 offen offset:1024 lds
    s_waitcnt lgkmcnt(10)
    v_mfma_f32_16x16x32_bf16 v[176:179], v[44:47], a[200:203], v[176:179]
    ds_read_b64_tr_b16 v[36:37], v6 offset:17952
    ds_read_b64_tr_b16 v[38:39], v6 offset:18464
    v_mfma_f32_16x16x32_bf16 v[180:183], v[44:47], a[204:207], v[180:183]
    buffer_load_dwordx4 v13, s[20:23], s47 offen offset:2048 lds
    v_mfma_f32_16x16x32_bf16 v[212:215], v[48:51], a[204:207], v[212:215]
    ds_read_b64_tr_b16 v[40:41], v6 offset:18976
    s_add_u32 m0, s44, 12416
    v_mfma_f32_16x16x32_bf16 v[208:211], v[48:51], a[200:203], v[208:211]
    ds_read_b64_tr_b16 v[42:43], v6 offset:19488
    s_waitcnt lgkmcnt(8)
    v_mfma_f32_16x16x32_bf16 v[80:83], v[20:23], a[200:203], v[80:83]
    ds_read_b64_tr_b16 v[44:45], v6 offset:20000
    s_add_u32 s47, s82, 921600
    v_mfma_f32_16x16x32_bf16 v[84:87], v[20:23], a[204:207], v[84:87]
    ds_read_b64_tr_b16 v[46:47], v6 offset:20512
    ds_read_b64_tr_b16 a[80:81], v4 offset:39296
    v_mfma_f32_16x16x32_bf16 v[188:191], v[24:27], a[204:207], v[188:191]
    ds_read_b64_tr_b16 v[48:49], v6 offset:17984
    ds_read_b64_tr_b16 v[50:51], v6 offset:18496
    v_mfma_f32_16x16x32_bf16 v[184:187], v[24:27], a[200:203], v[184:187]
    buffer_load_dwordx4 v11, s[20:23], s47 offen offset:0 lds
    s_waitcnt lgkmcnt(9)
    v_mfma_f32_16x16x32_bf16 v[216:219], v[28:31], a[200:203], v[216:219]
    ds_read_b64_tr_b16 v[20:21], v6 offset:19008
    ds_read_b64_tr_b16 v[22:23], v6 offset:19520
    v_mfma_f32_16x16x32_bf16 v[220:223], v[28:31], a[204:207], v[220:223]
    buffer_load_dwordx4 v12, s[20:23], s47 offen offset:1024 lds
    v_mfma_f32_16x16x32_bf16 v[92:95], v[32:35], a[204:207], v[92:95]
    ds_read_b64_tr_b16 v[24:25], v6 offset:20032
    ds_read_b64_tr_b16 a[82:83], v4 offset:39808
    v_mfma_f32_16x16x32_bf16 v[88:91], v[32:35], a[200:203], v[88:91]
    ds_read_b64_tr_b16 v[26:27], v6 offset:20544
    s_waitcnt lgkmcnt(10)
    v_mfma_f32_16x16x32_bf16 v[168:171], v[36:39], a[208:211], v[168:171]
    ds_read_b64_tr_b16 v[28:29], v6 offset:18016
    ds_read_b64_tr_b16 v[30:31], v6 offset:18528
    v_mfma_f32_16x16x32_bf16 v[172:175], v[36:39], a[212:215], v[172:175]
    buffer_load_dwordx4 v13, s[20:23], s47 offen offset:2048 lds
    v_mfma_f32_16x16x32_bf16 v[204:207], v[40:43], a[212:215], v[204:207]
    ds_read_b64_tr_b16 v[32:33], v6 offset:19040
    ds_read_b64_tr_b16 a[84:85], v6 offset:5504
    v_mfma_f32_16x16x32_bf16 v[200:203], v[40:43], a[208:211], v[200:203]
    ds_read_b64_tr_b16 v[34:35], v6 offset:19552
    s_waitcnt lgkmcnt(10)
    v_mfma_f32_16x16x32_bf16 v[72:75], v[44:47], a[208:211], v[72:75]
    ds_read_b64_tr_b16 v[36:37], v6 offset:20064
    ds_read_b64_tr_b16 a[86:87], v6 offset:6016
    v_mfma_f32_16x16x32_bf16 v[76:79], v[44:47], a[212:215], v[76:79]
    ds_read_b64_tr_b16 v[38:39], v6 offset:20576
    ds_read_b64_tr_b16 a[88:89], v6 offset:6528
    v_mfma_f32_16x16x32_bf16 v[180:183], v[48:51], a[212:215], v[180:183]
    s_barrier
    ds_read_b64_tr_b16 v[40:41], v4 offset:49696
    ds_read_b64_tr_b16 a[90:91], v6 offset:7040
    v_mfma_f32_16x16x32_bf16 v[176:179], v[48:51], a[208:211], v[176:179]
    ds_read_b64_tr_b16 v[42:43], v4 offset:50208
    s_waitcnt lgkmcnt(12)
    v_mfma_f32_16x16x32_bf16 v[208:211], v[20:23], a[208:211], v[208:211]
    ds_read_b64_tr_b16 v[44:45], v4 offset:50720
    ds_read_b64_tr_b16 a[92:93], v6 offset:7552
    v_mfma_f32_16x16x32_bf16 v[212:215], v[20:23], a[212:215], v[212:215]
    ds_read_b64_tr_b16 v[46:47], v4 offset:51232
    ds_read_b64_tr_b16 a[94:95], v6 offset:8064
    v_mfma_f32_16x16x32_bf16 v[84:87], v[24:27], a[212:215], v[84:87]
    ds_read_b64_tr_b16 v[48:49], v4 offset:51744
    s_add_u32 s100, s80, 884736
    v_mfma_f32_16x16x32_bf16 v[80:83], v[24:27], a[208:211], v[80:83]
    ds_read_b64_tr_b16 v[50:51], v4 offset:52256
    s_waitcnt lgkmcnt(13)
    v_mfma_f32_16x16x32_bf16 v[184:187], v[28:31], a[208:211], v[184:187]
    ds_read_b64_tr_b16 v[20:21], v4 offset:49728
    ds_read_b64_tr_b16 v[22:23], v4 offset:50240
    v_mfma_f32_16x16x32_bf16 v[188:191], v[28:31], a[212:215], v[188:191]
    buffer_load_dwordx4 a[240:243], v14, s[16:19], s100 offen offset:0 sc1
    v_mfma_f32_16x16x32_bf16 v[220:223], v[32:35], a[212:215], v[220:223]
    ds_read_b64_tr_b16 v[24:25], v4 offset:50752
    v_mul_u32_u24 v124, 1152, v152
    v_mfma_f32_16x16x32_bf16 v[216:219], v[32:35], a[208:211], v[216:219]
    ds_read_b64_tr_b16 v[26:27], v4 offset:51264
    s_waitcnt lgkmcnt(10)
    v_mfma_f32_16x16x32_bf16 v[88:91], v[36:39], a[208:211], v[88:91]
    ds_read_b64_tr_b16 v[28:29], v4 offset:51776
    ds_read_b64_tr_b16 v[30:31], v4 offset:52288
    v_mfma_f32_16x16x32_bf16 v[92:95], v[36:39], a[212:215], v[92:95]
    buffer_load_dwordx4 a[244:247], v14, s[16:19], s100 offen offset:1024 sc1
    v_mfma_f32_16x16x32_bf16 v[172:175], v[40:43], a[220:223], v[172:175]
    ds_read_b64_tr_b16 v[32:33], v4 offset:49760
    s_add_u32 s100, s80, 921600
    v_mfma_f32_16x16x32_bf16 v[168:171], v[40:43], a[216:219], v[168:171]
    ds_read_b64_tr_b16 v[34:35], v4 offset:50272
    s_waitcnt lgkmcnt(8)
    v_mfma_f32_16x16x32_bf16 v[200:203], v[44:47], a[216:219], v[200:203]
    ds_read_b64_tr_b16 v[36:37], v4 offset:50784
    ds_read_b64_tr_b16 v[38:39], v4 offset:51296
    v_mfma_f32_16x16x32_bf16 v[204:207], v[44:47], a[220:223], v[204:207]
    buffer_load_dwordx4 a[248:251], v14, s[16:19], s100 offen offset:0 sc1
    v_mfma_f32_16x16x32_bf16 v[76:79], v[48:51], a[220:223], v[76:79]
    ds_read_b64_tr_b16 v[40:41], v4 offset:51808
    v_lshl_add_u32 v124, v153, 2, v124
    v_mfma_f32_16x16x32_bf16 v[72:75], v[48:51], a[216:219], v[72:75]
    ds_read_b64_tr_b16 v[42:43], v4 offset:52320
    s_waitcnt lgkmcnt(8)
    v_mfma_f32_16x16x32_bf16 v[176:179], v[20:23], a[216:219], v[176:179]
    ds_read_b64_tr_b16 v[44:45], v4 offset:62112
    ds_read_b64_tr_b16 v[46:47], v4 offset:62624
    v_mfma_f32_16x16x32_bf16 v[180:183], v[20:23], a[220:223], v[180:183]
    buffer_load_dwordx4 a[252:255], v14, s[16:19], s100 offen offset:1024 sc1
    v_mfma_f32_16x16x32_bf16 v[212:215], v[24:27], a[220:223], v[212:215]
    ds_read_b64_tr_b16 v[48:49], v4 offset:63136
    s_add_u32 s100, s81, 884736
    v_mfma_f32_16x16x32_bf16 v[208:211], v[24:27], a[216:219], v[208:211]
    ds_read_b64_tr_b16 v[50:51], v4 offset:63648
    s_waitcnt lgkmcnt(8)
    v_mfma_f32_16x16x32_bf16 v[80:83], v[28:31], a[216:219], v[80:83]
    ds_read_b64_tr_b16 v[20:21], v4 offset:64160
    ds_read_b64_tr_b16 v[22:23], v4 offset:64672
    v_mfma_f32_16x16x32_bf16 v[84:87], v[28:31], a[220:223], v[84:87]
    buffer_load_dwordx4 v[224:227], v14, s[16:19], s100 offen offset:0 sc1
    v_mfma_f32_16x16x32_bf16 v[188:191], v[32:35], a[220:223], v[188:191]
    ds_read_b64_tr_b16 v[24:25], v4 offset:62144
    v_add_u32 v124, 4096, v124
    v_mfma_f32_16x16x32_bf16 v[184:187], v[32:35], a[216:219], v[184:187]
    ds_read_b64_tr_b16 v[26:27], v4 offset:62656
    s_waitcnt lgkmcnt(8)
    v_mfma_f32_16x16x32_bf16 v[216:219], v[36:39], a[216:219], v[216:219]
    ds_read_b64_tr_b16 v[28:29], v4 offset:63168
    ds_read_b64_tr_b16 v[30:31], v4 offset:63680
    v_mfma_f32_16x16x32_bf16 v[220:223], v[36:39], a[220:223], v[220:223]
    buffer_load_dwordx4 v[228:231], v14, s[16:19], s100 offen offset:1024 sc1
    v_mfma_f32_16x16x32_bf16 v[92:95], v[40:43], a[220:223], v[92:95]
    ds_read_b64_tr_b16 v[32:33], v4 offset:64192
    s_add_u32 s100, s81, 921600
    v_mfma_f32_16x16x32_bf16 v[88:91], v[40:43], a[216:219], v[88:91]
    ds_read_b64_tr_b16 v[34:35], v4 offset:64704
    s_waitcnt lgkmcnt(8)
    v_mfma_f32_16x16x32_bf16 v[168:171], v[44:47], a[224:227], v[168:171]
    ds_read_b64_tr_b16 v[36:37], v4 offset:62176
    ds_read_b64_tr_b16 v[38:39], v4 offset:62688
    v_mfma_f32_16x16x32_bf16 v[172:175], v[44:47], a[228:231], v[172:175]
    buffer_load_dwordx4 v[232:235], v14, s[16:19], s100 offen offset:0 sc1
    v_mfma_f32_16x16x32_bf16 v[204:207], v[48:51], a[228:231], v[204:207]
    ds_read_b64_tr_b16 v[40:41], v4 offset:63200
    s_mov_b32 s54, 18432
    v_mfma_f32_16x16x32_bf16 v[200:203], v[48:51], a[224:227], v[200:203]
    ds_read_b64_tr_b16 v[42:43], v4 offset:63712
    s_waitcnt lgkmcnt(8)
    v_lshlrev_b32 v125, 3, v126
    s_cmp_eq_u32 s42, 2
    s_cselect_b32 s37, 1, 0
    s_cselect_b32 s45, 0x2000, 8
    v_lshrrev_b32 v154, s37, v125
    v_lshl_add_u32 v125, v153, 14, v125
    v_lshl_add_u32 v154, v153, 14, v154
    v_and_b32 v126, 15, v152
    v_sub_u32 v152, v152, v126
    v_lshl_add_u32 v126, v152, 2, v126
    v_lshlrev_b32 v126, 2, v126
    v_add_u32 v126, 393216, v126
    s_add_u32 s55, s45, 8388608
    s_add_u32 s56, s45, 8404992
    s_lshl_b32 s36, s40, 2
    s_add_u32 s36, s36, s42
    s_lshl_b32 s36, s36, 2
    s_add_u32 s36, s36, s32
    s_lshl_b32 s37, s36, 9
    s_add_u32 s37, s37, 524288
    v_and_b32 v156, 3, v1
    v_lshl_add_u32 v156, v156, 7, s37
    s_lshl_b32 s45, s41, 7
    s_add_u32 s37, s37, s45
    v_and_b32 v157, 31, v1
    v_lshl_add_u32 v157, v157, 2, s37
    s_mul_i32 s36, s36, 49152
    s_add_u32 s36, s36, 12582912
    v_lshl_add_u32 v19, v1, 4, s36
    s_mul_i32 s37, s41, 12288
    v_add_u32 v127, s37, v19
    s_sub_u32 s28, s94, 4096
    s_subb_u32 s29, s95, 0
    s_and_b32 s29, s29, 0xffff
    s_mov_b32 s30, 2363392
    s_mov_b32 s31, 0x20000
    s_mov_b32 s63, 4096
    s_mov_b32 s64, 8192
    s_xor_b32 s36, s41, 1
    s_mul_i32 s36, s36, 12288
    s_add_u32 s49, s36, 0
    s_xor_b32 s36, s41, 2
    s_mul_i32 s36, s36, 12288
    s_add_u32 s50, s36, 4096
    s_xor_b32 s36, s41, 3
    s_mul_i32 s36, s36, 12288
    s_add_u32 s51, s36, 8192
    s_mov_b32 s57, 7340032
    s_mov_b32 s58, 7356416
    s_mov_b32 s59, 7864320
    s_mov_b32 s60, 7880704
    s_mov_b32 s61, 8388608
    s_mov_b32 s62, 8404992
    v_and_b32 v129, 0xffff0000, v52
    v_lshlrev_b32 v130, 16, v53
    v_and_b32 v131, 0xffff0000, v53
    v_lshlrev_b32 v132, 16, v54
    v_and_b32 v133, 0xffff0000, v54
    v_lshlrev_b32 v134, 16, v55
    v_and_b32 v135, 0xffff0000, v55
    v_lshlrev_b32 v136, 16, v56
    v_and_b32 v137, 0xffff0000, v56
    v_lshlrev_b32 v138, 16, v57
    v_and_b32 v139, 0xffff0000, v57
    v_lshlrev_b32 v140, 16, v58
    v_and_b32 v141, 0xffff0000, v58
    v_lshlrev_b32 v142, 16, v59
    v_and_b32 v143, 0xffff0000, v59
    v_lshlrev_b32 v144, 16, v60
    v_and_b32 v145, 0xffff0000, v60
    v_lshlrev_b32 v146, 16, v61
    v_and_b32 v147, 0xffff0000, v61
    v_lshlrev_b32 v148, 16, v8
    v_and_b32 v149, 0xffff0000, v8
    v_lshlrev_b32 v150, 16, v9
    v_and_b32 v151, 0xffff0000, v9
    v_mov_b32 v55, s66
    v_mov_b32 v59, s66
    v_mov_b32 v63, s66
    v_mfma_f32_16x16x32_bf16 v[72:75], v[20:23], a[224:227], v[72:75]
    ds_read_b64_tr_b16 v[44:45], v4 offset:64224
    ds_read_b64_tr_b16 v[46:47], v4 offset:64736
    v_mfma_f32_16x16x32_bf16 v[76:79], v[20:23], a[228:231], v[76:79]
    buffer_load_dwordx4 v[236:239], v14, s[16:19], s100 offen offset:1024 sc1
    v_mfma_f32_16x16x32_bf16 v[180:183], v[24:27], a[228:231], v[180:183]
    ds_read_b64_tr_b16 v[48:49], v5 offset:8992
    ds_read_b64_tr_b16 v[50:51], v5 offset:9504
    v_mfma_f32_16x16x32_bf16 v[176:179], v[24:27], a[224:227], v[176:179]
    buffer_load_dword v120, v126, s[16:19], 0 offen offset:0 sc1
    s_waitcnt lgkmcnt(8)
    v_mfma_f32_16x16x32_bf16 v[208:211], v[28:31], a[224:227], v[208:211]
    ds_read_b64_tr_b16 v[20:21], v5 offset:10016
    ds_read_b64_tr_b16 v[22:23], v5 offset:10528
    v_mfma_f32_16x16x32_bf16 v[212:215], v[28:31], a[228:231], v[212:215]
    buffer_load_dword v121, v126, s[16:19], 0 offen offset:256 sc1
    v_mfma_f32_16x16x32_bf16 v[84:87], v[32:35], a[228:231], v[84:87]
    ds_read_b64_tr_b16 v[24:25], v5 offset:11040
    s_add_u32 s100, s82, 884736
    v_mfma_f32_16x16x32_bf16 v[80:83], v[32:35], a[224:227], v[80:83]
    ds_read_b64_tr_b16 v[26:27], v5 offset:11552
    s_waitcnt lgkmcnt(8)
    v_mfma_f32_16x16x32_bf16 v[184:187], v[36:39], a[224:227], v[184:187]
    ds_read_b64_tr_b16 v[28:29], v5 offset:9024
    ds_read_b64_tr_b16 v[30:31], v5 offset:9536
    v_mfma_f32_16x16x32_bf16 v[188:191], v[36:39], a[228:231], v[188:191]
    buffer_load_dwordx4 v[240:243], v14, s[16:19], s100 offen offset:0 sc1
    v_mfma_f32_16x16x32_bf16 v[220:223], v[40:43], a[228:231], v[220:223]
    ds_read_b64_tr_b16 v[32:33], v5 offset:10048
    ds_read_b64_tr_b16 v[34:35], v5 offset:10560
    v_mfma_f32_16x16x32_bf16 v[216:219], v[40:43], a[224:227], v[216:219]
    buffer_load_dwordx4 v[244:247], v14, s[16:19], s100 offen offset:1024 sc1
    s_waitcnt lgkmcnt(8)
    v_mfma_f32_16x16x32_bf16 v[88:91], v[44:47], a[224:227], v[88:91]
    ds_read_b64_tr_b16 v[36:37], v5 offset:11072
    ds_read_b64_tr_b16 v[38:39], v5 offset:11584
    v_mfma_f32_16x16x32_bf16 v[92:95], v[44:47], a[228:231], v[92:95]
    buffer_load_dwordx4 v[96:99], v125, s[16:19], s57 offen sc1
    v_mfma_f32_16x16x32_bf16 v[172:175], v[48:51], a[236:239], v[172:175]
    ds_read_b64_tr_b16 v[40:41], v5 offset:9056
    s_add_u32 s100, s82, 921600
    v_mfma_f32_16x16x32_bf16 v[168:171], v[48:51], a[232:235], v[168:171]
    ds_read_b64_tr_b16 v[42:43], v5 offset:9568
    s_waitcnt lgkmcnt(8)
    v_mfma_f32_16x16x32_bf16 v[200:203], v[20:23], a[232:235], v[200:203]
    ds_read_b64_tr_b16 v[44:45], v5 offset:10080
    ds_read_b64_tr_b16 v[46:47], v5 offset:10592
    v_mfma_f32_16x16x32_bf16 v[204:207], v[20:23], a[236:239], v[204:207]
    buffer_load_dwordx4 v[248:251], v14, s[16:19], s100 offen offset:0 sc1
    v_mfma_f32_16x16x32_bf16 v[76:79], v[24:27], a[236:239], v[76:79]
    ds_read_b64_tr_b16 v[48:49], v5 offset:11104
    ds_read_b64_tr_b16 v[50:51], v5 offset:11616
    v_mfma_f32_16x16x32_bf16 v[72:75], v[24:27], a[232:235], v[72:75]
    buffer_load_dwordx4 v[252:255], v14, s[16:19], s100 offen offset:1024 sc1
    s_waitcnt lgkmcnt(8)
    v_mfma_f32_16x16x32_bf16 v[176:179], v[28:31], a[232:235], v[176:179]
    s_waitcnt vmcnt(24)
    s_barrier
    ds_read_b64_tr_b16 v[20:21], v5 offset:21408
    ds_read_b64_tr_b16 v[22:23], v5 offset:21920
    v_mfma_f32_16x16x32_bf16 v[180:183], v[28:31], a[236:239], v[180:183]
    buffer_load_dwordx4 v[100:103], v125, s[16:19], s58 offen sc1
    v_mfma_f32_16x16x32_bf16 v[212:215], v[32:35], a[236:239], v[212:215]
    ds_read_b64_tr_b16 v[24:25], v5 offset:22432
    v_mfma_f32_16x16x32_bf16 v[208:211], v[32:35], a[232:235], v[208:211]
    ds_read_b64_tr_b16 v[26:27], v5 offset:22944
    s_waitcnt lgkmcnt(8)
    v_mfma_f32_16x16x32_bf16 v[80:83], v[36:39], a[232:235], v[80:83]
    ds_read_b64_tr_b16 v[28:29], v5 offset:23456
    ds_read_b64_tr_b16 v[30:31], v5 offset:23968
    v_mfma_f32_16x16x32_bf16 v[84:87], v[36:39], a[236:239], v[84:87]
    buffer_load_dwordx4 v[104:107], v125, s[16:19], s59 offen sc1
    v_mfma_f32_16x16x32_bf16 v[188:191], v[40:43], a[236:239], v[188:191]
    ds_read_b64_tr_b16 v[32:33], v5 offset:33824
    ds_read_b64_tr_b16 v[34:35], v5 offset:34336
    v_mfma_f32_16x16x32_bf16 v[184:187], v[40:43], a[232:235], v[184:187]
    buffer_load_dwordx4 v[108:111], v125, s[16:19], s60 offen sc1
    s_waitcnt lgkmcnt(8)
    v_mfma_f32_16x16x32_bf16 v[216:219], v[44:47], a[232:235], v[216:219]
    ds_read_b64_tr_b16 v[36:37], v5 offset:34848
    ds_read_b64_tr_b16 v[38:39], v5 offset:35360
    v_mfma_f32_16x16x32_bf16 v[220:223], v[44:47], a[236:239], v[220:223]
    buffer_load_dwordx2 v[112:113], v154, s[16:19], s61 offen sc1
    v_mfma_f32_16x16x32_bf16 v[92:95], v[48:51], a[236:239], v[92:95]
    ds_read_b64_tr_b16 v[40:41], v5 offset:35872
    v_mfma_f32_16x16x32_bf16 v[88:91], v[48:51], a[232:235], v[88:91]
    ds_read_b64_tr_b16 v[42:43], v5 offset:36384
    s_waitcnt lgkmcnt(8)
    s_waitcnt vmcnt(18)
    v_mfma_f32_16x16x32_bf16 v[168:171], v[20:23], a[240:243], v[168:171]
    ds_read_b64_tr_b16 v[44:45], v5 offset:46240
    ds_read_b64_tr_b16 v[46:47], v5 offset:46752
    s_waitcnt vmcnt(17)
    v_mfma_f32_16x16x32_bf16 v[172:175], v[20:23], a[244:247], v[172:175]
    buffer_load_dwordx2 v[114:115], v154, s[16:19], s55 offen sc1
    v_mfma_f32_16x16x32_bf16 v[204:207], v[24:27], a[244:247], v[204:207]
    ds_read_b64_tr_b16 v[48:49], v5 offset:47264
    ds_read_b64_tr_b16 v[50:51], v5 offset:47776
    v_mfma_f32_16x16x32_bf16 v[200:203], v[24:27], a[240:243], v[200:203]
    buffer_load_dwordx2 v[116:117], v154, s[16:19], s62 offen sc1
    s_waitcnt lgkmcnt(8)
    v_mfma_f32_16x16x32_bf16 v[72:75], v[28:31], a[240:243], v[72:75]
    ds_read_b64_tr_b16 v[20:21], v5 offset:48288
    ds_read_b64_tr_b16 v[22:23], v5 offset:48800
    v_mfma_f32_16x16x32_bf16 v[76:79], v[28:31], a[244:247], v[76:79]
    buffer_load_dwordx2 v[118:119], v154, s[16:19], s56 offen sc1
    s_waitcnt vmcnt(18)
    v_mfma_f32_16x16x32_bf16 v[172:175], v[32:35], a[252:255], v[172:175]
    s_barrier
    ds_read_b64_tr_b16 v[24:25], v5 offset:58656
    v_mfma_f32_16x16x32_bf16 v[168:171], v[32:35], a[248:251], v[168:171]
    ds_read_b64_tr_b16 v[26:27], v5 offset:59168
    s_waitcnt lgkmcnt(8)
    v_mfma_f32_16x16x32_bf16 v[200:203], v[36:39], a[248:251], v[200:203]
    ds_read_b64_tr_b16 v[28:29], v5 offset:59680
    v_mfma_f32_16x16x32_bf16 v[204:207], v[36:39], a[252:255], v[204:207]
    ds_read_b64_tr_b16 v[30:31], v5 offset:60192
    v_mfma_f32_16x16x32_bf16 v[76:79], v[40:43], a[252:255], v[76:79]
    ds_read_b64_tr_b16 v[32:33], v5 offset:60704
    v_mfma_f32_16x16x32_bf16 v[72:75], v[40:43], a[248:251], v[72:75]
    ds_read_b64_tr_b16 v[34:35], v5 offset:61216
    s_waitcnt lgkmcnt(8)
    s_waitcnt vmcnt(17)
    v_mfma_f32_16x16x32_bf16 v[168:171], v[44:47], v[224:227], v[168:171]
    ds_read_b64_tr_b16 v[36:37], v4 offset:32
    s_waitcnt vmcnt(16)
    v_mfma_f32_16x16x32_bf16 v[172:175], v[44:47], v[228:231], v[172:175]
    ds_read_b64_tr_b16 v[38:39], v4 offset:544
    v_mfma_f32_16x16x32_bf16 v[204:207], v[48:51], v[228:231], v[204:207]
    ds_read_b64_tr_b16 v[40:41], v4 offset:1056
    v_mfma_f32_16x16x32_bf16 v[200:203], v[48:51], v[224:227], v[200:203]
    ds_read_b64_tr_b16 v[42:43], v4 offset:1568
    s_waitcnt lgkmcnt(8)
    v_mfma_f32_16x16x32_bf16 v[72:75], v[20:23], v[224:227], v[72:75]
    ds_read_b64_tr_b16 v[44:45], v4 offset:2080
    v_mfma_f32_16x16x32_bf16 v[76:79], v[20:23], v[228:231], v[76:79]
    ds_read_b64_tr_b16 v[46:47], v4 offset:2592
    s_waitcnt vmcnt(14)
    v_mfma_f32_16x16x32_bf16 v[172:175], v[24:27], v[236:239], v[172:175]
    ds_read_b64_tr_b16 v[48:49], v4 offset:12448
    v_mfma_f32_16x16x32_bf16 v[168:171], v[24:27], v[232:235], v[168:171]
    ds_read_b64_tr_b16 v[50:51], v4 offset:12960
    s_waitcnt lgkmcnt(8)
    v_mfma_f32_16x16x32_bf16 v[200:203], v[28:31], v[232:235], v[200:203]
    ds_read_b64_tr_b16 v[20:21], v4 offset:13472
    v_mfma_f32_16x16x32_bf16 v[204:207], v[28:31], v[236:239], v[204:207]
    ds_read_b64_tr_b16 v[22:23], v4 offset:13984
    v_mfma_f32_16x16x32_bf16 v[76:79], v[32:35], v[236:239], v[76:79]
    ds_read_b64_tr_b16 v[24:25], v4 offset:14496
    v_mfma_f32_16x16x32_bf16 v[72:75], v[32:35], v[232:235], v[72:75]
    ds_read_b64_tr_b16 v[26:27], v4 offset:15008
    s_waitcnt lgkmcnt(8)
    s_waitcnt vmcnt(11)
    v_mfma_f32_16x16x32_bf16 v[168:171], v[36:39], v[240:243], v[168:171]
    ds_read_b64_tr_b16 v[28:29], v5 offset:21440
    s_waitcnt vmcnt(10)
    v_mfma_f32_16x16x32_bf16 v[172:175], v[36:39], v[244:247], v[172:175]
    ds_read_b64_tr_b16 v[30:31], v5 offset:21952
    v_mfma_f32_16x16x32_bf16 v[204:207], v[40:43], v[244:247], v[204:207]
    ds_read_b64_tr_b16 v[32:33], v5 offset:22464
    v_mfma_f32_16x16x32_bf16 v[200:203], v[40:43], v[240:243], v[200:203]
    ds_read_b64_tr_b16 v[34:35], v5 offset:22976
    s_waitcnt lgkmcnt(8)
    v_mfma_f32_16x16x32_bf16 v[72:75], v[44:47], v[240:243], v[72:75]
    ds_read_b64_tr_b16 v[36:37], v5 offset:23488
    v_mfma_f32_16x16x32_bf16 v[76:79], v[44:47], v[244:247], v[76:79]
    ds_read_b64_tr_b16 v[38:39], v5 offset:24000
    s_waitcnt vmcnt(7)
    v_mfma_f32_16x16x32_bf16 v[172:175], v[48:51], v[252:255], v[172:175]
    ds_read_b64_tr_b16 v[40:41], v5 offset:33856
    v_mfma_f32_16x16x32_bf16 v[168:171], v[48:51], v[248:251], v[168:171]
    ds_read_b64_tr_b16 v[42:43], v5 offset:34368
    s_waitcnt lgkmcnt(8)
    v_mfma_f32_16x16x32_bf16 v[200:203], v[20:23], v[248:251], v[200:203]
    ds_read_b64_tr_b16 v[44:45], v5 offset:34880
    v_mfma_f32_16x16x32_bf16 v[204:207], v[20:23], v[252:255], v[204:207]
    ds_read_b64_tr_b16 v[46:47], v5 offset:35392
    v_mfma_f32_16x16x32_bf16 v[76:79], v[24:27], v[252:255], v[76:79]
    ds_read_b64_tr_b16 v[48:49], v5 offset:35904
    v_cvt_pk_bf16_f32 v168, v168, v169
    v_cvt_pk_bf16_f32 v169, v170, v171
    v_mfma_f32_16x16x32_bf16 v[72:75], v[24:27], v[248:251], v[72:75]
    ds_read_b64_tr_b16 v[50:51], v5 offset:36416
    v_cvt_pk_bf16_f32 v170, v172, v173
    s_waitcnt lgkmcnt(8)
    v_mfma_f32_16x16x32_bf16 v[176:179], v[28:31], a[240:243], v[176:179]
    ds_read_b64_tr_b16 v[20:21], v5 offset:46272
    v_mov_b32 v171, s66
    v_mfma_f32_16x16x32_bf16 v[180:183], v[28:31], a[244:247], v[180:183]
    ds_read_b64_tr_b16 v[22:23], v5 offset:46784
    v_mfma_f32_16x16x32_bf16 v[212:215], v[32:35], a[244:247], v[212:215]
    ds_read_b64_tr_b16 v[24:25], v5 offset:47296
    ds_read_b64_tr_b16 v[26:27], v5 offset:47808
    v_mfma_f32_16x16x32_bf16 v[208:211], v[32:35], a[240:243], v[208:211]
    buffer_store_dwordx4 v[168:171], v19, s[16:19], s49 offen offset:0 sc1
    s_waitcnt lgkmcnt(8)
    v_mfma_f32_16x16x32_bf16 v[80:83], v[36:39], a[240:243], v[80:83]
    ds_read_b64_tr_b16 v[28:29], v5 offset:48320
    v_cvt_pk_bf16_f32 v52, v174, v175
    v_cvt_pk_bf16_f32 v200, v200, v201
    v_mfma_f32_16x16x32_bf16 v[84:87], v[36:39], a[244:247], v[84:87]
    ds_read_b64_tr_b16 v[30:31], v5 offset:48832
    v_cvt_pk_bf16_f32 v201, v202, v203
    v_cvt_pk_bf16_f32 v202, v204, v205
    v_mfma_f32_16x16x32_bf16 v[180:183], v[40:43], a[252:255], v[180:183]
    ds_read_b64_tr_b16 v[32:33], v5 offset:58688
    v_mov_b32 v203, s66
    v_mfma_f32_16x16x32_bf16 v[176:179], v[40:43], a[248:251], v[176:179]
    ds_read_b64_tr_b16 v[34:35], v5 offset:59200
    s_waitcnt lgkmcnt(8)
    v_mfma_f32_16x16x32_bf16 v[208:211], v[44:47], a[248:251], v[208:211]
    ds_read_b64_tr_b16 v[36:37], v5 offset:59712
    ds_read_b64_tr_b16 v[38:39], v5 offset:60224
    v_mfma_f32_16x16x32_bf16 v[212:215], v[44:47], a[252:255], v[212:215]
    buffer_store_dwordx4 v[200:203], v19, s[16:19], s49 offen offset:1024 sc1
    v_mfma_f32_16x16x32_bf16 v[84:87], v[48:51], a[252:255], v[84:87]
    ds_read_b64_tr_b16 v[40:41], v5 offset:60736
    v_cvt_pk_bf16_f32 v53, v206, v207
    v_cvt_pk_bf16_f32 v72, v72, v73
    v_mfma_f32_16x16x32_bf16 v[80:83], v[48:51], a[248:251], v[80:83]
    ds_read_b64_tr_b16 v[42:43], v5 offset:61248
    v_cvt_pk_bf16_f32 v73, v74, v75
    s_waitcnt lgkmcnt(8)
    v_mfma_f32_16x16x32_bf16 v[176:179], v[20:23], v[224:227], v[176:179]
    ds_read_b64_tr_b16 v[44:45], v4 offset:64
    v_cvt_pk_bf16_f32 v74, v76, v77
    v_mov_b32 v75, s66
    v_mfma_f32_16x16x32_bf16 v[180:183], v[20:23], v[228:231], v[180:183]
    ds_read_b64_tr_b16 v[46:47], v4 offset:576
    v_mfma_f32_16x16x32_bf16 v[212:215], v[24:27], v[228:231], v[212:215]
    ds_read_b64_tr_b16 v[48:49], v4 offset:1088
    ds_read_b64_tr_b16 v[50:51], v4 offset:1600
    v_mfma_f32_16x16x32_bf16 v[208:211], v[24:27], v[224:227], v[208:211]
    buffer_store_dwordx4 v[72:75], v19, s[16:19], s49 offen offset:2048 sc1
    s_waitcnt lgkmcnt(8)
    v_mfma_f32_16x16x32_bf16 v[80:83], v[28:31], v[224:227], v[80:83]
    ds_read_b64_tr_b16 v[20:21], v4 offset:2112
    v_cvt_pk_bf16_f32 v54, v78, v79
    v_mfma_f32_16x16x32_bf16 v[84:87], v[28:31], v[228:231], v[84:87]
    ds_read_b64_tr_b16 v[22:23], v4 offset:2624
    v_mfma_f32_16x16x32_bf16 v[180:183], v[32:35], v[236:239], v[180:183]
    ds_read_b64_tr_b16 v[24:25], v4 offset:12480
    ds_read_b64_tr_b16 v[26:27], v4 offset:12992
    v_mfma_f32_16x16x32_bf16 v[176:179], v[32:35], v[232:235], v[176:179]
    buffer_store_dwordx4 v[52:55], v19, s[16:19], s49 offen offset:3072 sc1
    s_waitcnt lgkmcnt(8)
    v_mfma_f32_16x16x32_bf16 v[208:211], v[36:39], v[232:235], v[208:211]
    ds_read_b64_tr_b16 v[28:29], v4 offset:13504
    v_mfma_f32_16x16x32_bf16 v[212:215], v[36:39], v[236:239], v[212:215]
    ds_read_b64_tr_b16 v[30:31], v4 offset:14016
    v_mfma_f32_16x16x32_bf16 v[84:87], v[40:43], v[236:239], v[84:87]
    ds_read_b64_tr_b16 v[32:33], v4 offset:14528
    v_mfma_f32_16x16x32_bf16 v[80:83], v[40:43], v[232:235], v[80:83]
    ds_read_b64_tr_b16 v[34:35], v4 offset:15040
    s_waitcnt lgkmcnt(8)
    v_mfma_f32_16x16x32_bf16 v[176:179], v[44:47], v[240:243], v[176:179]
    ds_read_b64_tr_b16 v[36:37], v5 offset:21472
    v_mfma_f32_16x16x32_bf16 v[180:183], v[44:47], v[244:247], v[180:183]
    ds_read_b64_tr_b16 v[38:39], v5 offset:21984
    v_mfma_f32_16x16x32_bf16 v[212:215], v[48:51], v[244:247], v[212:215]
    ds_read_b64_tr_b16 v[40:41], v5 offset:22496
    v_mfma_f32_16x16x32_bf16 v[208:211], v[48:51], v[240:243], v[208:211]
    ds_read_b64_tr_b16 v[42:43], v5 offset:23008
    s_waitcnt lgkmcnt(8)
    v_mfma_f32_16x16x32_bf16 v[80:83], v[20:23], v[240:243], v[80:83]
    ds_read_b64_tr_b16 v[44:45], v5 offset:23520
    v_mfma_f32_16x16x32_bf16 v[84:87], v[20:23], v[244:247], v[84:87]
    ds_read_b64_tr_b16 v[46:47], v5 offset:24032
    v_mfma_f32_16x16x32_bf16 v[180:183], v[24:27], v[252:255], v[180:183]
    ds_read_b64_tr_b16 v[48:49], v5 offset:33888
    v_mfma_f32_16x16x32_bf16 v[176:179], v[24:27], v[248:251], v[176:179]
    ds_read_b64_tr_b16 v[50:51], v5 offset:34400
    s_waitcnt lgkmcnt(8)
    v_mfma_f32_16x16x32_bf16 v[208:211], v[28:31], v[248:251], v[208:211]
    ds_read_b64_tr_b16 v[20:21], v5 offset:34912
    v_mfma_f32_16x16x32_bf16 v[212:215], v[28:31], v[252:255], v[212:215]
    ds_read_b64_tr_b16 v[22:23], v5 offset:35424
    v_mfma_f32_16x16x32_bf16 v[84:87], v[32:35], v[252:255], v[84:87]
    ds_read_b64_tr_b16 v[24:25], v5 offset:35936
    v_cvt_pk_bf16_f32 v176, v176, v177
    v_cvt_pk_bf16_f32 v177, v178, v179
    v_mfma_f32_16x16x32_bf16 v[80:83], v[32:35], v[248:251], v[80:83]
    ds_read_b64_tr_b16 v[26:27], v5 offset:36448
    v_cvt_pk_bf16_f32 v178, v180, v181
    s_waitcnt lgkmcnt(8)
    v_mfma_f32_16x16x32_bf16 v[184:187], v[36:39], a[240:243], v[184:187]
    ds_read_b64_tr_b16 v[28:29], v5 offset:46304
    v_mov_b32 v179, s66
    v_mfma_f32_16x16x32_bf16 v[188:191], v[36:39], a[244:247], v[188:191]
    ds_read_b64_tr_b16 v[30:31], v5 offset:46816
    v_mfma_f32_16x16x32_bf16 v[220:223], v[40:43], a[244:247], v[220:223]
    ds_read_b64_tr_b16 v[32:33], v5 offset:47328
    ds_read_b64_tr_b16 v[34:35], v5 offset:47840
    v_mfma_f32_16x16x32_bf16 v[216:219], v[40:43], a[240:243], v[216:219]
    buffer_store_dwordx4 v[176:179], v19, s[16:19], s50 offen offset:0 sc1
    s_waitcnt lgkmcnt(8)
    v_mfma_f32_16x16x32_bf16 v[88:91], v[44:47], a[240:243], v[88:91]
    ds_read_b64_tr_b16 v[36:37], v5 offset:48352
    v_cvt_pk_bf16_f32 v56, v182, v183
    v_cvt_pk_bf16_f32 v208, v208, v209
    v_mfma_f32_16x16x32_bf16 v[92:95], v[44:47], a[244:247], v[92:95]
    ds_read_b64_tr_b16 v[38:39], v5 offset:48864
    v_cvt_pk_bf16_f32 v209, v210, v211
    v_cvt_pk_bf16_f32 v210, v212, v213
    v_mfma_f32_16x16x32_bf16 v[188:191], v[48:51], a[252:255], v[188:191]
    ds_read_b64_tr_b16 v[40:41], v5 offset:58720
    v_mov_b32 v211, s66
    v_mfma_f32_16x16x32_bf16 v[184:187], v[48:51], a[248:251], v[184:187]
    ds_read_b64_tr_b16 v[42:43], v5 offset:59232
    s_waitcnt lgkmcnt(8)
    v_mfma_f32_16x16x32_bf16 v[216:219], v[20:23], a[248:251], v[216:219]
    ds_read_b64_tr_b16 v[44:45], v5 offset:59744
    ds_read_b64_tr_b16 v[46:47], v5 offset:60256
    v_mfma_f32_16x16x32_bf16 v[220:223], v[20:23], a[252:255], v[220:223]
    buffer_store_dwordx4 v[208:211], v19, s[16:19], s50 offen offset:1024 sc1
    v_mfma_f32_16x16x32_bf16 v[92:95], v[24:27], a[252:255], v[92:95]
    ds_read_b64_tr_b16 v[48:49], v5 offset:60768
    v_cvt_pk_bf16_f32 v57, v214, v215
    v_cvt_pk_bf16_f32 v80, v80, v81
    v_mfma_f32_16x16x32_bf16 v[88:91], v[24:27], a[248:251], v[88:91]
    ds_read_b64_tr_b16 v[50:51], v5 offset:61280
    v_cvt_pk_bf16_f32 v81, v82, v83
    s_waitcnt lgkmcnt(8)
    v_mfma_f32_16x16x32_bf16 v[184:187], v[28:31], v[224:227], v[184:187]
    ds_read_b64_tr_b16 v[20:21], v4 offset:96
    v_cvt_pk_bf16_f32 v82, v84, v85
    v_mov_b32 v83, s66
    v_mfma_f32_16x16x32_bf16 v[188:191], v[28:31], v[228:231], v[188:191]
    ds_read_b64_tr_b16 v[22:23], v4 offset:608
    v_mfma_f32_16x16x32_bf16 v[220:223], v[32:35], v[228:231], v[220:223]
    ds_read_b64_tr_b16 v[24:25], v4 offset:1120
    ds_read_b64_tr_b16 v[26:27], v4 offset:1632
    v_mfma_f32_16x16x32_bf16 v[216:219], v[32:35], v[224:227], v[216:219]
    buffer_store_dwordx4 v[80:83], v19, s[16:19], s50 offen offset:2048 sc1
    s_waitcnt lgkmcnt(8)
    v_mfma_f32_16x16x32_bf16 v[88:91], v[36:39], v[224:227], v[88:91]
    ds_read_b64_tr_b16 v[28:29], v4 offset:2144
    v_cvt_pk_bf16_f32 v58, v86, v87
    v_mfma_f32_16x16x32_bf16 v[92:95], v[36:39], v[228:231], v[92:95]
    ds_read_b64_tr_b16 v[30:31], v4 offset:2656
    v_mfma_f32_16x16x32_bf16 v[188:191], v[40:43], v[236:239], v[188:191]
    ds_read_b64_tr_b16 v[32:33], v4 offset:12512
    ds_read_b64_tr_b16 v[34:35], v4 offset:13024
    v_mfma_f32_16x16x32_bf16 v[184:187], v[40:43], v[232:235], v[184:187]
    buffer_store_dwordx4 v[56:59], v19, s[16:19], s50 offen offset:3072 sc1
    s_waitcnt lgkmcnt(8)
    v_mfma_f32_16x16x32_bf16 v[216:219], v[44:47], v[232:235], v[216:219]
    ds_read_b64_tr_b16 v[36:37], v4 offset:13536
    v_mfma_f32_16x16x32_bf16 v[220:223], v[44:47], v[236:239], v[220:223]
    ds_read_b64_tr_b16 v[38:39], v4 offset:14048
    v_mfma_f32_16x16x32_bf16 v[92:95], v[48:51], v[236:239], v[92:95]
    ds_read_b64_tr_b16 v[40:41], v4 offset:14560
    v_mfma_f32_16x16x32_bf16 v[88:91], v[48:51], v[232:235], v[88:91]
    ds_read_b64_tr_b16 v[42:43], v4 offset:15072
    s_waitcnt lgkmcnt(8)
    v_mfma_f32_16x16x32_bf16 v[184:187], v[20:23], v[240:243], v[184:187]
    ds_read_b64_tr_b16 v[44:45], v6 offset:17920
    v_mfma_f32_16x16x32_bf16 v[188:191], v[20:23], v[244:247], v[188:191]
    ds_read_b64_tr_b16 v[46:47], v6 offset:18432
    v_mfma_f32_16x16x32_bf16 v[220:223], v[24:27], v[244:247], v[220:223]
    ds_read_b64_tr_b16 v[48:49], v6 offset:18944
    v_mfma_f32_16x16x32_bf16 v[216:219], v[24:27], v[240:243], v[216:219]
    ds_read_b64_tr_b16 v[50:51], v6 offset:19456
    s_waitcnt lgkmcnt(8)
    v_mfma_f32_16x16x32_bf16 v[88:91], v[28:31], v[240:243], v[88:91]
    ds_read_b64_tr_b16 v[20:21], v6 offset:19968
    v_mfma_f32_16x16x32_bf16 v[92:95], v[28:31], v[244:247], v[92:95]
    ds_read_b64_tr_b16 v[22:23], v6 offset:20480
    v_mfma_f32_16x16x32_bf16 v[188:191], v[32:35], v[252:255], v[188:191]
    ds_read_b64_tr_b16 v[24:25], v4 offset:49664
    v_mfma_f32_16x16x32_bf16 v[184:187], v[32:35], v[248:251], v[184:187]
    ds_read_b64_tr_b16 v[26:27], v4 offset:50176
    s_waitcnt lgkmcnt(8)
    v_mfma_f32_16x16x32_bf16 v[216:219], v[36:39], v[248:251], v[216:219]
    ds_read_b64_tr_b16 v[28:29], v4 offset:50688
    v_mfma_f32_16x16x32_bf16 v[220:223], v[36:39], v[252:255], v[220:223]
    ds_read_b64_tr_b16 v[30:31], v4 offset:51200
    v_mfma_f32_16x16x32_bf16 v[92:95], v[40:43], v[252:255], v[92:95]
    ds_read_b64_tr_b16 v[32:33], v4 offset:51712
    v_cvt_pk_bf16_f32 v184, v184, v185
    v_cvt_pk_bf16_f32 v185, v186, v187
    v_mfma_f32_16x16x32_bf16 v[88:91], v[40:43], v[248:251], v[88:91]
    ds_read_b64_tr_b16 v[34:35], v4 offset:52224
    v_cvt_pk_bf16_f32 v186, v188, v189
    s_waitcnt lgkmcnt(8)
    v_mfma_f32_16x16x32_bf16 v[160:163], v[44:47], a[208:211], v[160:163]
    ds_read_b64_tr_b16 v[36:37], v4 offset:62080
    v_mov_b32 v187, s66
    v_mfma_f32_16x16x32_bf16 v[164:167], v[44:47], a[212:215], v[164:167]
    ds_read_b64_tr_b16 v[38:39], v4 offset:62592
    v_mfma_f32_16x16x32_bf16 v[196:199], v[48:51], a[212:215], v[196:199]
    ds_read_b64_tr_b16 v[40:41], v4 offset:63104
    ds_read_b64_tr_b16 v[42:43], v4 offset:63616
    v_mfma_f32_16x16x32_bf16 v[192:195], v[48:51], a[208:211], v[192:195]
    buffer_store_dwordx4 v[184:187], v19, s[16:19], s51 offen offset:0 sc1
    s_waitcnt lgkmcnt(8)
    v_mfma_f32_16x16x32_bf16 v[64:67], v[20:23], a[208:211], v[64:67]
    ds_read_b64_tr_b16 v[44:45], v4 offset:64128
    v_cvt_pk_bf16_f32 v60, v190, v191
    v_cvt_pk_bf16_f32 v216, v216, v217
    v_mfma_f32_16x16x32_bf16 v[68:71], v[20:23], a[212:215], v[68:71]
    ds_read_b64_tr_b16 v[46:47], v4 offset:64640
    v_cvt_pk_bf16_f32 v217, v218, v219
    v_cvt_pk_bf16_f32 v218, v220, v221
    v_mfma_f32_16x16x32_bf16 v[164:167], v[24:27], a[220:223], v[164:167]
    ds_read_b64_tr_b16 v[48:49], v5 offset:8960
    v_mov_b32 v219, s66
    v_mfma_f32_16x16x32_bf16 v[160:163], v[24:27], a[216:219], v[160:163]
    ds_read_b64_tr_b16 v[50:51], v5 offset:9472
    s_waitcnt lgkmcnt(8)
    v_mfma_f32_16x16x32_bf16 v[192:195], v[28:31], a[216:219], v[192:195]
    ds_read_b64_tr_b16 v[20:21], v5 offset:9984
    ds_read_b64_tr_b16 v[22:23], v5 offset:10496
    v_mfma_f32_16x16x32_bf16 v[196:199], v[28:31], a[220:223], v[196:199]
    buffer_store_dwordx4 v[216:219], v19, s[16:19], s51 offen offset:1024 sc1
    v_mfma_f32_16x16x32_bf16 v[68:71], v[32:35], a[220:223], v[68:71]
    ds_read_b64_tr_b16 v[24:25], v5 offset:11008
    v_cvt_pk_bf16_f32 v61, v222, v223
    v_cvt_pk_bf16_f32 v88, v88, v89
    v_mfma_f32_16x16x32_bf16 v[64:67], v[32:35], a[216:219], v[64:67]
    ds_read_b64_tr_b16 v[26:27], v5 offset:11520
    v_cvt_pk_bf16_f32 v89, v90, v91
    s_waitcnt lgkmcnt(8)
    v_mfma_f32_16x16x32_bf16 v[160:163], v[36:39], a[224:227], v[160:163]
    ds_read_b64_tr_b16 v[28:29], v5 offset:21376
    v_cvt_pk_bf16_f32 v90, v92, v93
    v_mov_b32 v91, s66
    v_mfma_f32_16x16x32_bf16 v[164:167], v[36:39], a[228:231], v[164:167]
    ds_read_b64_tr_b16 v[30:31], v5 offset:21888
    v_mfma_f32_16x16x32_bf16 v[196:199], v[40:43], a[228:231], v[196:199]
    ds_read_b64_tr_b16 v[32:33], v5 offset:22400
    ds_read_b64_tr_b16 v[34:35], v5 offset:22912
    v_mfma_f32_16x16x32_bf16 v[192:195], v[40:43], a[224:227], v[192:195]
    buffer_store_dwordx4 v[88:91], v19, s[16:19], s51 offen offset:2048 sc1
    s_waitcnt lgkmcnt(8)
    v_mfma_f32_16x16x32_bf16 v[64:67], v[44:47], a[224:227], v[64:67]
    ds_read_b64_tr_b16 v[36:37], v5 offset:23424
    v_cvt_pk_bf16_f32 v62, v94, v95
    v_mfma_f32_16x16x32_bf16 v[68:71], v[44:47], a[228:231], v[68:71]
    ds_read_b64_tr_b16 v[38:39], v5 offset:23936
    v_mfma_f32_16x16x32_bf16 v[164:167], v[48:51], a[236:239], v[164:167]
    ds_read_b64_tr_b16 v[40:41], v5 offset:33792
    ds_read_b64_tr_b16 v[42:43], v5 offset:34304
    v_mfma_f32_16x16x32_bf16 v[160:163], v[48:51], a[232:235], v[160:163]
    buffer_store_dwordx4 v[60:63], v19, s[16:19], s51 offen offset:3072 sc1
    s_waitcnt lgkmcnt(8)
    v_mfma_f32_16x16x32_bf16 v[192:195], v[20:23], a[232:235], v[192:195]
    ds_read_b64_tr_b16 v[44:45], v5 offset:34816
    v_mfma_f32_16x16x32_bf16 v[196:199], v[20:23], a[236:239], v[196:199]
    ds_read_b64_tr_b16 v[46:47], v5 offset:35328
    v_mfma_f32_16x16x32_bf16 v[68:71], v[24:27], a[236:239], v[68:71]
    ds_read_b64_tr_b16 v[48:49], v5 offset:35840
    v_mfma_f32_16x16x32_bf16 v[64:67], v[24:27], a[232:235], v[64:67]
    ds_read_b64_tr_b16 v[50:51], v5 offset:36352
    s_waitcnt lgkmcnt(8)
    v_mfma_f32_16x16x32_bf16 v[160:163], v[28:31], a[240:243], v[160:163]
    ds_read_b64_tr_b16 v[20:21], v5 offset:46208
    v_mfma_f32_16x16x32_bf16 v[164:167], v[28:31], a[244:247], v[164:167]
    ds_read_b64_tr_b16 v[22:23], v5 offset:46720
    v_mfma_f32_16x16x32_bf16 v[196:199], v[32:35], a[244:247], v[196:199]
    ds_read_b64_tr_b16 v[24:25], v5 offset:47232
    v_mfma_f32_16x16x32_bf16 v[192:195], v[32:35], a[240:243], v[192:195]
    ds_read_b64_tr_b16 v[26:27], v5 offset:47744
    s_waitcnt lgkmcnt(8)
    v_mfma_f32_16x16x32_bf16 v[64:67], v[36:39], a[240:243], v[64:67]
    ds_read_b64_tr_b16 v[28:29], v5 offset:48256
    v_mfma_f32_16x16x32_bf16 v[68:71], v[36:39], a[244:247], v[68:71]
    ds_read_b64_tr_b16 v[30:31], v5 offset:48768
    v_mfma_f32_16x16x32_bf16 v[164:167], v[40:43], a[252:255], v[164:167]
    ds_read_b64_tr_b16 v[32:33], v5 offset:58624
    v_mfma_f32_16x16x32_bf16 v[160:163], v[40:43], a[248:251], v[160:163]
    ds_read_b64_tr_b16 v[34:35], v5 offset:59136
    s_waitcnt lgkmcnt(8)
    v_mfma_f32_16x16x32_bf16 v[192:195], v[44:47], a[248:251], v[192:195]
    ds_read_b64_tr_b16 v[36:37], v5 offset:59648
    v_mfma_f32_16x16x32_bf16 v[196:199], v[44:47], a[252:255], v[196:199]
    ds_read_b64_tr_b16 v[38:39], v5 offset:60160
    v_mfma_f32_16x16x32_bf16 v[68:71], v[48:51], a[252:255], v[68:71]
    ds_read_b64_tr_b16 v[40:41], v5 offset:60672
    v_mfma_f32_16x16x32_bf16 v[64:67], v[48:51], a[248:251], v[64:67]
    ds_read_b64_tr_b16 v[42:43], v5 offset:61184
    s_waitcnt lgkmcnt(8)
    v_mfma_f32_16x16x32_bf16 v[160:163], v[20:23], v[224:227], v[160:163]
    ds_read_b64_tr_b16 v[44:45], v4 offset:0
    v_mfma_f32_16x16x32_bf16 v[164:167], v[20:23], v[228:231], v[164:167]
    ds_read_b64_tr_b16 v[46:47], v4 offset:512
    v_mfma_f32_16x16x32_bf16 v[196:199], v[24:27], v[228:231], v[196:199]
    ds_read_b64_tr_b16 v[48:49], v4 offset:1024
    v_mfma_f32_16x16x32_bf16 v[192:195], v[24:27], v[224:227], v[192:195]
    ds_read_b64_tr_b16 v[50:51], v4 offset:1536
    s_waitcnt lgkmcnt(8)
    v_mfma_f32_16x16x32_bf16 v[64:67], v[28:31], v[224:227], v[64:67]
    ds_read_b64_tr_b16 v[20:21], v4 offset:2048
    v_mfma_f32_16x16x32_bf16 v[68:71], v[28:31], v[228:231], v[68:71]
    ds_read_b64_tr_b16 v[22:23], v4 offset:2560
    v_mfma_f32_16x16x32_bf16 v[164:167], v[32:35], v[236:239], v[164:167]
    ds_read_b64_tr_b16 v[24:25], v4 offset:12416
    v_mfma_f32_16x16x32_bf16 v[160:163], v[32:35], v[232:235], v[160:163]
    ds_read_b64_tr_b16 v[26:27], v4 offset:12928
    s_waitcnt lgkmcnt(8)
    v_mfma_f32_16x16x32_bf16 v[192:195], v[36:39], v[232:235], v[192:195]
    ds_read_b64_tr_b16 v[28:29], v4 offset:13440
    v_mfma_f32_16x16x32_bf16 v[196:199], v[36:39], v[236:239], v[196:199]
    ds_read_b64_tr_b16 v[30:31], v4 offset:13952
    v_mfma_f32_16x16x32_bf16 v[68:71], v[40:43], v[236:239], v[68:71]
    ds_read_b64_tr_b16 v[32:33], v4 offset:14464
    ds_read_b64_tr_b16 v[34:35], v4 offset:14976
    v_mfma_f32_16x16x32_bf16 v[64:67], v[40:43], v[232:235], v[64:67]
    buffer_load_dwordx4 v[172:175], v127, s[16:19], 0 offen offset:0 sc1
    s_waitcnt lgkmcnt(8)
    v_mfma_f32_16x16x32_bf16 v[160:163], v[44:47], v[240:243], v[160:163]
    v_mfma_f32_16x16x32_bf16 v[164:167], v[44:47], v[244:247], v[164:167]
    buffer_load_dwordx4 v[204:207], v127, s[16:19], 0 offen offset:1024 sc1
    v_mfma_f32_16x16x32_bf16 v[196:199], v[48:51], v[244:247], v[196:199]
    v_mfma_f32_16x16x32_bf16 v[192:195], v[48:51], v[240:243], v[192:195]
    buffer_load_dwordx4 v[76:79], v127, s[16:19], 0 offen offset:2048 sc1
    s_waitcnt lgkmcnt(4)
    v_mfma_f32_16x16x32_bf16 v[64:67], v[20:23], v[240:243], v[64:67]
    v_mfma_f32_16x16x32_bf16 v[68:71], v[20:23], v[244:247], v[68:71]
    buffer_load_dwordx4 v[52:55], v127, s[16:19], 0 offen offset:3072 sc1
    v_mfma_f32_16x16x32_bf16 v[164:167], v[24:27], v[252:255], v[164:167]
    v_mfma_f32_16x16x32_bf16 v[160:163], v[24:27], v[248:251], v[160:163]
    s_waitcnt lgkmcnt(0)
    v_mfma_f32_16x16x32_bf16 v[192:195], v[28:31], v[248:251], v[192:195]
    v_mfma_f32_16x16x32_bf16 v[196:199], v[28:31], v[252:255], v[196:199]
    v_mfma_f32_16x16x32_bf16 v[68:71], v[32:35], v[252:255], v[68:71]
    v_mfma_f32_16x16x32_bf16 v[64:67], v[32:35], v[248:251], v[64:67]
    v_mfma_f32_16x16x32_bf16 v[160:163], a[0:3], a[144:147], v[160:163]
    v_mfma_f32_16x16x32_bf16 v[164:167], a[0:3], a[148:151], v[164:167]
    v_mfma_f32_16x16x32_bf16 v[196:199], a[4:7], a[148:151], v[196:199]
    v_mfma_f32_16x16x32_bf16 v[192:195], a[4:7], a[144:147], v[192:195]
    v_mfma_f32_16x16x32_bf16 v[64:67], a[8:11], a[144:147], v[64:67]
    v_mfma_f32_16x16x32_bf16 v[68:71], a[8:11], a[148:151], v[68:71]
    v_mfma_f32_16x16x32_bf16 v[164:167], a[12:15], a[156:159], v[164:167]
    v_mfma_f32_16x16x32_bf16 v[160:163], a[12:15], a[152:155], v[160:163]
    v_mfma_f32_16x16x32_bf16 v[192:195], a[16:19], a[152:155], v[192:195]
    v_mfma_f32_16x16x32_bf16 v[196:199], a[16:19], a[156:159], v[196:199]
    v_mfma_f32_16x16x32_bf16 v[68:71], a[20:23], a[156:159], v[68:71]
    v_mfma_f32_16x16x32_bf16 v[64:67], a[20:23], a[152:155], v[64:67]
    v_mfma_f32_16x16x32_bf16 v[160:163], a[24:27], a[160:163], v[160:163]
    v_mfma_f32_16x16x32_bf16 v[164:167], a[24:27], a[164:167], v[164:167]
    v_mfma_f32_16x16x32_bf16 v[196:199], a[28:31], a[164:167], v[196:199]
    v_mfma_f32_16x16x32_bf16 v[192:195], a[28:31], a[160:163], v[192:195]
    v_mfma_f32_16x16x32_bf16 v[64:67], a[32:35], a[160:163], v[64:67]
    v_mfma_f32_16x16x32_bf16 v[68:71], a[32:35], a[164:167], v[68:71]
    v_mfma_f32_16x16x32_bf16 v[164:167], a[36:39], a[172:175], v[164:167]
    v_mfma_f32_16x16x32_bf16 v[160:163], a[36:39], a[168:171], v[160:163]
    v_mfma_f32_16x16x32_bf16 v[192:195], a[40:43], a[168:171], v[192:195]
    v_mfma_f32_16x16x32_bf16 v[196:199], a[40:43], a[172:175], v[196:199]
    v_mfma_f32_16x16x32_bf16 v[68:71], a[44:47], a[172:175], v[68:71]
    v_mfma_f32_16x16x32_bf16 v[64:67], a[44:47], a[168:171], v[64:67]
    buffer_load_dwordx4 v[180:183], v127, s[16:19], s63 offen offset:0 sc1
    v_mfma_f32_16x16x32_bf16 v[160:163], a[48:51], a[176:179], v[160:163]
    v_mfma_f32_16x16x32_bf16 v[164:167], a[48:51], a[180:183], v[164:167]
    buffer_load_dwordx4 v[212:215], v127, s[16:19], s63 offen offset:1024 sc1
    v_mfma_f32_16x16x32_bf16 v[196:199], a[52:55], a[180:183], v[196:199]
    v_mfma_f32_16x16x32_bf16 v[192:195], a[52:55], a[176:179], v[192:195]
    buffer_load_dwordx4 v[84:87], v127, s[16:19], s63 offen offset:2048 sc1
    v_mfma_f32_16x16x32_bf16 v[64:67], a[56:59], a[176:179], v[64:67]
    v_mfma_f32_16x16x32_bf16 v[68:71], a[56:59], a[180:183], v[68:71]
    buffer_load_dwordx4 v[56:59], v127, s[16:19], s63 offen offset:3072 sc1
    v_mfma_f32_16x16x32_bf16 v[164:167], a[60:63], a[188:191], v[164:167]
    v_mfma_f32_16x16x32_bf16 v[160:163], a[60:63], a[184:187], v[160:163]
    v_mfma_f32_16x16x32_bf16 v[192:195], a[64:67], a[184:187], v[192:195]
    v_mfma_f32_16x16x32_bf16 v[196:199], a[64:67], a[188:191], v[196:199]
    v_mfma_f32_16x16x32_bf16 v[68:71], a[68:71], a[188:191], v[68:71]
    v_mfma_f32_16x16x32_bf16 v[64:67], a[68:71], a[184:187], v[64:67]
    v_mfma_f32_16x16x32_bf16 v[160:163], a[72:75], a[192:195], v[160:163]
    v_mfma_f32_16x16x32_bf16 v[164:167], a[72:75], a[196:199], v[164:167]
    v_mfma_f32_16x16x32_bf16 v[196:199], a[76:79], a[196:199], v[196:199]
    v_mfma_f32_16x16x32_bf16 v[192:195], a[76:79], a[192:195], v[192:195]
    buffer_load_dwordx4 v[188:191], v127, s[16:19], s64 offen offset:0 sc1
    v_mfma_f32_16x16x32_bf16 v[64:67], a[80:83], a[192:195], v[64:67]
    v_mfma_f32_16x16x32_bf16 v[68:71], a[80:83], a[196:199], v[68:71]
    buffer_load_dwordx4 v[220:223], v127, s[16:19], s64 offen offset:1024 sc1
    v_mfma_f32_16x16x32_bf16 v[164:167], a[84:87], a[204:207], v[164:167]
    v_mfma_f32_16x16x32_bf16 v[160:163], a[84:87], a[200:203], v[160:163]
    buffer_load_dwordx4 v[92:95], v127, s[16:19], s64 offen offset:2048 sc1
    v_mfma_f32_16x16x32_bf16 v[192:195], a[88:91], a[200:203], v[192:195]
    v_mfma_f32_16x16x32_bf16 v[196:199], a[88:91], a[204:207], v[196:199]
    buffer_load_dwordx4 v[60:63], v127, s[16:19], s64 offen offset:3072 sc1
    v_mfma_f32_16x16x32_bf16 v[68:71], a[92:95], a[204:207], v[68:71]
    v_mfma_f32_16x16x32_bf16 v[64:67], a[92:95], a[200:203], v[64:67]
    s_mov_b32 s101, 30000
L_chk_ya:
    v_xor_b32 v155, s66, v120
    v_bitop3_b32 v155, v121, s66, v155 bitop3:0xbe
    v_bitop3_b32 v155, v96, s66, v155 bitop3:0xbe
    v_bitop3_b32 v155, v97, s66, v155 bitop3:0xbe
    v_bitop3_b32 v155, v98, s66, v155 bitop3:0xbe
    v_bitop3_b32 v155, v99, s66, v155 bitop3:0xbe
    s_waitcnt vmcnt(30)
    v_bitop3_b32 v155, v100, s66, v155 bitop3:0xbe
    v_bitop3_b32 v155, v101, s66, v155 bitop3:0xbe
    v_bitop3_b32 v155, v102, s66, v155 bitop3:0xbe
    v_bitop3_b32 v155, v103, s66, v155 bitop3:0xbe
    s_waitcnt vmcnt(29)
    v_bitop3_b32 v155, v104, s66, v155 bitop3:0xbe
    v_bitop3_b32 v155, v105, s66, v155 bitop3:0xbe
    v_bitop3_b32 v155, v106, s66, v155 bitop3:0xbe
    v_bitop3_b32 v155, v107, s66, v155 bitop3:0xbe
    s_waitcnt vmcnt(28)
    v_bitop3_b32 v155, v108, s66, v155 bitop3:0xbe
    v_bitop3_b32 v155, v109, s66, v155 bitop3:0xbe
    v_bitop3_b32 v155, v110, s66, v155 bitop3:0xbe
    v_bitop3_b32 v155, v111, s66, v155 bitop3:0xbe
    s_waitcnt vmcnt(27)
    v_bitop3_b32 v155, v112, s66, v155 bitop3:0xbe
    v_bitop3_b32 v155, v113, s66, v155 bitop3:0xbe
    s_waitcnt vmcnt(26)
    v_bitop3_b32 v155, v114, s66, v155 bitop3:0xbe
    v_bitop3_b32 v155, v115, s66, v155 bitop3:0xbe
    s_waitcnt vmcnt(25)
    v_bitop3_b32 v155, v116, s66, v155 bitop3:0xbe
    v_bitop3_b32 v155, v117, s66, v155 bitop3:0xbe
    s_waitcnt vmcnt(24)
    v_bitop3_b32 v155, v118, s66, v155 bitop3:0xbe
    v_bitop3_b32 v155, v119, s66, v155 bitop3:0xbe
    v_and_b32 v155, 0xffff, v155
    v_cmp_ne_u32 vcc, 0, v155
    s_cbranch_vccnz L_retry_ya
L_ok_ya:
    v_and_b32 v120, 0xffff0000, v120
    v_sub_f32 v122, 1.0, v120
    v_cvt_pk_bf16_f32 v20, v122, 0
    v_lshlrev_b32 v21, 16, v20
    v_and_b32 v121, 0xffff0000, v121
    v_sub_f32 v123, 1.0, v121
    v_cvt_pk_bf16_f32 v22, v123, 0
    v_lshlrev_b32 v23, 16, v22
    v_and_b32 v96, 0xffff0000, v96
    v_mul_f32 v128, v120, v128
    v_mul_f32 v160, v21, v160
    v_fma_f32 v128, v96, v128, v160
    v_and_b32 v98, 0xffff0000, v98
    v_mul_f32 v129, v120, v129
    v_mul_f32 v161, v21, v161
    v_fma_f32 v129, v98, v129, v161
    v_and_b32 v100, 0xffff0000, v100
    v_mul_f32 v130, v120, v130
    v_mul_f32 v162, v21, v162
    v_fma_f32 v130, v100, v130, v162
    v_and_b32 v102, 0xffff0000, v102
    v_mul_f32 v131, v120, v131
    v_mul_f32 v163, v21, v163
    v_fma_f32 v131, v102, v131, v163
    v_and_b32 v97, 0xffff0000, v97
    v_mul_f32 v132, v121, v132
    v_mul_f32 v164, v23, v164
    v_fma_f32 v132, v97, v132, v164
    v_and_b32 v99, 0xffff0000, v99
    v_mul_f32 v133, v121, v133
    v_mul_f32 v165, v23, v165
    v_fma_f32 v133, v99, v133, v165
    v_and_b32 v101, 0xffff0000, v101
    v_mul_f32 v134, v121, v134
    v_mul_f32 v166, v23, v166
    v_fma_f32 v134, v101, v134, v166
    v_and_b32 v103, 0xffff0000, v103
    v_mul_f32 v135, v121, v135
    v_mul_f32 v167, v23, v167
    v_fma_f32 v135, v103, v135, v167
    v_and_b32 v104, 0xffff0000, v104
    v_mul_f32 v136, v120, v136
    v_mul_f32 v192, v21, v192
    v_fma_f32 v136, v104, v136, v192
    v_and_b32 v106, 0xffff0000, v106
    v_mul_f32 v137, v120, v137
    v_mul_f32 v193, v21, v193
    v_fma_f32 v137, v106, v137, v193
    v_and_b32 v108, 0xffff0000, v108
    v_mul_f32 v138, v120, v138
    v_mul_f32 v194, v21, v194
    v_fma_f32 v138, v108, v138, v194
    v_and_b32 v110, 0xffff0000, v110
    v_mul_f32 v139, v120, v139
    v_mul_f32 v195, v21, v195
    v_fma_f32 v139, v110, v139, v195
    v_and_b32 v105, 0xffff0000, v105
    v_mul_f32 v140, v121, v140
    v_mul_f32 v196, v23, v196
    v_fma_f32 v140, v105, v140, v196
    v_and_b32 v107, 0xffff0000, v107
    v_mul_f32 v141, v121, v141
    v_mul_f32 v197, v23, v197
    v_fma_f32 v141, v107, v141, v197
    v_and_b32 v109, 0xffff0000, v109
    v_mul_f32 v142, v121, v142
    v_mul_f32 v198, v23, v198
    v_fma_f32 v142, v109, v142, v198
    v_and_b32 v111, 0xffff0000, v111
    v_mul_f32 v143, v121, v143
    v_mul_f32 v199, v23, v199
    v_fma_f32 v143, v111, v143, v199
    v_and_b32 v112, 0xffff0000, v112
    v_mul_f32 v144, v120, v144
    v_mul_f32 v64, v21, v64
    v_fma_f32 v144, v112, v144, v64
    v_and_b32 v114, 0xffff0000, v114
    v_mul_f32 v145, v120, v145
    v_mul_f32 v65, v21, v65
    v_fma_f32 v145, v114, v145, v65
    v_and_b32 v116, 0xffff0000, v116
    v_mul_f32 v146, v120, v146
    v_mul_f32 v66, v21, v66
    v_fma_f32 v146, v116, v146, v66
    v_and_b32 v118, 0xffff0000, v118
    v_mul_f32 v147, v120, v147
    v_mul_f32 v67, v21, v67
    v_fma_f32 v147, v118, v147, v67
    v_and_b32 v113, 0xffff0000, v113
    v_mul_f32 v148, v121, v148
    v_mul_f32 v68, v23, v68
    v_fma_f32 v148, v113, v148, v68
    v_and_b32 v115, 0xffff0000, v115
    v_mul_f32 v149, v121, v149
    v_mul_f32 v69, v23, v69
    v_fma_f32 v149, v115, v149, v69
    v_and_b32 v117, 0xffff0000, v117
    v_mul_f32 v150, v121, v150
    v_mul_f32 v70, v23, v70
    v_fma_f32 v150, v117, v150, v70
    v_and_b32 v119, 0xffff0000, v119
    v_mul_f32 v151, v121, v151
    v_mul_f32 v71, v23, v71
    v_fma_f32 v151, v119, v151, v71
L_chk_p1:
    s_waitcnt vmcnt(11)
    v_xor_b32 v155, s66, v175
    s_waitcnt vmcnt(10)
    v_bitop3_b32 v155, v207, s66, v155 bitop3:0xbe
    s_waitcnt vmcnt(9)
    v_bitop3_b32 v155, v79, s66, v155 bitop3:0xbe
    s_waitcnt vmcnt(8)
    v_bitop3_b32 v155, v55, s66, v155 bitop3:0xbe
    v_cmp_ne_u32 vcc, 0, v155
    s_cbranch_vccnz L_retry_p1
L_ok_p1:
    v_dot2_f32_bf16 v128, v172, v20, v128
    v_dot2_f32_bf16 v129, v172, v21, v129
    v_dot2_f32_bf16 v130, v173, v20, v130
    v_dot2_f32_bf16 v131, v173, v21, v131
    v_dot2_f32_bf16 v132, v174, v22, v132
    v_dot2_f32_bf16 v133, v174, v23, v133
    v_dot2_f32_bf16 v134, v52, v22, v134
    v_dot2_f32_bf16 v135, v52, v23, v135
    v_dot2_f32_bf16 v136, v204, v20, v136
    v_dot2_f32_bf16 v137, v204, v21, v137
    v_dot2_f32_bf16 v138, v205, v20, v138
    v_dot2_f32_bf16 v139, v205, v21, v139
    v_dot2_f32_bf16 v140, v206, v22, v140
    v_dot2_f32_bf16 v141, v206, v23, v141
    v_dot2_f32_bf16 v142, v53, v22, v142
    v_dot2_f32_bf16 v143, v53, v23, v143
    v_dot2_f32_bf16 v144, v76, v20, v144
    v_dot2_f32_bf16 v145, v76, v21, v145
    v_dot2_f32_bf16 v146, v77, v20, v146
    v_dot2_f32_bf16 v147, v77, v21, v147
    v_dot2_f32_bf16 v148, v78, v22, v148
    v_dot2_f32_bf16 v149, v78, v23, v149
    v_dot2_f32_bf16 v150, v54, v22, v150
    v_dot2_f32_bf16 v151, v54, v23, v151
L_chk_p2:
    s_waitcnt vmcnt(7)
    v_xor_b32 v155, s66, v183
    s_waitcnt vmcnt(6)
    v_bitop3_b32 v155, v215, s66, v155 bitop3:0xbe
    s_waitcnt vmcnt(5)
    v_bitop3_b32 v155, v87, s66, v155 bitop3:0xbe
    s_waitcnt vmcnt(4)
    v_bitop3_b32 v155, v59, s66, v155 bitop3:0xbe
    v_cmp_ne_u32 vcc, 0, v155
    s_cbranch_vccnz L_retry_p2
L_ok_p2:
    v_dot2_f32_bf16 v128, v180, v20, v128
    v_dot2_f32_bf16 v129, v180, v21, v129
    v_dot2_f32_bf16 v130, v181, v20, v130
    v_dot2_f32_bf16 v131, v181, v21, v131
    v_dot2_f32_bf16 v132, v182, v22, v132
    v_dot2_f32_bf16 v133, v182, v23, v133
    v_dot2_f32_bf16 v134, v56, v22, v134
    v_dot2_f32_bf16 v135, v56, v23, v135
    v_dot2_f32_bf16 v136, v212, v20, v136
    v_dot2_f32_bf16 v137, v212, v21, v137
    v_dot2_f32_bf16 v138, v213, v20, v138
    v_dot2_f32_bf16 v139, v213, v21, v139
    v_dot2_f32_bf16 v140, v214, v22, v140
    v_dot2_f32_bf16 v141, v214, v23, v141
    v_dot2_f32_bf16 v142, v57, v22, v142
    v_dot2_f32_bf16 v143, v57, v23, v143
    v_dot2_f32_bf16 v144, v84, v20, v144
    v_dot2_f32_bf16 v145, v84, v21, v145
    v_dot2_f32_bf16 v146, v85, v20, v146
    v_dot2_f32_bf16 v147, v85, v21, v147
    v_dot2_f32_bf16 v148, v86, v22, v148
    v_dot2_f32_bf16 v149, v86, v23, v149
    v_dot2_f32_bf16 v150, v58, v22, v150
    v_dot2_f32_bf16 v151, v58, v23, v151
L_chk_p3:
    s_waitcnt vmcnt(3)
    v_xor_b32 v155, s66, v191
    s_waitcnt vmcnt(2)
    v_bitop3_b32 v155, v223, s66, v155 bitop3:0xbe
    s_waitcnt vmcnt(1)
    v_bitop3_b32 v155, v95, s66, v155 bitop3:0xbe
    s_waitcnt vmcnt(0)
    v_bitop3_b32 v155, v63, s66, v155 bitop3:0xbe
    v_cmp_ne_u32 vcc, 0, v155
    s_cbranch_vccnz L_retry_p3
L_ok_p3:
    v_dot2_f32_bf16 v128, v188, v20, v128
    v_dot2_f32_bf16 v129, v188, v21, v129
    v_dot2_f32_bf16 v130, v189, v20, v130
    v_dot2_f32_bf16 v131, v189, v21, v131
    v_dot2_f32_bf16 v132, v190, v22, v132
    v_dot2_f32_bf16 v133, v190, v23, v133
    v_dot2_f32_bf16 v134, v60, v22, v134
    v_dot2_f32_bf16 v135, v60, v23, v135
    v_dot2_f32_bf16 v136, v220, v20, v136
    v_dot2_f32_bf16 v137, v220, v21, v137
    v_dot2_f32_bf16 v138, v221, v20, v138
    v_dot2_f32_bf16 v139, v221, v21, v139
    v_dot2_f32_bf16 v140, v222, v22, v140
    v_dot2_f32_bf16 v141, v222, v23, v141
    v_dot2_f32_bf16 v142, v61, v22, v142
    v_dot2_f32_bf16 v143, v61, v23, v143
    v_dot2_f32_bf16 v144, v92, v20, v144
    v_dot2_f32_bf16 v145, v92, v21, v145
    v_dot2_f32_bf16 v146, v93, v20, v146
    v_dot2_f32_bf16 v147, v93, v21, v147
    v_dot2_f32_bf16 v148, v94, v22, v148
    v_dot2_f32_bf16 v149, v94, v23, v149
    v_dot2_f32_bf16 v150, v62, v22, v150
    v_dot2_f32_bf16 v151, v62, v23, v151
    v_cvt_pk_bf16_f32 v128, v128, v129
    v_cvt_pk_bf16_f32 v129, v130, v131
    buffer_store_dwordx2 v[128:129], v124, s[28:31], 0 offen offset:0
    v_cvt_pk_bf16_f32 v132, v132, v133
    v_cvt_pk_bf16_f32 v133, v134, v135
    buffer_store_dwordx2 v[132:133], v124, s[28:31], s54 offen offset:0
    v_cvt_pk_bf16_f32 v136, v136, v137
    v_cvt_pk_bf16_f32 v137, v138, v139
    buffer_store_dwordx2 v[136:137], v124, s[28:31], 0 offen offset:128
    v_cvt_pk_bf16_f32 v140, v140, v141
    v_cvt_pk_bf16_f32 v141, v142, v143
    buffer_store_dwordx2 v[140:141], v124, s[28:31], s54 offen offset:128
    v_cvt_pk_bf16_f32 v144, v144, v145
    v_cvt_pk_bf16_f32 v145, v146, v147
    buffer_store_dwordx2 v[144:145], v124, s[28:31], 0 offen offset:256
    v_cvt_pk_bf16_f32 v148, v148, v149
    v_cvt_pk_bf16_f32 v149, v150, v151
    buffer_store_dwordx2 v[148:149], v124, s[28:31], s54 offen offset:256
    s_endpgm
L_conv:
    s_waitcnt lgkmcnt(4)
    v_mfma_f32_16x16x32_bf16 v[96:99], v[20:23], a[0:3], 0
    ds_read_b64_tr_b16 v[32:33], v4 offset:18592
    s_mov_b32 s12, s92
    s_and_b32 s13, s93, 0xffff
    v_mfma_f32_16x16x32_bf16 v[112:115], v[20:23], a[4:7], 0
    ds_read_b64_tr_b16 v[34:35], v4 offset:19616
    s_mov_b32 s14, 1152
    s_mov_b32 s15, 0x20000
    v_mfma_f32_16x16x32_bf16 v[128:131], v[20:23], a[8:11], 0
    v_lshlrev_b32 v11, 4, v1
    s_and_b32 s94, s2, 7
    v_mfma_f32_16x16x32_bf16 v[144:147], v[20:23], a[12:15], 0
    s_lshl_b32 s94, s94, 3
    s_waitcnt lgkmcnt(4)
    v_mfma_f32_16x16x32_bf16 v[148:151], v[24:27], a[12:15], 0
    ds_read_b64_tr_b16 v[20:21], v4 offset:17024
    s_add_u32 s94, s94, s43
    s_lshl_b32 s68, s94, 2
    v_mfma_f32_16x16x32_bf16 v[132:135], v[24:27], a[8:11], 0
    ds_read_b64_tr_b16 v[22:23], v4 offset:18048
    s_add_u32 s68, s68, s32
    s_lshl_b32 s68, s68, 13
    v_mfma_f32_16x16x32_bf16 v[116:119], v[24:27], a[4:7], 0
    s_add_u32 s69, s94, 512
    s_lshl_b32 s69, s69, 12
    v_mfma_f32_16x16x32_bf16 v[100:103], v[24:27], a[0:3], 0
    buffer_store_dwordx4 v[80:83], v7, s[16:19], s38 offen offset:0 sc1
    s_waitcnt lgkmcnt(4)
    v_mfma_f32_16x16x32_bf16 v[104:107], v[28:31], a[0:3], 0
    ds_read_b64_tr_b16 v[24:25], v4 offset:17056
    v_mul_u32_u24 v61, 73728, v9
    v_lshl_add_u32 v61, v10, 4, v61
    v_mfma_f32_16x16x32_bf16 v[120:123], v[28:31], a[4:7], 0
    ds_read_b64_tr_b16 v[26:27], v4 offset:18080
    v_and_b32 v13, 15, v1
    v_mov_b32 v18, 2147483632
    v_mfma_f32_16x16x32_bf16 v[136:139], v[28:31], a[8:11], 0
    v_cmp_eq_u32 vcc, 15, v13
    s_nop 1
    v_cndmask_b32 v13, v18, 0, vcc
    v_mfma_f32_16x16x32_bf16 v[152:155], v[28:31], a[12:15], 0
    buffer_store_dwordx4 v[84:87], v7, s[16:19], s38 offen offset:1024 sc1
    s_waitcnt lgkmcnt(4)
    v_mfma_f32_16x16x32_bf16 v[156:159], v[32:35], a[12:15], 0
    ds_read_b64_tr_b16 v[28:29], v4 offset:19072
    s_mov_b32 s80, s76
    s_and_b32 s81, s77, 0xffff
    v_mfma_f32_16x16x32_bf16 v[140:143], v[32:35], a[8:11], 0
    ds_read_b64_tr_b16 v[30:31], v4 offset:20096
    s_mov_b32 s82, 2359296
    s_mov_b32 s83, 0x20000
    v_mfma_f32_16x16x32_bf16 v[124:127], v[32:35], a[4:7], 0
    s_lshr_b32 s45, s94, 1
    s_lshr_b32 s46, s2, 3
    v_mfma_f32_16x16x32_bf16 v[108:111], v[32:35], a[0:3], 0
    buffer_store_dwordx4 v[88:91], v7, s[16:19], s38 offen offset:2048 sc1
    s_waitcnt lgkmcnt(4)
    v_mfma_f32_16x16x32_bf16 v[96:99], v[20:23], a[16:19], v[96:99]
    ds_read_b64_tr_b16 v[32:33], v4 offset:19104
    s_sub_u32 s45, s45, s46
    s_mul_i32 s45, s45, 73728
    v_mfma_f32_16x16x32_bf16 v[112:115], v[20:23], a[20:23], v[112:115]
    ds_read_b64_tr_b16 v[34:35], v4 offset:20128
    s_and_b32 s46, s2, 7
    s_sub_u32 s46, 8, s46
    v_mfma_f32_16x16x32_bf16 v[128:131], v[20:23], a[24:27], v[128:131]
    s_lshl_b32 s37, s46, 7
    s_add_u32 s37, s37, s45
    v_mfma_f32_16x16x32_bf16 v[144:147], v[20:23], a[28:31], v[144:147]
    buffer_store_dwordx4 v[92:95], v7, s[16:19], s38 offen offset:3072 sc1
    s_waitcnt lgkmcnt(4)
    v_mfma_f32_16x16x32_bf16 v[148:151], v[24:27], a[28:31], v[148:151]
    s_waitcnt vmcnt(20)
    s_barrier
    ds_read_b64_tr_b16 v[20:21], v4 offset:33024
    s_add_u32 m0, s33, 136064
    s_add_u32 s47, s34, s63
    v_mfma_f32_16x16x32_bf16 v[132:135], v[24:27], a[24:27], v[132:135]
    ds_read_b64_tr_b16 v[22:23], v4 offset:34048
    v_add_u32 v48, s37, v70
    v_add_u32 v49, s37, v71
    v_mfma_f32_16x16x32_bf16 v[116:119], v[24:27], a[20:23], v[116:119]
    s_lshl_b32 s37, s46, 13
    s_add_u32 s37, s37, s45
    v_mfma_f32_16x16x32_bf16 v[100:103], v[24:27], a[16:19], v[100:103]
    buffer_load_dwordx4 v2, s[4:7], s47 offen offset:0 lds
    s_waitcnt lgkmcnt(4)
    v_mfma_f32_16x16x32_bf16 v[104:107], v[28:31], a[16:19], v[104:107]
    ds_read_b64_tr_b16 v[24:25], v4 offset:33056
    s_bitcmp1_b32 s94, 0
    s_cselect_b32 s88, s28, s24
    s_cselect_b32 s89, s29, s25
    s_cselect_b32 s45, 3145728, 0
    v_mfma_f32_16x16x32_bf16 v[120:123], v[28:31], a[20:23], v[120:123]
    ds_read_b64_tr_b16 v[26:27], v4 offset:34080
    s_add_u32 s37, s37, s45
    v_add_u32 v50, s37, v78
    v_mfma_f32_16x16x32_bf16 v[136:139], v[28:31], a[24:27], v[136:139]
    s_mov_b32 s90, s26
    s_mov_b32 s91, 0x20000
    v_mfma_f32_16x16x32_bf16 v[152:155], v[28:31], a[28:31], v[152:155]
    buffer_load_dwordx4 v3, s[4:7], s47 offen offset:1024 lds
    s_waitcnt lgkmcnt(4)
    v_mfma_f32_16x16x32_bf16 v[156:159], v[32:35], a[28:31], v[156:159]
    ds_read_b64_tr_b16 v[28:29], v4 offset:35072
    s_add_u32 s38, s38, s96
    v_min_u32 v58, 53, v1
    v_mfma_f32_16x16x32_bf16 v[140:143], v[32:35], a[24:27], v[140:143]
    ds_read_b64_tr_b16 v[30:31], v4 offset:36096
    v_mul_u32_u24 v59, 0x5556, v58
    v_lshrrev_b32 v59, 16, v59
    v_mfma_f32_16x16x32_bf16 v[124:127], v[32:35], a[20:23], v[124:127]
    v_mul_u32_u24 v79, 8832, v59
    v_lshl_add_u32 v58, v58, 7, v79
    v_mfma_f32_16x16x32_bf16 v[108:111], v[32:35], a[16:19], v[108:111]
    buffer_load_dwordx4 v2, s[8:11], s47 offen offset:2048 lds
    s_waitcnt lgkmcnt(4)
    v_mfma_f32_16x16x32_bf16 v[96:99], v[20:23], a[32:35], v[96:99]
    ds_read_b64_tr_b16 v[32:33], v4 offset:35104
    s_lshl_b32 s45, s43, 2
    s_add_u32 s45, s45, s32
    s_mul_i32 s45, s45, 165888
    s_mul_i32 s46, s41, 2304
    s_add_u32 s45, s45, s46
    s_add_u32 s45, s45, 5632
    v_add_u32 v58, s45, v58
    v_mfma_f32_16x16x32_bf16 v[112:115], v[20:23], a[36:39], v[112:115]
    ds_read_b64_tr_b16 v[34:35], v4 offset:36128
    v_mul_f32 v160, s39, v160
    v_mul_f32 v161, s39, v161
    v_mfma_f32_16x16x32_bf16 v[128:131], v[20:23], a[40:43], v[128:131]
    v_exp_f32 v160, v160
    v_mfma_f32_16x16x32_bf16 v[144:147], v[20:23], a[44:47], v[144:147]
    buffer_load_dwordx4 v3, s[8:11], s47 offen offset:3072 lds
    s_waitcnt lgkmcnt(4)
    v_mfma_f32_16x16x32_bf16 v[148:151], v[24:27], a[44:47], v[148:151]
    ds_read_b64_tr_b16 v[20:21], v4 offset:33536
    v_exp_f32 v161, v161
    v_mfma_f32_16x16x32_bf16 v[132:135], v[24:27], a[40:43], v[132:135]
    ds_read_b64_tr_b16 v[22:23], v4 offset:34560
    s_add_u32 m0, s33, 0
    s_add_u32 s47, s34, s64
    v_mfma_f32_16x16x32_bf16 v[116:119], v[24:27], a[36:39], v[116:119]
    v_mul_f32 v162, s39, v162
    v_mul_f32 v163, s39, v163
    v_mfma_f32_16x16x32_bf16 v[100:103], v[24:27], a[32:35], v[100:103]
    buffer_load_dwordx4 v2, s[4:7], s47 offen offset:0 lds
    s_waitcnt lgkmcnt(4)
    v_mfma_f32_16x16x32_bf16 v[104:107], v[28:31], a[32:35], v[104:107]
    ds_read_b64_tr_b16 v[24:25], v4 offset:33568
    v_exp_f32 v162, v162
    v_mfma_f32_16x16x32_bf16 v[120:123], v[28:31], a[36:39], v[120:123]
    ds_read_b64_tr_b16 v[26:27], v4 offset:34592
    v_exp_f32 v163, v163
    v_mfma_f32_16x16x32_bf16 v[136:139], v[28:31], a[40:43], v[136:139]
    v_mul_f32 v164, s39, v164
    v_mul_f32 v165, s39, v165
    v_mfma_f32_16x16x32_bf16 v[152:155], v[28:31], a[44:47], v[152:155]
    buffer_load_dwordx4 v3, s[4:7], s47 offen offset:1024 lds
    s_waitcnt lgkmcnt(4)
    v_mfma_f32_16x16x32_bf16 v[156:159], v[32:35], a[44:47], v[156:159]
    ds_read_b64_tr_b16 v[28:29], v4 offset:35584
    v_exp_f32 v164, v164
    v_mfma_f32_16x16x32_bf16 v[140:143], v[32:35], a[40:43], v[140:143]
    ds_read_b64_tr_b16 v[30:31], v4 offset:36608
    v_exp_f32 v165, v165
    v_mfma_f32_16x16x32_bf16 v[124:127], v[32:35], a[36:39], v[124:127]
    v_mul_f32 v166, s39, v166
    v_mul_f32 v167, s39, v167
    v_mfma_f32_16x16x32_bf16 v[108:111], v[32:35], a[32:35], v[108:111]
    buffer_load_dwordx4 v2, s[8:11], s47 offen offset:2048 lds
    s_waitcnt lgkmcnt(4)
    v_mfma_f32_16x16x32_bf16 v[96:99], v[20:23], a[48:51], v[96:99]
    ds_read_b64_tr_b16 v[32:33], v4 offset:35616
    v_exp_f32 v166, v166
    v_mfma_f32_16x16x32_bf16 v[112:115], v[20:23], a[52:55], v[112:115]
    ds_read_b64_tr_b16 v[34:35], v4 offset:36640
    v_exp_f32 v167, v167
    v_mfma_f32_16x16x32_bf16 v[128:131], v[20:23], a[56:59], v[128:131]
    v_add_f32 v160, 1.0, v160
    v_add_f32 v161, 1.0, v161
    v_mfma_f32_16x16x32_bf16 v[144:147], v[20:23], a[60:63], v[144:147]
    buffer_load_dwordx4 v3, s[8:11], s47 offen offset:3072 lds
    s_waitcnt lgkmcnt(4)
    v_mfma_f32_16x16x32_bf16 v[148:151], v[24:27], a[60:63], v[148:151]
    ds_read_b64_tr_b16 v[20:21], v4 offset:49536
    v_rcp_f32 v160, v160
    v_mfma_f32_16x16x32_bf16 v[132:135], v[24:27], a[56:59], v[132:135]
    ds_read_b64_tr_b16 v[22:23], v4 offset:50560
    v_rcp_f32 v161, v161
    v_mfma_f32_16x16x32_bf16 v[116:119], v[24:27], a[52:55], v[116:119]
    s_add_u32 m0, s33, 82560
    s_add_u32 s47, s34, s65
    v_mfma_f32_16x16x32_bf16 v[100:103], v[24:27], a[48:51], v[100:103]
    buffer_load_dwordx4 v2, s[4:7], s47 offen offset:0 lds
    s_waitcnt lgkmcnt(4)
    v_mfma_f32_16x16x32_bf16 v[104:107], v[28:31], a[48:51], v[104:107]
    ds_read_b64_tr_b16 v[24:25], v4 offset:49568
    v_add_f32 v162, 1.0, v162
    v_add_f32 v163, 1.0, v163
    v_mfma_f32_16x16x32_bf16 v[120:123], v[28:31], a[52:55], v[120:123]
    ds_read_b64_tr_b16 v[26:27], v4 offset:50592
    v_rcp_f32 v162, v162
    v_mfma_f32_16x16x32_bf16 v[136:139], v[28:31], a[56:59], v[136:139]
    v_rcp_f32 v163, v163
    v_mfma_f32_16x16x32_bf16 v[152:155], v[28:31], a[60:63], v[152:155]
    buffer_load_dwordx4 v3, s[4:7], s47 offen offset:1024 lds
    s_waitcnt lgkmcnt(4)
    v_mfma_f32_16x16x32_bf16 v[156:159], v[32:35], a[60:63], v[156:159]
    ds_read_b64_tr_b16 v[28:29], v4 offset:51584
    v_add_f32 v164, 1.0, v164
    v_add_f32 v165, 1.0, v165
    v_mfma_f32_16x16x32_bf16 v[140:143], v[32:35], a[56:59], v[140:143]
    ds_read_b64_tr_b16 v[30:31], v4 offset:52608
    v_rcp_f32 v164, v164
    v_mfma_f32_16x16x32_bf16 v[124:127], v[32:35], a[52:55], v[124:127]
    v_rcp_f32 v165, v165
    v_mfma_f32_16x16x32_bf16 v[108:111], v[32:35], a[48:51], v[108:111]
    buffer_load_dwordx4 v2, s[8:11], s47 offen offset:2048 lds
    s_waitcnt lgkmcnt(4)
    v_mfma_f32_16x16x32_bf16 v[96:99], v[20:23], a[64:67], v[96:99]
    ds_read_b64_tr_b16 v[32:33], v4 offset:51616
    v_add_f32 v166, 1.0, v166
    v_add_f32 v167, 1.0, v167
    v_mfma_f32_16x16x32_bf16 v[112:115], v[20:23], a[68:71], v[112:115]
    ds_read_b64_tr_b16 v[34:35], v4 offset:52640
    v_rcp_f32 v166, v166
    v_mfma_f32_16x16x32_bf16 v[128:131], v[20:23], a[72:75], v[128:131]
    v_rcp_f32 v167, v167
    v_mfma_f32_16x16x32_bf16 v[144:147], v[20:23], a[76:79], v[144:147]
    buffer_load_dwordx4 v3, s[8:11], s47 offen offset:3072 lds
    s_waitcnt lgkmcnt(4)
    v_mfma_f32_16x16x32_bf16 v[148:151], v[24:27], a[76:79], v[148:151]
    ds_read_b64_tr_b16 v[20:21], v4 offset:50048
    v_mul_f32 v160, v160, v168
    v_mul_f32 v161, v161, v169
    v_mfma_f32_16x16x32_bf16 v[132:135], v[24:27], a[72:75], v[132:135]
    ds_read_b64_tr_b16 v[22:23], v4 offset:51072
    v_mul_f32 v162, v162, v170
    v_mul_f32 v163, v163, v171
    v_mfma_f32_16x16x32_bf16 v[116:119], v[24:27], a[68:71], v[116:119]
    v_mul_f32 v164, v164, v172
    v_mul_f32 v165, v165, v173
    v_mfma_f32_16x16x32_bf16 v[100:103], v[24:27], a[64:67], v[100:103]
    buffer_load_dword v59, v58, s[4:7], 0 offen
    s_waitcnt lgkmcnt(4)
    v_mfma_f32_16x16x32_bf16 v[104:107], v[28:31], a[64:67], v[104:107]
    ds_read_b64_tr_b16 v[24:25], v4 offset:50080
    v_mul_f32 v166, v166, v174
    v_mul_f32 v167, v167, v175
    v_mfma_f32_16x16x32_bf16 v[120:123], v[28:31], a[68:71], v[120:123]
    ds_read_b64_tr_b16 v[26:27], v4 offset:51104
    v_cvt_pk_bf16_f32 v168, v160, v161
    v_cvt_pk_bf16_f32 v169, v162, v163
    v_mfma_f32_16x16x32_bf16 v[136:139], v[28:31], a[72:75], v[136:139]
    v_cvt_pk_bf16_f32 v170, v164, v165
    v_cvt_pk_bf16_f32 v171, v166, v167
    v_mfma_f32_16x16x32_bf16 v[152:155], v[28:31], a[76:79], v[152:155]
    buffer_store_dwordx4 v[168:171], v7, s[16:19], s38 offen offset:0 sc1
    s_waitcnt lgkmcnt(4)
    v_mfma_f32_16x16x32_bf16 v[156:159], v[32:35], a[76:79], v[156:159]
    ds_read_b64_tr_b16 v[28:29], v4 offset:52096
    v_mul_f32 v176, s39, v176
    v_mul_f32 v177, s39, v177
    v_mfma_f32_16x16x32_bf16 v[140:143], v[32:35], a[72:75], v[140:143]
    ds_read_b64_tr_b16 v[30:31], v4 offset:53120
    v_exp_f32 v176, v176
    v_mfma_f32_16x16x32_bf16 v[124:127], v[32:35], a[68:71], v[124:127]
    v_exp_f32 v177, v177
    v_mfma_f32_16x16x32_bf16 v[108:111], v[32:35], a[64:67], v[108:111]
    v_mul_f32 v178, s39, v178
    s_waitcnt lgkmcnt(4)
    v_mfma_f32_16x16x32_bf16 v[96:99], v[20:23], a[80:83], v[96:99]
    ds_read_b64_tr_b16 v[32:33], v4 offset:52128
    v_exp_f32 v178, v178
    v_mfma_f32_16x16x32_bf16 v[112:115], v[20:23], a[84:87], v[112:115]
    ds_read_b64_tr_b16 v[34:35], v4 offset:53152
    v_mul_f32 v179, s39, v179
    v_mul_f32 v180, s39, v180
    v_mfma_f32_16x16x32_bf16 v[128:131], v[20:23], a[88:91], v[128:131]
    v_exp_f32 v179, v179
    v_mfma_f32_16x16x32_bf16 v[144:147], v[20:23], a[92:95], v[144:147]
    v_mul_f32 v181, s39, v181
    s_waitcnt lgkmcnt(4)
    v_mfma_f32_16x16x32_bf16 v[148:151], v[24:27], a[92:95], v[148:151]
    s_waitcnt vmcnt(22)
    s_barrier
    ds_read_b64_tr_b16 v[20:21], v5 offset:512
    v_exp_f32 v180, v180
    v_mfma_f32_16x16x32_bf16 v[132:135], v[24:27], a[88:91], v[132:135]
    ds_read_b64_tr_b16 v[22:23], v5 offset:1536
    v_exp_f32 v181, v181
    v_mfma_f32_16x16x32_bf16 v[116:119], v[24:27], a[84:87], v[116:119]
    s_lshl_b32 s47, s32, 11
    s_add_u32 m0, s47, 16512
    v_mfma_f32_16x16x32_bf16 v[100:103], v[24:27], a[80:83], v[100:103]
    buffer_store_dword v17, v62, s[16:19], 0 offen offset:512 sc1
    s_waitcnt lgkmcnt(4)
    v_mfma_f32_16x16x32_bf16 v[104:107], v[28:31], a[80:83], v[104:107]
    ds_read_b64_tr_b16 v[24:25], v5 offset:544
    v_mul_f32 v182, s39, v182
    v_mul_f32 v183, s39, v183
    v_mfma_f32_16x16x32_bf16 v[120:123], v[28:31], a[84:87], v[120:123]
    ds_read_b64_tr_b16 v[26:27], v5 offset:1568
    v_exp_f32 v182, v182
    v_mfma_f32_16x16x32_bf16 v[136:139], v[28:31], a[88:91], v[136:139]
    v_exp_f32 v183, v183
    v_mfma_f32_16x16x32_bf16 v[152:155], v[28:31], a[92:95], v[152:155]
    buffer_load_dwordx4 v48, s[88:91], 0 offen offset:0 lds
    s_waitcnt lgkmcnt(4)
    v_mfma_f32_16x16x32_bf16 v[156:159], v[32:35], a[92:95], v[156:159]
    ds_read_b64_tr_b16 v[28:29], v5 offset:2560
    v_add_f32 v176, 1.0, v176
    v_add_f32 v177, 1.0, v177
    v_mfma_f32_16x16x32_bf16 v[140:143], v[32:35], a[88:91], v[140:143]
    ds_read_b64_tr_b16 v[30:31], v5 offset:3584
    v_rcp_f32 v176, v176
    v_mfma_f32_16x16x32_bf16 v[124:127], v[32:35], a[84:87], v[124:127]
    v_rcp_f32 v177, v177
    v_mfma_f32_16x16x32_bf16 v[108:111], v[32:35], a[80:83], v[108:111]
    buffer_load_dwordx4 v49, s[88:91], 0 offen offset:1024 lds
    s_waitcnt lgkmcnt(4)
    v_mfma_f32_16x16x32_bf16 v[96:99], v[20:23], a[96:99], v[96:99]
    ds_read_b64_tr_b16 v[32:33], v5 offset:2592
    s_lshl_b32 s47, s32, 11
    s_add_u32 m0, s47, 28800
    v_mfma_f32_16x16x32_bf16 v[112:115], v[20:23], a[100:103], v[112:115]
    ds_read_b64_tr_b16 v[34:35], v5 offset:3616
    v_add_f32 v178, 1.0, v178
    v_add_f32 v179, 1.0, v179
    v_mfma_f32_16x16x32_bf16 v[128:131], v[20:23], a[104:107], v[128:131]
    v_rcp_f32 v178, v178
    v_mfma_f32_16x16x32_bf16 v[144:147], v[20:23], a[108:111], v[144:147]
    buffer_load_dwordx4 v11, s[12:15], 0 offen offset:0 lds
    s_waitcnt lgkmcnt(4)
    v_mfma_f32_16x16x32_bf16 v[148:151], v[24:27], a[108:111], v[148:151]
    ds_read_b64_tr_b16 v[20:21], v5 offset:1024
    v_rcp_f32 v179, v179
    v_mfma_f32_16x16x32_bf16 v[132:135], v[24:27], a[104:107], v[132:135]
    ds_read_b64_tr_b16 v[22:23], v5 offset:2048
    v_add_f32 v180, 1.0, v180
    v_add_f32 v181, 1.0, v181
    v_mfma_f32_16x16x32_bf16 v[116:119], v[24:27], a[100:103], v[116:119]
    v_rcp_f32 v180, v180
    v_mfma_f32_16x16x32_bf16 v[100:103], v[24:27], a[96:99], v[100:103]
    buffer_load_dwordx4 v11, s[12:15], 0 offen offset:1024 lds
    s_waitcnt lgkmcnt(4)
    v_mfma_f32_16x16x32_bf16 v[104:107], v[28:31], a[96:99], v[104:107]
    ds_read_b64_tr_b16 v[24:25], v5 offset:1056
    v_rcp_f32 v181, v181
    v_mfma_f32_16x16x32_bf16 v[120:123], v[28:31], a[100:103], v[120:123]
    ds_read_b64_tr_b16 v[26:27], v5 offset:2080
    v_add_f32 v182, 1.0, v182
    v_add_f32 v183, 1.0, v183
    v_mfma_f32_16x16x32_bf16 v[136:139], v[28:31], a[104:107], v[136:139]
    v_rcp_f32 v182, v182
    v_mfma_f32_16x16x32_bf16 v[152:155], v[28:31], a[108:111], v[152:155]
    buffer_load_dword v79, v58, s[8:11], 0 offen offset:2048
    s_waitcnt lgkmcnt(4)
    v_mfma_f32_16x16x32_bf16 v[156:159], v[32:35], a[108:111], v[156:159]
    ds_read_b64_tr_b16 v[28:29], v5 offset:3072
    v_rcp_f32 v183, v183
    v_mfma_f32_16x16x32_bf16 v[140:143], v[32:35], a[104:107], v[140:143]
    ds_read_b64_tr_b16 v[30:31], v5 offset:4096
    v_mul_f32 v176, v176, v184
    v_mul_f32 v177, v177, v185
    v_mfma_f32_16x16x32_bf16 v[124:127], v[32:35], a[100:103], v[124:127]
    v_mul_f32 v178, v178, v186
    v_mul_f32 v179, v179, v187
    v_mfma_f32_16x16x32_bf16 v[108:111], v[32:35], a[96:99], v[108:111]
    v_mul_f32 v180, v180, v188
    s_waitcnt lgkmcnt(4)
    v_mfma_f32_16x16x32_bf16 v[96:99], v[20:23], a[112:115], v[96:99]
    ds_read_b64_tr_b16 v[32:33], v5 offset:3104
    v_mul_f32 v181, v181, v189
    v_mul_f32 v182, v182, v190
    v_mfma_f32_16x16x32_bf16 v[112:115], v[20:23], a[116:119], v[112:115]
    ds_read_b64_tr_b16 v[34:35], v5 offset:4128
    v_mul_f32 v183, v183, v191
    v_cvt_pk_bf16_f32 v184, v176, v177
    v_mfma_f32_16x16x32_bf16 v[128:131], v[20:23], a[120:123], v[128:131]
    v_cvt_pk_bf16_f32 v185, v178, v179
    v_cvt_pk_bf16_f32 v186, v180, v181
    v_mfma_f32_16x16x32_bf16 v[144:147], v[20:23], a[124:127], v[144:147]
    v_cvt_pk_bf16_f32 v187, v182, v183
    s_waitcnt lgkmcnt(4)
    v_mfma_f32_16x16x32_bf16 v[148:151], v[24:27], a[124:127], v[148:151]
    ds_read_b64_tr_b16 v[20:21], v5 offset:37504
    v_mul_f32 v192, s39, v192
    v_mul_f32 v193, s39, v193
    v_mfma_f32_16x16x32_bf16 v[132:135], v[24:27], a[120:123], v[132:135]
    ds_read_b64_tr_b16 v[22:23], v5 offset:38528
    v_exp_f32 v192, v192
    v_mfma_f32_16x16x32_bf16 v[116:119], v[24:27], a[116:119], v[116:119]
    v_exp_f32 v193, v193
    v_mfma_f32_16x16x32_bf16 v[100:103], v[24:27], a[112:115], v[100:103]
    buffer_store_dwordx4 v[184:187], v7, s[16:19], s38 offen offset:1024 sc1
    s_waitcnt lgkmcnt(4)
    v_mfma_f32_16x16x32_bf16 v[104:107], v[28:31], a[112:115], v[104:107]
    ds_read_b64_tr_b16 v[24:25], v5 offset:37536
    s_add_u32 s37, s68, 4096
    v_min_u32 v14, 7, v1
    v_mfma_f32_16x16x32_bf16 v[120:123], v[28:31], a[116:119], v[120:123]
    ds_read_b64_tr_b16 v[26:27], v5 offset:38560
    s_lshl_b32 s98, s43, 2
    s_add_u32 s98, s98, s32
    s_mul_i32 s98, s98, 1024
    v_lshl_add_u32 v14, v14, 7, s98
    v_mfma_f32_16x16x32_bf16 v[136:139], v[28:31], a[120:123], v[136:139]
    v_min_u32 v14, (L_code_end - L_cpconv0 - 64), v14
    v_mul_f32 v194, s39, v194
    v_mfma_f32_16x16x32_bf16 v[152:155], v[28:31], a[124:127], v[152:155]
L_cpconv0:
    s_getpc_b64 s[98:99]
    global_load_dword v74, v14, s[98:99]
    s_waitcnt lgkmcnt(4)
    v_mfma_f32_16x16x32_bf16 v[156:159], v[32:35], a[124:127], v[156:159]
    ds_read_b64_tr_b16 v[28:29], v5 offset:39552
    v_exp_f32 v194, v194
    v_mfma_f32_16x16x32_bf16 v[140:143], v[32:35], a[120:123], v[140:143]
    ds_read_b64_tr_b16 v[30:31], v5 offset:40576
    v_mul_f32 v195, s39, v195
    v_mul_f32 v196, s39, v196
    v_mfma_f32_16x16x32_bf16 v[124:127], v[32:35], a[116:119], v[124:127]
    v_exp_f32 v195, v195
    v_mfma_f32_16x16x32_bf16 v[108:111], v[32:35], a[112:115], v[108:111]
    buffer_load_dword v56, v13, s[80:83], s68 offen
    s_waitcnt lgkmcnt(4)
    v_mfma_f32_16x16x32_bf16 v[96:99], v[20:23], a[128:131], v[96:99]
    ds_read_b64_tr_b16 v[32:33], v5 offset:39584
    v_exp_f32 v196, v196
    v_mfma_f32_16x16x32_bf16 v[112:115], v[20:23], a[132:135], v[112:115]
    ds_read_b64_tr_b16 v[34:35], v5 offset:40608
    v_mul_f32 v197, s39, v197
    v_mul_f32 v198, s39, v198
    v_mfma_f32_16x16x32_bf16 v[128:131], v[20:23], a[136:139], v[128:131]
    v_exp_f32 v197, v197
    v_mfma_f32_16x16x32_bf16 v[144:147], v[20:23], a[140:143], v[144:147]
    buffer_load_dword v57, v13, s[80:83], s37 offen
    s_waitcnt lgkmcnt(4)
    v_mfma_f32_16x16x32_bf16 v[148:151], v[24:27], a[140:143], v[148:151]
    ds_read_b64_tr_b16 v[20:21], v5 offset:38016
    v_exp_f32 v198, v198
    v_mfma_f32_16x16x32_bf16 v[132:135], v[24:27], a[136:139], v[132:135]
    ds_read_b64_tr_b16 v[22:23], v5 offset:39040
    v_mul_f32 v199, s39, v199
    v_add_f32 v192, 1.0, v192
    v_mfma_f32_16x16x32_bf16 v[116:119], v[24:27], a[132:135], v[116:119]
    v_exp_f32 v199, v199
    v_mfma_f32_16x16x32_bf16 v[100:103], v[24:27], a[128:131], v[100:103]
    buffer_load_dwordx4 v[80:83], v11, s[80:83], s68 offen offset:0
    s_waitcnt lgkmcnt(4)
    v_mfma_f32_16x16x32_bf16 v[104:107], v[28:31], a[128:131], v[104:107]
    ds_read_b64_tr_b16 v[24:25], v5 offset:38048
    v_rcp_f32 v192, v192
    v_mfma_f32_16x16x32_bf16 v[120:123], v[28:31], a[132:135], v[120:123]
    ds_read_b64_tr_b16 v[26:27], v5 offset:39072
    v_add_f32 v193, 1.0, v193
    v_add_f32 v194, 1.0, v194
    v_mfma_f32_16x16x32_bf16 v[136:139], v[28:31], a[136:139], v[136:139]
    v_rcp_f32 v193, v193
    v_mfma_f32_16x16x32_bf16 v[152:155], v[28:31], a[140:143], v[152:155]
    buffer_load_dwordx4 v[84:87], v11, s[80:83], s68 offen offset:1024
    s_waitcnt lgkmcnt(4)
    v_mfma_f32_16x16x32_bf16 v[156:159], v[32:35], a[140:143], v[156:159]
    ds_read_b64_tr_b16 v[28:29], v5 offset:40064
    v_rcp_f32 v194, v194
    v_mfma_f32_16x16x32_bf16 v[140:143], v[32:35], a[136:139], v[140:143]
    ds_read_b64_tr_b16 v[30:31], v5 offset:41088
    v_add_f32 v195, 1.0, v195
    v_add_f32 v196, 1.0, v196
    v_mfma_f32_16x16x32_bf16 v[124:127], v[32:35], a[132:135], v[124:127]
    v_rcp_f32 v195, v195
    v_mfma_f32_16x16x32_bf16 v[108:111], v[32:35], a[128:131], v[108:111]
    buffer_load_dwordx4 v[88:91], v11, s[80:83], s68 offen offset:2048
    s_waitcnt lgkmcnt(4)
    v_mfma_f32_16x16x32_bf16 v[96:99], v[20:23], a[144:147], v[96:99]
    ds_read_b64_tr_b16 v[32:33], v5 offset:40096
    v_rcp_f32 v196, v196
    v_mfma_f32_16x16x32_bf16 v[112:115], v[20:23], a[148:151], v[112:115]
    ds_read_b64_tr_b16 v[34:35], v5 offset:41120
    v_add_f32 v197, 1.0, v197
    v_add_f32 v198, 1.0, v198
    v_mfma_f32_16x16x32_bf16 v[128:131], v[20:23], a[152:155], v[128:131]
    v_rcp_f32 v197, v197
    v_mfma_f32_16x16x32_bf16 v[144:147], v[20:23], a[156:159], v[144:147]
    buffer_load_dwordx4 v[92:95], v11, s[80:83], s68 offen offset:3072
    s_waitcnt lgkmcnt(4)
    v_mfma_f32_16x16x32_bf16 v[148:151], v[24:27], a[156:159], v[148:151]
    s_waitcnt vmcnt(11)
    s_barrier
    ds_read_b64_tr_b16 v[20:21], v5 offset:54016
    v_rcp_f32 v198, v198
    v_mfma_f32_16x16x32_bf16 v[132:135], v[24:27], a[152:155], v[132:135]
    ds_read_b64_tr_b16 v[22:23], v5 offset:55040
    v_add_u32 v72, 16512, v77
    v_xor_b32 v73, 16, v77
    v_mfma_f32_16x16x32_bf16 v[116:119], v[24:27], a[148:151], v[116:119]
    v_add_u32 v73, 16512, v73
    v_add_f32 v199, 1.0, v199
    v_mfma_f32_16x16x32_bf16 v[100:103], v[24:27], a[144:147], v[100:103]
    v_mul_f32 v192, v192, v200
    s_waitcnt lgkmcnt(4)
    v_mfma_f32_16x16x32_bf16 v[104:107], v[28:31], a[144:147], v[104:107]
    ds_read_b64_tr_b16 v[24:25], v5 offset:54048
    s_lshl_b32 s36, s32, 10
    s_add_u32 s36, s36, 24704
    v_add_u32 v68, s36, v75
    v_add_u32 v69, s36, v76
    v_mfma_f32_16x16x32_bf16 v[120:123], v[28:31], a[148:151], v[120:123]
    ds_read_b64_tr_b16 v[26:27], v5 offset:55072
    v_rcp_f32 v199, v199
    v_mfma_f32_16x16x32_bf16 v[136:139], v[28:31], a[152:155], v[136:139]
    ds_read_b64_tr_b16 v[52:53], v72 offset:0
    ds_read_b64_tr_b16 v[54:55], v72 offset:512
    v_mfma_f32_16x16x32_bf16 v[152:155], v[28:31], a[156:159], v[152:155]
    ds_read_b64_tr_b16 v[64:65], v73 offset:0
    s_waitcnt lgkmcnt(7)
    v_mfma_f32_16x16x32_bf16 v[156:159], v[32:35], a[156:159], v[156:159]
    ds_read_b64_tr_b16 v[28:29], v5 offset:56064
    ds_read_b64_tr_b16 v[66:67], v73 offset:512
    v_mul_f32 v193, v193, v201
    v_mfma_f32_16x16x32_bf16 v[140:143], v[32:35], a[152:155], v[140:143]
    ds_read_b64_tr_b16 v[30:31], v5 offset:57088
    v_mul_f32 v194, v194, v202
    v_mul_f32 v195, v195, v203
    v_mfma_f32_16x16x32_bf16 v[124:127], v[32:35], a[148:151], v[124:127]
    v_mul_f32 v196, v196, v204
    v_mul_f32 v197, v197, v205
    v_mfma_f32_16x16x32_bf16 v[108:111], v[32:35], a[144:147], v[108:111]
    v_mul_f32 v198, v198, v206
    s_waitcnt lgkmcnt(8)
    v_mfma_f32_16x16x32_bf16 v[96:99], v[20:23], a[160:163], v[96:99]
    ds_read_b64_tr_b16 v[32:33], v5 offset:56096
    v_mul_f32 v199, v199, v207
    v_cvt_pk_bf16_f32 v200, v192, v193
    v_mfma_f32_16x16x32_bf16 v[112:115], v[20:23], a[164:167], v[112:115]
    ds_read_b64_tr_b16 v[34:35], v5 offset:57120
    v_cvt_pk_bf16_f32 v201, v194, v195
    v_cvt_pk_bf16_f32 v202, v196, v197
    v_mfma_f32_16x16x32_bf16 v[128:131], v[20:23], a[168:171], v[128:131]
    s_waitcnt lgkmcnt(6)
    ds_write_b128 v68, v[52:55]
    v_mfma_f32_16x16x32_bf16 v[144:147], v[20:23], a[172:175], v[144:147]
    ds_read_b128 v[52:55], v69
    v_mfma_f32_16x16x32_bf16 v[148:151], v[24:27], a[172:175], v[148:151]
    ds_read_b64_tr_b16 v[20:21], v5 offset:54528
    v_cvt_pk_bf16_f32 v203, v198, v199
    v_mul_f32 v208, s39, v208
    v_mfma_f32_16x16x32_bf16 v[132:135], v[24:27], a[168:171], v[132:135]
    ds_read_b64_tr_b16 v[22:23], v5 offset:55552
    v_exp_f32 v208, v208
    v_mfma_f32_16x16x32_bf16 v[116:119], v[24:27], a[164:167], v[116:119]
    v_mul_f32 v209, s39, v209
    v_mul_f32 v210, s39, v210
    v_mfma_f32_16x16x32_bf16 v[100:103], v[24:27], a[160:163], v[100:103]
    buffer_store_dwordx4 v[200:203], v7, s[16:19], s38 offen offset:2048 sc1
    s_waitcnt lgkmcnt(6)
    v_mfma_f32_16x16x32_bf16 v[104:107], v[28:31], a[160:163], v[104:107]
    ds_read_b64_tr_b16 v[24:25], v5 offset:54560
    v_exp_f32 v209, v209
    v_mfma_f32_16x16x32_bf16 v[120:123], v[28:31], a[164:167], v[120:123]
    ds_read_b64_tr_b16 v[26:27], v5 offset:55584
    v_exp_f32 v210, v210
    v_mfma_f32_16x16x32_bf16 v[136:139], v[28:31], a[168:171], v[136:139]
    v_mul_f32 v211, s39, v211
    v_mul_f32 v212, s39, v212
    v_mfma_f32_16x16x32_bf16 v[152:155], v[28:31], a[172:175], v[152:155]
    s_mov_b32 s100, 1048576
    s_waitcnt lgkmcnt(4)
    buffer_store_dwordx4 v[52:55], v50, s[16:19], s100 offen sc1
    v_mfma_f32_16x16x32_bf16 v[156:159], v[32:35], a[172:175], v[156:159]
    ds_read_b64_tr_b16 v[28:29], v5 offset:56576
    ds_write_b128 v68, v[64:67]
    v_mfma_f32_16x16x32_bf16 v[140:143], v[32:35], a[168:171], v[140:143]
    ds_read_b64_tr_b16 v[30:31], v5 offset:57600
    v_exp_f32 v211, v211
    v_mfma_f32_16x16x32_bf16 v[124:127], v[32:35], a[164:167], v[124:127]
    v_exp_f32 v212, v212
    v_mfma_f32_16x16x32_bf16 v[108:111], v[32:35], a[160:163], v[108:111]
    ds_read_b128 v[64:67], v69
    s_waitcnt lgkmcnt(6)
    v_mfma_f32_16x16x32_bf16 v[96:99], v[20:23], a[176:179], v[96:99]
    ds_read_b64_tr_b16 v[32:33], v5 offset:56608
    v_mul_f32 v213, s39, v213
    v_mul_f32 v214, s39, v214
    v_mfma_f32_16x16x32_bf16 v[112:115], v[20:23], a[180:183], v[112:115]
    ds_read_b64_tr_b16 v[34:35], v5 offset:57632
    v_exp_f32 v213, v213
    v_mfma_f32_16x16x32_bf16 v[128:131], v[20:23], a[184:187], v[128:131]
    v_exp_f32 v214, v214
    v_mfma_f32_16x16x32_bf16 v[144:147], v[20:23], a[188:191], v[144:147]
    v_mul_f32 v215, s39, v215
    s_waitcnt lgkmcnt(6)
    v_mfma_f32_16x16x32_bf16 v[148:151], v[24:27], a[188:191], v[148:151]
    ds_read_b64_tr_b16 v[20:21], v6 offset:4992
    v_exp_f32 v215, v215
    v_mfma_f32_16x16x32_bf16 v[132:135], v[24:27], a[184:187], v[132:135]
    ds_read_b64_tr_b16 v[22:23], v6 offset:6016
    v_add_f32 v208, 1.0, v208
    v_add_f32 v209, 1.0, v209
    v_mfma_f32_16x16x32_bf16 v[116:119], v[24:27], a[180:183], v[116:119]
    v_rcp_f32 v208, v208
    v_mfma_f32_16x16x32_bf16 v[100:103], v[24:27], a[176:179], v[100:103]
    s_mov_b32 s100, 1049600
    s_waitcnt lgkmcnt(4)
    buffer_store_dwordx4 v[64:67], v50, s[16:19], s100 offen sc1
    v_mfma_f32_16x16x32_bf16 v[104:107], v[28:31], a[176:179], v[104:107]
    ds_read_b64_tr_b16 v[24:25], v6 offset:5024
    v_rcp_f32 v209, v209
    v_mfma_f32_16x16x32_bf16 v[120:123], v[28:31], a[180:183], v[120:123]
    ds_read_b64_tr_b16 v[26:27], v6 offset:6048
    v_add_f32 v210, 1.0, v210
    v_add_f32 v211, 1.0, v211
    v_mfma_f32_16x16x32_bf16 v[136:139], v[28:31], a[184:187], v[136:139]
    v_rcp_f32 v210, v210
    v_mfma_f32_16x16x32_bf16 v[152:155], v[28:31], a[188:191], v[152:155]
    v_add_f32 v212, 1.0, v212
    s_waitcnt lgkmcnt(4)
    v_mfma_f32_16x16x32_bf16 v[156:159], v[32:35], a[188:191], v[156:159]
    ds_read_b64_tr_b16 v[28:29], v6 offset:7040
    v_rcp_f32 v211, v211
    v_mfma_f32_16x16x32_bf16 v[140:143], v[32:35], a[184:187], v[140:143]
    ds_read_b64_tr_b16 v[30:31], v6 offset:8064
    v_rcp_f32 v212, v212
    v_mfma_f32_16x16x32_bf16 v[124:127], v[32:35], a[180:183], v[124:127]
    v_add_f32 v213, 1.0, v213
    v_add_f32 v214, 1.0, v214
    v_mfma_f32_16x16x32_bf16 v[108:111], v[32:35], a[176:179], v[108:111]
    v_add_f32 v215, 1.0, v215
    s_waitcnt lgkmcnt(4)
    v_mfma_f32_16x16x32_bf16 v[96:99], v[20:23], a[192:195], v[96:99]
    ds_read_b64_tr_b16 v[32:33], v6 offset:7072
    v_rcp_f32 v213, v213
    v_mfma_f32_16x16x32_bf16 v[112:115], v[20:23], a[196:199], v[112:115]
    ds_read_b64_tr_b16 v[34:35], v6 offset:8096
    v_rcp_f32 v214, v214
    v_mfma_f32_16x16x32_bf16 v[128:131], v[20:23], a[200:203], v[128:131]
    v_rcp_f32 v215, v215
    v_mfma_f32_16x16x32_bf16 v[144:147], v[20:23], a[204:207], v[144:147]
    v_mul_f32 v208, v208, v216
    s_waitcnt lgkmcnt(4)
    v_mfma_f32_16x16x32_bf16 v[148:151], v[24:27], a[204:207], v[148:151]
    ds_read_b64_tr_b16 v[20:21], v6 offset:5504
    v_mul_f32 v209, v209, v217
    v_mul_f32 v210, v210, v218
    v_mfma_f32_16x16x32_bf16 v[132:135], v[24:27], a[200:203], v[132:135]
    ds_read_b64_tr_b16 v[22:23], v6 offset:6528
    v_mul_f32 v211, v211, v219
    v_mul_f32 v212, v212, v220
    v_mfma_f32_16x16x32_bf16 v[116:119], v[24:27], a[196:199], v[116:119]
    v_mul_f32 v213, v213, v221
    v_mul_f32 v214, v214, v222
    v_mfma_f32_16x16x32_bf16 v[100:103], v[24:27], a[192:195], v[100:103]
    v_mul_f32 v215, v215, v223
    s_waitcnt lgkmcnt(4)
    v_mfma_f32_16x16x32_bf16 v[104:107], v[28:31], a[192:195], v[104:107]
    ds_read_b64_tr_b16 v[24:25], v6 offset:5536
    v_cvt_pk_bf16_f32 v216, v208, v209
    v_cvt_pk_bf16_f32 v217, v210, v211
    v_mfma_f32_16x16x32_bf16 v[120:123], v[28:31], a[196:199], v[120:123]
    ds_read_b64_tr_b16 v[26:27], v6 offset:6560
    v_cvt_pk_bf16_f32 v218, v212, v213
    v_cvt_pk_bf16_f32 v219, v214, v215
    v_mfma_f32_16x16x32_bf16 v[136:139], v[28:31], a[200:203], v[136:139]
    v_mfma_f32_16x16x32_bf16 v[152:155], v[28:31], a[204:207], v[152:155]
    buffer_store_dwordx4 v[216:219], v7, s[16:19], s38 offen offset:3072 sc1
    s_waitcnt lgkmcnt(4)
    v_mfma_f32_16x16x32_bf16 v[156:159], v[32:35], a[204:207], v[156:159]
    ds_read_b64_tr_b16 v[28:29], v6 offset:7552
    s_add_u32 s38, s38, s96
    v_mfma_f32_16x16x32_bf16 v[140:143], v[32:35], a[200:203], v[140:143]
    ds_read_b64_tr_b16 v[30:31], v6 offset:8576
    v_mfma_f32_16x16x32_bf16 v[124:127], v[32:35], a[196:199], v[124:127]
    v_mfma_f32_16x16x32_bf16 v[108:111], v[32:35], a[192:195], v[108:111]
    s_waitcnt lgkmcnt(4)
    v_mfma_f32_16x16x32_bf16 v[96:99], v[20:23], a[208:211], v[96:99]
    ds_read_b64_tr_b16 v[32:33], v6 offset:7584
    v_mfma_f32_16x16x32_bf16 v[112:115], v[20:23], a[212:215], v[112:115]
    ds_read_b64_tr_b16 v[34:35], v6 offset:8608
    v_mfma_f32_16x16x32_bf16 v[128:131], v[20:23], a[216:219], v[128:131]
    v_mfma_f32_16x16x32_bf16 v[144:147], v[20:23], a[220:223], v[144:147]
    s_waitcnt lgkmcnt(4)
    v_mfma_f32_16x16x32_bf16 v[148:151], v[24:27], a[220:223], v[148:151]
    s_barrier
    ds_read_b64_tr_b16 v[20:21], v4 offset:0
    v_mfma_f32_16x16x32_bf16 v[132:135], v[24:27], a[216:219], v[132:135]
    ds_read_b64_tr_b16 v[22:23], v4 offset:1024
    v_mfma_f32_16x16x32_bf16 v[116:119], v[24:27], a[212:215], v[116:119]
    v_mfma_f32_16x16x32_bf16 v[100:103], v[24:27], a[208:211], v[100:103]
    s_waitcnt lgkmcnt(4)
    v_mfma_f32_16x16x32_bf16 v[104:107], v[28:31], a[208:211], v[104:107]
    ds_read_b64_tr_b16 v[24:25], v4 offset:32
    v_mfma_f32_16x16x32_bf16 v[120:123], v[28:31], a[212:215], v[120:123]
    ds_read_b64_tr_b16 v[26:27], v4 offset:1056
    v_mfma_f32_16x16x32_bf16 v[136:139], v[28:31], a[216:219], v[136:139]
    v_mfma_f32_16x16x32_bf16 v[152:155], v[28:31], a[220:223], v[152:155]
    s_waitcnt lgkmcnt(4)
    v_mfma_f32_16x16x32_bf16 v[156:159], v[32:35], a[220:223], v[156:159]
    ds_read_b64_tr_b16 v[28:29], v4 offset:2048
    v_mfma_f32_16x16x32_bf16 v[140:143], v[32:35], a[216:219], v[140:143]
    ds_read_b64_tr_b16 v[30:31], v4 offset:3072
    v_mfma_f32_16x16x32_bf16 v[124:127], v[32:35], a[212:215], v[124:127]
    v_mfma_f32_16x16x32_bf16 v[108:111], v[32:35], a[208:211], v[108:111]
    s_waitcnt lgkmcnt(4)
    v_mfma_f32_16x16x32_bf16 v[96:99], v[20:23], a[224:227], v[96:99]
    ds_read_b64_tr_b16 v[32:33], v4 offset:2080
    v_mfma_f32_16x16x32_bf16 v[112:115], v[20:23], a[228:231], v[112:115]
    ds_read_b64_tr_b16 v[34:35], v4 offset:3104
    v_mfma_f32_16x16x32_bf16 v[128:131], v[20:23], a[232:235], v[128:131]
    v_mfma_f32_16x16x32_bf16 v[144:147], v[20:23], a[236:239], v[144:147]
    buffer_load_dword v16, v60, s[16:19], 0 offen offset:512 sc1
    s_waitcnt lgkmcnt(4)
    v_mfma_f32_16x16x32_bf16 v[148:151], v[24:27], a[236:239], v[148:151]
    ds_read_b64_tr_b16 v[20:21], v4 offset:512
    v_mfma_f32_16x16x32_bf16 v[132:135], v[24:27], a[232:235], v[132:135]
    ds_read_b64_tr_b16 v[22:23], v4 offset:1536
    v_mfma_f32_16x16x32_bf16 v[116:119], v[24:27], a[228:231], v[116:119]
    v_mfma_f32_16x16x32_bf16 v[100:103], v[24:27], a[224:227], v[100:103]
    s_waitcnt lgkmcnt(4)
    v_mfma_f32_16x16x32_bf16 v[104:107], v[28:31], a[224:227], v[104:107]
    ds_read_b64_tr_b16 v[24:25], v4 offset:544
    v_mfma_f32_16x16x32_bf16 v[120:123], v[28:31], a[228:231], v[120:123]
    ds_read_b64_tr_b16 v[26:27], v4 offset:1568
    v_mfma_f32_16x16x32_bf16 v[136:139], v[28:31], a[232:235], v[136:139]
    v_mfma_f32_16x16x32_bf16 v[152:155], v[28:31], a[236:239], v[152:155]
    s_waitcnt lgkmcnt(4)
    v_mfma_f32_16x16x32_bf16 v[156:159], v[32:35], a[236:239], v[156:159]
    ds_read_b64_tr_b16 v[28:29], v4 offset:2560
    v_mfma_f32_16x16x32_bf16 v[140:143], v[32:35], a[232:235], v[140:143]
    ds_read_b64_tr_b16 v[30:31], v4 offset:3584
    v_mfma_f32_16x16x32_bf16 v[124:127], v[32:35], a[228:231], v[124:127]
    v_mfma_f32_16x16x32_bf16 v[108:111], v[32:35], a[224:227], v[108:111]
    s_waitcnt lgkmcnt(4)
    v_mfma_f32_16x16x32_bf16 v[96:99], v[20:23], a[240:243], v[96:99]
    ds_read_b64_tr_b16 v[32:33], v4 offset:2592
    v_mfma_f32_16x16x32_bf16 v[112:115], v[20:23], a[244:247], v[112:115]
    ds_read_b64_tr_b16 v[34:35], v4 offset:3616
    v_mfma_f32_16x16x32_bf16 v[128:131], v[20:23], a[248:251], v[128:131]
    v_mfma_f32_16x16x32_bf16 v[144:147], v[20:23], a[252:255], v[144:147]
    s_waitcnt lgkmcnt(4)
    v_mfma_f32_16x16x32_bf16 v[148:151], v[24:27], a[252:255], v[148:151]
    ds_read_b64_tr_b16 v[20:21], v5 offset:17024
    v_mfma_f32_16x16x32_bf16 v[132:135], v[24:27], a[248:251], v[132:135]
    ds_read_b64_tr_b16 v[22:23], v5 offset:18048
    v_mfma_f32_16x16x32_bf16 v[116:119], v[24:27], a[244:247], v[116:119]
    v_mfma_f32_16x16x32_bf16 v[100:103], v[24:27], a[240:243], v[100:103]
    s_waitcnt lgkmcnt(4)
    v_mfma_f32_16x16x32_bf16 v[104:107], v[28:31], a[240:243], v[104:107]
    ds_read_b64_tr_b16 v[24:25], v5 offset:17056
    v_mfma_f32_16x16x32_bf16 v[120:123], v[28:31], a[244:247], v[120:123]
    ds_read_b64_tr_b16 v[26:27], v5 offset:18080
    v_mfma_f32_16x16x32_bf16 v[136:139], v[28:31], a[248:251], v[136:139]
    v_mfma_f32_16x16x32_bf16 v[152:155], v[28:31], a[252:255], v[152:155]
    s_waitcnt lgkmcnt(4)
    v_mfma_f32_16x16x32_bf16 v[156:159], v[32:35], a[252:255], v[156:159]
    ds_read_b64_tr_b16 v[28:29], v5 offset:19072
    v_mfma_f32_16x16x32_bf16 v[140:143], v[32:35], a[248:251], v[140:143]
    ds_read_b64_tr_b16 v[30:31], v5 offset:20096
    v_mfma_f32_16x16x32_bf16 v[124:127], v[32:35], a[244:247], v[124:127]
    v_mfma_f32_16x16x32_bf16 v[108:111], v[32:35], a[240:243], v[108:111]
    s_waitcnt lgkmcnt(4)
    v_mfma_f32_16x16x32_bf16 v[96:99], v[20:23], v[224:227], v[96:99]
    ds_read_b64_tr_b16 v[32:33], v5 offset:19104
    v_mfma_f32_16x16x32_bf16 v[112:115], v[20:23], v[228:231], v[112:115]
    ds_read_b64_tr_b16 v[34:35], v5 offset:20128
    v_mfma_f32_16x16x32_bf16 v[128:131], v[20:23], v[232:235], v[128:131]
    v_mfma_f32_16x16x32_bf16 v[144:147], v[20:23], v[236:239], v[144:147]
    s_waitcnt lgkmcnt(4)
    v_mfma_f32_16x16x32_bf16 v[148:151], v[24:27], v[236:239], v[148:151]
    ds_read_b64_tr_b16 v[20:21], v5 offset:17536
    v_mfma_f32_16x16x32_bf16 v[132:135], v[24:27], v[232:235], v[132:135]
    ds_read_b64_tr_b16 v[22:23], v5 offset:18560
    v_mfma_f32_16x16x32_bf16 v[116:119], v[24:27], v[228:231], v[116:119]
    v_mfma_f32_16x16x32_bf16 v[100:103], v[24:27], v[224:227], v[100:103]
    s_waitcnt lgkmcnt(4)
    v_mfma_f32_16x16x32_bf16 v[104:107], v[28:31], v[224:227], v[104:107]
    ds_read_b64_tr_b16 v[24:25], v5 offset:17568
    v_mfma_f32_16x16x32_bf16 v[120:123], v[28:31], v[228:231], v[120:123]
    ds_read_b64_tr_b16 v[26:27], v5 offset:18592
    v_mfma_f32_16x16x32_bf16 v[136:139], v[28:31], v[232:235], v[136:139]
    v_mfma_f32_16x16x32_bf16 v[152:155], v[28:31], v[236:239], v[152:155]
    s_waitcnt lgkmcnt(4)
    v_mfma_f32_16x16x32_bf16 v[156:159], v[32:35], v[236:239], v[156:159]
    ds_read_b64_tr_b16 v[28:29], v5 offset:19584
    v_mfma_f32_16x16x32_bf16 v[140:143], v[32:35], v[232:235], v[140:143]
    ds_read_b64_tr_b16 v[30:31], v5 offset:20608
    v_mfma_f32_16x16x32_bf16 v[124:127], v[32:35], v[228:231], v[124:127]
    v_mfma_f32_16x16x32_bf16 v[108:111], v[32:35], v[224:227], v[108:111]
    s_waitcnt lgkmcnt(4)
    v_mfma_f32_16x16x32_bf16 v[96:99], v[20:23], v[240:243], v[96:99]
    ds_read_b64_tr_b16 v[32:33], v5 offset:19616
    v_mfma_f32_16x16x32_bf16 v[112:115], v[20:23], v[244:247], v[112:115]
    ds_read_b64_tr_b16 v[34:35], v5 offset:20640
    v_mfma_f32_16x16x32_bf16 v[128:131], v[20:23], v[248:251], v[128:131]
    v_mfma_f32_16x16x32_bf16 v[144:147], v[20:23], v[252:255], v[144:147]
    s_waitcnt lgkmcnt(4)
    v_mfma_f32_16x16x32_bf16 v[148:151], v[24:27], v[252:255], v[148:151]
    v_mfma_f32_16x16x32_bf16 v[132:135], v[24:27], v[248:251], v[132:135]
    v_mfma_f32_16x16x32_bf16 v[116:119], v[24:27], v[244:247], v[116:119]
    v_mfma_f32_16x16x32_bf16 v[100:103], v[24:27], v[240:243], v[100:103]
    s_waitcnt lgkmcnt(2)
    v_mfma_f32_16x16x32_bf16 v[104:107], v[28:31], v[240:243], v[104:107]
    v_mfma_f32_16x16x32_bf16 v[120:123], v[28:31], v[244:247], v[120:123]
    v_mfma_f32_16x16x32_bf16 v[136:139], v[28:31], v[248:251], v[136:139]
    v_mfma_f32_16x16x32_bf16 v[152:155], v[28:31], v[252:255], v[152:155]
    s_waitcnt lgkmcnt(0)
    v_mfma_f32_16x16x32_bf16 v[156:159], v[32:35], v[252:255], v[156:159]
    v_mfma_f32_16x16x32_bf16 v[140:143], v[32:35], v[248:251], v[140:143]
    v_mfma_f32_16x16x32_bf16 v[124:127], v[32:35], v[244:247], v[124:127]
    v_mfma_f32_16x16x32_bf16 v[108:111], v[32:35], v[240:243], v[108:111]
    s_waitcnt vmcnt(0)
    v_cmp_ne_u32 vcc, s66, v16
    s_cbranch_vccnz L_slow_convA
L_ret_convA:
    s_lshr_b32 s45, s68, 9
    s_load_dwordx4 s[4:7], s[74:75], s45
    s_lshr_b32 s45, s68, 11
    s_load_dword s34, s[78:79], s45
    s_add_u32 s46, s94, 512
    s_lshl_b32 s45, s46, 3
    s_load_dwordx2 s[88:89], s[74:75], s45
    s_lshr_b32 s45, s46, 1
    s_lshl_b32 s45, s45, 2
    s_load_dword s33, s[78:79], s45
    s_lshr_b32 s37, s68, 5
    s_add_u32 s36, s37, 1048576
    s_add_u32 s37, s37, 4194304
    buffer_load_dwordx4 v[162:165], v61, s[16:19], s36 offen offset:0 sc1
    buffer_load_dwordx4 v[166:169], v61, s[16:19], s37 offen offset:0 sc1
    s_lshr_b32 s37, s68, 5
    s_add_u32 s36, s37, 1638400
    s_add_u32 s37, s37, 4784128
    buffer_load_dwordx4 v[172:175], v61, s[16:19], s36 offen offset:0 sc1
    buffer_load_dwordx4 v[176:179], v61, s[16:19], s37 offen offset:0 sc1
    s_lshr_b32 s37, s68, 5
    s_add_u32 s36, s37, 2228224
    s_add_u32 s37, s37, 5373952
    buffer_load_dwordx4 v[182:185], v61, s[16:19], s36 offen offset:0 sc1
    buffer_load_dwordx4 v[186:189], v61, s[16:19], s37 offen offset:0 sc1
    s_lshr_b32 s37, s68, 5
    s_add_u32 s36, s37, 2818048
    s_add_u32 s37, s37, 5963776
    buffer_load_dwordx4 v[192:195], v61, s[16:19], s36 offen offset:0 sc1
    buffer_load_dwordx4 v[196:199], v61, s[16:19], s37 offen offset:0 sc1
    v_mul_f32 v96, s39, v96
    v_mul_f32 v97, s39, v97
    v_mul_f32 v98, s39, v98
    v_mul_f32 v99, s39, v99
    v_mul_f32 v100, s39, v100
    v_mul_f32 v101, s39, v101
    v_mul_f32 v102, s39, v102
    v_mul_f32 v103, s39, v103
    v_mul_f32 v112, s39, v112
    v_mul_f32 v113, s39, v113
    v_mul_f32 v114, s39, v114
    v_mul_f32 v115, s39, v115
    v_mul_f32 v116, s39, v116
    v_mul_f32 v117, s39, v117
    v_mul_f32 v118, s39, v118
    v_mul_f32 v119, s39, v119
    v_mul_f32 v128, s39, v128
    v_mul_f32 v129, s39, v129
    v_mul_f32 v130, s39, v130
    v_mul_f32 v131, s39, v131
    v_mul_f32 v132, s39, v132
    v_mul_f32 v133, s39, v133
    v_mul_f32 v134, s39, v134
    v_mul_f32 v135, s39, v135
    v_mul_f32 v144, s39, v144
    v_mul_f32 v145, s39, v145
    v_mul_f32 v146, s39, v146
    v_mul_f32 v147, s39, v147
    v_mul_f32 v148, s39, v148
    v_mul_f32 v149, s39, v149
    v_mul_f32 v150, s39, v150
    v_mul_f32 v151, s39, v151
    v_exp_f32 v96, v96
    v_exp_f32 v97, v97
    v_exp_f32 v98, v98
    v_exp_f32 v99, v99
    v_exp_f32 v100, v100
    v_exp_f32 v101, v101
    v_exp_f32 v102, v102
    v_exp_f32 v103, v103
    v_exp_f32 v112, v112
    v_exp_f32 v113, v113
    v_exp_f32 v114, v114
    v_exp_f32 v115, v115
    v_exp_f32 v116, v116
    v_exp_f32 v117, v117
    v_exp_f32 v118, v118
    v_exp_f32 v119, v119
    v_exp_f32 v128, v128
    v_exp_f32 v129, v129
    v_exp_f32 v130, v130
    v_exp_f32 v131, v131
    v_exp_f32 v132, v132
    v_exp_f32 v133, v133
    v_exp_f32 v134, v134
    v_exp_f32 v135, v135
    v_exp_f32 v144, v144
    v_exp_f32 v145, v145
    v_exp_f32 v146, v146
    v_exp_f32 v147, v147
    v_exp_f32 v148, v148
    v_exp_f32 v149, v149
    v_exp_f32 v150, v150
    v_exp_f32 v151, v151
    v_add_f32 v96, 1.0, v96
    v_add_f32 v97, 1.0, v97
    v_add_f32 v98, 1.0, v98
    v_add_f32 v99, 1.0, v99
    v_add_f32 v100, 1.0, v100
    v_add_f32 v101, 1.0, v101
    v_add_f32 v102, 1.0, v102
    v_add_f32 v103, 1.0, v103
    v_add_f32 v112, 1.0, v112
    v_add_f32 v113, 1.0, v113
    v_add_f32 v114, 1.0, v114
    v_add_f32 v115, 1.0, v115
    v_add_f32 v116, 1.0, v116
    v_add_f32 v117, 1.0, v117
    v_add_f32 v118, 1.0, v118
    v_add_f32 v119, 1.0, v119
    v_add_f32 v128, 1.0, v128
    v_add_f32 v129, 1.0, v129
    v_add_f32 v130, 1.0, v130
    v_add_f32 v131, 1.0, v131
    v_add_f32 v132, 1.0, v132
    v_add_f32 v133, 1.0, v133
    v_add_f32 v134, 1.0, v134
    v_add_f32 v135, 1.0, v135
    v_add_f32 v144, 1.0, v144
    v_add_f32 v145, 1.0, v145
    v_add_f32 v146, 1.0, v146
    v_add_f32 v147, 1.0, v147
    v_add_f32 v148, 1.0, v148
    v_add_f32 v149, 1.0, v149
    v_add_f32 v150, 1.0, v150
    v_add_f32 v151, 1.0, v151
    v_rcp_f32 v96, v96
    v_rcp_f32 v97, v97
    v_rcp_f32 v98, v98
    v_rcp_f32 v99, v99
    v_rcp_f32 v100, v100
    v_rcp_f32 v101, v101
    v_rcp_f32 v102, v102
    v_rcp_f32 v103, v103
    v_rcp_f32 v112, v112
    v_rcp_f32 v113, v113
    v_rcp_f32 v114, v114
    v_rcp_f32 v115, v115
    v_rcp_f32 v116, v116
    v_rcp_f32 v117, v117
    v_rcp_f32 v118, v118
    v_rcp_f32 v119, v119
    v_rcp_f32 v128, v128
    v_rcp_f32 v129, v129
    v_rcp_f32 v130, v130
    v_rcp_f32 v131, v131
    v_rcp_f32 v132, v132
    v_rcp_f32 v133, v133
    v_rcp_f32 v134, v134
    v_rcp_f32 v135, v135
    v_rcp_f32 v144, v144
    v_rcp_f32 v145, v145
    v_rcp_f32 v146, v146
    v_rcp_f32 v147, v147
    v_rcp_f32 v148, v148
    v_rcp_f32 v149, v149
    v_rcp_f32 v150, v150
    v_rcp_f32 v151, v151
    v_mul_f32 v96, v96, v104
    v_mul_f32 v97, v97, v105
    v_mul_f32 v98, v98, v106
    v_mul_f32 v99, v99, v107
    v_mul_f32 v100, v100, v108
    v_mul_f32 v101, v101, v109
    v_mul_f32 v102, v102, v110
    v_mul_f32 v103, v103, v111
    v_mul_f32 v112, v112, v120
    v_mul_f32 v113, v113, v121
    v_mul_f32 v114, v114, v122
    v_mul_f32 v115, v115, v123
    v_mul_f32 v116, v116, v124
    v_mul_f32 v117, v117, v125
    v_mul_f32 v118, v118, v126
    v_mul_f32 v119, v119, v127
    v_mul_f32 v128, v128, v136
    v_mul_f32 v129, v129, v137
    v_mul_f32 v130, v130, v138
    v_mul_f32 v131, v131, v139
    v_mul_f32 v132, v132, v140
    v_mul_f32 v133, v133, v141
    v_mul_f32 v134, v134, v142
    v_mul_f32 v135, v135, v143
    v_mul_f32 v144, v144, v152
    v_mul_f32 v145, v145, v153
    v_mul_f32 v146, v146, v154
    v_mul_f32 v147, v147, v155
    v_mul_f32 v148, v148, v156
    v_mul_f32 v149, v149, v157
    v_mul_f32 v150, v150, v158
    v_mul_f32 v151, v151, v159
    v_cvt_pk_bf16_f32 v104, v96, v97
    v_cvt_pk_bf16_f32 v105, v98, v99
    v_cvt_pk_bf16_f32 v106, v100, v101
    v_cvt_pk_bf16_f32 v107, v102, v103
    v_cvt_pk_bf16_f32 v120, v112, v113
    v_cvt_pk_bf16_f32 v121, v114, v115
    v_cvt_pk_bf16_f32 v122, v116, v117
    v_cvt_pk_bf16_f32 v123, v118, v119
    v_cvt_pk_bf16_f32 v136, v128, v129
    v_cvt_pk_bf16_f32 v137, v130, v131
    v_cvt_pk_bf16_f32 v138, v132, v133
    v_cvt_pk_bf16_f32 v139, v134, v135
    v_cvt_pk_bf16_f32 v152, v144, v145
    v_cvt_pk_bf16_f32 v153, v146, v147
    v_cvt_pk_bf16_f32 v154, v148, v149
    v_cvt_pk_bf16_f32 v155, v150, v151
    buffer_store_dwordx4 v[104:107], v7, s[16:19], s38 offen offset:0 sc1
    buffer_store_dwordx4 v[120:123], v7, s[16:19], s38 offen offset:1024 sc1
    buffer_store_dwordx4 v[136:139], v7, s[16:19], s38 offen offset:2048 sc1
    buffer_store_dwordx4 v[152:155], v7, s[16:19], s38 offen offset:3072 sc1
    s_add_u32 s38, s38, s96
    s_lshl_b32 s36, s32, 11
    s_add_u32 s36, s36, 28800
    v_and_b32 v19, 48, v1
    v_add_u32 v19, s36, v19
    v_add_u32 v2, s48, v19
    ds_read_b128 v[96:99], v2 offset:0
    ds_read_b128 v[100:103], v2 offset:64
    v_add_u32 v3, s49, v19
    ds_read_b128 v[104:107], v3 offset:0
    ds_read_b128 v[108:111], v3 offset:64
    v_add_u32 v2, s50, v19
    ds_read_b128 v[112:115], v2 offset:0
    ds_read_b128 v[116:119], v2 offset:64
    v_add_u32 v3, s51, v19
    ds_read_b128 v[120:123], v3 offset:0
    ds_read_b128 v[124:127], v3 offset:64
    v_add_u32 v2, s52, v19
    ds_read_b128 v[128:131], v2 offset:0
    ds_read_b128 v[132:135], v2 offset:64
    v_add_u32 v3, s53, v19
    ds_read_b128 v[136:139], v3 offset:0
    ds_read_b128 v[140:143], v3 offset:64
    v_add_u32 v2, s54, v19
    ds_read_b128 v[144:147], v2 offset:0
    ds_read_b128 v[148:151], v2 offset:64
    v_add_u32 v3, s55, v19
    ds_read_b128 v[152:155], v3 offset:0
    ds_read_b128 v[156:159], v3 offset:64
    v_add_u32 v2, s56, v19
    ds_read_b128 v[20:23], v2 offset:0
    ds_read_b128 v[24:27], v2 offset:64
    s_waitcnt lgkmcnt(0)
    s_barrier
    s_cmp_lt_u32 s41, 2
    s_cbranch_scc0 L_g23
    s_cmp_eq_u32 s41, 0
    s_cbranch_scc0 L_g1
    v_mfma_f32_16x16x32_bf16 v[32:35], v[96:99], a[0:3], 0
    v_mfma_f32_16x16x32_bf16 v[32:35], v[100:103], a[16:19], v[32:35]
    v_mfma_f32_16x16x32_bf16 v[32:35], v[104:107], a[32:35], v[32:35]
    v_mfma_f32_16x16x32_bf16 v[32:35], v[108:111], a[48:51], v[32:35]
    v_mfma_f32_16x16x32_bf16 v[32:35], v[112:115], a[64:67], v[32:35]
    v_mfma_f32_16x16x32_bf16 v[32:35], v[116:119], a[80:83], v[32:35]
    v_mfma_f32_16x16x32_bf16 v[32:35], v[120:123], a[96:99], v[32:35]
    v_mfma_f32_16x16x32_bf16 v[32:35], v[124:127], a[112:115], v[32:35]
    v_mfma_f32_16x16x32_bf16 v[32:35], v[128:131], a[128:131], v[32:35]
    v_mfma_f32_16x16x32_bf16 v[32:35], v[132:135], a[144:147], v[32:35]
    v_mfma_f32_16x16x32_bf16 v[32:35], v[136:139], a[160:163], v[32:35]
    v_mfma_f32_16x16x32_bf16 v[32:35], v[140:143], a[176:179], v[32:35]
    v_mfma_f32_16x16x32_bf16 v[32:35], v[144:147], a[192:195], v[32:35]
    v_mfma_f32_16x16x32_bf16 v[32:35], v[148:151], a[208:211], v[32:35]
    v_mfma_f32_16x16x32_bf16 v[32:35], v[152:155], a[224:227], v[32:35]
    v_mfma_f32_16x16x32_bf16 v[32:35], v[156:159], a[240:243], v[32:35]
    v_mfma_f32_16x16x32_bf16 v[32:35], v[20:23], v[224:227], v[32:35]
    v_mfma_f32_16x16x32_bf16 v[32:35], v[24:27], v[240:243], v[32:35]
L_gdone:
    s_lshr_b32 s36, s4, 16
    s_pack_ll_b32_b16 s48, s36, s4
    s_lshr_b32 s36, s5, 16
    s_pack_ll_b32_b16 s49, s36, s5
    s_and_b32 s50, s4, 0xffff
    s_pack_lh_b32_b16 s51, s5, s4
    s_and_b32 s52, s5, 0xffff0000
    s_lshl_b32 s64, s66, 16
    s_mul_i32 s65, s32, 25856
    v_add_u32 v4, s65, v11
    v_sub_u32 v5, s65, v11
    v_add_u32 v5, 9328, v5
    v_bfe_u32 v18, v1, 3, 1
    v_mul_u32_u24 v18, 4160, v18
    v_lshl_add_u32 v6, v10, 2, v18
    v_and_b32 v7, 0x1f0, v11
    v_add_u32 v7, 12416, v7
    v_add_u32 v19, s65, v6
    v_add_u32 v18, s65, v7
    v_mov_b32 v96, 0
    v_mov_b32 v97, 0
    v_mov_b32 v98, 0
    v_mov_b32 v99, 0
    v_lshlrev_b32 v56, 16, v56
    ds_write_b32 v19, v56 offset:0
    ds_write_b128 v18, v[96:99] offset:0
    v_lshlrev_b32 v57, 16, v57
    ds_write_b32 v19, v57 offset:12928
    ds_write_b128 v18, v[96:99] offset:12928
    v_add_u32 v18, 103424, v7
    ds_write_b128 v18, v[96:99]
    v_mov_b32_dpp v120, v80 wave_shl:1 row_mask:0xf bank_mask:0xf
    v_readlane_b32 s45, v84, 0
    s_nop 3
    v_writelane_b32 v120, s45, 63
    v_alignbit_b32 v104, v81, v80, 16
    v_alignbit_b32 v105, v82, v81, 16
    v_alignbit_b32 v106, v83, v82, 16
    v_alignbit_b32 v107, v120, v83, 16
    ds_write_b128 v4, v[80:83] offset:32
    ds_write_b128 v4, v[104:107] offset:4192
    v_mov_b32_dpp v121, v84 wave_shl:1 row_mask:0xf bank_mask:0xf
    v_readlane_b32 s45, v88, 0
    s_nop 3
    v_writelane_b32 v121, s45, 63
    v_alignbit_b32 v108, v85, v84, 16
    v_alignbit_b32 v109, v86, v85, 16
    v_alignbit_b32 v110, v87, v86, 16
    v_alignbit_b32 v111, v121, v87, 16
    ds_write_b128 v4, v[84:87] offset:1056
    ds_write_b128 v4, v[108:111] offset:5216
    v_mov_b32_dpp v122, v88 wave_shl:1 row_mask:0xf bank_mask:0xf
    v_readlane_b32 s45, v92, 0
    s_nop 3
    v_writelane_b32 v122, s45, 63
    v_alignbit_b32 v112, v89, v88, 16
    v_alignbit_b32 v113, v90, v89, 16
    v_alignbit_b32 v114, v91, v90, 16
    v_alignbit_b32 v115, v122, v91, 16
    ds_write_b128 v4, v[88:91] offset:2080
    ds_write_b128 v4, v[112:115] offset:6240
    v_mov_b32_dpp v123, v92 wave_shl:1 row_mask:0xf bank_mask:0xf
    v_alignbit_b32 v116, v93, v92, 16
    v_alignbit_b32 v117, v94, v93, 16
    v_alignbit_b32 v118, v95, v94, 16
    v_alignbit_b32 v119, v123, v95, 16
    ds_write_b128 v4, v[92:95] offset:3104
    ds_write_b128 v4, v[116:119] offset:7264
    s_lshl_b32 s36, s40, 3
    s_add_u32 s36, s36, s41
    s_and_b32 s37, s32, 1
    s_lshl_b32 s37, s37, 2
    s_add_u32 s36, s36, s37
    s_lshl_b32 s36, s36, 8
    s_add_u32 s36, s36, 393216
    s_cmp_lt_u32 s32, 2
    s_cselect_b32 s36, s36, 0x40000000
    v_lshl_add_u32 v19, v1, 2, s36
    v_cvt_pk_bf16_f32 v32, 0, v32
    v_mul_f32 v32, s39, v32
    v_exp_f32 v32, v32
    s_nop 0
    v_add_f32 v32, 1.0, v32
    v_rcp_f32 v32, v32
    s_nop 0
    v_cvt_pk_bf16_f32 v32, s64, v32
    buffer_store_dword v32, v19, s[16:19], 0 offen sc1
    v_and_b32 v20, 15, v1
    v_lshrrev_b32 v21, 4, v1
    v_and_b32 v19, 1, v20
    v_add_u32 v18, v20, v19
    v_lshlrev_b32 v18, 1, v18
    v_lshl_add_u32 v18, v21, 4, v18
    v_xor_b32 v19, 1, v19
    v_mul_u32_u24 v19, 4160, v19
    v_add_u32 v3, v19, v18
    v_add_u32 v220, s65, v3
    v_lshlrev_b32 v19, 5, v20
    v_lshlrev_b32 v18, 4, v21
    v_sub_u32 v18, v18, v19
    v_add_u32 v14, 8800, v18
    v_add_u32 v2, s65, v14
    v_lshl_add_u32 v19, v21, 3, v20
    v_sub_u32 v19, 15, v19
    v_and_b32 v18, 1, v19
    v_lshlrev_b32 v18, 4, v18
    v_mov_b32 v22, 0xffff
    v_lshlrev_b32 v22, v18, v22
    v_ashrrev_i32 v19, 1, v19
    s_pack_ll_b32_b16 s61, s34, s34
    v_add_u32 v221, 1024, v220
    v_add_u32 v222, 2048, v220
    v_add_u32 v223, 3072, v220
    v_cmp_eq_u32 vcc, 0, v19
    s_nop 1
    v_cndmask_b32 v128, 0, v22, vcc
    v_cmp_eq_u32 vcc, 1, v19
    s_nop 1
    v_cndmask_b32 v129, 0, v22, vcc
    v_cmp_eq_u32 vcc, 2, v19
    s_nop 1
    v_cndmask_b32 v130, 0, v22, vcc
    v_cmp_eq_u32 vcc, 3, v19
    s_nop 1
    v_cndmask_b32 v131, 0, v22, vcc
    v_and_b32 v136, s61, v128
    v_and_b32 v137, s61, v129
    v_and_b32 v138, s61, v130
    v_and_b32 v139, s61, v131
    s_lshl_b32 s36, s94, 7
    s_add_u32 s36, s36, 327680
    s_cmp_eq_u32 s32, 0
    s_cselect_b32 s36, s36, 0x40000000
    v_and_b32 v50, 31, v1
    v_lshl_add_u32 v50, v50, 2, s36
    v_mov_b32 v160, 0
    v_mov_b32 v161, 0
    s_waitcnt vmcnt(12)
    v_mov_b32_dpp v160, v164 wave_shr:1 row_mask:0xf bank_mask:0xf
    v_mov_b32_dpp v161, v165 wave_shr:1 row_mask:0xf bank_mask:0xf
    v_readlane_b32 s8, v164, 63
    v_readlane_b32 s9, v165, 63
    v_dot2_f32_bf16 v20, v162, s50, 0
    v_dot2_f32_bf16 v21, v162, s48, 0
    v_dot2_f32_bf16 v22, v163, s50, 0
    v_dot2_f32_bf16 v23, v163, s48, 0
    v_dot2_f32_bf16 v24, v164, s50, 0
    v_dot2_f32_bf16 v25, v164, s48, 0
    v_dot2_f32_bf16 v26, v165, s50, 0
    v_dot2_f32_bf16 v27, v165, s48, 0
    v_dot2_f32_bf16 v20, v161, s51, v20
    v_dot2_f32_bf16 v21, v161, s49, v21
    v_dot2_f32_bf16 v22, v162, s51, v22
    v_dot2_f32_bf16 v23, v162, s49, v23
    v_dot2_f32_bf16 v24, v163, s51, v24
    v_dot2_f32_bf16 v25, v163, s49, v25
    v_dot2_f32_bf16 v26, v164, s51, v26
    v_dot2_f32_bf16 v27, v164, s49, v27
    v_dot2_f32_bf16 v20, v160, s52, v20
    v_dot2_f32_bf16 v22, v161, s52, v22
    v_dot2_f32_bf16 v24, v162, s52, v24
    v_dot2_f32_bf16 v26, v163, s52, v26
    s_waitcnt vmcnt(11)
    v_lshlrev_b32 v160, 16, v166
    v_and_b32 v166, 0xffff0000, v166
    v_lshlrev_b32 v161, 16, v167
    v_and_b32 v167, 0xffff0000, v167
    v_lshlrev_b32 v162, 16, v168
    v_and_b32 v168, 0xffff0000, v168
    v_lshlrev_b32 v163, 16, v169
    v_and_b32 v169, 0xffff0000, v169
    v_mul_f32 v20, v20, v160
    v_mul_f32 v21, v21, v166
    v_mul_f32 v22, v22, v161
    v_mul_f32 v23, v23, v167
    v_mul_f32 v24, v24, v162
    v_mul_f32 v25, v25, v168
    v_mul_f32 v26, v26, v163
    v_mul_f32 v27, v27, v169
    v_cvt_pk_bf16_f32 v166, v27, v26
    v_cvt_pk_bf16_f32 v167, v25, v24
    v_cvt_pk_bf16_f32 v168, v23, v22
    v_cvt_pk_bf16_f32 v169, v21, v20
    ds_write_b128 v5, v[166:169] offset:3072
    v_mov_b32 v170, s8
    v_mov_b32 v171, s9
    s_waitcnt vmcnt(10)
    v_mov_b32_dpp v170, v174 wave_shr:1 row_mask:0xf bank_mask:0xf
    v_mov_b32_dpp v171, v175 wave_shr:1 row_mask:0xf bank_mask:0xf
    v_readlane_b32 s8, v174, 63
    v_readlane_b32 s9, v175, 63
    v_dot2_f32_bf16 v20, v172, s50, 0
    v_dot2_f32_bf16 v21, v172, s48, 0
    v_dot2_f32_bf16 v22, v173, s50, 0
    v_dot2_f32_bf16 v23, v173, s48, 0
    v_dot2_f32_bf16 v24, v174, s50, 0
    v_dot2_f32_bf16 v25, v174, s48, 0
    v_dot2_f32_bf16 v26, v175, s50, 0
    v_dot2_f32_bf16 v27, v175, s48, 0
    v_dot2_f32_bf16 v20, v171, s51, v20
    v_dot2_f32_bf16 v21, v171, s49, v21
    v_dot2_f32_bf16 v22, v172, s51, v22
    v_dot2_f32_bf16 v23, v172, s49, v23
    v_dot2_f32_bf16 v24, v173, s51, v24
    v_dot2_f32_bf16 v25, v173, s49, v25
    v_dot2_f32_bf16 v26, v174, s51, v26
    v_dot2_f32_bf16 v27, v174, s49, v27
    v_dot2_f32_bf16 v20, v170, s52, v20
    v_dot2_f32_bf16 v22, v171, s52, v22
    v_dot2_f32_bf16 v24, v172, s52, v24
    v_dot2_f32_bf16 v26, v173, s52, v26
    s_waitcnt vmcnt(9)
    v_lshlrev_b32 v170, 16, v176
    v_and_b32 v176, 0xffff0000, v176
    v_lshlrev_b32 v171, 16, v177
    v_and_b32 v177, 0xffff0000, v177
    v_lshlrev_b32 v172, 16, v178
    v_and_b32 v178, 0xffff0000, v178
    v_lshlrev_b32 v173, 16, v179
    v_and_b32 v179, 0xffff0000, v179
    v_mul_f32 v20, v20, v170
    v_mul_f32 v21, v21, v176
    v_mul_f32 v22, v22, v171
    v_mul_f32 v23, v23, v177
    v_mul_f32 v24, v24, v172
    v_mul_f32 v25, v25, v178
    v_mul_f32 v26, v26, v173
    v_mul_f32 v27, v27, v179
    v_cvt_pk_bf16_f32 v176, v27, v26
    v_cvt_pk_bf16_f32 v177, v25, v24
    v_cvt_pk_bf16_f32 v178, v23, v22
    v_cvt_pk_bf16_f32 v179, v21, v20
    ds_write_b128 v5, v[176:179] offset:2048
    v_mov_b32 v180, s8
    v_mov_b32 v181, s9
    s_waitcnt vmcnt(8)
    v_mov_b32_dpp v180, v184 wave_shr:1 row_mask:0xf bank_mask:0xf
    v_mov_b32_dpp v181, v185 wave_shr:1 row_mask:0xf bank_mask:0xf
    v_readlane_b32 s8, v184, 63
    v_readlane_b32 s9, v185, 63
    v_dot2_f32_bf16 v20, v182, s50, 0
    v_dot2_f32_bf16 v21, v182, s48, 0
    v_dot2_f32_bf16 v22, v183, s50, 0
    v_dot2_f32_bf16 v23, v183, s48, 0
    v_dot2_f32_bf16 v24, v184, s50, 0
    v_dot2_f32_bf16 v25, v184, s48, 0
    v_dot2_f32_bf16 v26, v185, s50, 0
    v_dot2_f32_bf16 v27, v185, s48, 0
    v_dot2_f32_bf16 v20, v181, s51, v20
    v_dot2_f32_bf16 v21, v181, s49, v21
    v_dot2_f32_bf16 v22, v182, s51, v22
    v_dot2_f32_bf16 v23, v182, s49, v23
    v_dot2_f32_bf16 v24, v183, s51, v24
    v_dot2_f32_bf16 v25, v183, s49, v25
    v_dot2_f32_bf16 v26, v184, s51, v26
    v_dot2_f32_bf16 v27, v184, s49, v27
    v_dot2_f32_bf16 v20, v180, s52, v20
    v_dot2_f32_bf16 v22, v181, s52, v22
    v_dot2_f32_bf16 v24, v182, s52, v24
    v_dot2_f32_bf16 v26, v183, s52, v26
    s_waitcnt vmcnt(7)
    v_lshlrev_b32 v180, 16, v186
    v_and_b32 v186, 0xffff0000, v186
    v_lshlrev_b32 v181, 16, v187
    v_and_b32 v187, 0xffff0000, v187
    v_lshlrev_b32 v182, 16, v188
    v_and_b32 v188, 0xffff0000, v188
    v_lshlrev_b32 v183, 16, v189
    v_and_b32 v189, 0xffff0000, v189
    v_mul_f32 v20, v20, v180
    v_mul_f32 v21, v21, v186
    v_mul_f32 v22, v22, v181
    v_mul_f32 v23, v23, v187
    v_mul_f32 v24, v24, v182
    v_mul_f32 v25, v25, v188
    v_mul_f32 v26, v26, v183
    v_mul_f32 v27, v27, v189
    v_cvt_pk_bf16_f32 v186, v27, v26
    v_cvt_pk_bf16_f32 v187, v25, v24
    v_cvt_pk_bf16_f32 v188, v23, v22
    v_cvt_pk_bf16_f32 v189, v21, v20
    ds_write_b128 v5, v[186:189] offset:1024
    v_mov_b32 v190, s8
    v_mov_b32 v191, s9
    s_waitcnt vmcnt(6)
    v_mov_b32_dpp v190, v194 wave_shr:1 row_mask:0xf bank_mask:0xf
    v_mov_b32_dpp v191, v195 wave_shr:1 row_mask:0xf bank_mask:0xf
    v_dot2_f32_bf16 v20, v192, s50, 0
    v_dot2_f32_bf16 v21, v192, s48, 0
    v_dot2_f32_bf16 v22, v193, s50, 0
    v_dot2_f32_bf16 v23, v193, s48, 0
    v_dot2_f32_bf16 v24, v194, s50, 0
    v_dot2_f32_bf16 v25, v194, s48, 0
    v_dot2_f32_bf16 v26, v195, s50, 0
    v_dot2_f32_bf16 v27, v195, s48, 0
    v_dot2_f32_bf16 v20, v191, s51, v20
    v_dot2_f32_bf16 v21, v191, s49, v21
    v_dot2_f32_bf16 v22, v192, s51, v22
    v_dot2_f32_bf16 v23, v192, s49, v23
    v_dot2_f32_bf16 v24, v193, s51, v24
    v_dot2_f32_bf16 v25, v193, s49, v25
    v_dot2_f32_bf16 v26, v194, s51, v26
    v_dot2_f32_bf16 v27, v194, s49, v27
    v_dot2_f32_bf16 v20, v190, s52, v20
    v_dot2_f32_bf16 v22, v191, s52, v22
    v_dot2_f32_bf16 v24, v192, s52, v24
    v_dot2_f32_bf16 v26, v193, s52, v26
    s_waitcnt vmcnt(5)
    v_lshlrev_b32 v190, 16, v196
    v_and_b32 v196, 0xffff0000, v196
    v_lshlrev_b32 v191, 16, v197
    v_and_b32 v197, 0xffff0000, v197
    v_lshlrev_b32 v192, 16, v198
    v_and_b32 v198, 0xffff0000, v198
    v_lshlrev_b32 v193, 16, v199
    v_and_b32 v199, 0xffff0000, v199
    v_mul_f32 v20, v20, v190
    v_mul_f32 v21, v21, v196
    v_mul_f32 v22, v22, v191
    v_mul_f32 v23, v23, v197
    v_mul_f32 v24, v24, v192
    v_mul_f32 v25, v25, v198
    v_mul_f32 v26, v26, v193
    v_mul_f32 v27, v27, v199
    v_cvt_pk_bf16_f32 v196, v27, v26
    v_cvt_pk_bf16_f32 v197, v25, v24
    v_cvt_pk_bf16_f32 v198, v23, v22
    v_cvt_pk_bf16_f32 v199, v21, v20
    ds_write_b128 v5, v[196:199] offset:0
    ds_read_b128 a[32:35], v2 offset:3584
    ds_read_b128 a[36:39], v2 offset:3072
    ds_read_b128 a[40:43], v2 offset:2560
    ds_read_b128 a[44:47], v2 offset:2048
    ds_read_b128 a[48:51], v2 offset:1536
    ds_read_b128 a[52:55], v2 offset:1024
    ds_read_b128 a[56:59], v2 offset:512
    ds_read_b128 a[60:63], v2 offset:0
    ds_read2_b32 a[0:1], v220 offset0:0 offset1:1
    ds_read2_b32 a[2:3], v220 offset0:2 offset1:3
    ds_read2_b32 a[4:5], v220 offset0:128 offset1:129
    ds_read2_b32 a[6:7], v220 offset0:130 offset1:131
    ds_read2_b32 a[8:9], v221 offset0:0 offset1:1
    ds_read2_b32 a[10:11], v221 offset0:2 offset1:3
    ds_read2_b32 a[12:13], v221 offset0:128 offset1:129
    ds_read2_b32 a[14:15], v221 offset0:130 offset1:131
    ds_read2_b32 a[16:17], v222 offset0:0 offset1:1
    ds_read2_b32 a[18:19], v222 offset0:2 offset1:3
    ds_read2_b32 a[20:21], v222 offset0:128 offset1:129
    ds_read2_b32 a[22:23], v222 offset0:130 offset1:131
    ds_read2_b32 a[24:25], v223 offset0:0 offset1:1
    ds_read2_b32 a[26:27], v223 offset0:2 offset1:3
    ds_read2_b32 a[28:29], v223 offset0:128 offset1:129
    ds_read2_b32 a[30:31], v223 offset0:130 offset1:131
    s_waitcnt vmcnt(1)
    s_barrier
    s_waitcnt lgkmcnt(15)
    v_mfma_f32_16x16x32_bf16 v[224:227], a[32:35], v[136:139], 0
    buffer_store_dword v17, v50, s[16:19], 0 offen sc1
    v_mfma_f32_16x16x32_bf16 v[228:231], a[36:39], v[136:139], 0
    ds_read_b128 a[96:99], v2 offset:3648
    s_add_u32 s100, s68, 4096
    v_mfma_f32_16x16x32_bf16 v[232:235], a[40:43], v[136:139], 0
    buffer_store_dword v17, v62, s[16:19], 0 offen offset:128 sc1
    v_mfma_f32_16x16x32_bf16 v[236:239], a[44:47], v[136:139], 0
    ds_read_b128 a[100:103], v2 offset:3136
    s_lshl_b32 s46, s43, 2
    v_mfma_f32_16x16x32_bf16 v[240:243], a[48:51], v[136:139], 0
    ds_read_b128 a[104:107], v2 offset:2624
    s_add_u32 s46, s46, s32
    v_mfma_f32_16x16x32_bf16 v[244:247], a[52:55], v[136:139], 0
    buffer_store_dword v17, v62, s[16:19], 0 offen offset:256 sc1
    v_mfma_f32_16x16x32_bf16 v[248:251], a[56:59], v[136:139], 0
    ds_read_b128 a[108:111], v2 offset:2112
    s_mul_i32 s37, s41, 1327104
    v_mfma_f32_16x16x32_bf16 v[252:255], a[60:63], v[136:139], 0
    ds_read_b128 a[112:115], v2 offset:1600
    s_mul_i32 s36, s46, 6912
    s_waitcnt lgkmcnt(15)
    v_mfma_f32_16x16x32_bf16 v[224:227], a[32:35], a[0:3], v[224:227]
    buffer_load_dwordx4 v[52:55], v11, s[80:83], s100 offen offset:0
    v_mfma_f32_16x16x32_bf16 v[228:231], a[36:39], a[0:3], v[228:231]
    ds_read_b128 a[116:119], v2 offset:1088
    s_add_u32 s36, s36, s37
    v_mfma_f32_16x16x32_bf16 v[232:235], a[40:43], a[0:3], v[232:235]
    ds_read_b128 a[120:123], v2 offset:576
    s_add_u32 s36, s36, 4096
    v_mfma_f32_16x16x32_bf16 v[236:239], a[44:47], a[0:3], v[236:239]
    buffer_load_dwordx4 v[36:39], v11, s[80:83], s100 offen offset:1024
    v_mfma_f32_16x16x32_bf16 v[240:243], a[48:51], a[0:3], v[240:243]
    ds_read_b128 a[124:127], v2 offset:64
    v_min_u32 v12, 53, v1
    v_mfma_f32_16x16x32_bf16 v[244:247], a[52:55], a[0:3], v[244:247]
    ds_read2_b32 a[64:65], v220 offset0:16 offset1:17
    v_lshl_add_u32 v12, v12, 7, s36
    v_mfma_f32_16x16x32_bf16 v[248:251], a[56:59], a[0:3], v[248:251]
    buffer_load_dwordx4 v[40:43], v11, s[80:83], s100 offen offset:2048
    v_mfma_f32_16x16x32_bf16 v[252:255], a[60:63], a[0:3], v[252:255]
    ds_read2_b32 a[66:67], v220 offset0:18 offset1:19
    s_lshl_b32 s36, s32, 4
    v_mfma_f32_16x16x32_bf16 v[228:231], a[32:35], a[4:7], v[228:231]
    ds_read2_b32 a[68:69], v220 offset0:144 offset1:145
    s_sub_u32 s36, s36, 2
    v_mfma_f32_16x16x32_bf16 v[232:235], a[36:39], a[4:7], v[232:235]
    buffer_load_dwordx4 v[44:47], v11, s[80:83], s100 offen offset:3072
    v_mfma_f32_16x16x32_bf16 v[236:239], a[40:43], a[4:7], v[236:239]
    ds_read2_b32 a[70:71], v220 offset0:146 offset1:147
    s_lshr_b32 s35, s68, 5
    v_mfma_f32_16x16x32_bf16 v[240:243], a[44:47], a[4:7], v[240:243]
    ds_read2_b32 a[72:73], v221 offset0:16 offset1:17
    s_add_u32 s44, s35, 1048576
    v_mfma_f32_16x16x32_bf16 v[244:247], a[48:51], a[4:7], v[244:247]
    s_add_u32 s35, s35, 4194304
    buffer_load_dwordx4 v[202:205], v61, s[16:19], s44 offen offset:128 sc1
    v_mfma_f32_16x16x32_bf16 v[248:251], a[52:55], a[4:7], v[248:251]
    ds_read2_b32 a[74:75], v221 offset0:18 offset1:19
    v_min_u32 v60, 17, v1
    v_mfma_f32_16x16x32_bf16 v[252:255], a[56:59], a[4:7], v[252:255]
    ds_read2_b32 a[76:77], v221 offset0:144 offset1:145
    v_add_u32 v60, s36, v60
    v_mfma_f32_16x16x32_bf16 v[232:235], a[32:35], a[8:11], v[232:235]
    buffer_load_dwordx4 v[206:209], v61, s[16:19], s35 offen offset:128 sc1
    v_mfma_f32_16x16x32_bf16 v[236:239], a[36:39], a[8:11], v[236:239]
    ds_read2_b32 a[78:79], v221 offset0:146 offset1:147
    s_lshr_b32 s35, s68, 5
    v_mfma_f32_16x16x32_bf16 v[240:243], a[40:43], a[8:11], v[240:243]
    ds_read2_b32 a[80:81], v222 offset0:16 offset1:17
    s_add_u32 s44, s35, 1638400
    v_mfma_f32_16x16x32_bf16 v[244:247], a[44:47], a[8:11], v[244:247]
    s_add_u32 s35, s35, 4784128
    buffer_load_dwordx4 v[212:215], v61, s[16:19], s44 offen offset:128 sc1
    v_mfma_f32_16x16x32_bf16 v[248:251], a[48:51], a[8:11], v[248:251]
    ds_read2_b32 a[82:83], v222 offset0:18 offset1:19
    v_max_i32 v60, 0, v60
    v_mfma_f32_16x16x32_bf16 v[252:255], a[52:55], a[8:11], v[252:255]
    ds_read2_b32 a[84:85], v222 offset0:144 offset1:145
    v_lshlrev_b32 v60, 7, v60
    s_waitcnt lgkmcnt(15)
    v_mfma_f32_16x16x32_bf16 v[236:239], a[32:35], a[12:15], v[236:239]
    buffer_load_dwordx4 v[216:219], v61, s[16:19], s35 offen offset:128 sc1
    v_mfma_f32_16x16x32_bf16 v[240:243], a[36:39], a[12:15], v[240:243]
    ds_read2_b32 a[86:87], v222 offset0:146 offset1:147
    s_lshr_b32 s35, s68, 5
    v_mfma_f32_16x16x32_bf16 v[244:247], a[40:43], a[12:15], v[244:247]
    ds_read2_b32 a[88:89], v223 offset0:16 offset1:17
    s_add_u32 s44, s35, 2228224
    v_mfma_f32_16x16x32_bf16 v[248:251], a[44:47], a[12:15], v[248:251]
    s_add_u32 s35, s35, 5373952
    buffer_load_dwordx4 v[66:69], v61, s[16:19], s44 offen offset:128 sc1
    v_mfma_f32_16x16x32_bf16 v[252:255], a[48:51], a[12:15], v[252:255]
    ds_read2_b32 a[90:91], v223 offset0:18 offset1:19
    v_add_u32 v60, 327680, v60
    v_mfma_f32_16x16x32_bf16 v[240:243], a[32:35], a[16:19], v[240:243]
    ds_read2_b32 a[92:93], v223 offset0:144 offset1:145
    v_mfma_f32_16x16x32_bf16 v[244:247], a[36:39], a[16:19], v[244:247]
    buffer_load_dwordx4 v[70:73], v61, s[16:19], s35 offen offset:128 sc1
    v_mfma_f32_16x16x32_bf16 v[248:251], a[40:43], a[16:19], v[248:251]
    ds_read2_b32 a[94:95], v223 offset0:146 offset1:147
    s_lshr_b32 s35, s68, 5
    v_mfma_f32_16x16x32_bf16 v[252:255], a[44:47], a[16:19], v[252:255]
    s_add_u32 s44, s35, 2818048
    s_add_u32 s35, s35, 5963776
    v_mfma_f32_16x16x32_bf16 v[244:247], a[32:35], a[20:23], v[244:247]
    buffer_load_dwordx4 v[76:79], v61, s[16:19], s44 offen offset:128 sc1
    v_mfma_f32_16x16x32_bf16 v[248:251], a[36:39], a[20:23], v[248:251]
    buffer_load_dwordx4 v[80:83], v61, s[16:19], s35 offen offset:128 sc1
    v_mfma_f32_16x16x32_bf16 v[252:255], a[40:43], a[20:23], v[252:255]
    v_mfma_f32_16x16x32_bf16 v[248:251], a[32:35], a[24:27], v[248:251]
    v_mfma_f32_16x16x32_bf16 v[252:255], a[36:39], a[24:27], v[252:255]
    v_mfma_f32_16x16x32_bf16 v[252:255], a[32:35], a[28:31], v[252:255]
    s_waitcnt lgkmcnt(0)
    v_mfma_f32_16x16x32_bf16 v[224:227], a[96:99], a[64:67], v[224:227]
    v_mfma_f32_16x16x32_bf16 v[228:231], a[100:103], a[64:67], v[228:231]
    ds_read_b128 a[32:35], v2 offset:3712
    ds_read_b128 a[36:39], v2 offset:3200
    v_mfma_f32_16x16x32_bf16 v[232:235], a[104:107], a[64:67], v[232:235]
    v_mfma_f32_16x16x32_bf16 v[236:239], a[108:111], a[64:67], v[236:239]
    ds_read_b128 a[40:43], v2 offset:2688
    ds_read_b128 a[44:47], v2 offset:2176
    v_mfma_f32_16x16x32_bf16 v[240:243], a[112:115], a[64:67], v[240:243]
    ds_read_b128 a[48:51], v2 offset:1664
    ds_read_b128 a[52:55], v2 offset:1152
    v_mfma_f32_16x16x32_bf16 v[244:247], a[116:119], a[64:67], v[244:247]
    v_mfma_f32_16x16x32_bf16 v[248:251], a[120:123], a[64:67], v[248:251]
    ds_read_b128 a[56:59], v2 offset:640
    v_mfma_f32_16x16x32_bf16 v[252:255], a[124:127], a[64:67], v[252:255]
    ds_read_b128 a[60:63], v2 offset:128
    v_mfma_f32_16x16x32_bf16 v[228:231], a[96:99], a[68:71], v[228:231]
    v_mfma_f32_16x16x32_bf16 v[232:235], a[100:103], a[68:71], v[232:235]
    ds_read2_b32 a[0:1], v220 offset0:32 offset1:33
    v_mfma_f32_16x16x32_bf16 v[236:239], a[104:107], a[68:71], v[236:239]
    ds_read2_b32 a[2:3], v220 offset0:34 offset1:35
    v_mfma_f32_16x16x32_bf16 v[240:243], a[108:111], a[68:71], v[240:243]
    v_mfma_f32_16x16x32_bf16 v[244:247], a[112:115], a[68:71], v[244:247]
    ds_read2_b32 a[4:5], v220 offset0:160 offset1:161
    v_mfma_f32_16x16x32_bf16 v[248:251], a[116:119], a[68:71], v[248:251]
    ds_read2_b32 a[6:7], v220 offset0:162 offset1:163
    v_mfma_f32_16x16x32_bf16 v[252:255], a[120:123], a[68:71], v[252:255]
    v_mfma_f32_16x16x32_bf16 v[232:235], a[96:99], a[72:75], v[232:235]
    ds_read2_b32 a[8:9], v221 offset0:32 offset1:33
    v_mfma_f32_16x16x32_bf16 v[236:239], a[100:103], a[72:75], v[236:239]
    ds_read2_b32 a[10:11], v221 offset0:34 offset1:35
    v_mfma_f32_16x16x32_bf16 v[240:243], a[104:107], a[72:75], v[240:243]
    v_mfma_f32_16x16x32_bf16 v[244:247], a[108:111], a[72:75], v[244:247]
    ds_read2_b32 a[12:13], v221 offset0:160 offset1:161
    v_mfma_f32_16x16x32_bf16 v[248:251], a[112:115], a[72:75], v[248:251]
    ds_read2_b32 a[14:15], v221 offset0:162 offset1:163
    v_mfma_f32_16x16x32_bf16 v[252:255], a[116:119], a[72:75], v[252:255]
    v_mfma_f32_16x16x32_bf16 v[236:239], a[96:99], a[76:79], v[236:239]
    ds_read2_b32 a[16:17], v222 offset0:32 offset1:33
    v_mfma_f32_16x16x32_bf16 v[240:243], a[100:103], a[76:79], v[240:243]
    ds_read2_b32 a[18:19], v222 offset0:34 offset1:35
    v_mfma_f32_16x16x32_bf16 v[244:247], a[104:107], a[76:79], v[244:247]
    v_mfma_f32_16x16x32_bf16 v[248:251], a[108:111], a[76:79], v[248:251]
    ds_read2_b32 a[20:21], v222 offset0:160 offset1:161
    v_mfma_f32_16x16x32_bf16 v[252:255], a[112:115], a[76:79], v[252:255]
    ds_read2_b32 a[22:23], v222 offset0:162 offset1:163
    v_mfma_f32_16x16x32_bf16 v[240:243], a[96:99], a[80:83], v[240:243]
    v_mfma_f32_16x16x32_bf16 v[244:247], a[100:103], a[80:83], v[244:247]
    ds_read2_b32 a[24:25], v223 offset0:32 offset1:33
    v_mfma_f32_16x16x32_bf16 v[248:251], a[104:107], a[80:83], v[248:251]
    ds_read2_b32 a[26:27], v223 offset0:34 offset1:35
    v_mfma_f32_16x16x32_bf16 v[252:255], a[108:111], a[80:83], v[252:255]
    v_mfma_f32_16x16x32_bf16 v[244:247], a[96:99], a[84:87], v[244:247]
    ds_read2_b32 a[28:29], v223 offset0:160 offset1:161
    v_mfma_f32_16x16x32_bf16 v[248:251], a[100:103], a[84:87], v[248:251]
    ds_read2_b32 a[30:31], v223 offset0:162 offset1:163
    v_mfma_f32_16x16x32_bf16 v[252:255], a[104:107], a[84:87], v[252:255]
    v_mfma_f32_16x16x32_bf16 v[248:251], a[96:99], a[88:91], v[248:251]
    v_mfma_f32_16x16x32_bf16 v[252:255], a[100:103], a[88:91], v[252:255]
    v_mfma_f32_16x16x32_bf16 v[252:255], a[96:99], a[92:95], v[252:255]
    s_waitcnt lgkmcnt(0)
    v_mfma_f32_16x16x32_bf16 v[224:227], a[32:35], a[0:3], v[224:227]
    s_mov_b32 s100, 442368
    buffer_load_dword a202, v12, s[20:23], s100 offen
    v_mfma_f32_16x16x32_bf16 v[228:231], a[36:39], a[0:3], v[228:231]
    ds_read_b128 a[96:99], v2 offset:3776
    ds_read_b128 a[100:103], v2 offset:3264
    v_mfma_f32_16x16x32_bf16 v[232:235], a[40:43], a[0:3], v[232:235]
    v_mfma_f32_16x16x32_bf16 v[236:239], a[44:47], a[0:3], v[236:239]
    ds_read_b128 a[104:107], v2 offset:2752
    ds_read_b128 a[108:111], v2 offset:2240
    v_mfma_f32_16x16x32_bf16 v[240:243], a[48:51], a[0:3], v[240:243]
    ds_read_b128 a[112:115], v2 offset:1728
    ds_read_b128 a[116:119], v2 offset:1216
    v_mfma_f32_16x16x32_bf16 v[244:247], a[52:55], a[0:3], v[244:247]
    v_mfma_f32_16x16x32_bf16 v[248:251], a[56:59], a[0:3], v[248:251]
    ds_read_b128 a[120:123], v2 offset:704
    v_mfma_f32_16x16x32_bf16 v[252:255], a[60:63], a[0:3], v[252:255]
    ds_read_b128 a[124:127], v2 offset:192
    v_mfma_f32_16x16x32_bf16 v[228:231], a[32:35], a[4:7], v[228:231]
    v_mfma_f32_16x16x32_bf16 v[232:235], a[36:39], a[4:7], v[232:235]
    ds_read2_b32 a[64:65], v220 offset0:48 offset1:49
    s_lshl_b32 s53, s6, 16
    v_mfma_f32_16x16x32_bf16 v[236:239], a[40:43], a[4:7], v[236:239]
    ds_read2_b32 a[66:67], v220 offset0:50 offset1:51
    s_and_b32 s54, s6, 0xffff0000
    v_mfma_f32_16x16x32_bf16 v[240:243], a[44:47], a[4:7], v[240:243]
    s_lshl_b32 s55, s7, 16
    s_and_b32 s56, s7, 0xffff0000
    v_mfma_f32_16x16x32_bf16 v[244:247], a[48:51], a[4:7], v[244:247]
    ds_read2_b32 a[68:69], v220 offset0:176 offset1:177
    s_pack_hh_b32_b16 s62, s34, s34
    v_mfma_f32_16x16x32_bf16 v[248:251], a[52:55], a[4:7], v[248:251]
    ds_read2_b32 a[70:71], v220 offset0:178 offset1:179
    v_and_b32 v32, s62, v128
    v_mfma_f32_16x16x32_bf16 v[252:255], a[56:59], a[4:7], v[252:255]
    v_and_b32 v33, s62, v129
    v_and_b32 v34, s62, v130
    v_mfma_f32_16x16x32_bf16 v[232:235], a[32:35], a[8:11], v[232:235]
    ds_read2_b32 a[72:73], v221 offset0:48 offset1:49
    v_and_b32 v35, s62, v131
    v_mfma_f32_16x16x32_bf16 v[236:239], a[36:39], a[8:11], v[236:239]
    ds_read2_b32 a[74:75], v221 offset0:50 offset1:51
    v_mfma_f32_16x16x32_bf16 v[240:243], a[40:43], a[8:11], v[240:243]
    s_pack_ll_b32_b16 s45, s33, s33
    s_pack_hh_b32_b16 s63, s33, s33
    s_bitcmp1_b32 s94, 0
    s_cselect_b32 s63, s63, s45
    s_cmp_eq_u32 s32, 0
    s_cselect_b32 s63, s63, 0
    v_mfma_f32_16x16x32_bf16 v[244:247], a[44:47], a[8:11], v[244:247]
    ds_read2_b32 a[76:77], v221 offset0:176 offset1:177
    v_and_b32 v92, s63, v128
    v_mfma_f32_16x16x32_bf16 v[248:251], a[48:51], a[8:11], v[248:251]
    ds_read2_b32 a[78:79], v221 offset0:178 offset1:179
    v_and_b32 v93, s63, v129
    v_mfma_f32_16x16x32_bf16 v[252:255], a[52:55], a[8:11], v[252:255]
    v_and_b32 v94, s63, v130
    v_and_b32 v95, s63, v131
    v_mfma_f32_16x16x32_bf16 v[236:239], a[32:35], a[12:15], v[236:239]
    ds_read2_b32 a[80:81], v222 offset0:48 offset1:49
    s_waitcnt vmcnt(12)
    v_mov_b32_dpp v124, v52 wave_shl:1 row_mask:0xf bank_mask:0xf
    v_mfma_f32_16x16x32_bf16 v[240:243], a[36:39], a[12:15], v[240:243]
    ds_read2_b32 a[82:83], v222 offset0:50 offset1:51
    v_mfma_f32_16x16x32_bf16 v[244:247], a[40:43], a[12:15], v[244:247]
    s_waitcnt vmcnt(11)
    v_readlane_b32 s45, v36, 0
    s_nop 3
    v_writelane_b32 v124, s45, 63
    v_mfma_f32_16x16x32_bf16 v[248:251], a[44:47], a[12:15], v[248:251]
    ds_read2_b32 a[84:85], v222 offset0:176 offset1:177
    v_alignbit_b32 v104, v53, v52, 16
    v_mfma_f32_16x16x32_bf16 v[252:255], a[48:51], a[12:15], v[252:255]
    ds_read2_b32 a[86:87], v222 offset0:178 offset1:179
    v_alignbit_b32 v105, v54, v53, 16
    v_mfma_f32_16x16x32_bf16 v[240:243], a[32:35], a[16:19], v[240:243]
    v_alignbit_b32 v106, v55, v54, 16
    v_alignbit_b32 v107, v124, v55, 16
    v_mfma_f32_16x16x32_bf16 v[244:247], a[36:39], a[16:19], v[244:247]
    ds_read2_b32 a[88:89], v223 offset0:48 offset1:49
    v_mfma_f32_16x16x32_bf16 v[248:251], a[40:43], a[16:19], v[248:251]
    ds_read2_b32 a[90:91], v223 offset0:50 offset1:51
    v_mfma_f32_16x16x32_bf16 v[252:255], a[44:47], a[16:19], v[252:255]
    ds_write_b128 v4, v[52:55] offset:12960
    v_mfma_f32_16x16x32_bf16 v[244:247], a[32:35], a[20:23], v[244:247]
    ds_read2_b32 a[92:93], v223 offset0:176 offset1:177
    v_mfma_f32_16x16x32_bf16 v[248:251], a[36:39], a[20:23], v[248:251]
    ds_read2_b32 a[94:95], v223 offset0:178 offset1:179
    v_mfma_f32_16x16x32_bf16 v[252:255], a[40:43], a[20:23], v[252:255]
    ds_write_b128 v4, v[104:107] offset:17120
    v_mfma_f32_16x16x32_bf16 v[248:251], a[32:35], a[24:27], v[248:251]
    v_mov_b32_dpp v125, v36 wave_shl:1 row_mask:0xf bank_mask:0xf
    v_mfma_f32_16x16x32_bf16 v[252:255], a[36:39], a[24:27], v[252:255]
    s_waitcnt vmcnt(10)
    v_readlane_b32 s45, v40, 0
    s_nop 3
    v_writelane_b32 v125, s45, 63
    v_mfma_f32_16x16x32_bf16 v[252:255], a[32:35], a[28:31], v[252:255]
    v_alignbit_b32 v108, v37, v36, 16
    v_alignbit_b32 v109, v38, v37, 16
    s_waitcnt lgkmcnt(1)
    v_mfma_f32_16x16x32_bf16 v[224:227], a[96:99], a[64:67], v[224:227]
    v_alignbit_b32 v110, v39, v38, 16
    v_alignbit_b32 v111, v125, v39, 16
    v_mfma_f32_16x16x32_bf16 v[228:231], a[100:103], a[64:67], v[228:231]
    ds_read_b128 a[32:35], v2 offset:3840
    ds_read_b128 a[36:39], v2 offset:3328
    v_mfma_f32_16x16x32_bf16 v[232:235], a[104:107], a[64:67], v[232:235]
    ds_write_b128 v4, v[36:39] offset:13984
    v_mfma_f32_16x16x32_bf16 v[236:239], a[108:111], a[64:67], v[236:239]
    ds_read_b128 a[40:43], v2 offset:2816
    ds_read_b128 a[44:47], v2 offset:2304
    v_mfma_f32_16x16x32_bf16 v[240:243], a[112:115], a[64:67], v[240:243]
    ds_read_b128 a[48:51], v2 offset:1792
    ds_read_b128 a[52:55], v2 offset:1280
    v_mfma_f32_16x16x32_bf16 v[244:247], a[116:119], a[64:67], v[244:247]
    ds_write_b128 v4, v[108:111] offset:18144
    v_mfma_f32_16x16x32_bf16 v[248:251], a[120:123], a[64:67], v[248:251]
    ds_read_b128 a[56:59], v2 offset:768
    v_mov_b32_dpp v126, v40 wave_shl:1 row_mask:0xf bank_mask:0xf
    v_mfma_f32_16x16x32_bf16 v[252:255], a[124:127], a[64:67], v[252:255]
    ds_read_b128 a[60:63], v2 offset:256
    v_mfma_f32_16x16x32_bf16 v[228:231], a[96:99], a[68:71], v[228:231]
    s_waitcnt vmcnt(9)
    v_readlane_b32 s45, v44, 0
    s_nop 3
    v_writelane_b32 v126, s45, 63
    v_mfma_f32_16x16x32_bf16 v[232:235], a[100:103], a[68:71], v[232:235]
    ds_read2_b32 a[0:1], v220 offset0:64 offset1:65
    v_alignbit_b32 v112, v41, v40, 16
    v_mfma_f32_16x16x32_bf16 v[236:239], a[104:107], a[68:71], v[236:239]
    ds_read2_b32 a[2:3], v220 offset0:66 offset1:67
    v_alignbit_b32 v113, v42, v41, 16
    v_mfma_f32_16x16x32_bf16 v[240:243], a[108:111], a[68:71], v[240:243]
    v_alignbit_b32 v114, v43, v42, 16
    v_alignbit_b32 v115, v126, v43, 16
    v_mfma_f32_16x16x32_bf16 v[244:247], a[112:115], a[68:71], v[244:247]
    ds_read2_b32 a[4:5], v220 offset0:192 offset1:193
    v_mfma_f32_16x16x32_bf16 v[248:251], a[116:119], a[68:71], v[248:251]
    ds_read2_b32 a[6:7], v220 offset0:194 offset1:195
    v_mfma_f32_16x16x32_bf16 v[252:255], a[120:123], a[68:71], v[252:255]
    ds_write_b128 v4, v[40:43] offset:15008
    v_mfma_f32_16x16x32_bf16 v[232:235], a[96:99], a[72:75], v[232:235]
    ds_read2_b32 a[8:9], v221 offset0:64 offset1:65
    v_mfma_f32_16x16x32_bf16 v[236:239], a[100:103], a[72:75], v[236:239]
    ds_read2_b32 a[10:11], v221 offset0:66 offset1:67
    v_mfma_f32_16x16x32_bf16 v[240:243], a[104:107], a[72:75], v[240:243]
    ds_write_b128 v4, v[112:115] offset:19168
    v_mfma_f32_16x16x32_bf16 v[244:247], a[108:111], a[72:75], v[244:247]
    ds_read2_b32 a[12:13], v221 offset0:192 offset1:193
    v_mov_b32_dpp v127, v44 wave_shl:1 row_mask:0xf bank_mask:0xf
    v_mfma_f32_16x16x32_bf16 v[248:251], a[112:115], a[72:75], v[248:251]
    ds_read2_b32 a[14:15], v221 offset0:194 offset1:195
    v_alignbit_b32 v116, v45, v44, 16
    v_mfma_f32_16x16x32_bf16 v[252:255], a[116:119], a[72:75], v[252:255]
    v_alignbit_b32 v117, v46, v45, 16
    v_alignbit_b32 v118, v47, v46, 16
    v_mfma_f32_16x16x32_bf16 v[236:239], a[96:99], a[76:79], v[236:239]
    ds_read2_b32 a[16:17], v222 offset0:64 offset1:65
    v_alignbit_b32 v119, v127, v47, 16
    v_mfma_f32_16x16x32_bf16 v[240:243], a[100:103], a[76:79], v[240:243]
    ds_read2_b32 a[18:19], v222 offset0:66 offset1:67
    v_mfma_f32_16x16x32_bf16 v[244:247], a[104:107], a[76:79], v[244:247]
    ds_write_b128 v4, v[44:47] offset:16032
    v_mfma_f32_16x16x32_bf16 v[248:251], a[108:111], a[76:79], v[248:251]
    ds_read2_b32 a[20:21], v222 offset0:192 offset1:193
    v_mfma_f32_16x16x32_bf16 v[252:255], a[112:115], a[76:79], v[252:255]
    ds_read2_b32 a[22:23], v222 offset0:194 offset1:195
    v_mfma_f32_16x16x32_bf16 v[240:243], a[96:99], a[80:83], v[240:243]
    ds_write_b128 v4, v[116:119] offset:20192
    v_mfma_f32_16x16x32_bf16 v[244:247], a[100:103], a[80:83], v[244:247]
    ds_read2_b32 a[24:25], v223 offset0:64 offset1:65
    v_mov_b32 v200, 0
    v_mfma_f32_16x16x32_bf16 v[248:251], a[104:107], a[80:83], v[248:251]
    ds_read2_b32 a[26:27], v223 offset0:66 offset1:67
    v_mov_b32 v201, 0
    v_mfma_f32_16x16x32_bf16 v[252:255], a[108:111], a[80:83], v[252:255]
    s_waitcnt vmcnt(8)
    v_mov_b32_dpp v200, v204 wave_shr:1 row_mask:0xf bank_mask:0xf
    v_mov_b32_dpp v201, v205 wave_shr:1 row_mask:0xf bank_mask:0xf
    v_mfma_f32_16x16x32_bf16 v[244:247], a[96:99], a[84:87], v[244:247]
    ds_read2_b32 a[28:29], v223 offset0:192 offset1:193
    v_readlane_b32 s8, v204, 63
    v_mfma_f32_16x16x32_bf16 v[248:251], a[100:103], a[84:87], v[248:251]
    ds_read2_b32 a[30:31], v223 offset0:194 offset1:195
    v_readlane_b32 s9, v205, 63
    v_mfma_f32_16x16x32_bf16 v[252:255], a[104:107], a[84:87], v[252:255]
    v_and_b32 v140, 0xffff0000, v200
    v_lshlrev_b32 v141, 16, v201
    v_mfma_f32_16x16x32_bf16 v[248:251], a[96:99], a[88:91], v[248:251]
    v_and_b32 v142, 0xffff0000, v201
    v_lshlrev_b32 v143, 16, v202
    v_mfma_f32_16x16x32_bf16 v[252:255], a[100:103], a[88:91], v[252:255]
    v_and_b32 v144, 0xffff0000, v202
    v_lshlrev_b32 v145, 16, v203
    v_mfma_f32_16x16x32_bf16 v[252:255], a[96:99], a[92:95], v[252:255]
    v_and_b32 v146, 0xffff0000, v203
    v_lshlrev_b32 v147, 16, v204
    s_waitcnt lgkmcnt(0)
    v_mfma_f32_16x16x32_bf16 v[224:227], a[32:35], a[0:3], v[224:227]
    s_mov_b32 s100, 1105920
    buffer_load_dword a203, v12, s[20:23], s100 offen
    v_mfma_f32_16x16x32_bf16 v[228:231], a[36:39], a[0:3], v[228:231]
    ds_read_b128 a[96:99], v2 offset:3904
    ds_read_b128 a[100:103], v2 offset:3392
    v_mfma_f32_16x16x32_bf16 v[232:235], a[40:43], a[0:3], v[232:235]
    v_and_b32 v148, 0xffff0000, v204
    v_lshlrev_b32 v149, 16, v205
    v_mfma_f32_16x16x32_bf16 v[236:239], a[44:47], a[0:3], v[236:239]
    ds_read_b128 a[104:107], v2 offset:2880
    ds_read_b128 a[108:111], v2 offset:2368
    v_mfma_f32_16x16x32_bf16 v[240:243], a[48:51], a[0:3], v[240:243]
    ds_read_b128 a[112:115], v2 offset:1856
    ds_read_b128 a[116:119], v2 offset:1344
    v_mfma_f32_16x16x32_bf16 v[244:247], a[52:55], a[0:3], v[244:247]
    v_and_b32 v150, 0xffff0000, v205
    v_mul_f32 v20, s53, v143
    v_mfma_f32_16x16x32_bf16 v[248:251], a[56:59], a[0:3], v[248:251]
    ds_read_b128 a[120:123], v2 offset:832
    v_mul_f32 v21, s53, v144
    v_mfma_f32_16x16x32_bf16 v[252:255], a[60:63], a[0:3], v[252:255]
    ds_read_b128 a[124:127], v2 offset:320
    v_mul_f32 v22, s53, v145
    v_mfma_f32_16x16x32_bf16 v[228:231], a[32:35], a[4:7], v[228:231]
    v_mul_f32 v23, s53, v146
    v_mul_f32 v24, s53, v147
    v_mfma_f32_16x16x32_bf16 v[232:235], a[36:39], a[4:7], v[232:235]
    ds_read2_b32 a[64:65], v220 offset0:80 offset1:81
    v_mul_f32 v25, s53, v148
    v_mfma_f32_16x16x32_bf16 v[236:239], a[40:43], a[4:7], v[236:239]
    ds_read2_b32 a[66:67], v220 offset0:82 offset1:83
    v_mul_f32 v26, s53, v149
    v_mfma_f32_16x16x32_bf16 v[240:243], a[44:47], a[4:7], v[240:243]
    v_mul_f32 v27, s53, v150
    v_fmac_f32 v20, s54, v142
    v_mfma_f32_16x16x32_bf16 v[244:247], a[48:51], a[4:7], v[244:247]
    ds_read2_b32 a[68:69], v220 offset0:208 offset1:209
    v_fmac_f32 v21, s54, v143
    v_mfma_f32_16x16x32_bf16 v[248:251], a[52:55], a[4:7], v[248:251]
    ds_read2_b32 a[70:71], v220 offset0:210 offset1:211
    v_fmac_f32 v22, s54, v144
    v_mfma_f32_16x16x32_bf16 v[252:255], a[56:59], a[4:7], v[252:255]
    v_fmac_f32 v23, s54, v145
    v_fmac_f32 v24, s54, v146
    v_mfma_f32_16x16x32_bf16 v[232:235], a[32:35], a[8:11], v[232:235]
    ds_read2_b32 a[72:73], v221 offset0:80 offset1:81
    v_fmac_f32 v25, s54, v147
    v_mfma_f32_16x16x32_bf16 v[236:239], a[36:39], a[8:11], v[236:239]
    ds_read2_b32 a[74:75], v221 offset0:82 offset1:83
    v_fmac_f32 v26, s54, v148
    v_mfma_f32_16x16x32_bf16 v[240:243], a[40:43], a[8:11], v[240:243]
    v_fmac_f32 v27, s54, v149
    v_fmac_f32 v20, s55, v141
    v_mfma_f32_16x16x32_bf16 v[244:247], a[44:47], a[8:11], v[244:247]
    ds_read2_b32 a[76:77], v221 offset0:208 offset1:209
    v_fmac_f32 v21, s55, v142
    v_mfma_f32_16x16x32_bf16 v[248:251], a[48:51], a[8:11], v[248:251]
    ds_read2_b32 a[78:79], v221 offset0:210 offset1:211
    v_fmac_f32 v22, s55, v143
    v_mfma_f32_16x16x32_bf16 v[252:255], a[52:55], a[8:11], v[252:255]
    v_fmac_f32 v23, s55, v144
    v_fmac_f32 v24, s55, v145
    v_mfma_f32_16x16x32_bf16 v[236:239], a[32:35], a[12:15], v[236:239]
    ds_read2_b32 a[80:81], v222 offset0:80 offset1:81
    v_fmac_f32 v25, s55, v146
    v_mfma_f32_16x16x32_bf16 v[240:243], a[36:39], a[12:15], v[240:243]
    ds_read2_b32 a[82:83], v222 offset0:82 offset1:83
    v_fmac_f32 v26, s55, v147
    v_mfma_f32_16x16x32_bf16 v[244:247], a[40:43], a[12:15], v[244:247]
    v_fmac_f32 v27, s55, v148
    v_fmac_f32 v20, s56, v140
    v_mfma_f32_16x16x32_bf16 v[248:251], a[44:47], a[12:15], v[248:251]
    ds_read2_b32 a[84:85], v222 offset0:208 offset1:209
    v_fmac_f32 v21, s56, v141
    v_mfma_f32_16x16x32_bf16 v[252:255], a[48:51], a[12:15], v[252:255]
    ds_read2_b32 a[86:87], v222 offset0:210 offset1:211
    v_fmac_f32 v22, s56, v142
    v_mfma_f32_16x16x32_bf16 v[240:243], a[32:35], a[16:19], v[240:243]
    v_fmac_f32 v23, s56, v143
    v_fmac_f32 v24, s56, v144
    v_mfma_f32_16x16x32_bf16 v[244:247], a[36:39], a[16:19], v[244:247]
    ds_read2_b32 a[88:89], v223 offset0:80 offset1:81
    v_fmac_f32 v25, s56, v145
    v_mfma_f32_16x16x32_bf16 v[248:251], a[40:43], a[16:19], v[248:251]
    ds_read2_b32 a[90:91], v223 offset0:82 offset1:83
    v_fmac_f32 v26, s56, v146
    v_mfma_f32_16x16x32_bf16 v[252:255], a[44:47], a[16:19], v[252:255]
    v_fmac_f32 v27, s56, v147
    s_waitcnt vmcnt(8)
    v_lshlrev_b32 v200, 16, v206
    v_mfma_f32_16x16x32_bf16 v[244:247], a[32:35], a[20:23], v[244:247]
    ds_read2_b32 a[92:93], v223 offset0:208 offset1:209
    v_and_b32 v206, 0xffff0000, v206
    v_mfma_f32_16x16x32_bf16 v[248:251], a[36:39], a[20:23], v[248:251]
    ds_read2_b32 a[94:95], v223 offset0:210 offset1:211
    v_lshlrev_b32 v201, 16, v207
    v_mfma_f32_16x16x32_bf16 v[252:255], a[40:43], a[20:23], v[252:255]
    v_and_b32 v207, 0xffff0000, v207
    v_lshlrev_b32 v202, 16, v208
    v_mfma_f32_16x16x32_bf16 v[248:251], a[32:35], a[24:27], v[248:251]
    v_and_b32 v208, 0xffff0000, v208
    v_lshlrev_b32 v203, 16, v209
    v_mfma_f32_16x16x32_bf16 v[252:255], a[36:39], a[24:27], v[252:255]
    v_and_b32 v209, 0xffff0000, v209
    v_mul_f32 v20, v20, v200
    v_mfma_f32_16x16x32_bf16 v[252:255], a[32:35], a[28:31], v[252:255]
    v_mul_f32 v21, v21, v206
    v_mul_f32 v22, v22, v201
    s_waitcnt lgkmcnt(0)
    v_mfma_f32_16x16x32_bf16 v[224:227], a[96:99], a[64:67], v[224:227]
    v_mul_f32 v23, v23, v207
    v_mul_f32 v24, v24, v202
    v_mfma_f32_16x16x32_bf16 v[228:231], a[100:103], a[64:67], v[228:231]
    ds_read_b128 a[32:35], v2 offset:3968
    ds_read_b128 a[36:39], v2 offset:3456
    v_mfma_f32_16x16x32_bf16 v[232:235], a[104:107], a[64:67], v[232:235]
    v_mul_f32 v25, v25, v208
    v_mul_f32 v26, v26, v203
    v_mfma_f32_16x16x32_bf16 v[236:239], a[108:111], a[64:67], v[236:239]
    ds_read_b128 a[40:43], v2 offset:2944
    ds_read_b128 a[44:47], v2 offset:2432
    v_mfma_f32_16x16x32_bf16 v[240:243], a[112:115], a[64:67], v[240:243]
    ds_read_b128 a[48:51], v2 offset:1920
    ds_read_b128 a[52:55], v2 offset:1408
    v_mfma_f32_16x16x32_bf16 v[244:247], a[116:119], a[64:67], v[244:247]
    v_mul_f32 v27, v27, v209
    v_cvt_pk_bf16_f32 v206, v27, v26
    v_mfma_f32_16x16x32_bf16 v[248:251], a[120:123], a[64:67], v[248:251]
    ds_read_b128 a[56:59], v2 offset:896
    v_cvt_pk_bf16_f32 v207, v25, v24
    v_mfma_f32_16x16x32_bf16 v[252:255], a[124:127], a[64:67], v[252:255]
    ds_read_b128 a[60:63], v2 offset:384
    v_cvt_pk_bf16_f32 v208, v23, v22
    v_mfma_f32_16x16x32_bf16 v[228:231], a[96:99], a[68:71], v[228:231]
    v_cvt_pk_bf16_f32 v209, v21, v20
    v_mfma_f32_16x16x32_bf16 v[232:235], a[100:103], a[68:71], v[232:235]
    ds_read2_b32 a[0:1], v220 offset0:96 offset1:97
    v_mfma_f32_16x16x32_bf16 v[236:239], a[104:107], a[68:71], v[236:239]
    ds_read2_b32 a[2:3], v220 offset0:98 offset1:99
    v_mfma_f32_16x16x32_bf16 v[240:243], a[108:111], a[68:71], v[240:243]
    ds_write_b128 v5, v[206:209] offset:16000
    v_mfma_f32_16x16x32_bf16 v[244:247], a[112:115], a[68:71], v[244:247]
    ds_read2_b32 a[4:5], v220 offset0:224 offset1:225
    v_mov_b32 v210, s8
    v_mfma_f32_16x16x32_bf16 v[248:251], a[116:119], a[68:71], v[248:251]
    ds_read2_b32 a[6:7], v220 offset0:226 offset1:227
    v_mov_b32 v211, s9
    v_mfma_f32_16x16x32_bf16 v[252:255], a[120:123], a[68:71], v[252:255]
    s_waitcnt vmcnt(7)
    v_mov_b32_dpp v210, v214 wave_shr:1 row_mask:0xf bank_mask:0xf
    v_mov_b32_dpp v211, v215 wave_shr:1 row_mask:0xf bank_mask:0xf
    v_mfma_f32_16x16x32_bf16 v[232:235], a[96:99], a[72:75], v[232:235]
    ds_read2_b32 a[8:9], v221 offset0:96 offset1:97
    v_readlane_b32 s8, v214, 63
    v_mfma_f32_16x16x32_bf16 v[236:239], a[100:103], a[72:75], v[236:239]
    ds_read2_b32 a[10:11], v221 offset0:98 offset1:99
    v_readlane_b32 s9, v215, 63
    v_mfma_f32_16x16x32_bf16 v[240:243], a[104:107], a[72:75], v[240:243]
    v_and_b32 v140, 0xffff0000, v210
    v_lshlrev_b32 v141, 16, v211
    v_mfma_f32_16x16x32_bf16 v[244:247], a[108:111], a[72:75], v[244:247]
    ds_read2_b32 a[12:13], v221 offset0:224 offset1:225
    v_and_b32 v142, 0xffff0000, v211
    v_mfma_f32_16x16x32_bf16 v[248:251], a[112:115], a[72:75], v[248:251]
    ds_read2_b32 a[14:15], v221 offset0:226 offset1:227
    v_lshlrev_b32 v143, 16, v212
    v_mfma_f32_16x16x32_bf16 v[252:255], a[116:119], a[72:75], v[252:255]
    v_and_b32 v144, 0xffff0000, v212
    v_lshlrev_b32 v145, 16, v213
    v_mfma_f32_16x16x32_bf16 v[236:239], a[96:99], a[76:79], v[236:239]
    ds_read2_b32 a[16:17], v222 offset0:96 offset1:97
    v_and_b32 v146, 0xffff0000, v213
    v_mfma_f32_16x16x32_bf16 v[240:243], a[100:103], a[76:79], v[240:243]
    ds_read2_b32 a[18:19], v222 offset0:98 offset1:99
    v_lshlrev_b32 v147, 16, v214
    v_mfma_f32_16x16x32_bf16 v[244:247], a[104:107], a[76:79], v[244:247]
    v_and_b32 v148, 0xffff0000, v214
    v_lshlrev_b32 v149, 16, v215
    v_mfma_f32_16x16x32_bf16 v[248:251], a[108:111], a[76:79], v[248:251]
    ds_read2_b32 a[20:21], v222 offset0:224 offset1:225
    v_and_b32 v150, 0xffff0000, v215
    v_mfma_f32_16x16x32_bf16 v[252:255], a[112:115], a[76:79], v[252:255]
    ds_read2_b32 a[22:23], v222 offset0:226 offset1:227
    v_mul_f32 v20, s53, v143
    v_mfma_f32_16x16x32_bf16 v[240:243], a[96:99], a[80:83], v[240:243]
    v_mul_f32 v21, s53, v144
    v_mul_f32 v22, s53, v145
    v_mfma_f32_16x16x32_bf16 v[244:247], a[100:103], a[80:83], v[244:247]
    ds_read2_b32 a[24:25], v223 offset0:96 offset1:97
    v_mul_f32 v23, s53, v146
    v_mfma_f32_16x16x32_bf16 v[248:251], a[104:107], a[80:83], v[248:251]
    ds_read2_b32 a[26:27], v223 offset0:98 offset1:99
    v_mul_f32 v24, s53, v147
    v_mfma_f32_16x16x32_bf16 v[252:255], a[108:111], a[80:83], v[252:255]
    v_mul_f32 v25, s53, v148
    v_mul_f32 v26, s53, v149
    v_mfma_f32_16x16x32_bf16 v[244:247], a[96:99], a[84:87], v[244:247]
    ds_read2_b32 a[28:29], v223 offset0:224 offset1:225
    v_mul_f32 v27, s53, v150
    v_mfma_f32_16x16x32_bf16 v[248:251], a[100:103], a[84:87], v[248:251]
    ds_read2_b32 a[30:31], v223 offset0:226 offset1:227
    v_fmac_f32 v20, s54, v142
    v_mfma_f32_16x16x32_bf16 v[252:255], a[104:107], a[84:87], v[252:255]
    v_fmac_f32 v21, s54, v143
    v_fmac_f32 v22, s54, v144
    v_mfma_f32_16x16x32_bf16 v[248:251], a[96:99], a[88:91], v[248:251]
    v_fmac_f32 v23, s54, v145
    v_fmac_f32 v24, s54, v146
    v_mfma_f32_16x16x32_bf16 v[252:255], a[100:103], a[88:91], v[252:255]
    v_fmac_f32 v25, s54, v147
    v_fmac_f32 v26, s54, v148
    v_mfma_f32_16x16x32_bf16 v[252:255], a[96:99], a[92:95], v[252:255]
    v_fmac_f32 v27, s54, v149
    v_fmac_f32 v20, s55, v141
    s_waitcnt lgkmcnt(0)
    v_mfma_f32_16x16x32_bf16 v[224:227], a[32:35], a[0:3], v[224:227]
    buffer_load_dword v16, v60, s[16:19], 0 offen offset:0 sc1
    v_mfma_f32_16x16x32_bf16 v[228:231], a[36:39], a[0:3], v[228:231]
    ds_read_b128 a[96:99], v2 offset:4032
    ds_read_b128 a[100:103], v2 offset:3520
    v_mfma_f32_16x16x32_bf16 v[232:235], a[40:43], a[0:3], v[232:235]
    buffer_load_dword v59, v13, s[80:83], s69 offen
    v_mfma_f32_16x16x32_bf16 v[236:239], a[44:47], a[0:3], v[236:239]
    ds_read_b128 a[104:107], v2 offset:3008
    ds_read_b128 a[108:111], v2 offset:2496
    v_mfma_f32_16x16x32_bf16 v[240:243], a[48:51], a[0:3], v[240:243]
    ds_read_b128 a[112:115], v2 offset:1984
    ds_read_b128 a[116:119], v2 offset:1472
    v_mfma_f32_16x16x32_bf16 v[244:247], a[52:55], a[0:3], v[244:247]
    s_lshl_b32 s46, s32, 10
    s_add_u32 s69, s69, s46
    v_mfma_f32_16x16x32_bf16 v[248:251], a[56:59], a[0:3], v[248:251]
    ds_read_b128 a[120:123], v2 offset:960
    v_fmac_f32 v21, s55, v142
    v_mfma_f32_16x16x32_bf16 v[252:255], a[60:63], a[0:3], v[252:255]
    ds_read_b128 a[124:127], v2 offset:448
    v_fmac_f32 v22, s55, v143
    v_mfma_f32_16x16x32_bf16 v[228:231], a[32:35], a[4:7], v[228:231]
    buffer_load_dwordx4 v[28:31], v11, s[80:83], s69 offen
    v_mfma_f32_16x16x32_bf16 v[232:235], a[36:39], a[4:7], v[232:235]
    ds_read2_b32 a[64:65], v220 offset0:112 offset1:113
    v_fmac_f32 v23, s55, v144
    v_mfma_f32_16x16x32_bf16 v[236:239], a[40:43], a[4:7], v[236:239]
    ds_read2_b32 a[66:67], v220 offset0:114 offset1:115
    v_fmac_f32 v24, s55, v145
    v_mfma_f32_16x16x32_bf16 v[240:243], a[44:47], a[4:7], v[240:243]
    buffer_load_dword v58, v11, s[80:83], s69 offen offset:16
    v_mfma_f32_16x16x32_bf16 v[244:247], a[48:51], a[4:7], v[244:247]
    ds_read2_b32 a[68:69], v220 offset0:240 offset1:241
    v_add_u32 v9, s46, v11
    v_mfma_f32_16x16x32_bf16 v[248:251], a[52:55], a[4:7], v[248:251]
    ds_read2_b32 a[70:71], v220 offset0:242 offset1:243
    v_sub_u32 v8, 115824, v9
    v_mfma_f32_16x16x32_bf16 v[252:255], a[56:59], a[4:7], v[252:255]
    v_add_u32 v9, 103424, v9
    v_cmp_eq_u32 s[10:11], 0, v63
    v_mfma_f32_16x16x32_bf16 v[232:235], a[32:35], a[8:11], v[232:235]
    ds_read2_b32 a[72:73], v221 offset0:112 offset1:113
    v_add_u32 v6, 103424, v6
    v_mfma_f32_16x16x32_bf16 v[236:239], a[36:39], a[8:11], v[236:239]
    ds_read2_b32 a[74:75], v221 offset0:114 offset1:115
    s_lshl_b32 s57, s88, 16
    v_mfma_f32_16x16x32_bf16 v[240:243], a[40:43], a[8:11], v[240:243]
    s_and_b32 s58, s88, 0xffff0000
    s_lshl_b32 s59, s89, 16
    v_mfma_f32_16x16x32_bf16 v[244:247], a[44:47], a[8:11], v[244:247]
    ds_read2_b32 a[76:77], v221 offset0:240 offset1:241
    s_and_b32 s60, s89, 0xffff0000
    v_mfma_f32_16x16x32_bf16 v[248:251], a[48:51], a[8:11], v[248:251]
    ds_read2_b32 a[78:79], v221 offset0:242 offset1:243
    v_fmac_f32 v25, s55, v146
    v_mfma_f32_16x16x32_bf16 v[252:255], a[52:55], a[8:11], v[252:255]
    v_fmac_f32 v26, s55, v147
    v_fmac_f32 v27, s55, v148
    v_mfma_f32_16x16x32_bf16 v[236:239], a[32:35], a[12:15], v[236:239]
    ds_read2_b32 a[80:81], v222 offset0:112 offset1:113
    v_fmac_f32 v20, s56, v140
    v_mfma_f32_16x16x32_bf16 v[240:243], a[36:39], a[12:15], v[240:243]
    ds_read2_b32 a[82:83], v222 offset0:114 offset1:115
    v_fmac_f32 v21, s56, v141
    v_mfma_f32_16x16x32_bf16 v[244:247], a[40:43], a[12:15], v[244:247]
    v_fmac_f32 v22, s56, v142
    v_fmac_f32 v23, s56, v143
    v_mfma_f32_16x16x32_bf16 v[248:251], a[44:47], a[12:15], v[248:251]
    ds_read2_b32 a[84:85], v222 offset0:240 offset1:241
    v_fmac_f32 v24, s56, v144
    v_mfma_f32_16x16x32_bf16 v[252:255], a[48:51], a[12:15], v[252:255]
    ds_read2_b32 a[86:87], v222 offset0:242 offset1:243
    v_fmac_f32 v25, s56, v145
    v_mfma_f32_16x16x32_bf16 v[240:243], a[32:35], a[16:19], v[240:243]
    v_fmac_f32 v26, s56, v146
    v_fmac_f32 v27, s56, v147
    v_mfma_f32_16x16x32_bf16 v[244:247], a[36:39], a[16:19], v[244:247]
    ds_read2_b32 a[88:89], v223 offset0:112 offset1:113
    s_waitcnt vmcnt(10)
    v_lshlrev_b32 v210, 16, v216
    v_mfma_f32_16x16x32_bf16 v[248:251], a[40:43], a[16:19], v[248:251]
    ds_read2_b32 a[90:91], v223 offset0:114 offset1:115
    v_and_b32 v216, 0xffff0000, v216
    v_mfma_f32_16x16x32_bf16 v[252:255], a[44:47], a[16:19], v[252:255]
    v_lshlrev_b32 v211, 16, v217
    v_and_b32 v217, 0xffff0000, v217
    v_mfma_f32_16x16x32_bf16 v[244:247], a[32:35], a[20:23], v[244:247]
    ds_read2_b32 a[92:93], v223 offset0:240 offset1:241
    v_lshlrev_b32 v212, 16, v218
    v_mfma_f32_16x16x32_bf16 v[248:251], a[36:39], a[20:23], v[248:251]
    ds_read2_b32 a[94:95], v223 offset0:242 offset1:243
    v_and_b32 v218, 0xffff0000, v218
    v_mfma_f32_16x16x32_bf16 v[252:255], a[40:43], a[20:23], v[252:255]
    v_lshlrev_b32 v213, 16, v219
    v_and_b32 v219, 0xffff0000, v219
    v_mfma_f32_16x16x32_bf16 v[248:251], a[32:35], a[24:27], v[248:251]
    v_mul_f32 v20, v20, v210
    v_mul_f32 v21, v21, v216
    v_mfma_f32_16x16x32_bf16 v[252:255], a[36:39], a[24:27], v[252:255]
    v_mul_f32 v22, v22, v211
    v_mul_f32 v23, v23, v217
    v_mfma_f32_16x16x32_bf16 v[252:255], a[32:35], a[28:31], v[252:255]
    v_mul_f32 v24, v24, v212
    v_mul_f32 v25, v25, v218
    s_waitcnt lgkmcnt(0)
    v_mfma_f32_16x16x32_bf16 v[224:227], a[96:99], a[64:67], v[224:227]
    v_mul_f32 v26, v26, v213
    v_mul_f32 v27, v27, v219
    v_mfma_f32_16x16x32_bf16 v[228:231], a[100:103], a[64:67], v[228:231]
    v_cvt_pk_bf16_f32 v216, v27, v26
    v_cvt_pk_bf16_f32 v217, v25, v24
    v_mfma_f32_16x16x32_bf16 v[232:235], a[104:107], a[64:67], v[232:235]
    v_cvt_pk_bf16_f32 v218, v23, v22
    v_cvt_pk_bf16_f32 v219, v21, v20
    v_mfma_f32_16x16x32_bf16 v[236:239], a[108:111], a[64:67], v[236:239]
    ds_write_b128 v5, v[216:219] offset:14976
    v_mfma_f32_16x16x32_bf16 v[240:243], a[112:115], a[64:67], v[240:243]
    v_mov_b32 v64, s8
    v_mov_b32 v65, s9
    v_mfma_f32_16x16x32_bf16 v[244:247], a[116:119], a[64:67], v[244:247]
    s_waitcnt vmcnt(9)
    v_mov_b32_dpp v64, v68 wave_shr:1 row_mask:0xf bank_mask:0xf
    v_mov_b32_dpp v65, v69 wave_shr:1 row_mask:0xf bank_mask:0xf
    v_mfma_f32_16x16x32_bf16 v[248:251], a[120:123], a[64:67], v[248:251]
    v_readlane_b32 s8, v68, 63
    v_readlane_b32 s9, v69, 63
    v_mfma_f32_16x16x32_bf16 v[252:255], a[124:127], a[64:67], v[252:255]
    v_and_b32 v140, 0xffff0000, v64
    v_lshlrev_b32 v141, 16, v65
    v_mfma_f32_16x16x32_bf16 v[228:231], a[96:99], a[68:71], v[228:231]
    v_and_b32 v142, 0xffff0000, v65
    v_lshlrev_b32 v143, 16, v66
    v_mfma_f32_16x16x32_bf16 v[232:235], a[100:103], a[68:71], v[232:235]
    v_and_b32 v144, 0xffff0000, v66
    v_lshlrev_b32 v145, 16, v67
    v_mfma_f32_16x16x32_bf16 v[236:239], a[104:107], a[68:71], v[236:239]
    v_and_b32 v146, 0xffff0000, v67
    v_lshlrev_b32 v147, 16, v68
    v_mfma_f32_16x16x32_bf16 v[240:243], a[108:111], a[68:71], v[240:243]
    v_and_b32 v148, 0xffff0000, v68
    v_lshlrev_b32 v149, 16, v69
    v_mfma_f32_16x16x32_bf16 v[244:247], a[112:115], a[68:71], v[244:247]
    v_and_b32 v150, 0xffff0000, v69
    v_mul_f32 v20, s53, v143
    v_mfma_f32_16x16x32_bf16 v[248:251], a[116:119], a[68:71], v[248:251]
    v_mul_f32 v21, s53, v144
    v_mul_f32 v22, s53, v145
    v_mfma_f32_16x16x32_bf16 v[252:255], a[120:123], a[68:71], v[252:255]
    v_mul_f32 v23, s53, v146
    v_mul_f32 v24, s53, v147
    v_mfma_f32_16x16x32_bf16 v[232:235], a[96:99], a[72:75], v[232:235]
    v_mul_f32 v25, s53, v148
    v_mul_f32 v26, s53, v149
    v_mfma_f32_16x16x32_bf16 v[236:239], a[100:103], a[72:75], v[236:239]
    v_mul_f32 v27, s53, v150
    v_fmac_f32 v20, s54, v142
    v_mfma_f32_16x16x32_bf16 v[240:243], a[104:107], a[72:75], v[240:243]
    v_fmac_f32 v21, s54, v143
    v_fmac_f32 v22, s54, v144
    v_mfma_f32_16x16x32_bf16 v[244:247], a[108:111], a[72:75], v[244:247]
    v_fmac_f32 v23, s54, v145
    v_fmac_f32 v24, s54, v146
    v_mfma_f32_16x16x32_bf16 v[248:251], a[112:115], a[72:75], v[248:251]
    v_fmac_f32 v25, s54, v147
    v_fmac_f32 v26, s54, v148
    v_mfma_f32_16x16x32_bf16 v[252:255], a[116:119], a[72:75], v[252:255]
    v_fmac_f32 v27, s54, v149
    v_fmac_f32 v20, s55, v141
    v_mfma_f32_16x16x32_bf16 v[236:239], a[96:99], a[76:79], v[236:239]
    v_fmac_f32 v21, s55, v142
    v_fmac_f32 v22, s55, v143
    v_mfma_f32_16x16x32_bf16 v[240:243], a[100:103], a[76:79], v[240:243]
    v_fmac_f32 v23, s55, v144
    v_fmac_f32 v24, s55, v145
    v_mfma_f32_16x16x32_bf16 v[244:247], a[104:107], a[76:79], v[244:247]
    v_fmac_f32 v25, s55, v146
    v_fmac_f32 v26, s55, v147
    v_mfma_f32_16x16x32_bf16 v[248:251], a[108:111], a[76:79], v[248:251]
    v_fmac_f32 v27, s55, v148
    v_fmac_f32 v20, s56, v140
    v_mfma_f32_16x16x32_bf16 v[252:255], a[112:115], a[76:79], v[252:255]
    v_fmac_f32 v21, s56, v141
    v_fmac_f32 v22, s56, v142
    v_mfma_f32_16x16x32_bf16 v[240:243], a[96:99], a[80:83], v[240:243]
    v_fmac_f32 v23, s56, v143
    v_fmac_f32 v24, s56, v144
    v_mfma_f32_16x16x32_bf16 v[244:247], a[100:103], a[80:83], v[244:247]
    v_fmac_f32 v25, s56, v145
    v_fmac_f32 v26, s56, v146
    v_mfma_f32_16x16x32_bf16 v[248:251], a[104:107], a[80:83], v[248:251]
    v_fmac_f32 v27, s56, v147
    s_waitcnt vmcnt(8)
    v_lshlrev_b32 v64, 16, v70
    v_mfma_f32_16x16x32_bf16 v[252:255], a[108:111], a[80:83], v[252:255]
    v_and_b32 v70, 0xffff0000, v70
    v_lshlrev_b32 v65, 16, v71
    v_mfma_f32_16x16x32_bf16 v[244:247], a[96:99], a[84:87], v[244:247]
    v_and_b32 v71, 0xffff0000, v71
    v_lshlrev_b32 v66, 16, v72
    v_mfma_f32_16x16x32_bf16 v[248:251], a[100:103], a[84:87], v[248:251]
    v_and_b32 v72, 0xffff0000, v72
    v_lshlrev_b32 v67, 16, v73
    v_mfma_f32_16x16x32_bf16 v[252:255], a[104:107], a[84:87], v[252:255]
    v_and_b32 v73, 0xffff0000, v73
    v_mul_f32 v20, v20, v64
    v_mfma_f32_16x16x32_bf16 v[248:251], a[96:99], a[88:91], v[248:251]
    v_mul_f32 v21, v21, v70
    v_mul_f32 v22, v22, v65
    v_mfma_f32_16x16x32_bf16 v[252:255], a[100:103], a[88:91], v[252:255]
    v_mul_f32 v23, v23, v71
    v_mul_f32 v24, v24, v66
    v_mfma_f32_16x16x32_bf16 v[252:255], a[96:99], a[92:95], v[252:255]
    v_mul_f32 v25, v25, v72
    v_mul_f32 v26, v26, v67
    v_mul_f32 v27, v27, v73
    v_cvt_pk_bf16_f32 v70, v27, v26
    v_cvt_pk_bf16_f32 v71, v25, v24
    v_cvt_pk_bf16_f32 v72, v23, v22
    v_cvt_pk_bf16_f32 v73, v21, v20
    ds_write_b128 v5, v[70:73] offset:13952
    v_mov_b32 v74, s8
    v_mov_b32 v75, s9
    s_waitcnt vmcnt(7)
    v_mov_b32_dpp v74, v78 wave_shr:1 row_mask:0xf bank_mask:0xf
    v_mov_b32_dpp v75, v79 wave_shr:1 row_mask:0xf bank_mask:0xf
    v_and_b32 v140, 0xffff0000, v74
    v_lshlrev_b32 v141, 16, v75
    v_and_b32 v142, 0xffff0000, v75
    v_lshlrev_b32 v143, 16, v76
    v_and_b32 v144, 0xffff0000, v76
    v_lshlrev_b32 v145, 16, v77
    v_and_b32 v146, 0xffff0000, v77
    v_lshlrev_b32 v147, 16, v78
    v_and_b32 v148, 0xffff0000, v78
    v_lshlrev_b32 v149, 16, v79
    v_and_b32 v150, 0xffff0000, v79
    v_mul_f32 v20, s53, v143
    v_mul_f32 v21, s53, v144
    v_mul_f32 v22, s53, v145
    v_mul_f32 v23, s53, v146
    v_mul_f32 v24, s53, v147
    v_mul_f32 v25, s53, v148
    v_mul_f32 v26, s53, v149
    v_mul_f32 v27, s53, v150
    v_fmac_f32 v20, s54, v142
    v_fmac_f32 v21, s54, v143
    v_fmac_f32 v22, s54, v144
    v_fmac_f32 v23, s54, v145
    v_fmac_f32 v24, s54, v146
    v_fmac_f32 v25, s54, v147
    v_fmac_f32 v26, s54, v148
    v_fmac_f32 v27, s54, v149
    v_fmac_f32 v20, s55, v141
    v_fmac_f32 v21, s55, v142
    v_fmac_f32 v22, s55, v143
    v_fmac_f32 v23, s55, v144
    v_fmac_f32 v24, s55, v145
    v_fmac_f32 v25, s55, v146
    v_fmac_f32 v26, s55, v147
    v_fmac_f32 v27, s55, v148
    v_fmac_f32 v20, s56, v140
    v_fmac_f32 v21, s56, v141
    v_fmac_f32 v22, s56, v142
    v_fmac_f32 v23, s56, v143
    v_fmac_f32 v24, s56, v144
    v_fmac_f32 v25, s56, v145
    v_fmac_f32 v26, s56, v146
    v_fmac_f32 v27, s56, v147
    s_waitcnt vmcnt(6)
    v_lshlrev_b32 v74, 16, v80
    v_and_b32 v80, 0xffff0000, v80
    v_lshlrev_b32 v75, 16, v81
    v_and_b32 v81, 0xffff0000, v81
    v_lshlrev_b32 v76, 16, v82
    v_and_b32 v82, 0xffff0000, v82
    v_lshlrev_b32 v77, 16, v83
    v_and_b32 v83, 0xffff0000, v83
    v_mul_f32 v20, v20, v74
    v_mul_f32 v21, v21, v80
    v_mul_f32 v22, v22, v75
    v_mul_f32 v23, v23, v81
    v_mul_f32 v24, v24, v76
    v_mul_f32 v25, v25, v82
    v_mul_f32 v26, v26, v77
    v_mul_f32 v27, v27, v83
    v_cvt_pk_bf16_f32 v80, v27, v26
    v_cvt_pk_bf16_f32 v81, v25, v24
    v_cvt_pk_bf16_f32 v82, v23, v22
    v_cvt_pk_bf16_f32 v83, v21, v20
    ds_write_b128 v5, v[80:83] offset:12928
    v_add_u32 v220, 12928, v220
    v_add_u32 v221, 12928, v221
    v_add_u32 v222, 12928, v222
    v_add_u32 v223, 12928, v223
    ds_read_b128 a[32:35], v2 offset:16512
    ds_read_b128 a[36:39], v2 offset:16000
    ds_read_b128 a[40:43], v2 offset:15488
    ds_read_b128 a[44:47], v2 offset:14976
    ds_read_b128 a[48:51], v2 offset:14464
    ds_read_b128 a[52:55], v2 offset:13952
    ds_read_b128 a[56:59], v2 offset:13440
    ds_read_b128 a[60:63], v2 offset:12928
    ds_read2_b32 a[0:1], v220 offset0:0 offset1:1
    ds_read2_b32 a[2:3], v220 offset0:2 offset1:3
    ds_read2_b32 a[4:5], v220 offset0:128 offset1:129
    ds_read2_b32 a[6:7], v220 offset0:130 offset1:131
    ds_read2_b32 a[8:9], v221 offset0:0 offset1:1
    ds_read2_b32 a[10:11], v221 offset0:2 offset1:3
    ds_read2_b32 a[12:13], v221 offset0:128 offset1:129
    ds_read2_b32 a[14:15], v221 offset0:130 offset1:131
    ds_read2_b32 a[16:17], v222 offset0:0 offset1:1
    ds_read2_b32 a[18:19], v222 offset0:2 offset1:3
    ds_read2_b32 a[20:21], v222 offset0:128 offset1:129
    ds_read2_b32 a[22:23], v222 offset0:130 offset1:131
    ds_read2_b32 a[24:25], v223 offset0:0 offset1:1
    ds_read2_b32 a[26:27], v223 offset0:2 offset1:3
    ds_read2_b32 a[28:29], v223 offset0:128 offset1:129
    ds_read2_b32 a[30:31], v223 offset0:130 offset1:131
    s_waitcnt lgkmcnt(15)
    v_mfma_f32_16x16x32_bf16 v[160:163], a[32:35], v[32:35], 0
    v_mfma_f32_16x16x32_bf16 v[164:167], a[36:39], v[32:35], 0
    ds_read_b128 a[96:99], v2 offset:16576
    v_mfma_f32_16x16x32_bf16 v[168:171], a[40:43], v[32:35], 0
    v_mfma_f32_16x16x32_bf16 v[172:175], a[44:47], v[32:35], 0
    ds_read_b128 a[100:103], v2 offset:16064
    v_mfma_f32_16x16x32_bf16 v[176:179], a[48:51], v[32:35], 0
    ds_read_b128 a[104:107], v2 offset:15552
    v_and_b32 v15, 0xf0, v11
    v_mfma_f32_16x16x32_bf16 v[180:183], a[52:55], v[32:35], 0
    v_and_b32 v18, 0x300, v11
    v_lshl_add_u32 v15, v18, 1, v15
    v_mfma_f32_16x16x32_bf16 v[184:187], a[56:59], v[32:35], 0
    ds_read_b128 a[108:111], v2 offset:15040
    s_lshl_b32 s12, s68, 1
    v_mfma_f32_16x16x32_bf16 v[188:191], a[60:63], v[32:35], 0
    ds_read_b128 a[112:115], v2 offset:14528
    s_add_u32 s12, s12, 7340032
    s_waitcnt lgkmcnt(15)
    v_mfma_f32_16x16x32_bf16 v[160:163], a[32:35], a[0:3], v[160:163]
    s_add_u32 s13, s12, 4096
    s_add_u32 s14, s12, 8192
    v_mfma_f32_16x16x32_bf16 v[164:167], a[36:39], a[0:3], v[164:167]
    ds_read_b128 a[116:119], v2 offset:14016
    s_add_u32 s15, s12, 12288
    v_mfma_f32_16x16x32_bf16 v[168:171], a[40:43], a[0:3], v[168:171]
    ds_read_b128 a[120:123], v2 offset:13504
    v_cvt_pk_bf16_f32 v96, s64, v224
    v_mfma_f32_16x16x32_bf16 v[172:175], a[44:47], a[0:3], v[172:175]
    v_cvt_pk_bf16_f32 v97, s64, v225
    v_cvt_pk_bf16_f32 v100, s64, v226
    v_mfma_f32_16x16x32_bf16 v[176:179], a[48:51], a[0:3], v[176:179]
    ds_read_b128 a[124:127], v2 offset:12992
    v_cvt_pk_bf16_f32 v101, s64, v227
    v_mfma_f32_16x16x32_bf16 v[180:183], a[52:55], a[0:3], v[180:183]
    ds_read2_b32 a[64:65], v220 offset0:16 offset1:17
    v_cvt_pk_bf16_f32 v104, s64, v228
    v_mfma_f32_16x16x32_bf16 v[184:187], a[56:59], a[0:3], v[184:187]
    v_cvt_pk_bf16_f32 v105, s64, v229
    v_cvt_pk_bf16_f32 v108, s64, v230
    v_mfma_f32_16x16x32_bf16 v[188:191], a[60:63], a[0:3], v[188:191]
    ds_read2_b32 a[66:67], v220 offset0:18 offset1:19
    v_cvt_pk_bf16_f32 v109, s64, v231
    v_mfma_f32_16x16x32_bf16 v[164:167], a[32:35], a[4:7], v[164:167]
    ds_read2_b32 a[68:69], v220 offset0:144 offset1:145
    v_cvt_pk_bf16_f32 v112, s64, v232
    v_mfma_f32_16x16x32_bf16 v[168:171], a[36:39], a[4:7], v[168:171]
    s_waitcnt vmcnt(3)
    v_cmp_ne_u32 vcc, s66, v16
    s_cbranch_vccnz L_slow_convB
L_ret_convB:
    v_mfma_f32_16x16x32_bf16 v[172:175], a[40:43], a[4:7], v[172:175]
    ds_read2_b32 a[70:71], v220 offset0:146 offset1:147
    s_add_u32 s36, s94, 512
    v_mfma_f32_16x16x32_bf16 v[176:179], a[44:47], a[4:7], v[176:179]
    ds_read2_b32 a[72:73], v221 offset0:16 offset1:17
    s_lshl_b32 s36, s36, 7
    v_mfma_f32_16x16x32_bf16 v[180:183], a[48:51], a[4:7], v[180:183]
    s_mul_i32 s37, s32, 589824
    s_add_u32 s37, s37, s36
    v_mfma_f32_16x16x32_bf16 v[184:187], a[52:55], a[4:7], v[184:187]
    ds_read2_b32 a[74:75], v221 offset0:18 offset1:19
    s_add_u32 s36, s37, 974968
    v_mfma_f32_16x16x32_bf16 v[188:191], a[56:59], a[4:7], v[188:191]
    ds_read2_b32 a[76:77], v221 offset0:144 offset1:145
    v_cvt_pk_bf16_f32 v113, s64, v233
    v_mfma_f32_16x16x32_bf16 v[168:171], a[32:35], a[8:11], v[168:171]
    buffer_load_dwordx2 v[36:37], v61, s[16:19], s36 offen sc1
    v_mfma_f32_16x16x32_bf16 v[172:175], a[36:39], a[8:11], v[172:175]
    ds_read2_b32 a[78:79], v221 offset0:146 offset1:147
    s_add_u32 s36, s37, 1048576
    v_mfma_f32_16x16x32_bf16 v[176:179], a[40:43], a[8:11], v[176:179]
    ds_read2_b32 a[80:81], v222 offset0:16 offset1:17
    s_add_u32 s37, s37, 4194304
    v_mfma_f32_16x16x32_bf16 v[180:183], a[44:47], a[8:11], v[180:183]
    buffer_load_dwordx4 v[38:41], v61, s[16:19], s36 offen offset:0 sc1
    v_mfma_f32_16x16x32_bf16 v[184:187], a[48:51], a[8:11], v[184:187]
    ds_read2_b32 a[82:83], v222 offset0:18 offset1:19
    v_cvt_pk_bf16_f32 v116, s64, v234
    v_mfma_f32_16x16x32_bf16 v[188:191], a[52:55], a[8:11], v[188:191]
    ds_read2_b32 a[84:85], v222 offset0:144 offset1:145
    v_cvt_pk_bf16_f32 v117, s64, v235
    s_waitcnt lgkmcnt(15)
    v_mfma_f32_16x16x32_bf16 v[172:175], a[32:35], a[12:15], v[172:175]
    buffer_load_dwordx4 v[42:45], v61, s[16:19], s37 offen offset:0 sc1
    v_mfma_f32_16x16x32_bf16 v[176:179], a[36:39], a[12:15], v[176:179]
    ds_read2_b32 a[86:87], v222 offset0:146 offset1:147
    v_cvt_pk_bf16_f32 v120, s64, v236
    v_mfma_f32_16x16x32_bf16 v[180:183], a[40:43], a[12:15], v[180:183]
    ds_read2_b32 a[88:89], v223 offset0:16 offset1:17
    v_cvt_pk_bf16_f32 v121, s64, v237
    v_mfma_f32_16x16x32_bf16 v[184:187], a[44:47], a[12:15], v[184:187]
    v_cvt_pk_bf16_f32 v124, s64, v238
    v_cvt_pk_bf16_f32 v125, s64, v239
    v_mfma_f32_16x16x32_bf16 v[188:191], a[48:51], a[12:15], v[188:191]
    ds_read2_b32 a[90:91], v223 offset0:18 offset1:19
    v_cvt_pk_bf16_f32 v128, s64, v240
    v_mfma_f32_16x16x32_bf16 v[176:179], a[32:35], a[16:19], v[176:179]
    ds_read2_b32 a[92:93], v223 offset0:144 offset1:145
    v_cvt_pk_bf16_f32 v129, s64, v241
    v_mfma_f32_16x16x32_bf16 v[180:183], a[36:39], a[16:19], v[180:183]
    v_cvt_pk_bf16_f32 v132, s64, v242
    v_cvt_pk_bf16_f32 v133, s64, v243
    v_mfma_f32_16x16x32_bf16 v[184:187], a[40:43], a[16:19], v[184:187]
    ds_read2_b32 a[94:95], v223 offset0:146 offset1:147
    v_cvt_pk_bf16_f32 v136, s64, v244
    v_mfma_f32_16x16x32_bf16 v[188:191], a[44:47], a[16:19], v[188:191]
    v_cvt_pk_bf16_f32 v137, s64, v245
    v_cvt_pk_bf16_f32 v140, s64, v246
    v_mfma_f32_16x16x32_bf16 v[180:183], a[32:35], a[20:23], v[180:183]
    v_cvt_pk_bf16_f32 v141, s64, v247
    v_cvt_pk_bf16_f32 v144, s64, v248
    v_mfma_f32_16x16x32_bf16 v[184:187], a[36:39], a[20:23], v[184:187]
    v_cvt_pk_bf16_f32 v145, s64, v249
    v_cvt_pk_bf16_f32 v148, s64, v250
    v_mfma_f32_16x16x32_bf16 v[188:191], a[40:43], a[20:23], v[188:191]
    v_cvt_pk_bf16_f32 v149, s64, v251
    v_cvt_pk_bf16_f32 v152, s64, v252
    v_mfma_f32_16x16x32_bf16 v[184:187], a[32:35], a[24:27], v[184:187]
    v_cvt_pk_bf16_f32 v153, s64, v253
    v_cvt_pk_bf16_f32 v156, s64, v254
    v_mfma_f32_16x16x32_bf16 v[188:191], a[36:39], a[24:27], v[188:191]
    v_cvt_pk_bf16_f32 v157, s64, v255
    v_mfma_f32_16x16x32_bf16 v[188:191], a[32:35], a[28:31], v[188:191]
    s_waitcnt lgkmcnt(0)
    v_mfma_f32_16x16x32_bf16 v[160:163], a[96:99], a[64:67], v[160:163]
    v_mfma_f32_16x16x32_bf16 v[164:167], a[100:103], a[64:67], v[164:167]
    ds_read_b128 a[32:35], v2 offset:16640
    ds_read_b128 a[36:39], v2 offset:16128
    v_mfma_f32_16x16x32_bf16 v[168:171], a[104:107], a[64:67], v[168:171]
    v_mfma_f32_16x16x32_bf16 v[172:175], a[108:111], a[64:67], v[172:175]
    ds_read_b128 a[40:43], v2 offset:15616
    ds_read_b128 a[44:47], v2 offset:15104
    v_mfma_f32_16x16x32_bf16 v[176:179], a[112:115], a[64:67], v[176:179]
    ds_read_b128 a[48:51], v2 offset:14592
    ds_read_b128 a[52:55], v2 offset:14080
    v_mfma_f32_16x16x32_bf16 v[180:183], a[116:119], a[64:67], v[180:183]
    v_mfma_f32_16x16x32_bf16 v[184:187], a[120:123], a[64:67], v[184:187]
    ds_read_b128 a[56:59], v2 offset:13568
    v_mfma_f32_16x16x32_bf16 v[188:191], a[124:127], a[64:67], v[188:191]
    ds_read_b128 a[60:63], v2 offset:13056
    v_mfma_f32_16x16x32_bf16 v[164:167], a[96:99], a[68:71], v[164:167]
    v_mfma_f32_16x16x32_bf16 v[168:171], a[100:103], a[68:71], v[168:171]
    ds_read2_b32 a[0:1], v220 offset0:32 offset1:33
    v_mfma_f32_16x16x32_bf16 v[172:175], a[104:107], a[68:71], v[172:175]
    ds_read2_b32 a[2:3], v220 offset0:34 offset1:35
    v_mfma_f32_16x16x32_bf16 v[176:179], a[108:111], a[68:71], v[176:179]
    v_mfma_f32_16x16x32_bf16 v[180:183], a[112:115], a[68:71], v[180:183]
    ds_read2_b32 a[4:5], v220 offset0:160 offset1:161
    v_mfma_f32_16x16x32_bf16 v[184:187], a[116:119], a[68:71], v[184:187]
    ds_read2_b32 a[6:7], v220 offset0:162 offset1:163
    v_mfma_f32_16x16x32_bf16 v[188:191], a[120:123], a[68:71], v[188:191]
    v_mfma_f32_16x16x32_bf16 v[168:171], a[96:99], a[72:75], v[168:171]
    ds_read2_b32 a[8:9], v221 offset0:32 offset1:33
    v_mfma_f32_16x16x32_bf16 v[172:175], a[100:103], a[72:75], v[172:175]
    ds_read2_b32 a[10:11], v221 offset0:34 offset1:35
    v_mfma_f32_16x16x32_bf16 v[176:179], a[104:107], a[72:75], v[176:179]
    v_mfma_f32_16x16x32_bf16 v[180:183], a[108:111], a[72:75], v[180:183]
    ds_read2_b32 a[12:13], v221 offset0:160 offset1:161
    v_mfma_f32_16x16x32_bf16 v[184:187], a[112:115], a[72:75], v[184:187]
    ds_read2_b32 a[14:15], v221 offset0:162 offset1:163
    v_mfma_f32_16x16x32_bf16 v[188:191], a[116:119], a[72:75], v[188:191]
    v_mfma_f32_16x16x32_bf16 v[172:175], a[96:99], a[76:79], v[172:175]
    ds_read2_b32 a[16:17], v222 offset0:32 offset1:33
    v_mfma_f32_16x16x32_bf16 v[176:179], a[100:103], a[76:79], v[176:179]
    ds_read2_b32 a[18:19], v222 offset0:34 offset1:35
    v_mfma_f32_16x16x32_bf16 v[180:183], a[104:107], a[76:79], v[180:183]
    v_mfma_f32_16x16x32_bf16 v[184:187], a[108:111], a[76:79], v[184:187]
    ds_read2_b32 a[20:21], v222 offset0:160 offset1:161
    v_mfma_f32_16x16x32_bf16 v[188:191], a[112:115], a[76:79], v[188:191]
    ds_read2_b32 a[22:23], v222 offset0:162 offset1:163
    v_mfma_f32_16x16x32_bf16 v[176:179], a[96:99], a[80:83], v[176:179]
    v_mfma_f32_16x16x32_bf16 v[180:183], a[100:103], a[80:83], v[180:183]
    ds_read2_b32 a[24:25], v223 offset0:32 offset1:33
    v_mfma_f32_16x16x32_bf16 v[184:187], a[104:107], a[80:83], v[184:187]
    ds_read2_b32 a[26:27], v223 offset0:34 offset1:35
    v_mfma_f32_16x16x32_bf16 v[188:191], a[108:111], a[80:83], v[188:191]
    v_mfma_f32_16x16x32_bf16 v[180:183], a[96:99], a[84:87], v[180:183]
    ds_read2_b32 a[28:29], v223 offset0:160 offset1:161
    v_mfma_f32_16x16x32_bf16 v[184:187], a[100:103], a[84:87], v[184:187]
    ds_read2_b32 a[30:31], v223 offset0:162 offset1:163
    v_mfma_f32_16x16x32_bf16 v[188:191], a[104:107], a[84:87], v[188:191]
    v_mfma_f32_16x16x32_bf16 v[184:187], a[96:99], a[88:91], v[184:187]
    v_mfma_f32_16x16x32_bf16 v[188:191], a[100:103], a[88:91], v[188:191]
    v_mfma_f32_16x16x32_bf16 v[188:191], a[96:99], a[92:95], v[188:191]
    s_waitcnt lgkmcnt(0)
    v_mfma_f32_16x16x32_bf16 v[160:163], a[32:35], a[0:3], v[160:163]
    s_mov_b32 s100, 663552
    buffer_load_dword a204, v12, s[20:23], s100 offen
    v_mfma_f32_16x16x32_bf16 v[164:167], a[36:39], a[0:3], v[164:167]
    ds_read_b128 a[96:99], v2 offset:16704
    ds_read_b128 a[100:103], v2 offset:16192
    v_mfma_f32_16x16x32_bf16 v[168:171], a[40:43], a[0:3], v[168:171]
    v_mfma_f32_16x16x32_bf16 v[172:175], a[44:47], a[0:3], v[172:175]
    ds_read_b128 a[104:107], v2 offset:15680
    ds_read_b128 a[108:111], v2 offset:15168
    v_mfma_f32_16x16x32_bf16 v[176:179], a[48:51], a[0:3], v[176:179]
    ds_read_b128 a[112:115], v2 offset:14656
    ds_read_b128 a[116:119], v2 offset:14144
    v_mfma_f32_16x16x32_bf16 v[180:183], a[52:55], a[0:3], v[180:183]
    v_mfma_f32_16x16x32_bf16 v[184:187], a[56:59], a[0:3], v[184:187]
    ds_read_b128 a[120:123], v2 offset:13632
    v_mfma_f32_16x16x32_bf16 v[188:191], a[60:63], a[0:3], v[188:191]
    ds_read_b128 a[124:127], v2 offset:13120
    v_mfma_f32_16x16x32_bf16 v[164:167], a[32:35], a[4:7], v[164:167]
    v_mfma_f32_16x16x32_bf16 v[168:171], a[36:39], a[4:7], v[168:171]
    ds_read2_b32 a[64:65], v220 offset0:48 offset1:49
    v_mfma_f32_16x16x32_bf16 v[172:175], a[40:43], a[4:7], v[172:175]
    ds_read2_b32 a[66:67], v220 offset0:50 offset1:51
    v_mfma_f32_16x16x32_bf16 v[176:179], a[44:47], a[4:7], v[176:179]
    v_mfma_f32_16x16x32_bf16 v[180:183], a[48:51], a[4:7], v[180:183]
    ds_read2_b32 a[68:69], v220 offset0:176 offset1:177
    v_mfma_f32_16x16x32_bf16 v[184:187], a[52:55], a[4:7], v[184:187]
    ds_read2_b32 a[70:71], v220 offset0:178 offset1:179
    v_mfma_f32_16x16x32_bf16 v[188:191], a[56:59], a[4:7], v[188:191]
    v_mfma_f32_16x16x32_bf16 v[168:171], a[32:35], a[8:11], v[168:171]
    ds_read2_b32 a[72:73], v221 offset0:48 offset1:49
    v_mfma_f32_16x16x32_bf16 v[172:175], a[36:39], a[8:11], v[172:175]
    ds_read2_b32 a[74:75], v221 offset0:50 offset1:51
    v_mfma_f32_16x16x32_bf16 v[176:179], a[40:43], a[8:11], v[176:179]
    v_mfma_f32_16x16x32_bf16 v[180:183], a[44:47], a[8:11], v[180:183]
    ds_read2_b32 a[76:77], v221 offset0:176 offset1:177
    v_mfma_f32_16x16x32_bf16 v[184:187], a[48:51], a[8:11], v[184:187]
    ds_read2_b32 a[78:79], v221 offset0:178 offset1:179
    v_mfma_f32_16x16x32_bf16 v[188:191], a[52:55], a[8:11], v[188:191]
    v_mfma_f32_16x16x32_bf16 v[172:175], a[32:35], a[12:15], v[172:175]
    ds_read2_b32 a[80:81], v222 offset0:48 offset1:49
    v_mfma_f32_16x16x32_bf16 v[176:179], a[36:39], a[12:15], v[176:179]
    ds_read2_b32 a[82:83], v222 offset0:50 offset1:51
    v_mfma_f32_16x16x32_bf16 v[180:183], a[40:43], a[12:15], v[180:183]
    v_mfma_f32_16x16x32_bf16 v[184:187], a[44:47], a[12:15], v[184:187]
    ds_read2_b32 a[84:85], v222 offset0:176 offset1:177
    v_mfma_f32_16x16x32_bf16 v[188:191], a[48:51], a[12:15], v[188:191]
    ds_read2_b32 a[86:87], v222 offset0:178 offset1:179
    v_mfma_f32_16x16x32_bf16 v[176:179], a[32:35], a[16:19], v[176:179]
    v_mfma_f32_16x16x32_bf16 v[180:183], a[36:39], a[16:19], v[180:183]
    ds_read2_b32 a[88:89], v223 offset0:48 offset1:49
    v_mfma_f32_16x16x32_bf16 v[184:187], a[40:43], a[16:19], v[184:187]
    ds_read2_b32 a[90:91], v223 offset0:50 offset1:51
    v_mfma_f32_16x16x32_bf16 v[188:191], a[44:47], a[16:19], v[188:191]
    v_mfma_f32_16x16x32_bf16 v[180:183], a[32:35], a[20:23], v[180:183]
    ds_read2_b32 a[92:93], v223 offset0:176 offset1:177
    v_mfma_f32_16x16x32_bf16 v[184:187], a[36:39], a[20:23], v[184:187]
    ds_read2_b32 a[94:95], v223 offset0:178 offset1:179
    v_mfma_f32_16x16x32_bf16 v[188:191], a[40:43], a[20:23], v[188:191]
    v_mfma_f32_16x16x32_bf16 v[184:187], a[32:35], a[24:27], v[184:187]
    v_mfma_f32_16x16x32_bf16 v[188:191], a[36:39], a[24:27], v[188:191]
    v_mfma_f32_16x16x32_bf16 v[188:191], a[32:35], a[28:31], v[188:191]
    s_waitcnt lgkmcnt(0)
    v_mfma_f32_16x16x32_bf16 v[160:163], a[96:99], a[64:67], v[160:163]
    v_mfma_f32_16x16x32_bf16 v[164:167], a[100:103], a[64:67], v[164:167]
    ds_read_b128 a[32:35], v2 offset:16768
    ds_read_b128 a[36:39], v2 offset:16256
    v_mfma_f32_16x16x32_bf16 v[168:171], a[104:107], a[64:67], v[168:171]
    v_mfma_f32_16x16x32_bf16 v[172:175], a[108:111], a[64:67], v[172:175]
    ds_read_b128 a[40:43], v2 offset:15744
    ds_read_b128 a[44:47], v2 offset:15232
    v_mfma_f32_16x16x32_bf16 v[176:179], a[112:115], a[64:67], v[176:179]
    ds_read_b128 a[48:51], v2 offset:14720
    ds_read_b128 a[52:55], v2 offset:14208
    v_mfma_f32_16x16x32_bf16 v[180:183], a[116:119], a[64:67], v[180:183]
    s_lshl_b32 s46, s32, 7
    s_add_u32 s46, s46, 103424
    v_mfma_f32_16x16x32_bf16 v[184:187], a[120:123], a[64:67], v[184:187]
    ds_read_b128 a[56:59], v2 offset:13696
    v_add_u32 v84, s46, v3
    v_mfma_f32_16x16x32_bf16 v[188:191], a[124:127], a[64:67], v[188:191]
    ds_read_b128 a[60:63], v2 offset:13184
    v_add_u32 v85, 1024, v84
    v_mfma_f32_16x16x32_bf16 v[164:167], a[96:99], a[68:71], v[164:167]
    v_add_u32 v86, 2048, v84
    v_add_u32 v87, 3072, v84
    v_mfma_f32_16x16x32_bf16 v[168:171], a[100:103], a[68:71], v[168:171]
    ds_read2_b32 a[0:1], v220 offset0:64 offset1:65
    v_add_u32 v88, s46, v14
    v_mfma_f32_16x16x32_bf16 v[172:175], a[104:107], a[68:71], v[172:175]
    ds_read2_b32 a[2:3], v220 offset0:66 offset1:67
    s_waitcnt vmcnt(6)
    v_lshlrev_b32 v59, 16, v59
    v_mfma_f32_16x16x32_bf16 v[176:179], a[108:111], a[68:71], v[176:179]
    ds_write_b32 v6, v59
    s_waitcnt vmcnt(5)
    v_alignbit_b32 v76, v29, v28, 16
    v_mfma_f32_16x16x32_bf16 v[180:183], a[112:115], a[68:71], v[180:183]
    ds_read2_b32 a[4:5], v220 offset0:192 offset1:193
    v_alignbit_b32 v77, v30, v29, 16
    v_mfma_f32_16x16x32_bf16 v[184:187], a[116:119], a[68:71], v[184:187]
    ds_read2_b32 a[6:7], v220 offset0:194 offset1:195
    v_alignbit_b32 v78, v31, v30, 16
    v_mfma_f32_16x16x32_bf16 v[188:191], a[120:123], a[68:71], v[188:191]
    s_waitcnt vmcnt(4)
    v_alignbit_b32 v79, v58, v31, 16
    v_mfma_f32_16x16x32_bf16 v[168:171], a[96:99], a[72:75], v[168:171]
    ds_read2_b32 a[8:9], v221 offset0:64 offset1:65
    v_mfma_f32_16x16x32_bf16 v[172:175], a[100:103], a[72:75], v[172:175]
    ds_read2_b32 a[10:11], v221 offset0:66 offset1:67
    v_mfma_f32_16x16x32_bf16 v[176:179], a[104:107], a[72:75], v[176:179]
    ds_write_b128 v9, v[28:31] offset:32
    v_mfma_f32_16x16x32_bf16 v[180:183], a[108:111], a[72:75], v[180:183]
    ds_read2_b32 a[12:13], v221 offset0:192 offset1:193
    v_mfma_f32_16x16x32_bf16 v[184:187], a[112:115], a[72:75], v[184:187]
    ds_read2_b32 a[14:15], v221 offset0:194 offset1:195
    v_mfma_f32_16x16x32_bf16 v[188:191], a[116:119], a[72:75], v[188:191]
    ds_write_b128 v9, v[76:79] offset:4192
    v_mfma_f32_16x16x32_bf16 v[172:175], a[96:99], a[76:79], v[172:175]
    ds_read2_b32 a[16:17], v222 offset0:64 offset1:65
    s_waitcnt vmcnt(3)
    v_cndmask_b32 v36, v36, 0, s[10:11]
    v_mfma_f32_16x16x32_bf16 v[176:179], a[100:103], a[76:79], v[176:179]
    ds_read2_b32 a[18:19], v222 offset0:66 offset1:67
    v_cndmask_b32 v37, v37, 0, s[10:11]
    v_mfma_f32_16x16x32_bf16 v[180:183], a[104:107], a[76:79], v[180:183]
    s_waitcnt vmcnt(2)
    v_mov_b32_dpp v36, v40 wave_shr:1 row_mask:0xf bank_mask:0xf
    v_mov_b32_dpp v37, v41 wave_shr:1 row_mask:0xf bank_mask:0xf
    v_mfma_f32_16x16x32_bf16 v[184:187], a[108:111], a[76:79], v[184:187]
    ds_read2_b32 a[20:21], v222 offset0:192 offset1:193
    v_and_b32 v64, 0xffff0000, v36
    v_mfma_f32_16x16x32_bf16 v[188:191], a[112:115], a[76:79], v[188:191]
    ds_read2_b32 a[22:23], v222 offset0:194 offset1:195
    v_lshlrev_b32 v65, 16, v37
    v_mfma_f32_16x16x32_bf16 v[176:179], a[96:99], a[80:83], v[176:179]
    v_and_b32 v66, 0xffff0000, v37
    v_lshlrev_b32 v67, 16, v38
    v_mfma_f32_16x16x32_bf16 v[180:183], a[100:103], a[80:83], v[180:183]
    ds_read2_b32 a[24:25], v223 offset0:64 offset1:65
    v_and_b32 v68, 0xffff0000, v38
    v_mfma_f32_16x16x32_bf16 v[184:187], a[104:107], a[80:83], v[184:187]
    ds_read2_b32 a[26:27], v223 offset0:66 offset1:67
    v_lshlrev_b32 v69, 16, v39
    v_mfma_f32_16x16x32_bf16 v[188:191], a[108:111], a[80:83], v[188:191]
    v_and_b32 v70, 0xffff0000, v39
    v_lshlrev_b32 v71, 16, v40
    v_mfma_f32_16x16x32_bf16 v[180:183], a[96:99], a[84:87], v[180:183]
    ds_read2_b32 a[28:29], v223 offset0:192 offset1:193
    v_and_b32 v72, 0xffff0000, v40
    v_mfma_f32_16x16x32_bf16 v[184:187], a[100:103], a[84:87], v[184:187]
    ds_read2_b32 a[30:31], v223 offset0:194 offset1:195
    v_lshlrev_b32 v73, 16, v41
    v_mfma_f32_16x16x32_bf16 v[188:191], a[104:107], a[84:87], v[188:191]
    v_and_b32 v74, 0xffff0000, v41
    v_mul_f32 v20, s57, v67
    v_mfma_f32_16x16x32_bf16 v[184:187], a[96:99], a[88:91], v[184:187]
    v_mul_f32 v21, s57, v68
    v_mul_f32 v22, s57, v69
    v_mfma_f32_16x16x32_bf16 v[188:191], a[100:103], a[88:91], v[188:191]
    v_mul_f32 v23, s57, v70
    v_mul_f32 v24, s57, v71
    v_mfma_f32_16x16x32_bf16 v[188:191], a[96:99], a[92:95], v[188:191]
    v_mul_f32 v25, s57, v72
    v_mul_f32 v26, s57, v73
    s_waitcnt lgkmcnt(0)
    v_mfma_f32_16x16x32_bf16 v[160:163], a[32:35], a[0:3], v[160:163]
    s_mov_b32 s100, 884736
    buffer_load_dword a205, v12, s[20:23], s100 offen
    v_mfma_f32_16x16x32_bf16 v[164:167], a[36:39], a[0:3], v[164:167]
    ds_read_b128 a[96:99], v2 offset:16832
    ds_read_b128 a[100:103], v2 offset:16320
    v_mfma_f32_16x16x32_bf16 v[168:171], a[40:43], a[0:3], v[168:171]
    v_mul_f32 v27, s57, v74
    v_fmac_f32 v20, s58, v66
    v_mfma_f32_16x16x32_bf16 v[172:175], a[44:47], a[0:3], v[172:175]
    ds_read_b128 a[104:107], v2 offset:15808
    ds_read_b128 a[108:111], v2 offset:15296
    v_mfma_f32_16x16x32_bf16 v[176:179], a[48:51], a[0:3], v[176:179]
    ds_read_b128 a[112:115], v2 offset:14784
    ds_read_b128 a[116:119], v2 offset:14272
    v_mfma_f32_16x16x32_bf16 v[180:183], a[52:55], a[0:3], v[180:183]
    v_fmac_f32 v21, s58, v67
    v_fmac_f32 v22, s58, v68
    v_mfma_f32_16x16x32_bf16 v[184:187], a[56:59], a[0:3], v[184:187]
    ds_read_b128 a[120:123], v2 offset:13760
    v_fmac_f32 v23, s58, v69
    v_mfma_f32_16x16x32_bf16 v[188:191], a[60:63], a[0:3], v[188:191]
    ds_read_b128 a[124:127], v2 offset:13248
    v_fmac_f32 v24, s58, v70
    v_mfma_f32_16x16x32_bf16 v[164:167], a[32:35], a[4:7], v[164:167]
    v_fmac_f32 v25, s58, v71
    v_fmac_f32 v26, s58, v72
    v_mfma_f32_16x16x32_bf16 v[168:171], a[36:39], a[4:7], v[168:171]
    ds_read2_b32 a[64:65], v220 offset0:80 offset1:81
    v_fmac_f32 v27, s58, v73
    v_mfma_f32_16x16x32_bf16 v[172:175], a[40:43], a[4:7], v[172:175]
    ds_read2_b32 a[66:67], v220 offset0:82 offset1:83
    v_fmac_f32 v20, s59, v65
    v_mfma_f32_16x16x32_bf16 v[176:179], a[44:47], a[4:7], v[176:179]
    v_fmac_f32 v21, s59, v66
    v_fmac_f32 v22, s59, v67
    v_mfma_f32_16x16x32_bf16 v[180:183], a[48:51], a[4:7], v[180:183]
    ds_read2_b32 a[68:69], v220 offset0:208 offset1:209
    v_fmac_f32 v23, s59, v68
    v_mfma_f32_16x16x32_bf16 v[184:187], a[52:55], a[4:7], v[184:187]
    ds_read2_b32 a[70:71], v220 offset0:210 offset1:211
    v_fmac_f32 v24, s59, v69
    v_mfma_f32_16x16x32_bf16 v[188:191], a[56:59], a[4:7], v[188:191]
    v_fmac_f32 v25, s59, v70
    v_fmac_f32 v26, s59, v71
    v_mfma_f32_16x16x32_bf16 v[168:171], a[32:35], a[8:11], v[168:171]
    ds_read2_b32 a[72:73], v221 offset0:80 offset1:81
    v_fmac_f32 v27, s59, v72
    v_mfma_f32_16x16x32_bf16 v[172:175], a[36:39], a[8:11], v[172:175]
    ds_read2_b32 a[74:75], v221 offset0:82 offset1:83
    v_fmac_f32 v20, s60, v64
    v_mfma_f32_16x16x32_bf16 v[176:179], a[40:43], a[8:11], v[176:179]
    v_fmac_f32 v21, s60, v65
    v_fmac_f32 v22, s60, v66
    v_mfma_f32_16x16x32_bf16 v[180:183], a[44:47], a[8:11], v[180:183]
    ds_read2_b32 a[76:77], v221 offset0:208 offset1:209
    v_fmac_f32 v23, s60, v67
    v_mfma_f32_16x16x32_bf16 v[184:187], a[48:51], a[8:11], v[184:187]
    ds_read2_b32 a[78:79], v221 offset0:210 offset1:211
    v_fmac_f32 v24, s60, v68
    v_mfma_f32_16x16x32_bf16 v[188:191], a[52:55], a[8:11], v[188:191]
    v_fmac_f32 v25, s60, v69
    v_fmac_f32 v26, s60, v70
    v_mfma_f32_16x16x32_bf16 v[172:175], a[32:35], a[12:15], v[172:175]
    ds_read2_b32 a[80:81], v222 offset0:80 offset1:81
    v_fmac_f32 v27, s60, v71
    v_mfma_f32_16x16x32_bf16 v[176:179], a[36:39], a[12:15], v[176:179]
    ds_read2_b32 a[82:83], v222 offset0:82 offset1:83
    s_waitcnt vmcnt(2)
    v_lshlrev_b32 v36, 16, v42
    v_mfma_f32_16x16x32_bf16 v[180:183], a[40:43], a[12:15], v[180:183]
    v_and_b32 v42, 0xffff0000, v42
    v_lshlrev_b32 v37, 16, v43
    v_mfma_f32_16x16x32_bf16 v[184:187], a[44:47], a[12:15], v[184:187]
    ds_read2_b32 a[84:85], v222 offset0:208 offset1:209
    v_and_b32 v43, 0xffff0000, v43
    v_mfma_f32_16x16x32_bf16 v[188:191], a[48:51], a[12:15], v[188:191]
    ds_read2_b32 a[86:87], v222 offset0:210 offset1:211
    v_lshlrev_b32 v38, 16, v44
    v_mfma_f32_16x16x32_bf16 v[176:179], a[32:35], a[16:19], v[176:179]
    v_and_b32 v44, 0xffff0000, v44
    v_lshlrev_b32 v39, 16, v45
    v_mfma_f32_16x16x32_bf16 v[180:183], a[36:39], a[16:19], v[180:183]
    ds_read2_b32 a[88:89], v223 offset0:80 offset1:81
    v_and_b32 v45, 0xffff0000, v45
    v_mfma_f32_16x16x32_bf16 v[184:187], a[40:43], a[16:19], v[184:187]
    ds_read2_b32 a[90:91], v223 offset0:82 offset1:83
    v_mul_f32 v20, v20, v36
    v_mfma_f32_16x16x32_bf16 v[188:191], a[44:47], a[16:19], v[188:191]
    v_mul_f32 v21, v21, v42
    v_mul_f32 v22, v22, v37
    v_mfma_f32_16x16x32_bf16 v[180:183], a[32:35], a[20:23], v[180:183]
    ds_read2_b32 a[92:93], v223 offset0:208 offset1:209
    v_mul_f32 v23, v23, v43
    v_mfma_f32_16x16x32_bf16 v[184:187], a[36:39], a[20:23], v[184:187]
    ds_read2_b32 a[94:95], v223 offset0:210 offset1:211
    v_mul_f32 v24, v24, v38
    v_mfma_f32_16x16x32_bf16 v[188:191], a[40:43], a[20:23], v[188:191]
    v_mul_f32 v25, v25, v44
    v_mul_f32 v26, v26, v39
    v_mfma_f32_16x16x32_bf16 v[184:187], a[32:35], a[24:27], v[184:187]
    v_mul_f32 v27, v27, v45
    v_cvt_pk_bf16_f32 v42, v27, v26
    v_mfma_f32_16x16x32_bf16 v[188:191], a[36:39], a[24:27], v[188:191]
    v_cvt_pk_bf16_f32 v43, v25, v24
    v_cvt_pk_bf16_f32 v44, v23, v22
    v_mfma_f32_16x16x32_bf16 v[188:191], a[32:35], a[28:31], v[188:191]
    v_cvt_pk_bf16_f32 v45, v21, v20
    s_waitcnt lgkmcnt(0)
    v_mfma_f32_16x16x32_bf16 v[160:163], a[96:99], a[64:67], v[160:163]
    ds_write_b128 v8, v[42:45] offset:0
    v_mfma_f32_16x16x32_bf16 v[164:167], a[100:103], a[64:67], v[164:167]
    ds_read_b128 a[32:35], v2 offset:16896
    ds_read_b128 a[36:39], v2 offset:16384
    v_mfma_f32_16x16x32_bf16 v[168:171], a[104:107], a[64:67], v[168:171]
    v_mfma_f32_16x16x32_bf16 v[172:175], a[108:111], a[64:67], v[172:175]
    ds_read_b128 a[40:43], v2 offset:15872
    ds_read_b128 a[44:47], v2 offset:15360
    v_mfma_f32_16x16x32_bf16 v[176:179], a[112:115], a[64:67], v[176:179]
    ds_read_b128 a[48:51], v2 offset:14848
    ds_read_b128 a[52:55], v2 offset:14336
    v_mfma_f32_16x16x32_bf16 v[180:183], a[116:119], a[64:67], v[180:183]
    v_mfma_f32_16x16x32_bf16 v[184:187], a[120:123], a[64:67], v[184:187]
    ds_read_b128 a[56:59], v2 offset:13824
    v_mfma_f32_16x16x32_bf16 v[188:191], a[124:127], a[64:67], v[188:191]
    ds_read_b128 a[60:63], v2 offset:13312
    v_mfma_f32_16x16x32_bf16 v[164:167], a[96:99], a[68:71], v[164:167]
    v_mfma_f32_16x16x32_bf16 v[168:171], a[100:103], a[68:71], v[168:171]
    ds_read2_b32 a[0:1], v220 offset0:96 offset1:97
    v_mfma_f32_16x16x32_bf16 v[172:175], a[104:107], a[68:71], v[172:175]
    ds_read2_b32 a[2:3], v220 offset0:98 offset1:99
    v_mfma_f32_16x16x32_bf16 v[176:179], a[108:111], a[68:71], v[176:179]
    v_mfma_f32_16x16x32_bf16 v[180:183], a[112:115], a[68:71], v[180:183]
    ds_read2_b32 a[4:5], v220 offset0:224 offset1:225
    v_mfma_f32_16x16x32_bf16 v[184:187], a[116:119], a[68:71], v[184:187]
    ds_read2_b32 a[6:7], v220 offset0:226 offset1:227
    v_mfma_f32_16x16x32_bf16 v[188:191], a[120:123], a[68:71], v[188:191]
    v_mfma_f32_16x16x32_bf16 v[168:171], a[96:99], a[72:75], v[168:171]
    ds_read2_b32 a[8:9], v221 offset0:96 offset1:97
    v_mfma_f32_16x16x32_bf16 v[172:175], a[100:103], a[72:75], v[172:175]
    ds_read2_b32 a[10:11], v221 offset0:98 offset1:99
    v_mfma_f32_16x16x32_bf16 v[176:179], a[104:107], a[72:75], v[176:179]
    v_mfma_f32_16x16x32_bf16 v[180:183], a[108:111], a[72:75], v[180:183]
    ds_read2_b32 a[12:13], v221 offset0:224 offset1:225
    v_mfma_f32_16x16x32_bf16 v[184:187], a[112:115], a[72:75], v[184:187]
    ds_read2_b32 a[14:15], v221 offset0:226 offset1:227
    v_mfma_f32_16x16x32_bf16 v[188:191], a[116:119], a[72:75], v[188:191]
    v_mfma_f32_16x16x32_bf16 v[172:175], a[96:99], a[76:79], v[172:175]
    ds_read2_b32 a[16:17], v222 offset0:96 offset1:97
    v_mfma_f32_16x16x32_bf16 v[176:179], a[100:103], a[76:79], v[176:179]
    ds_read2_b32 a[18:19], v222 offset0:98 offset1:99
    v_mfma_f32_16x16x32_bf16 v[180:183], a[104:107], a[76:79], v[180:183]
    v_mfma_f32_16x16x32_bf16 v[184:187], a[108:111], a[76:79], v[184:187]
    ds_read2_b32 a[20:21], v222 offset0:224 offset1:225
    v_mfma_f32_16x16x32_bf16 v[188:191], a[112:115], a[76:79], v[188:191]
    ds_read2_b32 a[22:23], v222 offset0:226 offset1:227
    v_mfma_f32_16x16x32_bf16 v[176:179], a[96:99], a[80:83], v[176:179]
    v_mfma_f32_16x16x32_bf16 v[180:183], a[100:103], a[80:83], v[180:183]
    ds_read2_b32 a[24:25], v223 offset0:96 offset1:97
    v_mfma_f32_16x16x32_bf16 v[184:187], a[104:107], a[80:83], v[184:187]
    ds_read2_b32 a[26:27], v223 offset0:98 offset1:99
    v_mfma_f32_16x16x32_bf16 v[188:191], a[108:111], a[80:83], v[188:191]
    v_mfma_f32_16x16x32_bf16 v[180:183], a[96:99], a[84:87], v[180:183]
    ds_read2_b32 a[28:29], v223 offset0:224 offset1:225
    v_mfma_f32_16x16x32_bf16 v[184:187], a[100:103], a[84:87], v[184:187]
    ds_read2_b32 a[30:31], v223 offset0:226 offset1:227
    v_mfma_f32_16x16x32_bf16 v[188:191], a[104:107], a[84:87], v[188:191]
    v_mfma_f32_16x16x32_bf16 v[184:187], a[96:99], a[88:91], v[184:187]
    v_mfma_f32_16x16x32_bf16 v[188:191], a[100:103], a[88:91], v[188:191]
    v_mfma_f32_16x16x32_bf16 v[188:191], a[96:99], a[92:95], v[188:191]
    s_waitcnt lgkmcnt(0)
    v_mfma_f32_16x16x32_bf16 v[160:163], a[32:35], a[0:3], v[160:163]
    v_mfma_f32_16x16x32_bf16 v[164:167], a[36:39], a[0:3], v[164:167]
    ds_read_b128 a[96:99], v2 offset:16960
    ds_read_b128 a[100:103], v2 offset:16448
    v_mfma_f32_16x16x32_bf16 v[168:171], a[40:43], a[0:3], v[168:171]
    v_mfma_f32_16x16x32_bf16 v[172:175], a[44:47], a[0:3], v[172:175]
    ds_read_b128 a[104:107], v2 offset:15936
    ds_read_b128 a[108:111], v2 offset:15424
    v_mfma_f32_16x16x32_bf16 v[176:179], a[48:51], a[0:3], v[176:179]
    ds_read_b128 a[112:115], v2 offset:14912
    ds_read_b128 a[116:119], v2 offset:14400
    v_mfma_f32_16x16x32_bf16 v[180:183], a[52:55], a[0:3], v[180:183]
    v_mfma_f32_16x16x32_bf16 v[184:187], a[56:59], a[0:3], v[184:187]
    ds_read_b128 a[120:123], v2 offset:13888
    v_mfma_f32_16x16x32_bf16 v[188:191], a[60:63], a[0:3], v[188:191]
    ds_read_b128 a[124:127], v2 offset:13376
    v_mfma_f32_16x16x32_bf16 v[164:167], a[32:35], a[4:7], v[164:167]
    v_mfma_f32_16x16x32_bf16 v[168:171], a[36:39], a[4:7], v[168:171]
    ds_read2_b32 a[64:65], v220 offset0:112 offset1:113
    v_mfma_f32_16x16x32_bf16 v[172:175], a[40:43], a[4:7], v[172:175]
    ds_read2_b32 a[66:67], v220 offset0:114 offset1:115
    v_mfma_f32_16x16x32_bf16 v[176:179], a[44:47], a[4:7], v[176:179]
    v_mfma_f32_16x16x32_bf16 v[180:183], a[48:51], a[4:7], v[180:183]
    ds_read2_b32 a[68:69], v220 offset0:240 offset1:241
    v_mfma_f32_16x16x32_bf16 v[184:187], a[52:55], a[4:7], v[184:187]
    ds_read2_b32 a[70:71], v220 offset0:242 offset1:243
    v_mfma_f32_16x16x32_bf16 v[188:191], a[56:59], a[4:7], v[188:191]
    v_mfma_f32_16x16x32_bf16 v[168:171], a[32:35], a[8:11], v[168:171]
    ds_read2_b32 a[72:73], v221 offset0:112 offset1:113
    v_mfma_f32_16x16x32_bf16 v[172:175], a[36:39], a[8:11], v[172:175]
    ds_read2_b32 a[74:75], v221 offset0:114 offset1:115
    v_mfma_f32_16x16x32_bf16 v[176:179], a[40:43], a[8:11], v[176:179]
    v_mfma_f32_16x16x32_bf16 v[180:183], a[44:47], a[8:11], v[180:183]
    ds_read2_b32 a[76:77], v221 offset0:240 offset1:241
    v_mfma_f32_16x16x32_bf16 v[184:187], a[48:51], a[8:11], v[184:187]
    ds_read2_b32 a[78:79], v221 offset0:242 offset1:243
    v_mfma_f32_16x16x32_bf16 v[188:191], a[52:55], a[8:11], v[188:191]
    v_mfma_f32_16x16x32_bf16 v[172:175], a[32:35], a[12:15], v[172:175]
    ds_read2_b32 a[80:81], v222 offset0:112 offset1:113
    v_mfma_f32_16x16x32_bf16 v[176:179], a[36:39], a[12:15], v[176:179]
    ds_read2_b32 a[82:83], v222 offset0:114 offset1:115
    v_mfma_f32_16x16x32_bf16 v[180:183], a[40:43], a[12:15], v[180:183]
    v_mfma_f32_16x16x32_bf16 v[184:187], a[44:47], a[12:15], v[184:187]
    ds_read2_b32 a[84:85], v222 offset0:240 offset1:241
    v_mfma_f32_16x16x32_bf16 v[188:191], a[48:51], a[12:15], v[188:191]
    ds_read2_b32 a[86:87], v222 offset0:242 offset1:243
    v_mfma_f32_16x16x32_bf16 v[176:179], a[32:35], a[16:19], v[176:179]
    v_mfma_f32_16x16x32_bf16 v[180:183], a[36:39], a[16:19], v[180:183]
    ds_read2_b32 a[88:89], v223 offset0:112 offset1:113
    v_mfma_f32_16x16x32_bf16 v[184:187], a[40:43], a[16:19], v[184:187]
    ds_read2_b32 a[90:91], v223 offset0:114 offset1:115
    v_mfma_f32_16x16x32_bf16 v[188:191], a[44:47], a[16:19], v[188:191]
    v_mfma_f32_16x16x32_bf16 v[180:183], a[32:35], a[20:23], v[180:183]
    ds_read2_b32 a[92:93], v223 offset0:240 offset1:241
    v_mfma_f32_16x16x32_bf16 v[184:187], a[36:39], a[20:23], v[184:187]
    ds_read2_b32 a[94:95], v223 offset0:242 offset1:243
    v_mfma_f32_16x16x32_bf16 v[188:191], a[40:43], a[20:23], v[188:191]
    v_mfma_f32_16x16x32_bf16 v[184:187], a[32:35], a[24:27], v[184:187]
    v_mfma_f32_16x16x32_bf16 v[188:191], a[36:39], a[24:27], v[188:191]
    v_mfma_f32_16x16x32_bf16 v[188:191], a[32:35], a[28:31], v[188:191]
    s_waitcnt lgkmcnt(0)
    s_barrier
    v_mfma_f32_16x16x32_bf16 v[160:163], a[96:99], a[64:67], v[160:163]
    v_mfma_f32_16x16x32_bf16 v[164:167], a[100:103], a[64:67], v[164:167]
    ds_read_b128 a[32:35], v88 offset:3584
    ds_read_b128 a[36:39], v88 offset:3072
    v_mfma_f32_16x16x32_bf16 v[168:171], a[104:107], a[64:67], v[168:171]
    v_mfma_f32_16x16x32_bf16 v[172:175], a[108:111], a[64:67], v[172:175]
    ds_read_b128 a[40:43], v88 offset:2560
    ds_read_b128 a[44:47], v88 offset:2048
    v_mfma_f32_16x16x32_bf16 v[176:179], a[112:115], a[64:67], v[176:179]
    ds_read_b128 a[48:51], v88 offset:1536
    ds_read_b128 a[52:55], v88 offset:1024
    v_mfma_f32_16x16x32_bf16 v[180:183], a[116:119], a[64:67], v[180:183]
    v_mfma_f32_16x16x32_bf16 v[184:187], a[120:123], a[64:67], v[184:187]
    ds_read_b128 a[56:59], v88 offset:512
    v_mfma_f32_16x16x32_bf16 v[188:191], a[124:127], a[64:67], v[188:191]
    ds_read_b128 a[60:63], v88 offset:0
    v_mfma_f32_16x16x32_bf16 v[164:167], a[96:99], a[68:71], v[164:167]
    v_mfma_f32_16x16x32_bf16 v[168:171], a[100:103], a[68:71], v[168:171]
    ds_read2_b32 a[0:1], v84 offset0:0 offset1:1
    v_mfma_f32_16x16x32_bf16 v[172:175], a[104:107], a[68:71], v[172:175]
    ds_read2_b32 a[2:3], v84 offset0:2 offset1:3
    v_mfma_f32_16x16x32_bf16 v[176:179], a[108:111], a[68:71], v[176:179]
    v_mfma_f32_16x16x32_bf16 v[180:183], a[112:115], a[68:71], v[180:183]
    ds_read2_b32 a[4:5], v84 offset0:128 offset1:129
    v_mfma_f32_16x16x32_bf16 v[184:187], a[116:119], a[68:71], v[184:187]
    ds_read2_b32 a[6:7], v84 offset0:130 offset1:131
    v_mfma_f32_16x16x32_bf16 v[188:191], a[120:123], a[68:71], v[188:191]
    v_mfma_f32_16x16x32_bf16 v[168:171], a[96:99], a[72:75], v[168:171]
    ds_read2_b32 a[8:9], v85 offset0:0 offset1:1
    v_mfma_f32_16x16x32_bf16 v[172:175], a[100:103], a[72:75], v[172:175]
    ds_read2_b32 a[10:11], v85 offset0:2 offset1:3
    v_mfma_f32_16x16x32_bf16 v[176:179], a[104:107], a[72:75], v[176:179]
    v_mfma_f32_16x16x32_bf16 v[180:183], a[108:111], a[72:75], v[180:183]
    ds_read2_b32 a[12:13], v85 offset0:128 offset1:129
    v_mfma_f32_16x16x32_bf16 v[184:187], a[112:115], a[72:75], v[184:187]
    ds_read2_b32 a[14:15], v85 offset0:130 offset1:131
    v_mfma_f32_16x16x32_bf16 v[188:191], a[116:119], a[72:75], v[188:191]
    v_mfma_f32_16x16x32_bf16 v[172:175], a[96:99], a[76:79], v[172:175]
    ds_read2_b32 a[16:17], v86 offset0:0 offset1:1
    v_mfma_f32_16x16x32_bf16 v[176:179], a[100:103], a[76:79], v[176:179]
    ds_read2_b32 a[18:19], v86 offset0:2 offset1:3
    v_mfma_f32_16x16x32_bf16 v[180:183], a[104:107], a[76:79], v[180:183]
    v_mfma_f32_16x16x32_bf16 v[184:187], a[108:111], a[76:79], v[184:187]
    ds_read2_b32 a[20:21], v86 offset0:128 offset1:129
    v_mfma_f32_16x16x32_bf16 v[188:191], a[112:115], a[76:79], v[188:191]
    ds_read2_b32 a[22:23], v86 offset0:130 offset1:131
    v_mfma_f32_16x16x32_bf16 v[176:179], a[96:99], a[80:83], v[176:179]
    v_mfma_f32_16x16x32_bf16 v[180:183], a[100:103], a[80:83], v[180:183]
    ds_read2_b32 a[24:25], v87 offset0:0 offset1:1
    v_mfma_f32_16x16x32_bf16 v[184:187], a[104:107], a[80:83], v[184:187]
    ds_read2_b32 a[26:27], v87 offset0:2 offset1:3
    v_mfma_f32_16x16x32_bf16 v[188:191], a[108:111], a[80:83], v[188:191]
    v_mfma_f32_16x16x32_bf16 v[180:183], a[96:99], a[84:87], v[180:183]
    ds_read2_b32 a[28:29], v87 offset0:128 offset1:129
    v_mfma_f32_16x16x32_bf16 v[184:187], a[100:103], a[84:87], v[184:187]
    ds_read2_b32 a[30:31], v87 offset0:130 offset1:131
    v_mfma_f32_16x16x32_bf16 v[188:191], a[104:107], a[84:87], v[188:191]
    v_mfma_f32_16x16x32_bf16 v[184:187], a[96:99], a[88:91], v[184:187]
    v_mfma_f32_16x16x32_bf16 v[188:191], a[100:103], a[88:91], v[188:191]
    v_mfma_f32_16x16x32_bf16 v[188:191], a[96:99], a[92:95], v[188:191]
    s_waitcnt lgkmcnt(0)
    v_mfma_f32_16x16x32_bf16 v[192:195], a[32:35], v[92:95], 0
    v_cvt_pk_bf16_f32 v98, s64, v160
    v_cvt_pk_bf16_f32 v99, s64, v161
    v_mfma_f32_16x16x32_bf16 v[196:199], a[36:39], v[92:95], 0
    ds_read_b128 a[96:99], v88 offset:3648
    v_cvt_pk_bf16_f32 v102, s64, v162
    v_mfma_f32_16x16x32_bf16 v[200:203], a[40:43], v[92:95], 0
    v_cvt_pk_bf16_f32 v103, s64, v163
    v_cvt_pk_bf16_f32 v106, s64, v164
    v_mfma_f32_16x16x32_bf16 v[204:207], a[44:47], v[92:95], 0
    ds_read_b128 a[100:103], v88 offset:3136
    v_cvt_pk_bf16_f32 v107, s64, v165
    v_mfma_f32_16x16x32_bf16 v[208:211], a[48:51], v[92:95], 0
    ds_read_b128 a[104:107], v88 offset:2624
    v_cvt_pk_bf16_f32 v110, s64, v166
    v_mfma_f32_16x16x32_bf16 v[212:215], a[52:55], v[92:95], 0
    buffer_store_dwordx4 v[96:99], v15, s[16:19], s12 offen offset:0 sc1
    v_mfma_f32_16x16x32_bf16 v[216:219], a[56:59], v[92:95], 0
    ds_read_b128 a[108:111], v88 offset:2112
    v_cvt_pk_bf16_f32 v111, s64, v167
    v_mfma_f32_16x16x32_bf16 v[220:223], a[60:63], v[92:95], 0
    ds_read_b128 a[112:115], v88 offset:1600
    v_cvt_pk_bf16_f32 v114, s64, v168
    v_mfma_f32_16x16x32_bf16 v[192:195], a[32:35], a[0:3], v[192:195]
    buffer_store_dwordx4 v[100:103], v15, s[16:19], s12 offen offset:256 sc1
    v_mfma_f32_16x16x32_bf16 v[196:199], a[36:39], a[0:3], v[196:199]
    ds_read_b128 a[116:119], v88 offset:1088
    v_cvt_pk_bf16_f32 v115, s64, v169
    v_mfma_f32_16x16x32_bf16 v[200:203], a[40:43], a[0:3], v[200:203]
    ds_read_b128 a[120:123], v88 offset:576
    v_cvt_pk_bf16_f32 v118, s64, v170
    v_mfma_f32_16x16x32_bf16 v[204:207], a[44:47], a[0:3], v[204:207]
    buffer_store_dwordx4 v[104:107], v15, s[16:19], s12 offen offset:2048 sc1
    v_mfma_f32_16x16x32_bf16 v[208:211], a[48:51], a[0:3], v[208:211]
    ds_read_b128 a[124:127], v88 offset:64
    v_cvt_pk_bf16_f32 v119, s64, v171
    v_mfma_f32_16x16x32_bf16 v[212:215], a[52:55], a[0:3], v[212:215]
    ds_read2_b32 a[64:65], v84 offset0:16 offset1:17
    v_cvt_pk_bf16_f32 v122, s64, v172
    v_mfma_f32_16x16x32_bf16 v[216:219], a[56:59], a[0:3], v[216:219]
    buffer_store_dwordx4 v[108:111], v15, s[16:19], s12 offen offset:2304 sc1
    v_mfma_f32_16x16x32_bf16 v[220:223], a[60:63], a[0:3], v[220:223]
    ds_read2_b32 a[66:67], v84 offset0:18 offset1:19
    v_cvt_pk_bf16_f32 v123, s64, v173
    v_mfma_f32_16x16x32_bf16 v[196:199], a[32:35], a[4:7], v[196:199]
    ds_read2_b32 a[68:69], v84 offset0:144 offset1:145
    v_cvt_pk_bf16_f32 v126, s64, v174
    v_mfma_f32_16x16x32_bf16 v[200:203], a[36:39], a[4:7], v[200:203]
    buffer_store_dwordx4 v[112:115], v15, s[16:19], s13 offen offset:0 sc1
    v_mfma_f32_16x16x32_bf16 v[204:207], a[40:43], a[4:7], v[204:207]
    ds_read2_b32 a[70:71], v84 offset0:146 offset1:147
    v_cvt_pk_bf16_f32 v127, s64, v175
    v_mfma_f32_16x16x32_bf16 v[208:211], a[44:47], a[4:7], v[208:211]
    ds_read2_b32 a[72:73], v85 offset0:16 offset1:17
    v_cvt_pk_bf16_f32 v130, s64, v176
    v_mfma_f32_16x16x32_bf16 v[212:215], a[48:51], a[4:7], v[212:215]
    buffer_store_dwordx4 v[116:119], v15, s[16:19], s13 offen offset:256 sc1
    v_mfma_f32_16x16x32_bf16 v[216:219], a[52:55], a[4:7], v[216:219]
    ds_read2_b32 a[74:75], v85 offset0:18 offset1:19
    v_cvt_pk_bf16_f32 v131, s64, v177
    v_mfma_f32_16x16x32_bf16 v[220:223], a[56:59], a[4:7], v[220:223]
    ds_read2_b32 a[76:77], v85 offset0:144 offset1:145
    v_cvt_pk_bf16_f32 v134, s64, v178
    v_mfma_f32_16x16x32_bf16 v[200:203], a[32:35], a[8:11], v[200:203]
    buffer_store_dwordx4 v[120:123], v15, s[16:19], s13 offen offset:2048 sc1
    v_mfma_f32_16x16x32_bf16 v[204:207], a[36:39], a[8:11], v[204:207]
    ds_read2_b32 a[78:79], v85 offset0:146 offset1:147
    v_cvt_pk_bf16_f32 v135, s64, v179
    v_mfma_f32_16x16x32_bf16 v[208:211], a[40:43], a[8:11], v[208:211]
    ds_read2_b32 a[80:81], v86 offset0:16 offset1:17
    v_cvt_pk_bf16_f32 v138, s64, v180
    v_mfma_f32_16x16x32_bf16 v[212:215], a[44:47], a[8:11], v[212:215]
    buffer_store_dwordx4 v[124:127], v15, s[16:19], s13 offen offset:2304 sc1
    v_mfma_f32_16x16x32_bf16 v[216:219], a[48:51], a[8:11], v[216:219]
    ds_read2_b32 a[82:83], v86 offset0:18 offset1:19
    v_cvt_pk_bf16_f32 v139, s64, v181
    v_mfma_f32_16x16x32_bf16 v[220:223], a[52:55], a[8:11], v[220:223]
    ds_read2_b32 a[84:85], v86 offset0:144 offset1:145
    v_cvt_pk_bf16_f32 v142, s64, v182
    v_mfma_f32_16x16x32_bf16 v[204:207], a[32:35], a[12:15], v[204:207]
    buffer_store_dwordx4 v[128:131], v15, s[16:19], s14 offen offset:0 sc1
    v_mfma_f32_16x16x32_bf16 v[208:211], a[36:39], a[12:15], v[208:211]
    ds_read2_b32 a[86:87], v86 offset0:146 offset1:147
    v_cvt_pk_bf16_f32 v143, s64, v183
    v_mfma_f32_16x16x32_bf16 v[212:215], a[40:43], a[12:15], v[212:215]
    ds_read2_b32 a[88:89], v87 offset0:16 offset1:17
    v_cvt_pk_bf16_f32 v146, s64, v184
    v_mfma_f32_16x16x32_bf16 v[216:219], a[44:47], a[12:15], v[216:219]
    buffer_store_dwordx4 v[132:135], v15, s[16:19], s14 offen offset:256 sc1
    v_mfma_f32_16x16x32_bf16 v[220:223], a[48:51], a[12:15], v[220:223]
    ds_read2_b32 a[90:91], v87 offset0:18 offset1:19
    v_cvt_pk_bf16_f32 v147, s64, v185
    v_mfma_f32_16x16x32_bf16 v[208:211], a[32:35], a[16:19], v[208:211]
    ds_read2_b32 a[92:93], v87 offset0:144 offset1:145
    v_cvt_pk_bf16_f32 v150, s64, v186
    v_mfma_f32_16x16x32_bf16 v[212:215], a[36:39], a[16:19], v[212:215]
    buffer_store_dwordx4 v[136:139], v15, s[16:19], s14 offen offset:2048 sc1
    v_mfma_f32_16x16x32_bf16 v[216:219], a[40:43], a[16:19], v[216:219]
    ds_read2_b32 a[94:95], v87 offset0:146 offset1:147
    v_cvt_pk_bf16_f32 v151, s64, v187
    v_mfma_f32_16x16x32_bf16 v[220:223], a[44:47], a[16:19], v[220:223]
    buffer_store_dwordx4 v[140:143], v15, s[16:19], s14 offen offset:2304 sc1
    v_mfma_f32_16x16x32_bf16 v[212:215], a[32:35], a[20:23], v[212:215]
    buffer_store_dwordx4 v[144:147], v15, s[16:19], s15 offen offset:0 sc1
    v_mfma_f32_16x16x32_bf16 v[216:219], a[36:39], a[20:23], v[216:219]
    buffer_store_dwordx4 v[148:151], v15, s[16:19], s15 offen offset:256 sc1
    v_mfma_f32_16x16x32_bf16 v[220:223], a[40:43], a[20:23], v[220:223]
    v_cvt_pk_bf16_f32 v154, s64, v188
    v_cvt_pk_bf16_f32 v155, s64, v189
    v_mfma_f32_16x16x32_bf16 v[216:219], a[32:35], a[24:27], v[216:219]
    v_cvt_pk_bf16_f32 v158, s64, v190
    v_cvt_pk_bf16_f32 v159, s64, v191
    v_mfma_f32_16x16x32_bf16 v[220:223], a[36:39], a[24:27], v[220:223]
    buffer_store_dwordx4 v[152:155], v15, s[16:19], s15 offen offset:2048 sc1
    v_mfma_f32_16x16x32_bf16 v[220:223], a[32:35], a[28:31], v[220:223]
    buffer_store_dwordx4 v[156:159], v15, s[16:19], s15 offen offset:2304 sc1
    s_waitcnt lgkmcnt(0)
    v_mfma_f32_16x16x32_bf16 v[192:195], a[96:99], a[64:67], v[192:195]
    v_mfma_f32_16x16x32_bf16 v[196:199], a[100:103], a[64:67], v[196:199]
    v_mfma_f32_16x16x32_bf16 v[200:203], a[104:107], a[64:67], v[200:203]
    v_mfma_f32_16x16x32_bf16 v[204:207], a[108:111], a[64:67], v[204:207]
    v_mfma_f32_16x16x32_bf16 v[208:211], a[112:115], a[64:67], v[208:211]
    v_mfma_f32_16x16x32_bf16 v[212:215], a[116:119], a[64:67], v[212:215]
    v_mfma_f32_16x16x32_bf16 v[216:219], a[120:123], a[64:67], v[216:219]
    v_mfma_f32_16x16x32_bf16 v[220:223], a[124:127], a[64:67], v[220:223]
    v_mfma_f32_16x16x32_bf16 v[196:199], a[96:99], a[68:71], v[196:199]
    v_mfma_f32_16x16x32_bf16 v[200:203], a[100:103], a[68:71], v[200:203]
    v_mfma_f32_16x16x32_bf16 v[204:207], a[104:107], a[68:71], v[204:207]
    v_mfma_f32_16x16x32_bf16 v[208:211], a[108:111], a[68:71], v[208:211]
    v_mfma_f32_16x16x32_bf16 v[212:215], a[112:115], a[68:71], v[212:215]
    v_mfma_f32_16x16x32_bf16 v[216:219], a[116:119], a[68:71], v[216:219]
    v_mfma_f32_16x16x32_bf16 v[220:223], a[120:123], a[68:71], v[220:223]
    v_mfma_f32_16x16x32_bf16 v[200:203], a[96:99], a[72:75], v[200:203]
    v_mfma_f32_16x16x32_bf16 v[204:207], a[100:103], a[72:75], v[204:207]
    v_mfma_f32_16x16x32_bf16 v[208:211], a[104:107], a[72:75], v[208:211]
    v_mfma_f32_16x16x32_bf16 v[212:215], a[108:111], a[72:75], v[212:215]
    v_mfma_f32_16x16x32_bf16 v[216:219], a[112:115], a[72:75], v[216:219]
    v_mfma_f32_16x16x32_bf16 v[220:223], a[116:119], a[72:75], v[220:223]
    v_mfma_f32_16x16x32_bf16 v[204:207], a[96:99], a[76:79], v[204:207]
    v_mfma_f32_16x16x32_bf16 v[208:211], a[100:103], a[76:79], v[208:211]
    v_mfma_f32_16x16x32_bf16 v[212:215], a[104:107], a[76:79], v[212:215]
    v_mfma_f32_16x16x32_bf16 v[216:219], a[108:111], a[76:79], v[216:219]
    v_mfma_f32_16x16x32_bf16 v[220:223], a[112:115], a[76:79], v[220:223]
    v_mfma_f32_16x16x32_bf16 v[208:211], a[96:99], a[80:83], v[208:211]
    v_mfma_f32_16x16x32_bf16 v[212:215], a[100:103], a[80:83], v[212:215]
    v_mfma_f32_16x16x32_bf16 v[216:219], a[104:107], a[80:83], v[216:219]
    v_mfma_f32_16x16x32_bf16 v[220:223], a[108:111], a[80:83], v[220:223]
    v_mfma_f32_16x16x32_bf16 v[212:215], a[96:99], a[84:87], v[212:215]
    v_mfma_f32_16x16x32_bf16 v[216:219], a[100:103], a[84:87], v[216:219]
    v_mfma_f32_16x16x32_bf16 v[220:223], a[104:107], a[84:87], v[220:223]
    v_mfma_f32_16x16x32_bf16 v[216:219], a[96:99], a[88:91], v[216:219]
    v_mfma_f32_16x16x32_bf16 v[220:223], a[100:103], a[88:91], v[220:223]
    v_mfma_f32_16x16x32_bf16 v[220:223], a[96:99], a[92:95], v[220:223]
    s_lshl_b32 s36, s32, 13
    s_add_u32 s36, s36, 116352
    v_add_u32 v19, s36, v11
    ds_write_b128 v19, v[192:195] offset:0
    ds_write_b128 v19, v[196:199] offset:1024
    ds_write_b128 v19, v[200:203] offset:2048
    ds_write_b128 v19, v[204:207] offset:3072
    ds_write_b128 v19, v[208:211] offset:4096
    ds_write_b128 v19, v[212:215] offset:5120
    ds_write_b128 v19, v[216:219] offset:6144
    ds_write_b128 v19, v[220:223] offset:7168
    s_lshl_b32 s36, s32, 11
    s_add_u32 s37, s36, 116352
    v_add_u32 v19, s37, v11
    s_add_u32 s37, s94, 512
    s_lshl_b32 s37, s37, 13
    s_add_u32 s36, s36, s37
    s_add_u32 s45, s36, 7340032
    v_lshrrev_b32 v18, 1, v15
    s_waitcnt lgkmcnt(0)
    s_barrier
    ds_read_b128 v[224:227], v19 offset:0
    ds_read_b128 v[228:231], v19 offset:1024
    ds_read_b128 v[232:235], v19 offset:8192
    ds_read_b128 v[236:239], v19 offset:9216
    ds_read_b128 v[240:243], v19 offset:16384
    ds_read_b128 v[244:247], v19 offset:17408
    ds_read_b128 v[248:251], v19 offset:24576
    ds_read_b128 v[252:255], v19 offset:25600
    s_waitcnt lgkmcnt(5)
    v_add_f32 v224, v224, v232
    v_add_f32 v225, v225, v233
    v_add_f32 v226, v226, v234
    v_add_f32 v227, v227, v235
    s_waitcnt lgkmcnt(4)
    v_add_f32 v228, v228, v236
    v_add_f32 v229, v229, v237
    v_add_f32 v230, v230, v238
    v_add_f32 v231, v231, v239
    s_waitcnt lgkmcnt(3)
    v_add_f32 v224, v224, v240
    v_add_f32 v225, v225, v241
    v_add_f32 v226, v226, v242
    v_add_f32 v227, v227, v243
    s_waitcnt lgkmcnt(2)
    v_add_f32 v228, v228, v244
    v_add_f32 v229, v229, v245
    v_add_f32 v230, v230, v246
    v_add_f32 v231, v231, v247
    s_waitcnt lgkmcnt(1)
    v_add_f32 v224, v224, v248
    v_add_f32 v225, v225, v249
    v_add_f32 v226, v226, v250
    v_add_f32 v227, v227, v251
    s_waitcnt lgkmcnt(0)
    v_add_f32 v228, v228, v252
    v_add_f32 v229, v229, v253
    v_add_f32 v230, v230, v254
    v_add_f32 v231, v231, v255
    v_cvt_pk_bf16_f32 v224, s64, v224
    v_cvt_pk_bf16_f32 v225, s64, v225
    v_cvt_pk_bf16_f32 v226, s64, v226
    v_cvt_pk_bf16_f32 v227, s64, v227
    v_cvt_pk_bf16_f32 v228, s64, v228
    v_cvt_pk_bf16_f32 v229, s64, v229
    v_cvt_pk_bf16_f32 v230, s64, v230
    v_cvt_pk_bf16_f32 v231, s64, v231
    buffer_store_dwordx2 v[224:225], v18, s[16:19], s45 offen offset:0 sc1
    buffer_store_dwordx2 v[226:227], v18, s[16:19], s45 offen offset:128 sc1
    buffer_store_dwordx2 v[228:229], v18, s[16:19], s45 offen offset:1024 sc1
    buffer_store_dwordx2 v[230:231], v18, s[16:19], s45 offen offset:1152 sc1
    s_endpgm

L_tag:
    s_mov_b32 s36, 360448
    s_buffer_load_dword s37, s[16:19], s36
    s_waitcnt lgkmcnt(0)
    s_add_u32 s37, s37, 1
    s_and_b32 s37, s37, 0x1fff
    s_or_b32 s37, s37, 0x5a5a4000
    v_mov_b32 v47, s37
    v_and_b32 v45, 31, v1
    v_lshlrev_b32 v45, 2, v45
    v_lshl_add_u32 v45, v8, 28, v45
    buffer_store_dword v47, v45, s[80:83], 0 offen offset:0 sc1
    buffer_store_dword v47, v45, s[16:19], s36 offen sc1
    s_branch L_tag_ret

L_q0:
    s_cmp_eq_u32 s101, 128
    s_cbranch_scc1 L_q0b
    s_cmp_eq_u32 s101, 256
    s_cbranch_scc1 L_q0c
    ds_read_b64 v[52:53], v170 offset:0
    ds_read_b64 v[54:55], v170 offset:2048
    s_branch L_qr0
L_q0b:
    ds_read_b64 v[56:57], v170 offset:0
    ds_read_b64 v[58:59], v170 offset:2048
    s_branch L_qr0
L_q0c:
    ds_read_b64 v[48:49], v170 offset:0
    ds_read_b64 v[50:51], v170 offset:2048
    s_branch L_qr0

L_q1:
    s_cmp_eq_u32 s101, 128
    s_cbranch_scc1 L_q1b
    s_cmp_eq_u32 s101, 256
    s_cbranch_scc1 L_q1c
    ds_read_b64 v[52:53], v170 offset:32896
    ds_read_b64 v[54:55], v170 offset:34944
    s_branch L_qr1
L_q1b:
    ds_read_b64 v[56:57], v170 offset:32896
    ds_read_b64 v[58:59], v170 offset:34944
    s_branch L_qr1
L_q1c:
    ds_read_b64 v[48:49], v170 offset:32896
    ds_read_b64 v[50:51], v170 offset:34944
    s_branch L_qr1

L_q2:
    s_cmp_eq_u32 s101, 128
    s_cbranch_scc1 L_q2b
    s_cmp_eq_u32 s101, 256
    s_cbranch_scc1 L_q2c
    ds_read_b64 v[52:53], v171 offset:256
    ds_read_b64 v[54:55], v171 offset:2304
    s_branch L_qr2
L_q2b:
    ds_read_b64 v[56:57], v171 offset:256
    ds_read_b64 v[58:59], v171 offset:2304
    s_branch L_qr2
L_q2c:
    ds_read_b64 v[48:49], v171 offset:256
    ds_read_b64 v[50:51], v171 offset:2304
    s_branch L_qr2

L_q3:
    s_cmp_eq_u32 s101, 128
    s_cbranch_scc1 L_q3b
    s_cmp_eq_u32 s101, 256
    s_cbranch_scc1 L_q3c
    ds_read_b64 v[52:53], v171 offset:33152
    ds_read_b64 v[54:55], v171 offset:35200
    s_branch L_qr3
L_q3b:
    ds_read_b64 v[56:57], v171 offset:33152
    ds_read_b64 v[58:59], v171 offset:35200
    s_branch L_qr3
L_q3c:
    ds_read_b64 v[48:49], v171 offset:33152
    ds_read_b64 v[50:51], v171 offset:35200
    s_branch L_qr3

L_q4:
    s_cmp_eq_u32 s101, 128
    s_cbranch_scc1 L_q4b
    s_cmp_eq_u32 s101, 256
    s_cbranch_scc1 L_q4c
    ds_read_b64 v[52:53], v172 offset:512
    ds_read_b64 v[54:55], v172 offset:2560
    s_branch L_qr4
L_q4b:
    ds_read_b64 v[56:57], v172 offset:512
    ds_read_b64 v[58:59], v172 offset:2560
    s_branch L_qr4
L_q4c:
    ds_read_b64 v[48:49], v172 offset:512
    ds_read_b64 v[50:51], v172 offset:2560
    s_branch L_qr4

L_q5:
    s_cmp_eq_u32 s101, 128
    s_cbranch_scc1 L_q5b
    s_cmp_eq_u32 s101, 256
    s_cbranch_scc1 L_q5c
    ds_read_b64 v[52:53], v170 offset:16512
    ds_read_b64 v[54:55], v170 offset:18560
    s_branch L_qr5
L_q5b:
    ds_read_b64 v[56:57], v170 offset:16512
    ds_read_b64 v[58:59], v170 offset:18560
    s_branch L_qr5
L_q5c:
    ds_read_b64 v[48:49], v170 offset:16512
    ds_read_b64 v[50:51], v170 offset:18560
    s_branch L_qr5

L_q6:
    s_cmp_eq_u32 s101, 128
    s_cbranch_scc1 L_q6b
    s_cmp_eq_u32 s101, 256
    s_cbranch_scc1 L_q6c
    ds_read_b64 v[52:53], v170 offset:49408
    ds_read_b64 v[54:55], v170 offset:51456
    s_branch L_qr6
L_q6b:
    ds_read_b64 v[56:57], v170 offset:49408
    ds_read_b64 v[58:59], v170 offset:51456
    s_branch L_qr6
L_q6c:
    ds_read_b64 v[48:49], v170 offset:49408
    ds_read_b64 v[50:51], v170 offset:51456
    s_branch L_qr6

L_q7:
    s_cmp_eq_u32 s101, 128
    s_cbranch_scc1 L_q7b
    s_cmp_eq_u32 s101, 256
    s_cbranch_scc1 L_q7c
    ds_read_b64 v[52:53], v171 offset:16768
    ds_read_b64 v[54:55], v171 offset:18816
    s_branch L_qr7
L_q7b:
    ds_read_b64 v[56:57], v171 offset:16768
    ds_read_b64 v[58:59], v171 offset:18816
    s_branch L_qr7
L_q7c:
    ds_read_b64 v[48:49], v171 offset:16768
    ds_read_b64 v[50:51], v171 offset:18816
    s_branch L_qr7

L_q8:
    s_cmp_eq_u32 s101, 128
    s_cbranch_scc1 L_q8b
    s_cmp_eq_u32 s101, 256
    s_cbranch_scc1 L_q8c
    ds_read_b64 v[52:53], v171 offset:49664
    ds_read_b64 v[54:55], v171 offset:51712
    s_branch L_qr8
L_q8b:
    ds_read_b64 v[56:57], v171 offset:49664
    ds_read_b64 v[58:59], v171 offset:51712
    s_branch L_qr8
L_q8c:
    ds_read_b64 v[48:49], v171 offset:49664
    ds_read_b64 v[50:51], v171 offset:51712
    s_branch L_qr8

L_slow_tag:
    s_mov_b32 s101, 30000
L_spin_tag:
    s_sleep 8
    buffer_load_dword v16, v61, s[80:83], 0 offen offset:0 sc1
    s_waitcnt vmcnt(0)
    v_cmp_eq_u32 vcc, 0, v16
    s_cbranch_vccz L_ret_tag
    s_sub_u32 s101, s101, 1
    s_cmp_lg_u32 s101, 0
    s_cbranch_scc1 L_spin_tag
    s_branch L_ret_tag

L_slow_mlpF1:
    s_mov_b32 s101, 30000
L_spin_mlpF1:
    s_sleep 8
    buffer_load_dword v16, v10, s[16:19], 0 offen offset:0 sc1
    s_waitcnt vmcnt(0)
    v_cmp_ne_u32 vcc, s66, v16
    s_cbranch_vccz L_ret_mlpF1
    s_sub_u32 s101, s101, 1
    s_cmp_lg_u32 s101, 0
    s_cbranch_scc1 L_spin_mlpF1
    s_branch L_ret_mlpF1

L_slow_mlpF1b:
    s_mov_b32 s101, 30000
L_spin_mlpF1b:
    s_sleep 8
    buffer_load_dword v16, v10, s[16:19], 0 offen offset:640 sc1
    s_waitcnt vmcnt(0)
    v_cmp_ne_u32 vcc, s66, v16
    s_cbranch_vccz L_ret_mlpF1b
    s_sub_u32 s101, s101, 1
    s_cmp_lg_u32 s101, 0
    s_cbranch_scc1 L_spin_mlpF1b
    s_branch L_ret_mlpF1b

L_slow_mlpF2:
    s_mov_b32 s101, 30000
L_spin_mlpF2:
    s_sleep 8
    buffer_load_dword v16, v15, s[16:19], 0 offen offset:128 sc1
    s_waitcnt vmcnt(0)
    v_cmp_ne_u32 vcc, s66, v16
    s_cbranch_vccz L_ret_mlpF2
    s_sub_u32 s101, s101, 1
    s_cmp_lg_u32 s101, 0
    s_cbranch_scc1 L_spin_mlpF2
    s_branch L_ret_mlpF2

L_slow_mlpF3:
    s_mov_b32 s101, 30000
L_spin_mlpF3:
    s_sleep 8
    buffer_load_dword v16, v15, s[16:19], 0 offen offset:256 sc1
    s_waitcnt vmcnt(0)
    v_cmp_ne_u32 vcc, s66, v16
    s_cbranch_vccz L_ret_mlpF3
    s_sub_u32 s101, s101, 1
    s_cmp_lg_u32 s101, 0
    s_cbranch_scc1 L_spin_mlpF3
    s_branch L_ret_mlpF3

L_retry_ya:
    s_sub_u32 s101, s101, 1
    s_cmp_lt_i32 s101, 0
    s_cbranch_scc1 L_ok_ya
    s_sleep 16
    buffer_load_dword v120, v126, s[16:19], 0 offen offset:0 sc1
    buffer_load_dword v121, v126, s[16:19], 0 offen offset:256 sc1
    buffer_load_dwordx4 v[96:99], v125, s[16:19], s57 offen sc1
    buffer_load_dwordx4 v[100:103], v125, s[16:19], s58 offen sc1
    buffer_load_dwordx4 v[104:107], v125, s[16:19], s59 offen sc1
    buffer_load_dwordx4 v[108:111], v125, s[16:19], s60 offen sc1
    buffer_load_dwordx2 v[112:113], v154, s[16:19], s61 offen sc1
    buffer_load_dwordx2 v[114:115], v154, s[16:19], s55 offen sc1
    buffer_load_dwordx2 v[116:117], v154, s[16:19], s62 offen sc1
    buffer_load_dwordx2 v[118:119], v154, s[16:19], s56 offen sc1
    s_waitcnt vmcnt(0)
    s_branch L_chk_ya

L_retry_p1:
    s_sub_u32 s101, s101, 1
    s_cmp_lt_i32 s101, 0
    s_cbranch_scc1 L_ok_p1
    s_sleep 4
    buffer_load_dwordx4 v[172:175], v127, s[16:19], 0 offen offset:0 sc1
    buffer_load_dwordx4 v[204:207], v127, s[16:19], 0 offen offset:1024 sc1
    buffer_load_dwordx4 v[76:79], v127, s[16:19], 0 offen offset:2048 sc1
    buffer_load_dwordx4 v[52:55], v127, s[16:19], 0 offen offset:3072 sc1
    buffer_load_dwordx4 v[180:183], v127, s[16:19], s63 offen offset:0 sc1
    buffer_load_dwordx4 v[212:215], v127, s[16:19], s63 offen offset:1024 sc1
    buffer_load_dwordx4 v[84:87], v127, s[16:19], s63 offen offset:2048 sc1
    buffer_load_dwordx4 v[56:59], v127, s[16:19], s63 offen offset:3072 sc1
    buffer_load_dwordx4 v[188:191], v127, s[16:19], s64 offen offset:0 sc1
    buffer_load_dwordx4 v[220:223], v127, s[16:19], s64 offen offset:1024 sc1
    buffer_load_dwordx4 v[92:95], v127, s[16:19], s64 offen offset:2048 sc1
    buffer_load_dwordx4 v[60:63], v127, s[16:19], s64 offen offset:3072 sc1
    s_waitcnt vmcnt(0)
    s_branch L_chk_p1

L_retry_p2:
    s_sub_u32 s101, s101, 1
    s_cmp_lt_i32 s101, 0
    s_cbranch_scc1 L_ok_p2
    s_sleep 4
    buffer_load_dwordx4 v[180:183], v127, s[16:19], s63 offen offset:0 sc1
    buffer_load_dwordx4 v[212:215], v127, s[16:19], s63 offen offset:1024 sc1
    buffer_load_dwordx4 v[84:87], v127, s[16:19], s63 offen offset:2048 sc1
    buffer_load_dwordx4 v[56:59], v127, s[16:19], s63 offen offset:3072 sc1
    buffer_load_dwordx4 v[188:191], v127, s[16:19], s64 offen offset:0 sc1
    buffer_load_dwordx4 v[220:223], v127, s[16:19], s64 offen offset:1024 sc1
    buffer_load_dwordx4 v[92:95], v127, s[16:19], s64 offen offset:2048 sc1
    buffer_load_dwordx4 v[60:63], v127, s[16:19], s64 offen offset:3072 sc1
    s_waitcnt vmcnt(0)
    s_branch L_chk_p2

L_retry_p3:
    s_sub_u32 s101, s101, 1
    s_cmp_lt_i32 s101, 0
    s_cbranch_scc1 L_ok_p3
    s_sleep 4
    buffer_load_dwordx4 v[188:191], v127, s[16:19], s64 offen offset:0 sc1
    buffer_load_dwordx4 v[220:223], v127, s[16:19], s64 offen offset:1024 sc1
    buffer_load_dwordx4 v[92:95], v127, s[16:19], s64 offen offset:2048 sc1
    buffer_load_dwordx4 v[60:63], v127, s[16:19], s64 offen offset:3072 sc1
    s_waitcnt vmcnt(0)
    s_branch L_chk_p3

L_slow_convA:
    s_mov_b32 s101, 30000
L_spin_convA:
    s_sleep 8
    buffer_load_dword v16, v60, s[16:19], 0 offen offset:512 sc1
    s_waitcnt vmcnt(0)
    v_cmp_ne_u32 vcc, s66, v16
    s_cbranch_vccz L_ret_convA
    s_sub_u32 s101, s101, 1
    s_cmp_lg_u32 s101, 0
    s_cbranch_scc1 L_spin_convA
    s_branch L_ret_convA
L_g1:
    v_mfma_f32_16x16x32_bf16 v[32:35], v[96:99], a[4:7], 0
    v_mfma_f32_16x16x32_bf16 v[32:35], v[100:103], a[20:23], v[32:35]
    v_mfma_f32_16x16x32_bf16 v[32:35], v[104:107], a[36:39], v[32:35]
    v_mfma_f32_16x16x32_bf16 v[32:35], v[108:111], a[52:55], v[32:35]
    v_mfma_f32_16x16x32_bf16 v[32:35], v[112:115], a[68:71], v[32:35]
    v_mfma_f32_16x16x32_bf16 v[32:35], v[116:119], a[84:87], v[32:35]
    v_mfma_f32_16x16x32_bf16 v[32:35], v[120:123], a[100:103], v[32:35]
    v_mfma_f32_16x16x32_bf16 v[32:35], v[124:127], a[116:119], v[32:35]
    v_mfma_f32_16x16x32_bf16 v[32:35], v[128:131], a[132:135], v[32:35]
    v_mfma_f32_16x16x32_bf16 v[32:35], v[132:135], a[148:151], v[32:35]
    v_mfma_f32_16x16x32_bf16 v[32:35], v[136:139], a[164:167], v[32:35]
    v_mfma_f32_16x16x32_bf16 v[32:35], v[140:143], a[180:183], v[32:35]
    v_mfma_f32_16x16x32_bf16 v[32:35], v[144:147], a[196:199], v[32:35]
    v_mfma_f32_16x16x32_bf16 v[32:35], v[148:151], a[212:215], v[32:35]
    v_mfma_f32_16x16x32_bf16 v[32:35], v[152:155], a[228:231], v[32:35]
    v_mfma_f32_16x16x32_bf16 v[32:35], v[156:159], a[244:247], v[32:35]
    v_mfma_f32_16x16x32_bf16 v[32:35], v[20:23], v[228:231], v[32:35]
    v_mfma_f32_16x16x32_bf16 v[32:35], v[24:27], v[244:247], v[32:35]
    s_branch L_gdone
L_g23:
    s_cmp_eq_u32 s41, 2
    s_cbranch_scc0 L_g3
    v_mfma_f32_16x16x32_bf16 v[32:35], v[96:99], a[8:11], 0
    v_mfma_f32_16x16x32_bf16 v[32:35], v[100:103], a[24:27], v[32:35]
    v_mfma_f32_16x16x32_bf16 v[32:35], v[104:107], a[40:43], v[32:35]
    v_mfma_f32_16x16x32_bf16 v[32:35], v[108:111], a[56:59], v[32:35]
    v_mfma_f32_16x16x32_bf16 v[32:35], v[112:115], a[72:75], v[32:35]
    v_mfma_f32_16x16x32_bf16 v[32:35], v[116:119], a[88:91], v[32:35]
    v_mfma_f32_16x16x32_bf16 v[32:35], v[120:123], a[104:107], v[32:35]
    v_mfma_f32_16x16x32_bf16 v[32:35], v[124:127], a[120:123], v[32:35]
    v_mfma_f32_16x16x32_bf16 v[32:35], v[128:131], a[136:139], v[32:35]
    v_mfma_f32_16x16x32_bf16 v[32:35], v[132:135], a[152:155], v[32:35]
    v_mfma_f32_16x16x32_bf16 v[32:35], v[136:139], a[168:171], v[32:35]
    v_mfma_f32_16x16x32_bf16 v[32:35], v[140:143], a[184:187], v[32:35]
    v_mfma_f32_16x16x32_bf16 v[32:35], v[144:147], a[200:203], v[32:35]
    v_mfma_f32_16x16x32_bf16 v[32:35], v[148:151], a[216:219], v[32:35]
    v_mfma_f32_16x16x32_bf16 v[32:35], v[152:155], a[232:235], v[32:35]
    v_mfma_f32_16x16x32_bf16 v[32:35], v[156:159], a[248:251], v[32:35]
    v_mfma_f32_16x16x32_bf16 v[32:35], v[20:23], v[232:235], v[32:35]
    v_mfma_f32_16x16x32_bf16 v[32:35], v[24:27], v[248:251], v[32:35]
    s_branch L_gdone
L_g3:
    v_mfma_f32_16x16x32_bf16 v[32:35], v[96:99], a[12:15], 0
    v_mfma_f32_16x16x32_bf16 v[32:35], v[100:103], a[28:31], v[32:35]
    v_mfma_f32_16x16x32_bf16 v[32:35], v[104:107], a[44:47], v[32:35]
    v_mfma_f32_16x16x32_bf16 v[32:35], v[108:111], a[60:63], v[32:35]
    v_mfma_f32_16x16x32_bf16 v[32:35], v[112:115], a[76:79], v[32:35]
    v_mfma_f32_16x16x32_bf16 v[32:35], v[116:119], a[92:95], v[32:35]
    v_mfma_f32_16x16x32_bf16 v[32:35], v[120:123], a[108:111], v[32:35]
    v_mfma_f32_16x16x32_bf16 v[32:35], v[124:127], a[124:127], v[32:35]
    v_mfma_f32_16x16x32_bf16 v[32:35], v[128:131], a[140:143], v[32:35]
    v_mfma_f32_16x16x32_bf16 v[32:35], v[132:135], a[156:159], v[32:35]
    v_mfma_f32_16x16x32_bf16 v[32:35], v[136:139], a[172:175], v[32:35]
    v_mfma_f32_16x16x32_bf16 v[32:35], v[140:143], a[188:191], v[32:35]
    v_mfma_f32_16x16x32_bf16 v[32:35], v[144:147], a[204:207], v[32:35]
    v_mfma_f32_16x16x32_bf16 v[32:35], v[148:151], a[220:223], v[32:35]
    v_mfma_f32_16x16x32_bf16 v[32:35], v[152:155], a[236:239], v[32:35]
    v_mfma_f32_16x16x32_bf16 v[32:35], v[156:159], a[252:255], v[32:35]
    v_mfma_f32_16x16x32_bf16 v[32:35], v[20:23], v[236:239], v[32:35]
    v_mfma_f32_16x16x32_bf16 v[32:35], v[24:27], v[252:255], v[32:35]
    s_branch L_gdone

L_slow_convB:
    s_mov_b32 s101, 30000
L_spin_convB:
    s_sleep 8
    buffer_load_dword v16, v60, s[16:19], 0 offen offset:0 sc1
    s_waitcnt vmcnt(0)
    v_cmp_ne_u32 vcc, s66, v16
    s_cbranch_vccz L_ret_convB
    s_sub_u32 s101, s101, 1
    s_cmp_lg_u32 s101, 0
    s_cbranch_scc1 L_spin_convB
    s_branch L_ret_convB
L_end:
    s_endpgm
L_code_end:
.section .rodata,"a"
.p2align 6
.amdhsa_kernel gated_mix__ssm_conv_h3__glu_gated_glu__prompt_kernel
  .amdhsa_next_free_vgpr 512
  .amdhsa_next_free_sgpr 102
  .amdhsa_accum_offset 256
  .amdhsa_group_segment_fixed_size 0
  .amdhsa_kernarg_size 112
  .amdhsa_user_sgpr_count 2
  .amdhsa_user_sgpr_kernarg_segment_ptr 1
  .amdhsa_system_sgpr_workgroup_id_x 1
.end_amdhsa_kernel
```
